```python
import torch

def _softmax(x, axis=-1):
    return torch.softmax(x, dim=axis)
def _gelu(x):
    return torch.nn.functional.gelu(x, approximate="tanh")
def _silu(x):
    return torch.nn.functional.silu(x)
def _sigmoid(x):
    return torch.sigmoid(x)
def _layernorm(x, axis=-1, eps=1e-5):
    m = x.mean(dim=axis, keepdim=True)
    v = x.var(dim=axis, keepdim=True, unbiased=False)
    return (x - m) / torch.sqrt(v + eps)
def _scatter_add(tgt, idx, src, axis=0):
    return tgt.clone().index_add_(axis, idx, src)
def _segment_sum(src, seg, n):
    out = torch.zeros((n,) + src.shape[1:], dtype=src.dtype)
    return out.index_add_(0, seg, src)
def _pad(x, pw):
    flat = tuple(v for pair in reversed(pw) for v in pair)
    return torch.nn.functional.pad(x, flat)

kernel_name = 'recurrent_scan__linear_kernel_hedgehog__dense_activation_mish__prompt'

def setup_inputs():

    _w = (lambda a: (lambda t: t.to(torch.bfloat16) if t.is_floating_point() else t)(torch.as_tensor(a)))
    def _A_setup():
        B, S, D, H = 1, 2048, 576, 32
        Dh = D // H
        return {
            "x": _w((lambda *s: torch.randn(*s, dtype=torch.bfloat16) * 0.05)(B, S, D)),
            "wqkv": _w((lambda *s: torch.randn(*s, dtype=torch.bfloat16) * 0.4)(D, 3 * D)),
            "w_phi": _w((lambda *s: torch.randn(*s, dtype=torch.bfloat16) * 0.4)(H, Dh, Dh) * (Dh ** -0.5)),
            "wo": _w((lambda *s: torch.randn(*s, dtype=torch.bfloat16) * 0.2)(D, D)),
        }
    _A_in = _A_setup()

    def _B_setup():
        B, S, D, F = 1, 2048, 576, 4608
        return {
            "x": _w((lambda *s: torch.randn(*s, dtype=torch.bfloat16) * 0.05)(B, S, D)),
            "w1": _w((lambda *s: torch.randn(*s, dtype=torch.bfloat16) * 0.4)(D, F) * (D ** -0.5)),
            "b1": _w((lambda *s: torch.randn(*s, dtype=torch.bfloat16) * 0.4)(F)),
            "w2": _w((lambda *s: torch.randn(*s, dtype=torch.bfloat16) * 0.1)(F, D) * (F ** -0.5)),
        }
    _B_in = _B_setup()

    return {
        "A_x": _A_in["x"],
        "A_wqkv": _A_in["wqkv"],
        "A_w_phi": _A_in["w_phi"],
        "A_wo": _A_in["wo"],
        "B_x": _B_in["x"],
        "B_w1": _B_in["w1"],
        "B_b1": _B_in["b1"],
        "B_w2": _B_in["w2"],
    }

def reference(A_x, A_wqkv, A_w_phi, A_wo, B_x, B_w1, B_b1, B_w2):
    def _A_ref(x, wqkv, w_phi, wo):
        B, S, D = x.shape
        H = 32; Dh = D // H
        qkv = (lambda x, *d: x.permute(*d))((x @ wqkv).reshape(B, S, 3, H, Dh), 2, 0, 3, 1, 4)
        q, k, v = qkv[0], qkv[1], qkv[2]
        pq = torch.einsum("bhsd,hdf->bhsf", q, w_phi)
        pk = torch.einsum("bhsd,hdf->bhsf", k, w_phi)
        phi_q = torch.concatenate([_softmax(pq, axis=-1), _softmax(-pq, axis=-1)], axis=-1)
        phi_k = torch.concatenate([_softmax(pk, axis=-1), _softmax(-pk, axis=-1)], axis=-1)
        kv = torch.einsum("bhsf,bhsd->bhfd", phi_k, v)
        z  = torch.einsum("bhsf->bhf", phi_k)
        num = torch.einsum("bhqf,bhfd->bhqd", phi_q, kv)
        den = torch.einsum("bhqf,bhf->bhq", phi_q, z)[..., None] + 1e-6
        o = num / den
        return (lambda x, *d: x.permute(*d))(o, 0, 2, 1, 3).reshape(B, S, D) @ wo

    def _B_ref(x, w1, b1, w2):
        h = torch.einsum("bsd,df->bsf", x, w1) + b1
        sp = torch.log1p(torch.exp(-torch.abs(h))) + torch.where(h > 0, h, torch.zeros_like(h))
        act = h * torch.tanh(sp)
        return torch.einsum("bsf,fd->bsd", act, w2)

    x = A_x
    xn = _layernorm(x, axis=-1)
    s = _A_ref(xn, A_wqkv, A_w_phi, A_wo)
    g = _silu(_B_ref(xn, B_w1, B_b1, B_w2))
    return x + s * g
```

```asm
; @launch grid=(256,1,1) block=(256,1,1) lds=163840
.amdgcn_target "amdgcn-amd-amdhsa--gfx950"
.text
.p2align 12
.globl recurrent_scan__linear_kernel_hedgehog__dense_activation_mish__prompt_kernel
.p2align 8
.type recurrent_scan__linear_kernel_hedgehog__dense_activation_mish__prompt_kernel,@function
recurrent_scan__linear_kernel_hedgehog__dense_activation_mish__prompt_kernel:
    s_cmp_ge_u32 s2, 256
    s_cbranch_scc1 L1_done
    s_load_dwordx16 s[64:79], s[0:1], 0
    s_load_dwordx4 s[80:83], s[0:1], 64
    s_load_dwordx2 s[84:85], s[0:1], 80
    v_and_b32 v240, 63, v0
    v_lshrrev_b32 v241, 6, v0
    v_mov_b32 v239, v0
    s_lshr_b32 s7, s2, 6
    s_bfe_u32 s6, s2, 0x30003
    v_readfirstlane_b32 s3, v241
    s_cmp_eq_u32 s7, 0
    s_cselect_b32 s52, 0, L1_mlp-L1_pc
    s_mov_b32 s53, L1_end-L1_pc-4
    s_getpc_b64 s[4:5]
L1_pc:
    s_lshl_b32 s39, s6, 13
    s_add_u32 s52, s52, s39
    v_lshrrev_b32 v251, 2, v239
    v_lshl_add_u32 v251, v251, 7, s52
    v_min_u32 v250, s53, v251
    global_load_dword v238, v250, s[4:5]
    s_and_b32 s32, s2, 1
    s_lshl_b32 s32, s32, 3
    s_add_u32 s32, s32, s6
    s_bfe_u32 s33, s2, 0x20001
    v_lshrrev_b32 v242, 3, v240
    v_and_b32 v243, 7, v240
    v_lshrrev_b32 v244, 1, v242
    v_xor_b32 v243, v243, v244
    v_mul_u32_u24 v244, 1152, v242
    v_lshl_add_u32 v244, v243, 4, v244
    s_lshl_b32 s35, s32, 2
    s_add_u32 s35, s35, s3
    s_mul_i32 s5, s35, 36864
    v_add_u32 v244, s5, v244
    v_xor_b32 v245, 64, v244
    v_add_u32 v245, 8192, v245
    v_add_u32 v246, 16384, v244
    v_add_u32 v247, 16384, v245
    s_lshl_b32 s36, s3, 14
    s_add_u32 s36, s36, 81920
    s_sub_u32 s55, s7, 1
    s_mul_i32 s52, s55, 384
    s_lshl_b32 s4, s6, 7
    s_cmp_eq_u32 s7, 0
    s_cselect_b32 s52, s4, s52
    s_waitcnt lgkmcnt(0)
    s_mov_b32 s8, s64
    s_and_b32 s9, s65, 0xffff
    s_mov_b32 s10, 2359296
    s_mov_b32 s11, 0x20000
    s_add_u32 m0, s36, 0
    s_nop 0
    buffer_load_dwordx4 v244, s[8:11], s52 offen offset:0 lds
    buffer_load_dwordx4 v245, s[8:11], s52 offen offset:1024 lds
    buffer_load_dwordx4 v246, s[8:11], s52 offen offset:2048 lds
    buffer_load_dwordx4 v247, s[8:11], s52 offen offset:3072 lds
    s_add_u32 m0, s36, 4096
    s_add_u32 s52, s52, 128
    s_cmp_eq_u32 s52, 1152
    s_cselect_b32 s52, 0, s52
    buffer_load_dwordx4 v244, s[8:11], s52 offen offset:0 lds
    v_and_b32 v242, 31, v240
    v_lshrrev_b32 v243, 5, v240
    v_bfe_u32 v248, v242, 1, 3
    v_lshrrev_b32 v249, 3, v242
    v_lshlrev_b32 v249, 10, v249
    v_and_b32 v250, 7, v242
    v_lshl_add_u32 v249, v250, 7, v249
    v_add_u32 v249, s36, v249
    buffer_load_dwordx4 v245, s[8:11], s52 offen offset:1024 lds
    v_add_u32 v250, 0, v243
    v_xor_b32 v250, v250, v248
    v_lshl_add_u32 v252, v250, 4, v249
    v_add_u32 v250, 2, v243
    v_xor_b32 v250, v250, v248
    v_lshl_add_u32 v253, v250, 4, v249
    v_add_u32 v250, 4, v243
    v_xor_b32 v250, v250, v248
    buffer_load_dwordx4 v246, s[8:11], s52 offen offset:2048 lds
    v_lshl_add_u32 v254, v250, 4, v249
    v_add_u32 v250, 6, v243
    v_xor_b32 v250, v250, v248
    v_lshl_add_u32 v255, v250, 4, v249
    v_mov_b32 v219, 0x3f803f80
    v_mov_b32 v220, 0
    v_mov_b32 v221, 0
    v_mov_b32 v222, 0
    buffer_load_dwordx4 v247, s[8:11], s52 offen offset:3072 lds
    v_mov_b32 v223, 0
    s_mov_b32 s24, s84
    s_and_b32 s25, s85, 0xffff
    s_mov_b32 s26, 268435456
    s_mov_b32 s27, 0x20000
    s_cmp_lg_u32 s7, 0
    s_cbranch_scc1 L1_mlp
L1_att:
    s_add_u32 m0, s36, 8192
    s_add_u32 s52, s52, 128
    s_cmp_eq_u32 s52, 1152
    s_cselect_b32 s52, 0, s52
    buffer_load_dwordx4 v244, s[8:11], s52 offen offset:0 lds
    s_mov_b32 s12, s66
    s_and_b32 s13, s67, 0xffff
    s_mov_b32 s14, 1990656
    s_mov_b32 s15, 0x20000
    s_mov_b32 s16, s70
    s_and_b32 s17, s71, 0xffff
    s_mov_b32 s18, 663552
    s_mov_b32 s19, 0x20000
    s_mov_b32 s20, s68
    s_and_b32 s21, s69, 0xffff
    s_mov_b32 s22, 20736
    s_mov_b32 s23, 0x20000
    s_mov_b32 s28, s82
    s_and_b32 s29, s83, 0xffff
    s_mov_b32 s30, 256
    s_mov_b32 s31, 0x20000
    buffer_load_dwordx4 v245, s[8:11], s52 offen offset:1024 lds
    s_lshl_b32 s60, s33, 6
    s_add_u32 s60, s60, 4
    s_mul_i32 s4, s3, 55296
    s_mul_i32 s5, s33, 288
    s_add_u32 s62, s4, s5
    s_mul_i32 s59, s3, 5120
    v_add_u32 v248, 0, v240
    v_mul_u32_u24 v249, 3277, v248
    v_lshrrev_b32 v249, 16, v249
    v_mul_u32_u24 v250, 20, v249
    v_sub_u32 v248, v248, v250
    v_min_u32 v248, 17, v248
    v_mul_u32_u24 v249, 3456, v249
    v_lshl_add_u32 v249, v248, 4, v249
    v_subrev_u32 v249, 0, v249
    v_add_u32 v224, s62, v249
    buffer_load_dwordx4 v246, s[8:11], s52 offen offset:2048 lds
    v_add_u32 v248, 64, v240
    v_mul_u32_u24 v249, 3277, v248
    v_lshrrev_b32 v249, 16, v249
    v_mul_u32_u24 v250, 20, v249
    v_sub_u32 v248, v248, v250
    v_min_u32 v248, 17, v248
    v_mul_u32_u24 v249, 3456, v249
    v_lshl_add_u32 v249, v248, 4, v249
    v_subrev_u32 v249, 1024, v249
    v_add_u32 v225, s62, v249
    v_add_u32 v248, 128, v240
    v_mul_u32_u24 v249, 3277, v248
    v_lshrrev_b32 v249, 16, v249
    v_mul_u32_u24 v250, 20, v249
    v_sub_u32 v248, v248, v250
    v_min_u32 v248, 17, v248
    buffer_load_dwordx4 v247, s[8:11], s52 offen offset:3072 lds
    v_mul_u32_u24 v249, 3456, v249
    v_lshl_add_u32 v249, v248, 4, v249
    v_subrev_u32 v249, 2048, v249
    v_add_u32 v226, s62, v249
    v_add_u32 v248, 192, v240
    v_mul_u32_u24 v249, 3277, v248
    v_lshrrev_b32 v249, 16, v249
    v_mul_u32_u24 v250, 20, v249
    v_sub_u32 v248, v248, v250
    v_min_u32 v248, 17, v248
    v_mul_u32_u24 v249, 3456, v249
    v_lshl_add_u32 v249, v248, 4, v249
    v_subrev_u32 v249, 3072, v249
    v_add_u32 v227, s62, v249
    v_add_u32 v248, 256, v240
    v_mul_u32_u24 v249, 3277, v248
    s_add_u32 m0, s36, 12288
    s_add_u32 s52, s52, 128
    s_cmp_eq_u32 s52, 1152
    s_cselect_b32 s52, 0, s52
    buffer_load_dwordx4 v244, s[8:11], s52 offen offset:0 lds
    v_lshrrev_b32 v249, 16, v249
    v_mul_u32_u24 v250, 20, v249
    v_sub_u32 v248, v248, v250
    v_min_u32 v248, 17, v248
    v_mul_u32_u24 v249, 3456, v249
    v_lshl_add_u32 v249, v248, 4, v249
    v_subrev_u32 v249, 0, v249
    v_add_u32 v228, s62, v249
    v_lshrrev_b32 v241, 5, v240
    v_bfe_u32 v242, v240, 2, 2
    v_bfe_u32 v243, v240, 4, 1
    v_lshlrev_b32 v243, 5, v243
    v_and_b32 v248, 3, v240
    v_lshl_add_u32 v243, v248, 3, v243
    v_lshl_add_u32 v248, v241, 3, v242
    v_mul_u32_u24 v249, 320, v248
    buffer_load_dwordx4 v245, s[8:11], s52 offen offset:1024 lds
    v_add_u32 v249, v249, v243
    v_add_u32 v233, 16384, v249
    v_add_u32 v234, 79872, v249
    v_add_u32 v235, 143360, v249
    s_mul_i32 s4, s6, 221184
    s_mov_b32 s64, s4
    s_add_u32 s65, s64, 221184
    s_cmp_eq_u32 s65, 1990656
    s_cselect_b32 s65, 0, s65
    s_add_u32 s66, s65, 221184
    s_cmp_eq_u32 s66, 1990656
    s_cselect_b32 s66, 0, s66
    s_add_u32 s67, s66, 221184
    s_cmp_eq_u32 s67, 1990656
    s_cselect_b32 s67, 0, s67
    s_add_u32 s68, s67, 221184
    s_cmp_eq_u32 s68, 1990656
    s_cselect_b32 s68, 0, s68
    s_add_u32 s69, s68, 221184
    s_cmp_eq_u32 s69, 1990656
    s_cselect_b32 s69, 0, s69
    buffer_load_dwordx4 v246, s[8:11], s52 offen offset:2048 lds
    s_add_u32 s70, s69, 221184
    s_cmp_eq_u32 s70, 1990656
    s_cselect_b32 s70, 0, s70
    s_add_u32 s71, s70, 221184
    s_cmp_eq_u32 s71, 1990656
    s_cselect_b32 s71, 0, s71
    s_add_u32 s72, s71, 221184
    s_cmp_eq_u32 s72, 1990656
    s_cselect_b32 s72, 0, s72
    s_mov_b32 s46, 0
    s_mov_b32 s47, -1
    buffer_load_dwordx4 v247, s[8:11], s52 offen offset:3072 lds
    s_waitcnt vmcnt(12)
    ds_read_b128 v[0:3], v252 offset:0
    ds_read_b128 v[4:7], v253 offset:0
    ds_read_b128 v[8:11], v254 offset:0
    ds_read_b128 v[12:15], v255 offset:0
    s_waitcnt lgkmcnt(0)
    s_add_u32 m0, s36, 0
    s_add_u32 s52, s52, 128
    s_cmp_eq_u32 s52, 1152
    s_cselect_b32 s52, 0, s52
    buffer_load_dwordx4 v244, s[8:11], s52 offen offset:0 lds
    v_dot2c_f32_bf16 v220, v0, v219
    v_dot2c_f32_bf16 v222, v0, v0
    v_dot2c_f32_bf16 v221, v1, v219
    v_dot2c_f32_bf16 v223, v1, v1
    v_dot2c_f32_bf16 v220, v2, v219
    buffer_load_dwordx4 v245, s[8:11], s52 offen offset:1024 lds
    v_dot2c_f32_bf16 v222, v2, v2
    v_dot2c_f32_bf16 v221, v3, v219
    v_dot2c_f32_bf16 v223, v3, v3
    v_dot2c_f32_bf16 v220, v4, v219
    v_dot2c_f32_bf16 v222, v4, v4
    buffer_load_dwordx4 v246, s[8:11], s52 offen offset:2048 lds
    v_dot2c_f32_bf16 v221, v5, v219
    v_dot2c_f32_bf16 v223, v5, v5
    v_dot2c_f32_bf16 v220, v6, v219
    v_dot2c_f32_bf16 v222, v6, v6
    v_dot2c_f32_bf16 v221, v7, v219
    buffer_load_dwordx4 v247, s[8:11], s52 offen offset:3072 lds
    v_dot2c_f32_bf16 v223, v7, v7
    v_dot2c_f32_bf16 v220, v8, v219
    v_dot2c_f32_bf16 v222, v8, v8
    v_dot2c_f32_bf16 v221, v9, v219
    v_dot2c_f32_bf16 v223, v9, v9
    s_mov_b32 s54, 0
    s_mov_b64 exec, 0
    s_cmp_eq_u32 s3, 0
    s_cbranch_scc1 L_sa1
    s_cmp_eq_u32 s3, 1
    s_cbranch_scc1 L_sa2
    s_cmp_eq_u32 s3, 2
    s_cbranch_scc1 L_sa3
    s_branch L_sa4
L_reta:
    s_cmp_eq_u32 s54, 1
    s_cbranch_scc1 L_hba1
    s_cmp_eq_u32 s54, 2
    s_cbranch_scc1 L_hba2
L_hba0:
    s_mov_b64 exec, -1
    s_waitcnt vmcnt(12)
    ds_read_b128 v[16:19], v252 offset:4096
    ds_read_b128 v[20:23], v253 offset:4096
    ds_read_b128 v[24:27], v254 offset:4096
    ds_read_b128 v[28:31], v255 offset:4096
    v_dot2c_f32_bf16 v220, v10, v219
    v_dot2c_f32_bf16 v222, v10, v10
    v_dot2c_f32_bf16 v221, v11, v219
    v_dot2c_f32_bf16 v223, v11, v11
    v_dot2c_f32_bf16 v220, v12, v219
    v_dot2c_f32_bf16 v222, v12, v12
    v_dot2c_f32_bf16 v221, v13, v219
    v_dot2c_f32_bf16 v223, v13, v13
    v_dot2c_f32_bf16 v220, v14, v219
    v_dot2c_f32_bf16 v222, v14, v14
    v_dot2c_f32_bf16 v221, v15, v219
    v_dot2c_f32_bf16 v223, v15, v15
    s_waitcnt lgkmcnt(0)
    s_add_u32 m0, s36, 4096
    s_add_u32 s52, s52, 128
    s_cmp_eq_u32 s52, 1152
    s_cselect_b32 s52, 0, s52
    buffer_load_dwordx4 v244, s[8:11], s52 offen offset:0 lds
    v_dot2c_f32_bf16 v220, v16, v219
    v_dot2c_f32_bf16 v222, v16, v16
    v_dot2c_f32_bf16 v221, v17, v219
    v_dot2c_f32_bf16 v223, v17, v17
    v_dot2c_f32_bf16 v220, v18, v219
    buffer_load_dwordx4 v245, s[8:11], s52 offen offset:1024 lds
    v_dot2c_f32_bf16 v222, v18, v18
    v_dot2c_f32_bf16 v221, v19, v219
    v_dot2c_f32_bf16 v223, v19, v19
    v_dot2c_f32_bf16 v220, v20, v219
    v_dot2c_f32_bf16 v222, v20, v20
    buffer_load_dwordx4 v246, s[8:11], s52 offen offset:2048 lds
    v_dot2c_f32_bf16 v221, v21, v219
    v_dot2c_f32_bf16 v223, v21, v21
    v_dot2c_f32_bf16 v220, v22, v219
    v_dot2c_f32_bf16 v222, v22, v22
    v_dot2c_f32_bf16 v221, v23, v219
    buffer_load_dwordx4 v247, s[8:11], s52 offen offset:3072 lds
    v_dot2c_f32_bf16 v223, v23, v23
    v_dot2c_f32_bf16 v220, v24, v219
    v_dot2c_f32_bf16 v222, v24, v24
    v_dot2c_f32_bf16 v221, v25, v219
    v_dot2c_f32_bf16 v223, v25, v25
    s_waitcnt vmcnt(12)
    ds_read_b128 v[32:35], v252 offset:8192
    ds_read_b128 v[36:39], v253 offset:8192
    ds_read_b128 v[40:43], v254 offset:8192
    ds_read_b128 v[44:47], v255 offset:8192
    v_dot2c_f32_bf16 v220, v26, v219
    v_dot2c_f32_bf16 v222, v26, v26
    v_dot2c_f32_bf16 v221, v27, v219
    v_dot2c_f32_bf16 v223, v27, v27
    v_dot2c_f32_bf16 v220, v28, v219
    v_dot2c_f32_bf16 v222, v28, v28
    v_dot2c_f32_bf16 v221, v29, v219
    v_dot2c_f32_bf16 v223, v29, v29
    v_dot2c_f32_bf16 v220, v30, v219
    v_dot2c_f32_bf16 v222, v30, v30
    v_dot2c_f32_bf16 v221, v31, v219
    v_dot2c_f32_bf16 v223, v31, v31
    s_waitcnt lgkmcnt(0)
    s_add_u32 m0, s36, 8192
    s_add_u32 s52, s52, 128
    s_cmp_eq_u32 s52, 1152
    s_cselect_b32 s52, 0, s52
    buffer_load_dwordx4 v244, s[8:11], s52 offen offset:0 lds
    v_dot2c_f32_bf16 v220, v32, v219
    v_dot2c_f32_bf16 v222, v32, v32
    v_dot2c_f32_bf16 v221, v33, v219
    v_dot2c_f32_bf16 v223, v33, v33
    v_dot2c_f32_bf16 v220, v34, v219
    buffer_load_dwordx4 v245, s[8:11], s52 offen offset:1024 lds
    v_dot2c_f32_bf16 v222, v34, v34
    v_dot2c_f32_bf16 v221, v35, v219
    v_dot2c_f32_bf16 v223, v35, v35
    v_dot2c_f32_bf16 v220, v36, v219
    v_dot2c_f32_bf16 v222, v36, v36
    buffer_load_dwordx4 v246, s[8:11], s52 offen offset:2048 lds
    v_dot2c_f32_bf16 v221, v37, v219
    v_dot2c_f32_bf16 v223, v37, v37
    v_dot2c_f32_bf16 v220, v38, v219
    v_dot2c_f32_bf16 v222, v38, v38
    v_dot2c_f32_bf16 v221, v39, v219
    buffer_load_dwordx4 v247, s[8:11], s52 offen offset:3072 lds
    v_dot2c_f32_bf16 v223, v39, v39
    v_dot2c_f32_bf16 v220, v40, v219
    v_dot2c_f32_bf16 v222, v40, v40
    v_dot2c_f32_bf16 v221, v41, v219
    v_dot2c_f32_bf16 v223, v41, v41
    s_mov_b32 s54, 1
    s_mov_b64 exec, 0
    s_cmp_eq_u32 s3, 0
    s_cbranch_scc1 L_sa5
    s_cmp_eq_u32 s3, 1
    s_cbranch_scc1 L_sa6
    s_cmp_eq_u32 s3, 2
    s_cbranch_scc1 L_sa7
    s_branch L_sa8
L_hba1:
    s_mov_b64 exec, -1
    s_waitcnt vmcnt(12)
    ds_read_b128 v[48:51], v252 offset:12288
    ds_read_b128 v[52:55], v253 offset:12288
    ds_read_b128 v[56:59], v254 offset:12288
    ds_read_b128 v[60:63], v255 offset:12288
    v_dot2c_f32_bf16 v220, v42, v219
    v_dot2c_f32_bf16 v222, v42, v42
    v_dot2c_f32_bf16 v221, v43, v219
    v_dot2c_f32_bf16 v223, v43, v43
    v_dot2c_f32_bf16 v220, v44, v219
    v_dot2c_f32_bf16 v222, v44, v44
    v_dot2c_f32_bf16 v221, v45, v219
    v_dot2c_f32_bf16 v223, v45, v45
    v_dot2c_f32_bf16 v220, v46, v219
    v_dot2c_f32_bf16 v222, v46, v46
    v_dot2c_f32_bf16 v221, v47, v219
    v_dot2c_f32_bf16 v223, v47, v47
    s_waitcnt lgkmcnt(0)
    s_add_u32 m0, s36, 12288
    s_add_u32 s52, s52, 128
    s_cmp_eq_u32 s52, 1152
    s_cselect_b32 s52, 0, s52
    buffer_load_dwordx4 v244, s[8:11], s52 offen offset:0 lds
    v_dot2c_f32_bf16 v220, v48, v219
    v_dot2c_f32_bf16 v222, v48, v48
    v_dot2c_f32_bf16 v221, v49, v219
    v_dot2c_f32_bf16 v223, v49, v49
    v_dot2c_f32_bf16 v220, v50, v219
    buffer_load_dwordx4 v245, s[8:11], s52 offen offset:1024 lds
    v_dot2c_f32_bf16 v222, v50, v50
    v_dot2c_f32_bf16 v221, v51, v219
    v_dot2c_f32_bf16 v223, v51, v51
    v_dot2c_f32_bf16 v220, v52, v219
    v_dot2c_f32_bf16 v222, v52, v52
    buffer_load_dwordx4 v246, s[8:11], s52 offen offset:2048 lds
    v_dot2c_f32_bf16 v221, v53, v219
    v_dot2c_f32_bf16 v223, v53, v53
    v_dot2c_f32_bf16 v220, v54, v219
    v_dot2c_f32_bf16 v222, v54, v54
    v_dot2c_f32_bf16 v221, v55, v219
    buffer_load_dwordx4 v247, s[8:11], s52 offen offset:3072 lds
    v_dot2c_f32_bf16 v223, v55, v55
    v_dot2c_f32_bf16 v220, v56, v219
    v_dot2c_f32_bf16 v222, v56, v56
    v_dot2c_f32_bf16 v221, v57, v219
    v_dot2c_f32_bf16 v223, v57, v57
    s_waitcnt vmcnt(12)
    ds_read_b128 v[64:67], v252 offset:0
    ds_read_b128 v[68:71], v253 offset:0
    ds_read_b128 v[72:75], v254 offset:0
    ds_read_b128 v[76:79], v255 offset:0
    v_dot2c_f32_bf16 v220, v58, v219
    v_dot2c_f32_bf16 v222, v58, v58
    v_dot2c_f32_bf16 v221, v59, v219
    v_dot2c_f32_bf16 v223, v59, v59
    v_dot2c_f32_bf16 v220, v60, v219
    v_dot2c_f32_bf16 v222, v60, v60
    v_dot2c_f32_bf16 v221, v61, v219
    v_dot2c_f32_bf16 v223, v61, v61
    v_dot2c_f32_bf16 v220, v62, v219
    v_dot2c_f32_bf16 v222, v62, v62
    v_dot2c_f32_bf16 v221, v63, v219
    v_dot2c_f32_bf16 v223, v63, v63
    s_waitcnt lgkmcnt(0)
    s_add_u32 m0, s36, 0
    s_add_u32 s52, s52, 128
    s_cmp_eq_u32 s52, 1152
    s_cselect_b32 s52, 0, s52
    buffer_load_dwordx4 v244, s[8:11], s52 offen offset:0 lds
    v_dot2c_f32_bf16 v220, v64, v219
    v_dot2c_f32_bf16 v222, v64, v64
    v_dot2c_f32_bf16 v221, v65, v219
    v_dot2c_f32_bf16 v223, v65, v65
    v_dot2c_f32_bf16 v220, v66, v219
    buffer_load_dwordx4 v245, s[8:11], s52 offen offset:1024 lds
    v_dot2c_f32_bf16 v222, v66, v66
    v_dot2c_f32_bf16 v221, v67, v219
    v_dot2c_f32_bf16 v223, v67, v67
    v_dot2c_f32_bf16 v220, v68, v219
    v_dot2c_f32_bf16 v222, v68, v68
    buffer_load_dwordx4 v246, s[8:11], s52 offen offset:2048 lds
    v_dot2c_f32_bf16 v221, v69, v219
    v_dot2c_f32_bf16 v223, v69, v69
    v_dot2c_f32_bf16 v220, v70, v219
    v_dot2c_f32_bf16 v222, v70, v70
    v_dot2c_f32_bf16 v221, v71, v219
    buffer_load_dwordx4 v247, s[8:11], s52 offen offset:3072 lds
    v_dot2c_f32_bf16 v223, v71, v71
    v_dot2c_f32_bf16 v220, v72, v219
    v_dot2c_f32_bf16 v222, v72, v72
    v_dot2c_f32_bf16 v221, v73, v219
    v_dot2c_f32_bf16 v223, v73, v73
    s_mov_b32 s54, 2
    s_mov_b64 exec, 0
    s_cmp_eq_u32 s3, 0
    s_cbranch_scc1 L_sa9
    s_cmp_eq_u32 s3, 1
    s_cbranch_scc1 L_sa10
    s_cmp_eq_u32 s3, 2
    s_cbranch_scc1 L_sa11
    s_branch L_sa12
L_hba2:
    s_mov_b64 exec, -1
    s_waitcnt vmcnt(12)
    ds_read_b128 v[80:83], v252 offset:4096
    ds_read_b128 v[84:87], v253 offset:4096
    ds_read_b128 v[88:91], v254 offset:4096
    ds_read_b128 v[92:95], v255 offset:4096
    v_dot2c_f32_bf16 v220, v74, v219
    v_dot2c_f32_bf16 v222, v74, v74
    v_dot2c_f32_bf16 v221, v75, v219
    v_dot2c_f32_bf16 v223, v75, v75
    v_dot2c_f32_bf16 v220, v76, v219
    v_dot2c_f32_bf16 v222, v76, v76
    v_dot2c_f32_bf16 v221, v77, v219
    v_dot2c_f32_bf16 v223, v77, v77
    v_dot2c_f32_bf16 v220, v78, v219
    v_dot2c_f32_bf16 v222, v78, v78
    v_dot2c_f32_bf16 v221, v79, v219
    v_dot2c_f32_bf16 v223, v79, v79
    s_waitcnt lgkmcnt(0)
    s_add_u32 m0, s59, 38912
    s_add_u32 s63, s64, 1152
    v_dot2c_f32_bf16 v220, v80, v219
    v_dot2c_f32_bf16 v222, v80, v80
    v_dot2c_f32_bf16 v221, v81, v219
    v_dot2c_f32_bf16 v223, v81, v81
    v_dot2c_f32_bf16 v220, v82, v219
    buffer_load_dwordx4 v224, s[12:15], s63 offen offset:0 lds
    v_dot2c_f32_bf16 v222, v82, v82
    v_dot2c_f32_bf16 v221, v83, v219
    v_dot2c_f32_bf16 v223, v83, v83
    v_dot2c_f32_bf16 v220, v84, v219
    v_dot2c_f32_bf16 v222, v84, v84
    buffer_load_dwordx4 v225, s[12:15], s63 offen offset:1024 lds
    v_dot2c_f32_bf16 v221, v85, v219
    v_dot2c_f32_bf16 v223, v85, v85
    v_dot2c_f32_bf16 v220, v86, v219
    v_dot2c_f32_bf16 v222, v86, v86
    v_dot2c_f32_bf16 v221, v87, v219
    buffer_load_dwordx4 v226, s[12:15], s63 offen offset:2048 lds
    v_dot2c_f32_bf16 v223, v87, v87
    v_dot2c_f32_bf16 v220, v88, v219
    v_dot2c_f32_bf16 v222, v88, v88
    v_dot2c_f32_bf16 v221, v89, v219
    v_dot2c_f32_bf16 v223, v89, v89
    s_waitcnt vmcnt(11)
    ds_read_b128 v[96:99], v252 offset:8192
    ds_read_b128 v[100:103], v253 offset:8192
    ds_read_b128 v[104:107], v254 offset:8192
    ds_read_b128 v[108:111], v255 offset:8192
    v_dot2c_f32_bf16 v220, v90, v219
    v_dot2c_f32_bf16 v222, v90, v90
    v_dot2c_f32_bf16 v221, v91, v219
    v_dot2c_f32_bf16 v223, v91, v91
    v_dot2c_f32_bf16 v220, v92, v219
    v_dot2c_f32_bf16 v222, v92, v92
    v_dot2c_f32_bf16 v221, v93, v219
    v_dot2c_f32_bf16 v223, v93, v93
    v_dot2c_f32_bf16 v220, v94, v219
    v_dot2c_f32_bf16 v222, v94, v94
    v_dot2c_f32_bf16 v221, v95, v219
    v_dot2c_f32_bf16 v223, v95, v95
    s_waitcnt lgkmcnt(0)
    buffer_load_dwordx4 v227, s[12:15], s63 offen offset:3072 lds
    s_add_u32 m0, s59, 43008
    v_dot2c_f32_bf16 v220, v96, v219
    v_dot2c_f32_bf16 v222, v96, v96
    v_dot2c_f32_bf16 v221, v97, v219
    v_dot2c_f32_bf16 v223, v97, v97
    v_dot2c_f32_bf16 v220, v98, v219
    buffer_load_dwordx4 v228, s[12:15], s63 offen offset:0 lds
    v_dot2c_f32_bf16 v222, v98, v98
    v_dot2c_f32_bf16 v221, v99, v219
    v_dot2c_f32_bf16 v223, v99, v99
    v_dot2c_f32_bf16 v220, v100, v219
    v_dot2c_f32_bf16 v222, v100, v100
    s_add_u32 m0, s59, 59392
    s_add_u32 s63, s65, 1152
    v_dot2c_f32_bf16 v221, v101, v219
    v_dot2c_f32_bf16 v223, v101, v101
    v_dot2c_f32_bf16 v220, v102, v219
    v_dot2c_f32_bf16 v222, v102, v102
    v_dot2c_f32_bf16 v221, v103, v219
    buffer_load_dwordx4 v224, s[12:15], s63 offen offset:0 lds
    v_dot2c_f32_bf16 v223, v103, v103
    v_dot2c_f32_bf16 v220, v104, v219
    v_dot2c_f32_bf16 v222, v104, v104
    v_dot2c_f32_bf16 v221, v105, v219
    v_dot2c_f32_bf16 v223, v105, v105
    s_waitcnt vmcnt(10)
    ds_read_b128 v[112:115], v252 offset:12288
    ds_read_b128 v[116:119], v253 offset:12288
    ds_read_b128 v[120:123], v254 offset:12288
    ds_read_b128 v[124:127], v255 offset:12288
    v_dot2c_f32_bf16 v220, v106, v219
    v_dot2c_f32_bf16 v222, v106, v106
    v_dot2c_f32_bf16 v221, v107, v219
    v_dot2c_f32_bf16 v223, v107, v107
    v_dot2c_f32_bf16 v220, v108, v219
    v_dot2c_f32_bf16 v222, v108, v108
    v_dot2c_f32_bf16 v221, v109, v219
    v_dot2c_f32_bf16 v223, v109, v109
    v_dot2c_f32_bf16 v220, v110, v219
    v_dot2c_f32_bf16 v222, v110, v110
    v_dot2c_f32_bf16 v221, v111, v219
    v_dot2c_f32_bf16 v223, v111, v111
    s_waitcnt lgkmcnt(0)
    buffer_load_dwordx4 v225, s[12:15], s63 offen offset:1024 lds
    v_dot2c_f32_bf16 v220, v112, v219
    v_dot2c_f32_bf16 v222, v112, v112
    v_dot2c_f32_bf16 v221, v113, v219
    v_dot2c_f32_bf16 v223, v113, v113
    v_dot2c_f32_bf16 v220, v114, v219
    buffer_load_dwordx4 v226, s[12:15], s63 offen offset:2048 lds
    v_dot2c_f32_bf16 v222, v114, v114
    v_dot2c_f32_bf16 v221, v115, v219
    v_dot2c_f32_bf16 v223, v115, v115
    v_dot2c_f32_bf16 v220, v116, v219
    v_dot2c_f32_bf16 v222, v116, v116
    buffer_load_dwordx4 v227, s[12:15], s63 offen offset:3072 lds
    s_add_u32 m0, s59, 63488
    v_dot2c_f32_bf16 v221, v117, v219
    v_dot2c_f32_bf16 v223, v117, v117
    v_dot2c_f32_bf16 v220, v118, v219
    v_dot2c_f32_bf16 v222, v118, v118
    v_dot2c_f32_bf16 v221, v119, v219
    buffer_load_dwordx4 v228, s[12:15], s63 offen offset:0 lds
    v_dot2c_f32_bf16 v223, v119, v119
    v_dot2c_f32_bf16 v220, v120, v219
    v_dot2c_f32_bf16 v222, v120, v120
    v_dot2c_f32_bf16 v221, v121, v219
    v_dot2c_f32_bf16 v223, v121, v121
    s_waitcnt vmcnt(10)
    ds_read_b128 v[128:131], v252 offset:0
    ds_read_b128 v[132:135], v253 offset:0
    ds_read_b128 v[136:139], v254 offset:0
    ds_read_b128 v[140:143], v255 offset:0
    v_dot2c_f32_bf16 v220, v122, v219
    v_dot2c_f32_bf16 v222, v122, v122
    v_dot2c_f32_bf16 v221, v123, v219
    v_dot2c_f32_bf16 v223, v123, v123
    v_dot2c_f32_bf16 v220, v124, v219
    v_dot2c_f32_bf16 v222, v124, v124
    v_dot2c_f32_bf16 v221, v125, v219
    v_dot2c_f32_bf16 v223, v125, v125
    v_dot2c_f32_bf16 v220, v126, v219
    v_dot2c_f32_bf16 v222, v126, v126
    v_dot2c_f32_bf16 v221, v127, v219
    v_dot2c_f32_bf16 v223, v127, v127
    s_waitcnt lgkmcnt(0)
    v_dot2c_f32_bf16 v220, v128, v219
    v_dot2c_f32_bf16 v222, v128, v128
    v_dot2c_f32_bf16 v221, v129, v219
    v_dot2c_f32_bf16 v223, v129, v129
    v_dot2c_f32_bf16 v220, v130, v219
    v_dot2c_f32_bf16 v222, v130, v130
    v_dot2c_f32_bf16 v221, v131, v219
    v_dot2c_f32_bf16 v223, v131, v131
    v_dot2c_f32_bf16 v220, v132, v219
    v_dot2c_f32_bf16 v222, v132, v132
    v_dot2c_f32_bf16 v221, v133, v219
    v_dot2c_f32_bf16 v223, v133, v133
    v_dot2c_f32_bf16 v220, v134, v219
    v_dot2c_f32_bf16 v222, v134, v134
    v_dot2c_f32_bf16 v221, v135, v219
    v_dot2c_f32_bf16 v223, v135, v135
    v_dot2c_f32_bf16 v220, v136, v219
    v_dot2c_f32_bf16 v222, v136, v136
    v_dot2c_f32_bf16 v221, v137, v219
    v_dot2c_f32_bf16 v223, v137, v137
    v_dot2c_f32_bf16 v220, v138, v219
    v_dot2c_f32_bf16 v222, v138, v138
    v_dot2c_f32_bf16 v221, v139, v219
    v_dot2c_f32_bf16 v223, v139, v139
    v_dot2c_f32_bf16 v220, v140, v219
    v_dot2c_f32_bf16 v222, v140, v140
    v_dot2c_f32_bf16 v221, v141, v219
    v_dot2c_f32_bf16 v223, v141, v141
    v_dot2c_f32_bf16 v220, v142, v219
    v_dot2c_f32_bf16 v222, v142, v142
    v_dot2c_f32_bf16 v221, v143, v219
    v_dot2c_f32_bf16 v223, v143, v143
    s_nop 1
    v_add_f32 v220, v220, v221
    v_add_f32 v222, v222, v223
    s_nop 1
    v_permlane32_swap_b32 v220, v222
    v_add_f32 v220, v220, v222
    v_mov_b32 v222, v220
    s_nop 1
    v_permlane32_swap_b32 v220, v222
    v_mul_f32 v220, 0x3ae38e39, v220
    v_mul_f32 v222, 0x3ae38e39, v222
    v_fma_f32 v222, -v220, v220, v222
    v_max_f32 v222, 0, v222
    v_add_f32 v222, 0x3727c5ac, v222
    v_rsq_f32 v222, v222
    s_nop 0
    v_mul_f32 v222, 1069066811, v222
    v_cvt_pk_bf16_f32 v222, v222, v222
    v_and_b32 v223, 0xffff0000, v222
    v_and_b32 v222, 0xffff, v222
    v_mul_f32 v220, v220, v223
    v_sub_f32 v220, 0, v220
    v_dot2_f32_bf16 v208, v0, v222, v220
    v_dot2_f32_bf16 v209, v0, v223, v220
    v_dot2_f32_bf16 v210, v1, v222, v220
    v_dot2_f32_bf16 v211, v1, v223, v220
    v_dot2_f32_bf16 v212, v2, v222, v220
    v_dot2_f32_bf16 v213, v2, v223, v220
    v_cvt_pk_bf16_f32 v0, v208, v209
    v_dot2_f32_bf16 v214, v3, v222, v220
    v_dot2_f32_bf16 v215, v3, v223, v220
    v_cvt_pk_bf16_f32 v1, v210, v211
    v_dot2_f32_bf16 v216, v4, v222, v220
    v_dot2_f32_bf16 v217, v4, v223, v220
    v_cvt_pk_bf16_f32 v2, v212, v213
    v_dot2_f32_bf16 v218, v5, v222, v220
    v_dot2_f32_bf16 v219, v5, v223, v220
    v_cvt_pk_bf16_f32 v3, v214, v215
    v_dot2_f32_bf16 v208, v6, v222, v220
    v_dot2_f32_bf16 v209, v6, v223, v220
    v_cvt_pk_bf16_f32 v4, v216, v217
    v_dot2_f32_bf16 v210, v7, v222, v220
    v_dot2_f32_bf16 v211, v7, v223, v220
    v_cvt_pk_bf16_f32 v5, v218, v219
    v_dot2_f32_bf16 v212, v8, v222, v220
    v_dot2_f32_bf16 v213, v8, v223, v220
    v_cvt_pk_bf16_f32 v6, v208, v209
    v_dot2_f32_bf16 v214, v9, v222, v220
    v_dot2_f32_bf16 v215, v9, v223, v220
    v_cvt_pk_bf16_f32 v7, v210, v211
    s_add_u32 m0, s59, 16384
    s_add_u32 s63, s66, 1152
    v_dot2_f32_bf16 v216, v10, v222, v220
    v_dot2_f32_bf16 v217, v10, v223, v220
    v_cvt_pk_bf16_f32 v8, v212, v213
    v_dot2_f32_bf16 v218, v11, v222, v220
    v_dot2_f32_bf16 v219, v11, v223, v220
    v_cvt_pk_bf16_f32 v9, v214, v215
    v_dot2_f32_bf16 v208, v12, v222, v220
    v_dot2_f32_bf16 v209, v12, v223, v220
    v_cvt_pk_bf16_f32 v10, v216, v217
    v_dot2_f32_bf16 v210, v13, v222, v220
    v_dot2_f32_bf16 v211, v13, v223, v220
    v_cvt_pk_bf16_f32 v11, v218, v219
    v_dot2_f32_bf16 v212, v14, v222, v220
    v_dot2_f32_bf16 v213, v14, v223, v220
    v_cvt_pk_bf16_f32 v12, v208, v209
    v_dot2_f32_bf16 v214, v15, v222, v220
    v_dot2_f32_bf16 v215, v15, v223, v220
    v_cvt_pk_bf16_f32 v13, v210, v211
    v_dot2_f32_bf16 v216, v16, v222, v220
    v_dot2_f32_bf16 v217, v16, v223, v220
    v_cvt_pk_bf16_f32 v14, v212, v213
    v_dot2_f32_bf16 v218, v17, v222, v220
    v_dot2_f32_bf16 v219, v17, v223, v220
    v_cvt_pk_bf16_f32 v15, v214, v215
    v_dot2_f32_bf16 v208, v18, v222, v220
    v_dot2_f32_bf16 v209, v18, v223, v220
    v_cvt_pk_bf16_f32 v16, v216, v217
    v_dot2_f32_bf16 v210, v19, v222, v220
    v_dot2_f32_bf16 v211, v19, v223, v220
    v_cvt_pk_bf16_f32 v17, v218, v219
    buffer_load_dwordx4 v224, s[12:15], s63 offen offset:0 lds
    v_dot2_f32_bf16 v212, v20, v222, v220
    v_dot2_f32_bf16 v213, v20, v223, v220
    v_cvt_pk_bf16_f32 v18, v208, v209
    v_dot2_f32_bf16 v214, v21, v222, v220
    v_dot2_f32_bf16 v215, v21, v223, v220
    v_cvt_pk_bf16_f32 v19, v210, v211
    v_dot2_f32_bf16 v216, v22, v222, v220
L_sa1:
    s_cbranch_execz L_reta
    v_dot2_f32_bf16 v217, v22, v223, v220
    v_cvt_pk_bf16_f32 v20, v212, v213
    v_dot2_f32_bf16 v218, v23, v222, v220
    v_dot2_f32_bf16 v219, v23, v223, v220
    v_cvt_pk_bf16_f32 v21, v214, v215
    v_dot2_f32_bf16 v208, v24, v222, v220
    v_dot2_f32_bf16 v209, v24, v223, v220
    v_cvt_pk_bf16_f32 v22, v216, v217
    v_dot2_f32_bf16 v210, v25, v222, v220
    v_dot2_f32_bf16 v211, v25, v223, v220
    v_cvt_pk_bf16_f32 v23, v218, v219
    v_dot2_f32_bf16 v212, v26, v222, v220
    v_dot2_f32_bf16 v213, v26, v223, v220
    v_cvt_pk_bf16_f32 v24, v208, v209
    v_dot2_f32_bf16 v214, v27, v222, v220
    v_dot2_f32_bf16 v215, v27, v223, v220
    v_cvt_pk_bf16_f32 v25, v210, v211
    v_dot2_f32_bf16 v216, v28, v222, v220
    v_dot2_f32_bf16 v217, v28, v223, v220
    v_cvt_pk_bf16_f32 v26, v212, v213
    v_dot2_f32_bf16 v218, v29, v222, v220
    v_dot2_f32_bf16 v219, v29, v223, v220
    v_cvt_pk_bf16_f32 v27, v214, v215
    buffer_load_dwordx4 v225, s[12:15], s63 offen offset:1024 lds
    v_dot2_f32_bf16 v208, v30, v222, v220
    v_dot2_f32_bf16 v209, v30, v223, v220
    v_cvt_pk_bf16_f32 v28, v216, v217
    v_dot2_f32_bf16 v210, v31, v222, v220
    v_dot2_f32_bf16 v211, v31, v223, v220
    v_cvt_pk_bf16_f32 v29, v218, v219
    v_dot2_f32_bf16 v212, v32, v222, v220
    v_dot2_f32_bf16 v213, v32, v223, v220
    v_cvt_pk_bf16_f32 v30, v208, v209
    v_dot2_f32_bf16 v214, v33, v222, v220
    v_dot2_f32_bf16 v215, v33, v223, v220
    v_cvt_pk_bf16_f32 v31, v210, v211
    v_dot2_f32_bf16 v216, v34, v222, v220
    v_dot2_f32_bf16 v217, v34, v223, v220
    v_cvt_pk_bf16_f32 v32, v212, v213
    v_dot2_f32_bf16 v218, v35, v222, v220
    v_dot2_f32_bf16 v219, v35, v223, v220
    v_cvt_pk_bf16_f32 v33, v214, v215
    v_dot2_f32_bf16 v208, v36, v222, v220
    v_dot2_f32_bf16 v209, v36, v223, v220
    v_cvt_pk_bf16_f32 v34, v216, v217
    v_dot2_f32_bf16 v210, v37, v222, v220
    v_dot2_f32_bf16 v211, v37, v223, v220
    v_cvt_pk_bf16_f32 v35, v218, v219
    v_dot2_f32_bf16 v212, v38, v222, v220
    v_dot2_f32_bf16 v213, v38, v223, v220
    v_cvt_pk_bf16_f32 v36, v208, v209
    v_dot2_f32_bf16 v214, v39, v222, v220
    v_dot2_f32_bf16 v215, v39, v223, v220
    v_cvt_pk_bf16_f32 v37, v210, v211
    buffer_load_dwordx4 v226, s[12:15], s63 offen offset:2048 lds
    v_dot2_f32_bf16 v216, v40, v222, v220
    v_dot2_f32_bf16 v217, v40, v223, v220
    v_cvt_pk_bf16_f32 v38, v212, v213
    v_dot2_f32_bf16 v218, v41, v222, v220
    v_dot2_f32_bf16 v219, v41, v223, v220
    v_cvt_pk_bf16_f32 v39, v214, v215
    v_dot2_f32_bf16 v208, v42, v222, v220
    v_dot2_f32_bf16 v209, v42, v223, v220
    v_cvt_pk_bf16_f32 v40, v216, v217
    v_dot2_f32_bf16 v210, v43, v222, v220
    v_dot2_f32_bf16 v211, v43, v223, v220
    v_cvt_pk_bf16_f32 v41, v218, v219
    v_dot2_f32_bf16 v212, v44, v222, v220
    v_dot2_f32_bf16 v213, v44, v223, v220
    v_cvt_pk_bf16_f32 v42, v208, v209
    v_dot2_f32_bf16 v214, v45, v222, v220
    v_dot2_f32_bf16 v215, v45, v223, v220
    v_cvt_pk_bf16_f32 v43, v210, v211
    v_dot2_f32_bf16 v216, v46, v222, v220
    v_dot2_f32_bf16 v217, v46, v223, v220
    v_cvt_pk_bf16_f32 v44, v212, v213
    v_dot2_f32_bf16 v218, v47, v222, v220
    v_dot2_f32_bf16 v219, v47, v223, v220
    v_cvt_pk_bf16_f32 v45, v214, v215
    v_dot2_f32_bf16 v208, v48, v222, v220
    v_dot2_f32_bf16 v209, v48, v223, v220
    v_cvt_pk_bf16_f32 v46, v216, v217
    v_dot2_f32_bf16 v210, v49, v222, v220
    v_dot2_f32_bf16 v211, v49, v223, v220
    v_cvt_pk_bf16_f32 v47, v218, v219
    buffer_load_dwordx4 v227, s[12:15], s63 offen offset:3072 lds
    s_add_u32 m0, s59, 20480
    v_dot2_f32_bf16 v212, v50, v222, v220
    v_dot2_f32_bf16 v213, v50, v223, v220
    v_cvt_pk_bf16_f32 v48, v208, v209
    v_dot2_f32_bf16 v214, v51, v222, v220
    v_dot2_f32_bf16 v215, v51, v223, v220
    v_cvt_pk_bf16_f32 v49, v210, v211
    v_dot2_f32_bf16 v216, v52, v222, v220
    v_dot2_f32_bf16 v217, v52, v223, v220
    v_cvt_pk_bf16_f32 v50, v212, v213
    v_dot2_f32_bf16 v218, v53, v222, v220
    v_dot2_f32_bf16 v219, v53, v223, v220
    v_cvt_pk_bf16_f32 v51, v214, v215
    v_dot2_f32_bf16 v208, v54, v222, v220
    v_dot2_f32_bf16 v209, v54, v223, v220
    v_cvt_pk_bf16_f32 v52, v216, v217
    v_dot2_f32_bf16 v210, v55, v222, v220
    v_dot2_f32_bf16 v211, v55, v223, v220
    v_cvt_pk_bf16_f32 v53, v218, v219
    v_dot2_f32_bf16 v212, v56, v222, v220
    v_dot2_f32_bf16 v213, v56, v223, v220
    v_cvt_pk_bf16_f32 v54, v208, v209
    v_dot2_f32_bf16 v214, v57, v222, v220
    v_dot2_f32_bf16 v215, v57, v223, v220
    v_cvt_pk_bf16_f32 v55, v210, v211
    v_dot2_f32_bf16 v216, v58, v222, v220
    v_dot2_f32_bf16 v217, v58, v223, v220
    v_cvt_pk_bf16_f32 v56, v212, v213
    v_dot2_f32_bf16 v218, v59, v222, v220
    v_dot2_f32_bf16 v219, v59, v223, v220
    v_cvt_pk_bf16_f32 v57, v214, v215
    buffer_load_dwordx4 v228, s[12:15], s63 offen offset:0 lds
    v_dot2_f32_bf16 v208, v60, v222, v220
    v_dot2_f32_bf16 v209, v60, v223, v220
    v_cvt_pk_bf16_f32 v58, v216, v217
    v_dot2_f32_bf16 v210, v61, v222, v220
    v_dot2_f32_bf16 v211, v61, v223, v220
    v_cvt_pk_bf16_f32 v59, v218, v219
    v_dot2_f32_bf16 v212, v62, v222, v220
    v_dot2_f32_bf16 v213, v62, v223, v220
    v_cvt_pk_bf16_f32 v60, v208, v209
    v_dot2_f32_bf16 v214, v63, v222, v220
    v_dot2_f32_bf16 v215, v63, v223, v220
    v_cvt_pk_bf16_f32 v61, v210, v211
    v_dot2_f32_bf16 v216, v64, v222, v220
    v_dot2_f32_bf16 v217, v64, v223, v220
    v_cvt_pk_bf16_f32 v62, v212, v213
    v_dot2_f32_bf16 v218, v65, v222, v220
    v_dot2_f32_bf16 v219, v65, v223, v220
    v_cvt_pk_bf16_f32 v63, v214, v215
    v_dot2_f32_bf16 v208, v66, v222, v220
    v_dot2_f32_bf16 v209, v66, v223, v220
    v_cvt_pk_bf16_f32 v64, v216, v217
    v_dot2_f32_bf16 v210, v67, v222, v220
    v_dot2_f32_bf16 v211, v67, v223, v220
    v_cvt_pk_bf16_f32 v65, v218, v219
    v_dot2_f32_bf16 v212, v68, v222, v220
    v_dot2_f32_bf16 v213, v68, v223, v220
    v_cvt_pk_bf16_f32 v66, v208, v209
    v_dot2_f32_bf16 v214, v69, v222, v220
    v_dot2_f32_bf16 v215, v69, v223, v220
    v_cvt_pk_bf16_f32 v67, v210, v211
    v_dot2_f32_bf16 v216, v70, v222, v220
    v_dot2_f32_bf16 v217, v70, v223, v220
    v_cvt_pk_bf16_f32 v68, v212, v213
    v_dot2_f32_bf16 v218, v71, v222, v220
    v_dot2_f32_bf16 v219, v71, v223, v220
    v_cvt_pk_bf16_f32 v69, v214, v215
    v_dot2_f32_bf16 v208, v72, v222, v220
    v_dot2_f32_bf16 v209, v72, v223, v220
    v_cvt_pk_bf16_f32 v70, v216, v217
    v_dot2_f32_bf16 v210, v73, v222, v220
    v_dot2_f32_bf16 v211, v73, v223, v220
    v_cvt_pk_bf16_f32 v71, v218, v219
    v_dot2_f32_bf16 v212, v74, v222, v220
    v_dot2_f32_bf16 v213, v74, v223, v220
    v_cvt_pk_bf16_f32 v72, v208, v209
    v_dot2_f32_bf16 v214, v75, v222, v220
    v_dot2_f32_bf16 v215, v75, v223, v220
    v_cvt_pk_bf16_f32 v73, v210, v211
    v_dot2_f32_bf16 v216, v76, v222, v220
    v_dot2_f32_bf16 v217, v76, v223, v220
    v_cvt_pk_bf16_f32 v74, v212, v213
    v_dot2_f32_bf16 v218, v77, v222, v220
    v_dot2_f32_bf16 v219, v77, v223, v220
    v_cvt_pk_bf16_f32 v75, v214, v215
    v_dot2_f32_bf16 v208, v78, v222, v220
    v_dot2_f32_bf16 v209, v78, v223, v220
    v_cvt_pk_bf16_f32 v76, v216, v217
    v_dot2_f32_bf16 v210, v79, v222, v220
    v_dot2_f32_bf16 v211, v79, v223, v220
    v_cvt_pk_bf16_f32 v77, v218, v219
    v_dot2_f32_bf16 v212, v80, v222, v220
    v_dot2_f32_bf16 v213, v80, v223, v220
    v_cvt_pk_bf16_f32 v78, v208, v209
    v_dot2_f32_bf16 v214, v81, v222, v220
    v_dot2_f32_bf16 v215, v81, v223, v220
    v_cvt_pk_bf16_f32 v79, v210, v211
    v_dot2_f32_bf16 v216, v82, v222, v220
    v_dot2_f32_bf16 v217, v82, v223, v220
    v_cvt_pk_bf16_f32 v80, v212, v213
    v_dot2_f32_bf16 v218, v83, v222, v220
    v_dot2_f32_bf16 v219, v83, v223, v220
    v_cvt_pk_bf16_f32 v81, v214, v215
    v_dot2_f32_bf16 v208, v84, v222, v220
    v_dot2_f32_bf16 v209, v84, v223, v220
    v_cvt_pk_bf16_f32 v82, v216, v217
    v_dot2_f32_bf16 v210, v85, v222, v220
    v_dot2_f32_bf16 v211, v85, v223, v220
    v_cvt_pk_bf16_f32 v83, v218, v219
    v_dot2_f32_bf16 v212, v86, v222, v220
    v_dot2_f32_bf16 v213, v86, v223, v220
    v_cvt_pk_bf16_f32 v84, v208, v209
    v_dot2_f32_bf16 v214, v87, v222, v220
    v_dot2_f32_bf16 v215, v87, v223, v220
    v_cvt_pk_bf16_f32 v85, v210, v211
    v_dot2_f32_bf16 v216, v88, v222, v220
    v_dot2_f32_bf16 v217, v88, v223, v220
    v_cvt_pk_bf16_f32 v86, v212, v213
    v_dot2_f32_bf16 v218, v89, v222, v220
    v_dot2_f32_bf16 v219, v89, v223, v220
    v_cvt_pk_bf16_f32 v87, v214, v215
    v_dot2_f32_bf16 v208, v90, v222, v220
    v_dot2_f32_bf16 v209, v90, v223, v220
    v_cvt_pk_bf16_f32 v88, v216, v217
    v_dot2_f32_bf16 v210, v91, v222, v220
    v_dot2_f32_bf16 v211, v91, v223, v220
    v_cvt_pk_bf16_f32 v89, v218, v219
    v_dot2_f32_bf16 v212, v92, v222, v220
    v_dot2_f32_bf16 v213, v92, v223, v220
    v_cvt_pk_bf16_f32 v90, v208, v209
    v_dot2_f32_bf16 v214, v93, v222, v220
    v_dot2_f32_bf16 v215, v93, v223, v220
    v_cvt_pk_bf16_f32 v91, v210, v211
    v_dot2_f32_bf16 v216, v94, v222, v220
    v_dot2_f32_bf16 v217, v94, v223, v220
    v_cvt_pk_bf16_f32 v92, v212, v213
    v_dot2_f32_bf16 v218, v95, v222, v220
    v_dot2_f32_bf16 v219, v95, v223, v220
    v_cvt_pk_bf16_f32 v93, v214, v215
    v_dot2_f32_bf16 v208, v96, v222, v220
    v_dot2_f32_bf16 v209, v96, v223, v220
    v_cvt_pk_bf16_f32 v94, v216, v217
    v_dot2_f32_bf16 v210, v97, v222, v220
    v_dot2_f32_bf16 v211, v97, v223, v220
    v_cvt_pk_bf16_f32 v95, v218, v219
    v_dot2_f32_bf16 v212, v98, v222, v220
    v_dot2_f32_bf16 v213, v98, v223, v220
    v_cvt_pk_bf16_f32 v96, v208, v209
    v_dot2_f32_bf16 v214, v99, v222, v220
    v_dot2_f32_bf16 v215, v99, v223, v220
    v_cvt_pk_bf16_f32 v97, v210, v211
    v_dot2_f32_bf16 v216, v100, v222, v220
    v_dot2_f32_bf16 v217, v100, v223, v220
    v_cvt_pk_bf16_f32 v98, v212, v213
    v_dot2_f32_bf16 v218, v101, v222, v220
    v_dot2_f32_bf16 v219, v101, v223, v220
    v_cvt_pk_bf16_f32 v99, v214, v215
    v_dot2_f32_bf16 v208, v102, v222, v220
    v_dot2_f32_bf16 v209, v102, v223, v220
    v_cvt_pk_bf16_f32 v100, v216, v217
    v_dot2_f32_bf16 v210, v103, v222, v220
    v_dot2_f32_bf16 v211, v103, v223, v220
    v_cvt_pk_bf16_f32 v101, v218, v219
    v_dot2_f32_bf16 v212, v104, v222, v220
    v_dot2_f32_bf16 v213, v104, v223, v220
    v_cvt_pk_bf16_f32 v102, v208, v209
    v_dot2_f32_bf16 v214, v105, v222, v220
    v_dot2_f32_bf16 v215, v105, v223, v220
    v_cvt_pk_bf16_f32 v103, v210, v211
    v_dot2_f32_bf16 v216, v106, v222, v220
    v_dot2_f32_bf16 v217, v106, v223, v220
    v_cvt_pk_bf16_f32 v104, v212, v213
    v_dot2_f32_bf16 v218, v107, v222, v220
    v_dot2_f32_bf16 v219, v107, v223, v220
    v_cvt_pk_bf16_f32 v105, v214, v215
    v_dot2_f32_bf16 v208, v108, v222, v220
    v_dot2_f32_bf16 v209, v108, v223, v220
    v_cvt_pk_bf16_f32 v106, v216, v217
    v_dot2_f32_bf16 v210, v109, v222, v220
    v_dot2_f32_bf16 v211, v109, v223, v220
    v_cvt_pk_bf16_f32 v107, v218, v219
    v_dot2_f32_bf16 v212, v110, v222, v220
    v_dot2_f32_bf16 v213, v110, v223, v220
    v_cvt_pk_bf16_f32 v108, v208, v209
    v_dot2_f32_bf16 v214, v111, v222, v220
    v_dot2_f32_bf16 v215, v111, v223, v220
    v_cvt_pk_bf16_f32 v109, v210, v211
    v_dot2_f32_bf16 v216, v112, v222, v220
    v_dot2_f32_bf16 v217, v112, v223, v220
    v_cvt_pk_bf16_f32 v110, v212, v213
    v_dot2_f32_bf16 v218, v113, v222, v220
    v_dot2_f32_bf16 v219, v113, v223, v220
    v_cvt_pk_bf16_f32 v111, v214, v215
    v_dot2_f32_bf16 v208, v114, v222, v220
    v_dot2_f32_bf16 v209, v114, v223, v220
    v_cvt_pk_bf16_f32 v112, v216, v217
    v_dot2_f32_bf16 v210, v115, v222, v220
    v_dot2_f32_bf16 v211, v115, v223, v220
    v_cvt_pk_bf16_f32 v113, v218, v219
    v_dot2_f32_bf16 v212, v116, v222, v220
    v_dot2_f32_bf16 v213, v116, v223, v220
    v_cvt_pk_bf16_f32 v114, v208, v209
    v_dot2_f32_bf16 v214, v117, v222, v220
    v_dot2_f32_bf16 v215, v117, v223, v220
    v_cvt_pk_bf16_f32 v115, v210, v211
    v_dot2_f32_bf16 v216, v118, v222, v220
    v_dot2_f32_bf16 v217, v118, v223, v220
    v_cvt_pk_bf16_f32 v116, v212, v213
    v_dot2_f32_bf16 v218, v119, v222, v220
    v_dot2_f32_bf16 v219, v119, v223, v220
    v_cvt_pk_bf16_f32 v117, v214, v215
    v_dot2_f32_bf16 v208, v120, v222, v220
    v_dot2_f32_bf16 v209, v120, v223, v220
    v_cvt_pk_bf16_f32 v118, v216, v217
    v_dot2_f32_bf16 v210, v121, v222, v220
    v_dot2_f32_bf16 v211, v121, v223, v220
    v_cvt_pk_bf16_f32 v119, v218, v219
    v_dot2_f32_bf16 v212, v122, v222, v220
    v_dot2_f32_bf16 v213, v122, v223, v220
    v_cvt_pk_bf16_f32 v120, v208, v209
    v_dot2_f32_bf16 v214, v123, v222, v220
    v_dot2_f32_bf16 v215, v123, v223, v220
    v_cvt_pk_bf16_f32 v121, v210, v211
    v_dot2_f32_bf16 v216, v124, v222, v220
    v_dot2_f32_bf16 v217, v124, v223, v220
    v_cvt_pk_bf16_f32 v122, v212, v213
    v_dot2_f32_bf16 v218, v125, v222, v220
    v_dot2_f32_bf16 v219, v125, v223, v220
    v_cvt_pk_bf16_f32 v123, v214, v215
    v_dot2_f32_bf16 v208, v126, v222, v220
    v_dot2_f32_bf16 v209, v126, v223, v220
    v_cvt_pk_bf16_f32 v124, v216, v217
    v_dot2_f32_bf16 v210, v127, v222, v220
    v_dot2_f32_bf16 v211, v127, v223, v220
    v_cvt_pk_bf16_f32 v125, v218, v219
    v_dot2_f32_bf16 v212, v128, v222, v220
    v_dot2_f32_bf16 v213, v128, v223, v220
    v_cvt_pk_bf16_f32 v126, v208, v209
    v_dot2_f32_bf16 v214, v129, v222, v220
    v_dot2_f32_bf16 v215, v129, v223, v220
    v_cvt_pk_bf16_f32 v127, v210, v211
    v_dot2_f32_bf16 v216, v130, v222, v220
    v_dot2_f32_bf16 v217, v130, v223, v220
    v_cvt_pk_bf16_f32 v128, v212, v213
    v_dot2_f32_bf16 v218, v131, v222, v220
    v_dot2_f32_bf16 v219, v131, v223, v220
    v_cvt_pk_bf16_f32 v129, v214, v215
    v_dot2_f32_bf16 v208, v132, v222, v220
    v_dot2_f32_bf16 v209, v132, v223, v220
    v_cvt_pk_bf16_f32 v130, v216, v217
    v_dot2_f32_bf16 v210, v133, v222, v220
    v_dot2_f32_bf16 v211, v133, v223, v220
    v_cvt_pk_bf16_f32 v131, v218, v219
    v_dot2_f32_bf16 v212, v134, v222, v220
    v_dot2_f32_bf16 v213, v134, v223, v220
    v_cvt_pk_bf16_f32 v132, v208, v209
    v_dot2_f32_bf16 v214, v135, v222, v220
    v_dot2_f32_bf16 v215, v135, v223, v220
    v_cvt_pk_bf16_f32 v133, v210, v211
    v_dot2_f32_bf16 v216, v136, v222, v220
    v_dot2_f32_bf16 v217, v136, v223, v220
    v_cvt_pk_bf16_f32 v134, v212, v213
    v_dot2_f32_bf16 v218, v137, v222, v220
    v_dot2_f32_bf16 v219, v137, v223, v220
    v_cvt_pk_bf16_f32 v135, v214, v215
    v_dot2_f32_bf16 v208, v138, v222, v220
    v_dot2_f32_bf16 v209, v138, v223, v220
    v_cvt_pk_bf16_f32 v136, v216, v217
    v_dot2_f32_bf16 v210, v139, v222, v220
    v_dot2_f32_bf16 v211, v139, v223, v220
    v_cvt_pk_bf16_f32 v137, v218, v219
    v_dot2_f32_bf16 v212, v140, v222, v220
    v_dot2_f32_bf16 v213, v140, v223, v220
    v_cvt_pk_bf16_f32 v138, v208, v209
    v_dot2_f32_bf16 v214, v141, v222, v220
    v_dot2_f32_bf16 v215, v141, v223, v220
    v_cvt_pk_bf16_f32 v139, v210, v211
    v_dot2_f32_bf16 v216, v142, v222, v220
    v_dot2_f32_bf16 v217, v142, v223, v220
    v_cvt_pk_bf16_f32 v140, v212, v213
    v_dot2_f32_bf16 v218, v143, v222, v220
    v_dot2_f32_bf16 v219, v143, v223, v220
    v_cvt_pk_bf16_f32 v141, v214, v215
    v_cvt_pk_bf16_f32 v142, v216, v217
    s_nop 0
    v_cvt_pk_bf16_f32 v143, v218, v219
    s_waitcnt vmcnt(10)
    s_barrier
    ds_read_b64_tr_b16 a[96:97], v233 offset:22528
    ds_read_b64_tr_b16 a[98:99], v233 offset:23808
    ds_read_b64_tr_b16 a[100:101], v233 offset:22592
    ds_read_b64_tr_b16 a[102:103], v233 offset:23872
    ds_read_b64_tr_b16 a[104:105], v233 offset:22656
    ds_read_b64_tr_b16 a[106:107], v233 offset:23936
    ds_read_b64_tr_b16 a[108:109], v233 offset:22720
    ds_read_b64_tr_b16 a[110:111], v233 offset:24000
    ds_read_b64_tr_b16 a[112:113], v233 offset:22784
    ds_read_b64_tr_b16 a[114:115], v233 offset:24064
    ds_read_b64_tr_b16 a[116:117], v233 offset:27648
    ds_read_b64_tr_b16 a[118:119], v233 offset:28928
    ds_read_b64_tr_b16 a[120:121], v233 offset:27712
    ds_read_b64_tr_b16 a[122:123], v233 offset:28992
    s_waitcnt lgkmcnt(8)
    v_mfma_f32_32x32x16_bf16 v[144:159], a[96:99], v[0:3], 0
    ds_read_b64_tr_b16 a[124:125], v233 offset:27776
    ds_read_b64_tr_b16 a[126:127], v233 offset:29056
    s_add_u32 m0, s59, 122880
    s_add_u32 s63, s67, 1152
    v_and_b32 v250, 3, v240
    v_lshlrev_b32 v250, 4, v250
    v_mfma_f32_32x32x16_bf16 v[160:175], a[100:103], v[0:3], 0
    ds_read_b64_tr_b16 a[96:97], v233 offset:27840
    ds_read_b64_tr_b16 a[98:99], v233 offset:29120
    v_lshrrev_b32 v251, 2, v240
    v_mov_b32 v252, 0x7ffffff0
    s_mul_i32 s42, s33, 5184
    s_mul_i32 s43, s3, 1296
    v_mfma_f32_32x32x16_bf16 v[176:191], a[104:107], v[0:3], 0
    ds_read_b64_tr_b16 a[100:101], v233 offset:27904
    ds_read_b64_tr_b16 a[102:103], v233 offset:29184
    buffer_load_dwordx4 v224, s[12:15], s63 offen offset:0 lds
    s_add_u32 s42, s42, s43
    s_lshl_b32 s43, s3, 2
    s_waitcnt lgkmcnt(8)
    v_mfma_f32_32x32x16_bf16 v[192:207], a[108:111], v[0:3], 0
    ds_read_b64_tr_b16 a[104:105], v233 offset:32768
    ds_read_b64_tr_b16 a[106:107], v233 offset:34048
    s_lshl_b32 s45, s3, 12
    v_subrev_u32 v248, s43, v251
    v_add_u32 v248, 0, v248
    v_mul_u32_u24 v249, 36, v248
    v_mfma_f32_32x32x16_bf16 v[208:223], a[112:115], v[0:3], 0
    ds_read_b64_tr_b16 a[108:109], v233 offset:32832
    ds_read_b64_tr_b16 a[110:111], v233 offset:34112
    buffer_load_dwordx4 v225, s[12:15], s63 offen offset:1024 lds
    v_add_u32 v249, v249, v250
    v_add_u32 v249, 0, v249
    v_mfma_f32_32x32x16_bf16 v[144:159], a[116:119], v[4:7], v[144:159]
    ds_read_b64_tr_b16 a[112:113], v233 offset:32896
    ds_read_b64_tr_b16 a[114:115], v233 offset:34176
    v_cmp_gt_u32 vcc, 18, v248
    s_nop 1
    v_cndmask_b32 v244, v252, v249, vcc
    v_subrev_u32 v248, s43, v251
    s_waitcnt lgkmcnt(8)
    v_mfma_f32_32x32x16_bf16 v[160:175], a[120:123], v[4:7], v[160:175]
    ds_read_b64_tr_b16 a[116:117], v233 offset:32960
    ds_read_b64_tr_b16 a[118:119], v233 offset:34240
    buffer_load_dwordx4 v226, s[12:15], s63 offen offset:2048 lds
    v_add_u32 v248, 16, v248
    v_mul_u32_u24 v249, 36, v248
    v_add_u32 v249, v249, v250
    v_mfma_f32_32x32x16_bf16 v[176:191], a[124:127], v[4:7], v[176:191]
    ds_read_b64_tr_b16 a[120:121], v233 offset:33024
    ds_read_b64_tr_b16 a[122:123], v233 offset:34304
    v_add_u32 v249, 0, v249
    v_cmp_gt_u32 vcc, 18, v248
    s_nop 1
    v_cndmask_b32 v245, v252, v249, vcc
    v_subrev_u32 v248, s43, v251
    v_mfma_f32_32x32x16_bf16 v[192:207], a[96:99], v[4:7], v[192:207]
    ds_read_b64_tr_b16 a[124:125], v233 offset:37888
    ds_read_b64_tr_b16 a[126:127], v233 offset:39168
    buffer_load_dwordx4 v227, s[12:15], s63 offen offset:3072 lds
    s_add_u32 m0, s59, 126976
    v_add_u32 v248, 4294967294, v248
    v_mul_u32_u24 v249, 36, v248
    s_waitcnt lgkmcnt(8)
    v_mfma_f32_32x32x16_bf16 v[208:223], a[100:103], v[4:7], v[208:223]
    ds_read_b64_tr_b16 a[96:97], v233 offset:37952
    ds_read_b64_tr_b16 a[98:99], v233 offset:39232
    v_add_u32 v249, v249, v250
    v_add_u32 v249, 648, v249
    v_cmp_gt_u32 vcc, 18, v248
    s_nop 1
    v_cndmask_b32 v246, v252, v249, vcc
    v_mfma_f32_32x32x16_bf16 v[144:159], a[104:107], v[8:11], v[144:159]
    ds_read_b64_tr_b16 a[100:101], v233 offset:38016
    ds_read_b64_tr_b16 a[102:103], v233 offset:39296
    buffer_load_dwordx4 v228, s[12:15], s63 offen offset:0 lds
    v_subrev_u32 v248, s43, v251
    v_add_u32 v248, 14, v248
    v_mul_u32_u24 v249, 36, v248
    v_mfma_f32_32x32x16_bf16 v[160:175], a[108:111], v[8:11], v[160:175]
    ds_read_b64_tr_b16 a[104:105], v233 offset:38080
    ds_read_b64_tr_b16 a[106:107], v233 offset:39360
    v_add_u32 v249, v249, v250
    v_add_u32 v249, 648, v249
    s_waitcnt lgkmcnt(8)
    v_mfma_f32_32x32x16_bf16 v[176:191], a[112:115], v[8:11], v[176:191]
    ds_read_b64_tr_b16 a[108:109], v233 offset:38144
    ds_read_b64_tr_b16 a[110:111], v233 offset:39424
    s_add_u32 m0, s59, 143360
    s_add_u32 s63, s68, 1152
    v_cmp_gt_u32 vcc, 18, v248
    s_nop 1
    v_cndmask_b32 v247, v252, v249, vcc
    s_waitcnt vmcnt(10)
    s_barrier
    v_mfma_f32_32x32x16_bf16 v[192:207], a[116:119], v[8:11], v[192:207]
    ds_read_b64_tr_b16 a[112:113], v233 offset:43008
    ds_read_b64_tr_b16 a[114:115], v233 offset:44288
    v_lshlrev_b32 v251, 4, v239
    v_cmp_gt_u32 vcc, 120, v239
    s_nop 1
    v_cndmask_b32 v249, v252, v251, vcc
    v_lshlrev_b32 v250, 4, v240
    v_mfma_f32_32x32x16_bf16 v[208:223], a[120:123], v[8:11], v[208:223]
    ds_read_b64_tr_b16 a[116:117], v233 offset:43072
    ds_read_b64_tr_b16 a[118:119], v233 offset:44352
    buffer_load_dwordx4 v224, s[12:15], s63 offen offset:0 lds
    s_lshl_b32 s44, s32, 16
    s_lshl_b32 s43, s33, 14
    s_waitcnt lgkmcnt(8)
    v_mfma_f32_32x32x16_bf16 v[144:159], a[124:127], v[12:15], v[144:159]
    ds_read_b64_tr_b16 a[120:121], v233 offset:43136
    ds_read_b64_tr_b16 a[122:123], v233 offset:44416
    s_add_u32 s44, s44, s43
    s_lshl_b32 s43, s3, 10
    s_add_u32 s44, s44, s43
    s_add_u32 s44, s44, 48234496
    v_mfma_f32_32x32x16_bf16 v[160:175], a[96:99], v[12:15], v[160:175]
    ds_read_b64_tr_b16 a[124:125], v233 offset:43200
    ds_read_b64_tr_b16 a[126:127], v233 offset:44480
    buffer_load_dwordx4 v225, s[12:15], s63 offen offset:1024 lds
    v_mov_b32 v252, 0
    v_mov_b32 v253, 0
    v_mov_b32 v254, 0
    v_mfma_f32_32x32x16_bf16 v[176:191], a[100:103], v[12:15], v[176:191]
    ds_read_b64_tr_b16 a[96:97], v233 offset:43264
    ds_read_b64_tr_b16 a[98:99], v233 offset:44544
    v_mov_b32 v255, 0
    s_mul_i32 s61, s33, 30720
    s_add_u32 s61, s61, 41943040
    s_waitcnt lgkmcnt(8)
    v_mfma_f32_32x32x16_bf16 v[192:207], a[104:107], v[12:15], v[192:207]
    ds_read_b64_tr_b16 a[100:101], v233 offset:48128
    ds_read_b64_tr_b16 a[102:103], v233 offset:49408
    buffer_load_dwordx4 v226, s[12:15], s63 offen offset:2048 lds
    s_mul_i32 s43, s32, 1920
    s_add_u32 s43, s43, s61
    v_min_u32 v248, 32, v243
    v_mfma_f32_32x32x16_bf16 v[208:223], a[108:111], v[12:15], v[208:223]
    ds_read_b64_tr_b16 a[104:105], v233 offset:48192
    ds_read_b64_tr_b16 a[106:107], v233 offset:49472
    v_lshl_add_u32 v237, v241, 2, v242
    v_lshl_add_u32 v237, v237, 6, v248
    v_mfma_f32_32x32x16_bf16 v[144:159], a[112:115], v[16:19], v[144:159]
    ds_read_b64_tr_b16 a[108:109], v233 offset:48256
    ds_read_b64_tr_b16 a[110:111], v233 offset:49536
    buffer_load_dwordx4 v227, s[12:15], s63 offen offset:3072 lds
    s_add_u32 m0, s59, 147456
    s_waitcnt lgkmcnt(8)
    v_mfma_f32_32x32x16_bf16 v[160:175], a[116:119], v[16:19], v[160:175]
    ds_read_b64_tr_b16 a[112:113], v233 offset:48320
    ds_read_b64_tr_b16 a[114:115], v233 offset:49600
    s_nop 0
L_sa2:
    s_cbranch_execz L_reta
    v_mfma_f32_32x32x16_bf16 v[176:191], a[120:123], v[16:19], v[176:191]
    ds_read_b64_tr_b16 a[116:117], v233 offset:48384
    ds_read_b64_tr_b16 a[118:119], v233 offset:49664
    buffer_load_dwordx4 v228, s[12:15], s63 offen offset:0 lds
    v_mfma_f32_32x32x16_bf16 v[192:207], a[124:127], v[16:19], v[192:207]
    ds_read_b64_tr_b16 a[120:121], v233 offset:53248
    ds_read_b64_tr_b16 a[122:123], v233 offset:54528
    s_waitcnt lgkmcnt(8)
    v_mfma_f32_32x32x16_bf16 v[208:223], a[96:99], v[16:19], v[208:223]
    ds_read_b64_tr_b16 a[124:125], v233 offset:53312
    ds_read_b64_tr_b16 a[126:127], v233 offset:54592
    s_add_u32 m0, s45, 0
    s_nop 0
    buffer_load_dwordx4 v244, s[20:23], s42 offen lds
    v_mfma_f32_32x32x16_bf16 v[144:159], a[100:103], v[20:23], v[144:159]
    ds_read_b64_tr_b16 a[96:97], v233 offset:53376
    ds_read_b64_tr_b16 a[98:99], v233 offset:54656
    v_mfma_f32_32x32x16_bf16 v[160:175], a[104:107], v[20:23], v[160:175]
    ds_read_b64_tr_b16 a[100:101], v233 offset:53440
    ds_read_b64_tr_b16 a[102:103], v233 offset:54720
    s_add_u32 m0, s45, 1024
    s_nop 0
    buffer_load_dwordx4 v245, s[20:23], s42 offen lds
    s_waitcnt lgkmcnt(8)
    v_mfma_f32_32x32x16_bf16 v[176:191], a[108:111], v[20:23], v[176:191]
    ds_read_b64_tr_b16 a[104:105], v233 offset:53504
    ds_read_b64_tr_b16 a[106:107], v233 offset:54784
    v_mfma_f32_32x32x16_bf16 v[192:207], a[112:115], v[20:23], v[192:207]
    ds_read_b64_tr_b16 a[108:109], v233 offset:58368
    ds_read_b64_tr_b16 a[110:111], v233 offset:59648
    s_add_u32 m0, s45, 2048
    s_nop 0
    buffer_load_dwordx4 v246, s[20:23], s42 offen lds
    v_mfma_f32_32x32x16_bf16 v[208:223], a[116:119], v[20:23], v[208:223]
    ds_read_b64_tr_b16 a[112:113], v233 offset:58432
    ds_read_b64_tr_b16 a[114:115], v233 offset:59712
    s_waitcnt lgkmcnt(8)
    v_mfma_f32_32x32x16_bf16 v[144:159], a[120:123], v[24:27], v[144:159]
    ds_read_b64_tr_b16 a[116:117], v233 offset:58496
    ds_read_b64_tr_b16 a[118:119], v233 offset:59776
    s_add_u32 m0, s45, 3072
    s_nop 0
    buffer_load_dwordx4 v247, s[20:23], s42 offen lds
    v_mfma_f32_32x32x16_bf16 v[160:175], a[124:127], v[24:27], v[160:175]
    ds_read_b64_tr_b16 a[120:121], v233 offset:58560
    ds_read_b64_tr_b16 a[122:123], v233 offset:59840
    v_mfma_f32_32x32x16_bf16 v[176:191], a[96:99], v[24:27], v[176:191]
    ds_read_b64_tr_b16 a[124:125], v233 offset:58624
    ds_read_b64_tr_b16 a[126:127], v233 offset:59904
    buffer_store_dwordx4 v[252:255], v249, s[24:27], s43 offen sc1
    s_waitcnt vmcnt(15)
    s_barrier
    s_waitcnt lgkmcnt(8)
    v_mfma_f32_32x32x16_bf16 v[192:207], a[100:103], v[24:27], v[192:207]
    ds_read_b64_tr_b16 a[96:97], v233 offset:0
    ds_read_b64_tr_b16 a[98:99], v233 offset:1280
    v_mfma_f32_32x32x16_bf16 v[208:223], a[104:107], v[24:27], v[208:223]
    ds_read_b64_tr_b16 a[100:101], v233 offset:64
    ds_read_b64_tr_b16 a[102:103], v233 offset:1344
    buffer_store_dwordx4 v[252:255], v250, s[24:27], s44 offen sc1
    v_mfma_f32_32x32x16_bf16 v[144:159], a[108:111], v[28:31], v[144:159]
    ds_read_b64_tr_b16 a[104:105], v233 offset:128
    ds_read_b64_tr_b16 a[106:107], v233 offset:1408
    s_waitcnt lgkmcnt(8)
    v_mfma_f32_32x32x16_bf16 v[160:175], a[112:115], v[28:31], v[160:175]
    ds_read_b64_tr_b16 a[108:109], v233 offset:192
    ds_read_b64_tr_b16 a[110:111], v233 offset:1472
    s_add_u32 m0, s59, 79872
    s_add_u32 s63, s69, 1152
    v_mfma_f32_32x32x16_bf16 v[176:191], a[116:119], v[28:31], v[176:191]
    ds_read_b64_tr_b16 a[112:113], v233 offset:256
    ds_read_b64_tr_b16 a[114:115], v233 offset:1536
    v_mfma_f32_32x32x16_bf16 v[192:207], a[120:123], v[28:31], v[192:207]
    ds_read_b64_tr_b16 a[116:117], v233 offset:5120
    ds_read_b64_tr_b16 a[118:119], v233 offset:6400
    buffer_load_dwordx4 v224, s[12:15], s63 offen offset:0 lds
    s_waitcnt lgkmcnt(8)
    v_mfma_f32_32x32x16_bf16 v[208:223], a[124:127], v[28:31], v[208:223]
    ds_read_b64_tr_b16 a[120:121], v233 offset:5184
    ds_read_b64_tr_b16 a[122:123], v233 offset:6464
    v_mfma_f32_32x32x16_bf16 v[144:159], a[96:99], v[32:35], v[144:159]
    ds_read_b64_tr_b16 a[124:125], v233 offset:5248
    ds_read_b64_tr_b16 a[126:127], v233 offset:6528
    buffer_load_dwordx4 v225, s[12:15], s63 offen offset:1024 lds
    v_mfma_f32_32x32x16_bf16 v[160:175], a[100:103], v[32:35], v[160:175]
    ds_read_b64_tr_b16 a[96:97], v233 offset:5312
    ds_read_b64_tr_b16 a[98:99], v233 offset:6592
    s_waitcnt lgkmcnt(8)
    v_mfma_f32_32x32x16_bf16 v[176:191], a[104:107], v[32:35], v[176:191]
    ds_read_b64_tr_b16 a[100:101], v233 offset:5376
    ds_read_b64_tr_b16 a[102:103], v233 offset:6656
    buffer_load_dwordx4 v226, s[12:15], s63 offen offset:2048 lds
    v_mfma_f32_32x32x16_bf16 v[192:207], a[108:111], v[32:35], v[192:207]
    ds_read_b64_tr_b16 a[104:105], v233 offset:10240
    ds_read_b64_tr_b16 a[106:107], v233 offset:11520
    v_mfma_f32_32x32x16_bf16 v[208:223], a[112:115], v[32:35], v[208:223]
    ds_read_b64_tr_b16 a[108:109], v233 offset:10304
    ds_read_b64_tr_b16 a[110:111], v233 offset:11584
    buffer_load_dwordx4 v227, s[12:15], s63 offen offset:3072 lds
    s_add_u32 m0, s59, 83968
    s_waitcnt lgkmcnt(8)
    v_mfma_f32_32x32x16_bf16 v[144:159], a[116:119], v[36:39], v[144:159]
    ds_read_b64_tr_b16 a[112:113], v233 offset:10368
    ds_read_b64_tr_b16 a[114:115], v233 offset:11648
    v_mfma_f32_32x32x16_bf16 v[160:175], a[120:123], v[36:39], v[160:175]
    ds_read_b64_tr_b16 a[116:117], v233 offset:10432
    ds_read_b64_tr_b16 a[118:119], v233 offset:11712
    buffer_load_dwordx4 v228, s[12:15], s63 offen offset:0 lds
    v_mfma_f32_32x32x16_bf16 v[176:191], a[124:127], v[36:39], v[176:191]
    ds_read_b64_tr_b16 a[120:121], v233 offset:10496
    ds_read_b64_tr_b16 a[122:123], v233 offset:11776
    s_waitcnt lgkmcnt(8)
    v_mfma_f32_32x32x16_bf16 v[192:207], a[96:99], v[36:39], v[192:207]
    ds_read_b64_tr_b16 a[124:125], v233 offset:15360
    ds_read_b64_tr_b16 a[126:127], v233 offset:16640
    s_add_u32 m0, s59, 100352
    s_add_u32 s63, s70, 1152
    v_mfma_f32_32x32x16_bf16 v[208:223], a[100:103], v[36:39], v[208:223]
    ds_read_b64_tr_b16 a[96:97], v233 offset:15424
    ds_read_b64_tr_b16 a[98:99], v233 offset:16704
    v_mfma_f32_32x32x16_bf16 v[144:159], a[104:107], v[40:43], v[144:159]
    ds_read_b64_tr_b16 a[100:101], v233 offset:15488
    ds_read_b64_tr_b16 a[102:103], v233 offset:16768
    buffer_load_dwordx4 v224, s[12:15], s63 offen offset:0 lds
    s_waitcnt lgkmcnt(8)
    v_mfma_f32_32x32x16_bf16 v[160:175], a[108:111], v[40:43], v[160:175]
    ds_read_b64_tr_b16 a[104:105], v233 offset:15552
    ds_read_b64_tr_b16 a[106:107], v233 offset:16832
    v_mfma_f32_32x32x16_bf16 v[176:191], a[112:115], v[40:43], v[176:191]
    ds_read_b64_tr_b16 a[108:109], v233 offset:15616
    ds_read_b64_tr_b16 a[110:111], v233 offset:16896
    buffer_load_dwordx4 v225, s[12:15], s63 offen offset:1024 lds
    s_waitcnt vmcnt(18)
    s_barrier
    v_mfma_f32_32x32x16_bf16 v[192:207], a[116:119], v[40:43], v[192:207]
    ds_read_b64_tr_b16 a[112:113], v234 offset:43008
    ds_read_b64_tr_b16 a[114:115], v234 offset:44288
    s_waitcnt lgkmcnt(8)
    v_mfma_f32_32x32x16_bf16 v[208:223], a[120:123], v[40:43], v[208:223]
    ds_read_b64_tr_b16 a[116:117], v234 offset:43072
    ds_read_b64_tr_b16 a[118:119], v234 offset:44352
    buffer_load_dwordx4 v226, s[12:15], s63 offen offset:2048 lds
    v_mfma_f32_32x32x16_bf16 v[144:159], a[124:127], v[44:47], v[144:159]
    ds_read_b64_tr_b16 a[120:121], v234 offset:43136
    ds_read_b64_tr_b16 a[122:123], v234 offset:44416
    v_mfma_f32_32x32x16_bf16 v[160:175], a[96:99], v[44:47], v[160:175]
    ds_read_b64_tr_b16 a[124:125], v234 offset:43200
    ds_read_b64_tr_b16 a[126:127], v234 offset:44480
    buffer_load_dwordx4 v227, s[12:15], s63 offen offset:3072 lds
    s_add_u32 m0, s59, 104448
    s_waitcnt lgkmcnt(8)
    v_mfma_f32_32x32x16_bf16 v[176:191], a[100:103], v[44:47], v[176:191]
    ds_read_b64_tr_b16 a[96:97], v234 offset:43264
    ds_read_b64_tr_b16 a[98:99], v234 offset:44544
    v_mfma_f32_32x32x16_bf16 v[192:207], a[104:107], v[44:47], v[192:207]
    ds_read_b64_tr_b16 a[100:101], v234 offset:48128
    ds_read_b64_tr_b16 a[102:103], v234 offset:49408
    buffer_load_dwordx4 v228, s[12:15], s63 offen offset:0 lds
    v_mfma_f32_32x32x16_bf16 v[208:223], a[108:111], v[44:47], v[208:223]
    ds_read_b64_tr_b16 a[104:105], v234 offset:48192
    ds_read_b64_tr_b16 a[106:107], v234 offset:49472
    s_waitcnt lgkmcnt(8)
    v_mfma_f32_32x32x16_bf16 v[144:159], a[112:115], v[48:51], v[144:159]
    ds_read_b64_tr_b16 a[108:109], v234 offset:48256
    ds_read_b64_tr_b16 a[110:111], v234 offset:49536
    s_add_u32 m0, s59, 38912
    s_add_u32 s63, s71, 1152
    v_mfma_f32_32x32x16_bf16 v[160:175], a[116:119], v[48:51], v[160:175]
    ds_read_b64_tr_b16 a[112:113], v234 offset:48320
    ds_read_b64_tr_b16 a[114:115], v234 offset:49600
    v_mfma_f32_32x32x16_bf16 v[176:191], a[120:123], v[48:51], v[176:191]
    ds_read_b64_tr_b16 a[116:117], v234 offset:48384
    ds_read_b64_tr_b16 a[118:119], v234 offset:49664
    buffer_load_dwordx4 v224, s[12:15], s63 offen offset:0 lds
    s_waitcnt lgkmcnt(8)
    v_mfma_f32_32x32x16_bf16 v[192:207], a[124:127], v[48:51], v[192:207]
    ds_read_b64_tr_b16 a[120:121], v234 offset:53248
    ds_read_b64_tr_b16 a[122:123], v234 offset:54528
    v_mfma_f32_32x32x16_bf16 v[208:223], a[96:99], v[48:51], v[208:223]
    ds_read_b64_tr_b16 a[124:125], v234 offset:53312
    ds_read_b64_tr_b16 a[126:127], v234 offset:54592
    buffer_load_dwordx4 v225, s[12:15], s63 offen offset:1024 lds
    v_mfma_f32_32x32x16_bf16 v[144:159], a[100:103], v[52:55], v[144:159]
    ds_read_b64_tr_b16 a[96:97], v234 offset:53376
    ds_read_b64_tr_b16 a[98:99], v234 offset:54656
    s_waitcnt lgkmcnt(8)
    v_mfma_f32_32x32x16_bf16 v[160:175], a[104:107], v[52:55], v[160:175]
    ds_read_b64_tr_b16 a[100:101], v234 offset:53440
    ds_read_b64_tr_b16 a[102:103], v234 offset:54720
    buffer_load_dwordx4 v226, s[12:15], s63 offen offset:2048 lds
    v_mfma_f32_32x32x16_bf16 v[176:191], a[108:111], v[52:55], v[176:191]
    ds_read_b64_tr_b16 a[104:105], v234 offset:53504
    ds_read_b64_tr_b16 a[106:107], v234 offset:54784
    v_mfma_f32_32x32x16_bf16 v[192:207], a[112:115], v[52:55], v[192:207]
    ds_read_b64_tr_b16 a[108:109], v234 offset:58368
    ds_read_b64_tr_b16 a[110:111], v234 offset:59648
    buffer_load_dwordx4 v227, s[12:15], s63 offen offset:3072 lds
    s_add_u32 m0, s59, 43008
    s_waitcnt lgkmcnt(8)
    v_mfma_f32_32x32x16_bf16 v[208:223], a[116:119], v[52:55], v[208:223]
    ds_read_b64_tr_b16 a[112:113], v234 offset:58432
    ds_read_b64_tr_b16 a[114:115], v234 offset:59712
    v_mfma_f32_32x32x16_bf16 v[144:159], a[120:123], v[56:59], v[144:159]
    ds_read_b64_tr_b16 a[116:117], v234 offset:58496
    ds_read_b64_tr_b16 a[118:119], v234 offset:59776
    buffer_load_dwordx4 v228, s[12:15], s63 offen offset:0 lds
    v_mfma_f32_32x32x16_bf16 v[160:175], a[124:127], v[56:59], v[160:175]
    ds_read_b64_tr_b16 a[120:121], v234 offset:58560
    ds_read_b64_tr_b16 a[122:123], v234 offset:59840
    s_waitcnt lgkmcnt(8)
    v_mfma_f32_32x32x16_bf16 v[176:191], a[96:99], v[56:59], v[176:191]
    ds_read_b64_tr_b16 a[124:125], v234 offset:58624
    ds_read_b64_tr_b16 a[126:127], v234 offset:59904
    s_add_u32 m0, s59, 59392
    s_add_u32 s63, s72, 1152
    s_waitcnt vmcnt(21)
    s_barrier
    v_mfma_f32_32x32x16_bf16 v[192:207], a[100:103], v[56:59], v[192:207]
    ds_read_b64_tr_b16 a[96:97], v235 offset:0
    ds_read_b64_tr_b16 a[98:99], v235 offset:1280
    v_mfma_f32_32x32x16_bf16 v[208:223], a[104:107], v[56:59], v[208:223]
    ds_read_b64_tr_b16 a[100:101], v235 offset:64
    ds_read_b64_tr_b16 a[102:103], v235 offset:1344
    buffer_load_dwordx4 v224, s[12:15], s63 offen offset:0 lds
    s_waitcnt lgkmcnt(8)
    v_mfma_f32_32x32x16_bf16 v[144:159], a[108:111], v[60:63], v[144:159]
    ds_read_b64_tr_b16 a[104:105], v235 offset:128
    ds_read_b64_tr_b16 a[106:107], v235 offset:1408
    v_mfma_f32_32x32x16_bf16 v[160:175], a[112:115], v[60:63], v[160:175]
    ds_read_b64_tr_b16 a[108:109], v235 offset:192
    ds_read_b64_tr_b16 a[110:111], v235 offset:1472
    buffer_load_dwordx4 v225, s[12:15], s63 offen offset:1024 lds
    v_mfma_f32_32x32x16_bf16 v[176:191], a[116:119], v[60:63], v[176:191]
    ds_read_b64_tr_b16 a[112:113], v235 offset:256
    ds_read_b64_tr_b16 a[114:115], v235 offset:1536
    s_waitcnt lgkmcnt(8)
    v_mfma_f32_32x32x16_bf16 v[192:207], a[120:123], v[60:63], v[192:207]
    ds_read_b64_tr_b16 a[116:117], v235 offset:5120
    ds_read_b64_tr_b16 a[118:119], v235 offset:6400
    buffer_load_dwordx4 v226, s[12:15], s63 offen offset:2048 lds
    v_mfma_f32_32x32x16_bf16 v[208:223], a[124:127], v[60:63], v[208:223]
    ds_read_b64_tr_b16 a[120:121], v235 offset:5184
    ds_read_b64_tr_b16 a[122:123], v235 offset:6464
    v_mfma_f32_32x32x16_bf16 v[144:159], a[96:99], v[64:67], v[144:159]
    ds_read_b64_tr_b16 a[124:125], v235 offset:5248
    ds_read_b64_tr_b16 a[126:127], v235 offset:6528
    buffer_load_dwordx4 v227, s[12:15], s63 offen offset:3072 lds
    s_add_u32 m0, s59, 63488
    s_waitcnt lgkmcnt(8)
    v_mfma_f32_32x32x16_bf16 v[160:175], a[100:103], v[64:67], v[160:175]
    ds_read_b64_tr_b16 a[96:97], v235 offset:5312
    ds_read_b64_tr_b16 a[98:99], v235 offset:6592
    v_mfma_f32_32x32x16_bf16 v[176:191], a[104:107], v[64:67], v[176:191]
    ds_read_b64_tr_b16 a[100:101], v235 offset:5376
    ds_read_b64_tr_b16 a[102:103], v235 offset:6656
    buffer_load_dwordx4 v228, s[12:15], s63 offen offset:0 lds
    v_mfma_f32_32x32x16_bf16 v[192:207], a[108:111], v[64:67], v[192:207]
    ds_read_b64_tr_b16 a[104:105], v235 offset:10240
    ds_read_b64_tr_b16 a[106:107], v235 offset:11520
    s_waitcnt lgkmcnt(8)
    v_mfma_f32_32x32x16_bf16 v[208:223], a[112:115], v[64:67], v[208:223]
    ds_read_b64_tr_b16 a[108:109], v235 offset:10304
    ds_read_b64_tr_b16 a[110:111], v235 offset:11584
    v_mfma_f32_32x32x16_bf16 v[144:159], a[116:119], v[68:71], v[144:159]
    ds_read_b64_tr_b16 a[112:113], v235 offset:10368
    ds_read_b64_tr_b16 a[114:115], v235 offset:11648
    v_mfma_f32_32x32x16_bf16 v[160:175], a[120:123], v[68:71], v[160:175]
    ds_read_b64_tr_b16 a[116:117], v235 offset:10432
    ds_read_b64_tr_b16 a[118:119], v235 offset:11712
    s_waitcnt lgkmcnt(8)
    v_mfma_f32_32x32x16_bf16 v[176:191], a[124:127], v[68:71], v[176:191]
    ds_read_b64_tr_b16 a[120:121], v235 offset:10496
    ds_read_b64_tr_b16 a[122:123], v235 offset:11776
    v_mfma_f32_32x32x16_bf16 v[192:207], a[96:99], v[68:71], v[192:207]
    ds_read_b64_tr_b16 a[124:125], v235 offset:15360
    ds_read_b64_tr_b16 a[126:127], v235 offset:16640
    v_mfma_f32_32x32x16_bf16 v[208:223], a[100:103], v[68:71], v[208:223]
    ds_read_b64_tr_b16 a[96:97], v235 offset:15424
    ds_read_b64_tr_b16 a[98:99], v235 offset:16704
    s_waitcnt lgkmcnt(8)
    v_mfma_f32_32x32x16_bf16 v[144:159], a[104:107], v[72:75], v[144:159]
    ds_read_b64_tr_b16 a[100:101], v235 offset:15488
    ds_read_b64_tr_b16 a[102:103], v235 offset:16768
    v_mfma_f32_32x32x16_bf16 v[160:175], a[108:111], v[72:75], v[160:175]
    ds_read_b64_tr_b16 a[104:105], v235 offset:15552
    ds_read_b64_tr_b16 a[106:107], v235 offset:16832
    v_mfma_f32_32x32x16_bf16 v[176:191], a[112:115], v[72:75], v[176:191]
    ds_read_b64_tr_b16 a[108:109], v235 offset:15616
    ds_read_b64_tr_b16 a[110:111], v235 offset:16896
    s_waitcnt vmcnt(15)
    s_barrier
    s_waitcnt lgkmcnt(8)
    v_mfma_f32_32x32x16_bf16 v[192:207], a[116:119], v[72:75], v[192:207]
    ds_read_b64_tr_b16 a[112:113], v234 offset:0
    ds_read_b64_tr_b16 a[114:115], v234 offset:1280
    s_add_u32 m0, s59, 122880
    s_add_u32 s63, s64, 2304
    v_mfma_f32_32x32x16_bf16 v[208:223], a[120:123], v[72:75], v[208:223]
    ds_read_b64_tr_b16 a[116:117], v234 offset:64
    ds_read_b64_tr_b16 a[118:119], v234 offset:1344
    v_mfma_f32_32x32x16_bf16 v[144:159], a[124:127], v[76:79], v[144:159]
    ds_read_b64_tr_b16 a[120:121], v234 offset:128
    ds_read_b64_tr_b16 a[122:123], v234 offset:1408
    buffer_load_dwordx4 v224, s[12:15], s63 offen offset:0 lds
    s_waitcnt lgkmcnt(8)
    v_mfma_f32_32x32x16_bf16 v[160:175], a[96:99], v[76:79], v[160:175]
    ds_read_b64_tr_b16 a[124:125], v234 offset:192
    ds_read_b64_tr_b16 a[126:127], v234 offset:1472
    v_mfma_f32_32x32x16_bf16 v[176:191], a[100:103], v[76:79], v[176:191]
    ds_read_b64_tr_b16 a[96:97], v234 offset:256
    ds_read_b64_tr_b16 a[98:99], v234 offset:1536
    buffer_load_dwordx4 v225, s[12:15], s63 offen offset:1024 lds
    v_mfma_f32_32x32x16_bf16 v[192:207], a[104:107], v[76:79], v[192:207]
    ds_read_b64_tr_b16 a[100:101], v234 offset:5120
    ds_read_b64_tr_b16 a[102:103], v234 offset:6400
    s_waitcnt lgkmcnt(8)
    v_mfma_f32_32x32x16_bf16 v[208:223], a[108:111], v[76:79], v[208:223]
    ds_read_b64_tr_b16 a[104:105], v234 offset:5184
    ds_read_b64_tr_b16 a[106:107], v234 offset:6464
    buffer_load_dwordx4 v226, s[12:15], s63 offen offset:2048 lds
    v_mfma_f32_32x32x16_bf16 v[144:159], a[112:115], v[80:83], v[144:159]
    ds_read_b64_tr_b16 a[108:109], v234 offset:5248
    ds_read_b64_tr_b16 a[110:111], v234 offset:6528
    v_mfma_f32_32x32x16_bf16 v[160:175], a[116:119], v[80:83], v[160:175]
    ds_read_b64_tr_b16 a[112:113], v234 offset:5312
    ds_read_b64_tr_b16 a[114:115], v234 offset:6592
    buffer_load_dwordx4 v227, s[12:15], s63 offen offset:3072 lds
    s_add_u32 m0, s59, 126976
    s_waitcnt lgkmcnt(8)
    v_mfma_f32_32x32x16_bf16 v[176:191], a[120:123], v[80:83], v[176:191]
    ds_read_b64_tr_b16 a[116:117], v234 offset:5376
    ds_read_b64_tr_b16 a[118:119], v234 offset:6656
    v_mfma_f32_32x32x16_bf16 v[192:207], a[124:127], v[80:83], v[192:207]
    ds_read_b64_tr_b16 a[120:121], v234 offset:10240
    ds_read_b64_tr_b16 a[122:123], v234 offset:11520
    buffer_load_dwordx4 v228, s[12:15], s63 offen offset:0 lds
    v_mfma_f32_32x32x16_bf16 v[208:223], a[96:99], v[80:83], v[208:223]
    ds_read_b64_tr_b16 a[124:125], v234 offset:10304
    ds_read_b64_tr_b16 a[126:127], v234 offset:11584
    s_waitcnt lgkmcnt(8)
    v_mfma_f32_32x32x16_bf16 v[144:159], a[100:103], v[84:87], v[144:159]
    ds_read_b64_tr_b16 a[96:97], v234 offset:10368
    ds_read_b64_tr_b16 a[98:99], v234 offset:11648
    v_mfma_f32_32x32x16_bf16 v[160:175], a[104:107], v[84:87], v[160:175]
    ds_read_b64_tr_b16 a[100:101], v234 offset:10432
    ds_read_b64_tr_b16 a[102:103], v234 offset:11712
    v_mfma_f32_32x32x16_bf16 v[176:191], a[108:111], v[84:87], v[176:191]
    ds_read_b64_tr_b16 a[104:105], v234 offset:10496
    ds_read_b64_tr_b16 a[106:107], v234 offset:11776
    s_waitcnt lgkmcnt(8)
    v_mfma_f32_32x32x16_bf16 v[192:207], a[112:115], v[84:87], v[192:207]
    ds_read_b64_tr_b16 a[108:109], v234 offset:15360
    ds_read_b64_tr_b16 a[110:111], v234 offset:16640
    v_mfma_f32_32x32x16_bf16 v[208:223], a[116:119], v[84:87], v[208:223]
    ds_read_b64_tr_b16 a[112:113], v234 offset:15424
    ds_read_b64_tr_b16 a[114:115], v234 offset:16704
    v_mfma_f32_32x32x16_bf16 v[144:159], a[120:123], v[88:91], v[144:159]
    ds_read_b64_tr_b16 a[116:117], v234 offset:15488
    ds_read_b64_tr_b16 a[118:119], v234 offset:16768
    s_waitcnt lgkmcnt(8)
    v_mfma_f32_32x32x16_bf16 v[160:175], a[124:127], v[88:91], v[160:175]
    ds_read_b64_tr_b16 a[120:121], v234 offset:15552
    ds_read_b64_tr_b16 a[122:123], v234 offset:16832
    v_mfma_f32_32x32x16_bf16 v[176:191], a[96:99], v[88:91], v[176:191]
    ds_read_b64_tr_b16 a[124:125], v234 offset:15616
    ds_read_b64_tr_b16 a[126:127], v234 offset:16896
    s_waitcnt vmcnt(15)
    s_barrier
    v_mfma_f32_32x32x16_bf16 v[192:207], a[100:103], v[88:91], v[192:207]
    ds_read_b64_tr_b16 a[96:97], v234 offset:20480
    ds_read_b64_tr_b16 a[98:99], v234 offset:21760
    s_add_u32 m0, s59, 143360
    s_add_u32 s63, s65, 2304
    s_waitcnt lgkmcnt(8)
    v_mfma_f32_32x32x16_bf16 v[208:223], a[104:107], v[88:91], v[208:223]
    ds_read_b64_tr_b16 a[100:101], v234 offset:20544
    ds_read_b64_tr_b16 a[102:103], v234 offset:21824
    v_mfma_f32_32x32x16_bf16 v[144:159], a[108:111], v[92:95], v[144:159]
    ds_read_b64_tr_b16 a[104:105], v234 offset:20608
    ds_read_b64_tr_b16 a[106:107], v234 offset:21888
    buffer_load_dwordx4 v224, s[12:15], s63 offen offset:0 lds
    v_mfma_f32_32x32x16_bf16 v[160:175], a[112:115], v[92:95], v[160:175]
    ds_read_b64_tr_b16 a[108:109], v234 offset:20672
    ds_read_b64_tr_b16 a[110:111], v234 offset:21952
    s_waitcnt lgkmcnt(8)
    v_mfma_f32_32x32x16_bf16 v[176:191], a[116:119], v[92:95], v[176:191]
    ds_read_b64_tr_b16 a[112:113], v234 offset:20736
    ds_read_b64_tr_b16 a[114:115], v234 offset:22016
    buffer_load_dwordx4 v225, s[12:15], s63 offen offset:1024 lds
    v_mfma_f32_32x32x16_bf16 v[192:207], a[120:123], v[92:95], v[192:207]
    ds_read_b64_tr_b16 a[116:117], v234 offset:25600
    ds_read_b64_tr_b16 a[118:119], v234 offset:26880
    v_mfma_f32_32x32x16_bf16 v[208:223], a[124:127], v[92:95], v[208:223]
    ds_read_b64_tr_b16 a[120:121], v234 offset:25664
    ds_read_b64_tr_b16 a[122:123], v234 offset:26944
    buffer_load_dwordx4 v226, s[12:15], s63 offen offset:2048 lds
    s_waitcnt lgkmcnt(8)
    v_mfma_f32_32x32x16_bf16 v[144:159], a[96:99], v[96:99], v[144:159]
    ds_read_b64_tr_b16 a[124:125], v234 offset:25728
    ds_read_b64_tr_b16 a[126:127], v234 offset:27008
    v_mfma_f32_32x32x16_bf16 v[160:175], a[100:103], v[96:99], v[160:175]
    ds_read_b64_tr_b16 a[96:97], v234 offset:25792
    ds_read_b64_tr_b16 a[98:99], v234 offset:27072
    buffer_load_dwordx4 v227, s[12:15], s63 offen offset:3072 lds
    s_add_u32 m0, s59, 147456
    v_mfma_f32_32x32x16_bf16 v[176:191], a[104:107], v[96:99], v[176:191]
    ds_read_b64_tr_b16 a[100:101], v234 offset:25856
    ds_read_b64_tr_b16 a[102:103], v234 offset:27136
    s_waitcnt lgkmcnt(8)
    v_mfma_f32_32x32x16_bf16 v[192:207], a[108:111], v[96:99], v[192:207]
    ds_read_b64_tr_b16 a[104:105], v234 offset:30720
    ds_read_b64_tr_b16 a[106:107], v234 offset:32000
    buffer_load_dwordx4 v228, s[12:15], s63 offen offset:0 lds
    v_mfma_f32_32x32x16_bf16 v[208:223], a[112:115], v[96:99], v[208:223]
    ds_read_b64_tr_b16 a[108:109], v234 offset:30784
    ds_read_b64_tr_b16 a[110:111], v234 offset:32064
    v_mfma_f32_32x32x16_bf16 v[144:159], a[116:119], v[100:103], v[144:159]
    ds_read_b64_tr_b16 a[112:113], v234 offset:30848
    ds_read_b64_tr_b16 a[114:115], v234 offset:32128
    s_waitcnt lgkmcnt(8)
    v_mfma_f32_32x32x16_bf16 v[160:175], a[120:123], v[100:103], v[160:175]
    ds_read_b64_tr_b16 a[116:117], v234 offset:30912
    ds_read_b64_tr_b16 a[118:119], v234 offset:32192
    v_mfma_f32_32x32x16_bf16 v[176:191], a[124:127], v[100:103], v[176:191]
    ds_read_b64_tr_b16 a[120:121], v234 offset:30976
    ds_read_b64_tr_b16 a[122:123], v234 offset:32256
    v_mfma_f32_32x32x16_bf16 v[192:207], a[96:99], v[100:103], v[192:207]
    ds_read_b64_tr_b16 a[124:125], v234 offset:35840
    ds_read_b64_tr_b16 a[126:127], v234 offset:37120
    s_waitcnt lgkmcnt(8)
    v_mfma_f32_32x32x16_bf16 v[208:223], a[100:103], v[100:103], v[208:223]
    ds_read_b64_tr_b16 a[96:97], v234 offset:35904
    ds_read_b64_tr_b16 a[98:99], v234 offset:37184
    v_mfma_f32_32x32x16_bf16 v[144:159], a[104:107], v[104:107], v[144:159]
    ds_read_b64_tr_b16 a[100:101], v234 offset:35968
    ds_read_b64_tr_b16 a[102:103], v234 offset:37248
    v_mfma_f32_32x32x16_bf16 v[160:175], a[108:111], v[104:107], v[160:175]
    ds_read_b64_tr_b16 a[104:105], v234 offset:36032
    ds_read_b64_tr_b16 a[106:107], v234 offset:37312
    s_waitcnt lgkmcnt(8)
    v_mfma_f32_32x32x16_bf16 v[176:191], a[112:115], v[104:107], v[176:191]
    ds_read_b64_tr_b16 a[108:109], v234 offset:36096
    ds_read_b64_tr_b16 a[110:111], v234 offset:37376
    s_waitcnt vmcnt(15)
    s_barrier
    v_mfma_f32_32x32x16_bf16 v[192:207], a[116:119], v[104:107], v[192:207]
    ds_read_b64_tr_b16 a[112:113], v233 offset:22528
    ds_read_b64_tr_b16 a[114:115], v233 offset:23808
    ds_read_b64_tr_b16 a[128:129], v237 offset:0
    s_add_u32 m0, s59, 79872
    s_add_u32 s63, s66, 2304
    v_lshrrev_b32 v248, 4, v240
    v_mfma_f32_32x32x16_bf16 v[208:223], a[120:123], v[104:107], v[208:223]
    ds_read_b64_tr_b16 a[116:117], v233 offset:22592
    ds_read_b64_tr_b16 a[118:119], v233 offset:23872
    ds_read_b64_tr_b16 a[130:131], v237 offset:512
    v_and_b32 v249, 15, v240
    v_lshlrev_b32 v249, 2, v249
    s_waitcnt lgkmcnt(10)
    v_mfma_f32_32x32x16_bf16 v[144:159], a[124:127], v[108:111], v[144:159]
    ds_read_b64_tr_b16 a[120:121], v233 offset:22656
    ds_read_b64_tr_b16 a[122:123], v233 offset:23936
    ds_read_b64_tr_b16 a[132:133], v237 offset:1024
    buffer_load_dwordx4 v224, s[12:15], s63 offen offset:0 lds
    v_lshl_add_u32 v229, v248, 8, v249
    v_mov_b32 v250, 0x7ffffff0
    v_mfma_f32_32x32x16_bf16 v[160:175], a[96:99], v[108:111], v[160:175]
    ds_read_b64_tr_b16 a[124:125], v233 offset:22720
    ds_read_b64_tr_b16 a[126:127], v233 offset:24000
    ds_read_b64_tr_b16 a[134:135], v237 offset:1536
    v_cmp_gt_u32 vcc, 16, v240
    s_nop 1
    v_cndmask_b32 v230, v250, v249, vcc
    v_and_b32 v248, 31, v240
    v_mfma_f32_32x32x16_bf16 v[176:191], a[100:103], v[108:111], v[176:191]
    ds_read_b64_tr_b16 a[96:97], v233 offset:22784
    ds_read_b64_tr_b16 a[98:99], v233 offset:24064
    ds_read_b64_tr_b16 a[136:137], v237 offset:2048
    buffer_load_dwordx4 v225, s[12:15], s63 offen offset:1024 lds
    s_lshl_b32 s42, s3, 5
    s_waitcnt lgkmcnt(13)
    v_mfma_f32_32x32x16_bf16 v[192:207], a[104:107], v[108:111], v[192:207]
    ds_read_b64_tr_b16 a[100:101], v233 offset:27648
    ds_read_b64_tr_b16 a[102:103], v233 offset:28928
    ds_read_b64_tr_b16 a[138:139], v237 offset:2560
    v_add_u32 v248, s42, v248
    v_mul_u32_u24 v232, 304, v248
    v_lshl_add_u32 v231, v241, 4, v232
    v_mfma_f32_32x32x16_bf16 v[208:223], a[108:111], v[108:111], v[208:223]
    ds_read_b64_tr_b16 a[104:105], v233 offset:27712
    ds_read_b64_tr_b16 a[106:107], v233 offset:28992
    ds_read_b64_tr_b16 a[140:141], v237 offset:3072
    buffer_load_dwordx4 v226, s[12:15], s63 offen offset:2048 lds
    v_add_u32 v231, 256, v231
    v_lshl_add_u32 v232, v241, 5, v232
    v_mfma_f32_32x32x16_bf16 v[144:159], a[112:115], v[112:115], v[144:159]
    ds_read_b64_tr_b16 a[108:109], v233 offset:27776
    ds_read_b64_tr_b16 a[110:111], v233 offset:29056
    ds_read_b64_tr_b16 a[142:143], v237 offset:3584
    v_mul_u32_u24 v249, 336, v248
    v_add_u32 v249, 79872, v249
    s_waitcnt lgkmcnt(13)
    v_mfma_f32_32x32x16_bf16 v[160:175], a[116:119], v[112:115], v[160:175]
    ds_read_b64_tr_b16 a[112:113], v233 offset:27840
    ds_read_b64_tr_b16 a[114:115], v233 offset:29120
    ds_read_b64_tr_b16 a[144:145], v237 offset:4096
    buffer_load_dwordx4 v227, s[12:15], s63 offen offset:3072 lds
    s_add_u32 m0, s59, 83968
    v_lshl_add_u32 v244, v241, 3, v249
    v_mul_u32_u24 v250, 12, v241
    v_mfma_f32_32x32x16_bf16 v[176:191], a[120:123], v[112:115], v[176:191]
    ds_read_b64_tr_b16 a[116:117], v233 offset:27904
    ds_read_b64_tr_b16 a[118:119], v233 offset:29184
    ds_read_b64_tr_b16 a[146:147], v237 offset:4608
    v_add_u32 v245, v250, v249
    v_mul_u32_u24 v250, 160, v241
    v_add_u32 v236, v250, v249
    v_mfma_f32_32x32x16_bf16 v[192:207], a[124:127], v[112:115], v[192:207]
    ds_read_b64_tr_b16 a[120:121], v233 offset:32768
    ds_read_b64_tr_b16 a[122:123], v233 offset:34048
    ds_read_b64_tr_b16 a[148:149], v237 offset:5120
    buffer_load_dwordx4 v228, s[12:15], s63 offen offset:0 lds
    s_mul_i32 s42, s3, 3840
    s_waitcnt lgkmcnt(13)
    v_mfma_f32_32x32x16_bf16 v[208:223], a[96:99], v[112:115], v[208:223]
    ds_read_b64_tr_b16 a[124:125], v233 offset:32832
    ds_read_b64_tr_b16 a[126:127], v233 offset:34112
    ds_read_b64_tr_b16 a[150:151], v237 offset:5632
    s_add_u32 s40, s61, s42
    s_add_u32 s41, s40, 15360
    v_mfma_f32_32x32x16_bf16 v[144:159], a[100:103], v[116:119], v[144:159]
    ds_read_b64_tr_b16 a[96:97], v233 offset:32896
    ds_read_b64_tr_b16 a[98:99], v233 offset:34176
    ds_read_b64_tr_b16 a[152:153], v237 offset:6144
    v_mfma_f32_32x32x16_bf16 v[160:175], a[104:107], v[116:119], v[160:175]
    ds_read_b64_tr_b16 a[100:101], v233 offset:32960
    ds_read_b64_tr_b16 a[102:103], v233 offset:34240
    ds_read_b64_tr_b16 a[154:155], v237 offset:6656
    s_waitcnt lgkmcnt(13)
    v_mfma_f32_32x32x16_bf16 v[176:191], a[108:111], v[116:119], v[176:191]
    ds_read_b64_tr_b16 a[104:105], v233 offset:33024
    ds_read_b64_tr_b16 a[106:107], v233 offset:34304
    ds_read_b64_tr_b16 a[156:157], v237 offset:7168
    v_mfma_f32_32x32x16_bf16 v[192:207], a[112:115], v[116:119], v[192:207]
    ds_read_b64_tr_b16 a[108:109], v233 offset:37888
    ds_read_b64_tr_b16 a[110:111], v233 offset:39168
    ds_read_b64_tr_b16 a[158:159], v237 offset:7680
    s_nop 0
L_sa3:
    s_cbranch_execz L_reta
    v_mfma_f32_32x32x16_bf16 v[208:223], a[116:119], v[116:119], v[208:223]
    ds_read_b64_tr_b16 a[112:113], v233 offset:37952
    ds_read_b64_tr_b16 a[114:115], v233 offset:39232
    ds_read_b64_tr_b16 a[160:161], v237 offset:8192
    s_waitcnt lgkmcnt(13)
    v_mfma_f32_32x32x16_bf16 v[144:159], a[120:123], v[120:123], v[144:159]
    ds_read_b64_tr_b16 a[116:117], v233 offset:38016
    ds_read_b64_tr_b16 a[118:119], v233 offset:39296
    ds_read_b64_tr_b16 a[162:163], v237 offset:8704
    v_mfma_f32_32x32x16_bf16 v[160:175], a[124:127], v[120:123], v[160:175]
    ds_read_b64_tr_b16 a[120:121], v233 offset:38080
    ds_read_b64_tr_b16 a[122:123], v233 offset:39360
    ds_read_b64_tr_b16 a[164:165], v237 offset:9216
    v_mfma_f32_32x32x16_bf16 v[176:191], a[96:99], v[120:123], v[176:191]
    ds_read_b64_tr_b16 a[124:125], v233 offset:38144
    ds_read_b64_tr_b16 a[126:127], v233 offset:39424
    ds_read_b64_tr_b16 a[166:167], v237 offset:9728
    s_waitcnt vmcnt(15)
    s_barrier
    s_waitcnt lgkmcnt(13)
    v_mfma_f32_32x32x16_bf16 v[192:207], a[100:103], v[120:123], v[192:207]
    ds_read_b64_tr_b16 a[96:97], v233 offset:43008
    ds_read_b64_tr_b16 a[98:99], v233 offset:44288
    ds_read_b64_tr_b16 a[168:169], v237 offset:10240
    s_add_u32 m0, s59, 100352
    s_add_u32 s63, s67, 2304
    v_mfma_f32_32x32x16_bf16 v[208:223], a[104:107], v[120:123], v[208:223]
    ds_read_b64_tr_b16 a[100:101], v233 offset:48128
    ds_read_b64_tr_b16 a[102:103], v233 offset:49408
    ds_read_b64_tr_b16 a[170:171], v237 offset:10752
    v_mfma_f32_32x32x16_bf16 v[144:159], a[108:111], v[124:127], v[144:159]
    ds_read_b64_tr_b16 a[104:105], v233 offset:53248
    ds_read_b64_tr_b16 a[106:107], v233 offset:54528
    ds_read_b64_tr_b16 a[172:173], v237 offset:11264
    buffer_load_dwordx4 v224, s[12:15], s63 offen offset:0 lds
    s_waitcnt lgkmcnt(13)
    v_mfma_f32_32x32x16_bf16 v[160:175], a[112:115], v[124:127], v[160:175]
    ds_read_b64_tr_b16 a[108:109], v233 offset:58368
    ds_read_b64_tr_b16 a[110:111], v233 offset:59648
    ds_read_b64_tr_b16 a[174:175], v237 offset:11776
    v_mfma_f32_32x32x16_bf16 v[176:191], a[116:119], v[124:127], v[176:191]
    ds_read_b64_tr_b16 a[112:113], v233 offset:43072
    ds_read_b64_tr_b16 a[114:115], v233 offset:44352
    ds_read_b64_tr_b16 a[176:177], v237 offset:12288
    buffer_load_dwordx4 v225, s[12:15], s63 offen offset:1024 lds
    v_mfma_f32_32x32x16_bf16 v[192:207], a[120:123], v[124:127], v[192:207]
    ds_read_b64_tr_b16 a[116:117], v233 offset:48192
    ds_read_b64_tr_b16 a[118:119], v233 offset:49472
    ds_read_b64_tr_b16 a[178:179], v237 offset:12800
    s_waitcnt lgkmcnt(13)
    v_mfma_f32_32x32x16_bf16 v[208:223], a[124:127], v[124:127], v[208:223]
    ds_read_b64_tr_b16 a[120:121], v233 offset:53312
    ds_read_b64_tr_b16 a[122:123], v233 offset:54592
    ds_read_b64_tr_b16 a[180:181], v237 offset:13312
    buffer_load_dwordx4 v226, s[12:15], s63 offen offset:2048 lds
    v_mfma_f32_32x32x16_bf16 v[144:159], a[96:99], v[128:131], v[144:159]
    ds_read_b64_tr_b16 a[124:125], v233 offset:58432
    ds_read_b64_tr_b16 a[126:127], v233 offset:59712
    ds_read_b64_tr_b16 a[182:183], v237 offset:13824
    v_mfma_f32_32x32x16_bf16 v[144:159], a[100:103], v[132:135], v[144:159]
    ds_read_b64_tr_b16 a[96:97], v233 offset:43136
    ds_read_b64_tr_b16 a[98:99], v233 offset:44416
    ds_read_b64_tr_b16 a[184:185], v237 offset:14336
    buffer_load_dwordx4 v227, s[12:15], s63 offen offset:3072 lds
    s_add_u32 m0, s59, 104448
    s_waitcnt lgkmcnt(13)
    v_mfma_f32_32x32x16_bf16 v[144:159], a[104:107], v[136:139], v[144:159]
    ds_read_b64_tr_b16 a[100:101], v233 offset:48256
    ds_read_b64_tr_b16 a[102:103], v233 offset:49536
    ds_read_b64_tr_b16 a[186:187], v237 offset:14848
    v_mfma_f32_32x32x16_bf16 v[144:159], a[108:111], v[140:143], v[144:159]
    ds_read_b64_tr_b16 a[104:105], v233 offset:53376
    ds_read_b64_tr_b16 a[106:107], v233 offset:54656
    ds_read_b64_tr_b16 a[188:189], v237 offset:15360
    buffer_load_dwordx4 v228, s[12:15], s63 offen offset:0 lds
    v_mfma_f32_32x32x16_bf16 v[160:175], a[112:115], v[128:131], v[160:175]
    ds_read_b64_tr_b16 a[108:109], v233 offset:58496
    ds_read_b64_tr_b16 a[110:111], v233 offset:59776
    ds_read_b64_tr_b16 a[190:191], v237 offset:15872
    s_waitcnt lgkmcnt(13)
    v_mfma_f32_32x32x16_bf16 v[160:175], a[116:119], v[132:135], v[160:175]
    ds_read_b64_tr_b16 a[112:113], v233 offset:43200
    ds_read_b64_tr_b16 a[114:115], v233 offset:44480
    v_mfma_f32_32x32x16_bf16 v[160:175], a[120:123], v[136:139], v[160:175]
    ds_read_b64_tr_b16 a[116:117], v233 offset:48320
    ds_read_b64_tr_b16 a[118:119], v233 offset:49600
    v_cvt_pk_bf16_f32 v144, v144, v145
    v_cvt_pk_bf16_f32 v145, v146, v147
    v_cvt_pk_bf16_f32 v146, v148, v149
    v_cvt_pk_bf16_f32 v147, v150, v151
    v_mfma_f32_32x32x16_bf16 v[160:175], a[124:127], v[140:143], v[160:175]
    ds_read_b64_tr_b16 a[120:121], v233 offset:53440
    ds_read_b64_tr_b16 a[122:123], v233 offset:54720
    v_cvt_pk_bf16_f32 v148, v152, v153
    v_cvt_pk_bf16_f32 v149, v154, v155
    v_cvt_pk_bf16_f32 v150, v156, v157
    s_waitcnt lgkmcnt(10)
    v_mfma_f32_32x32x16_bf16 v[176:191], a[96:99], v[128:131], v[176:191]
    ds_read_b64_tr_b16 a[124:125], v233 offset:58560
    ds_read_b64_tr_b16 a[126:127], v233 offset:59840
    v_cvt_pk_bf16_f32 v151, v158, v159
    v_mfma_f32_32x32x16_bf16 v[176:191], a[100:103], v[132:135], v[176:191]
    ds_read_b64_tr_b16 a[96:97], v233 offset:43264
    ds_read_b64_tr_b16 a[98:99], v233 offset:44544
    v_mfma_f32_32x32x16_bf16 v[176:191], a[104:107], v[136:139], v[176:191]
    ds_read_b64_tr_b16 a[100:101], v233 offset:48384
    ds_read_b64_tr_b16 a[102:103], v233 offset:49664
    v_cvt_pk_bf16_f32 v152, v160, v161
    v_cvt_pk_bf16_f32 v153, v162, v163
    v_cvt_pk_bf16_f32 v154, v164, v165
    s_waitcnt lgkmcnt(8)
    v_mfma_f32_32x32x16_bf16 v[176:191], a[108:111], v[140:143], v[176:191]
    ds_read_b64_tr_b16 a[104:105], v233 offset:53504
    ds_read_b64_tr_b16 a[106:107], v233 offset:54784
    v_cvt_pk_bf16_f32 v155, v166, v167
    v_cvt_pk_bf16_f32 v156, v168, v169
    v_cvt_pk_bf16_f32 v157, v170, v171
    v_cvt_pk_bf16_f32 v158, v172, v173
    v_mfma_f32_32x32x16_bf16 v[192:207], a[112:115], v[128:131], v[192:207]
    ds_read_b64_tr_b16 a[108:109], v233 offset:58624
    ds_read_b64_tr_b16 a[110:111], v233 offset:59904
    v_cvt_pk_bf16_f32 v159, v174, v175
    s_waitcnt vmcnt(15)
    s_barrier
    v_mfma_f32_32x32x16_bf16 v[192:207], a[116:119], v[132:135], v[192:207]
    ds_read_b64_tr_b16 a[112:113], v234 offset:43008
    ds_read_b64_tr_b16 a[114:115], v234 offset:44288
    v_mov_b32 v237, 0
    s_add_u32 m0, s59, 38912
    s_add_u32 s63, s68, 2304
    s_waitcnt lgkmcnt(8)
    v_mfma_f32_32x32x16_bf16 v[192:207], a[120:123], v[136:139], v[192:207]
    ds_read_b64_tr_b16 a[116:117], v234 offset:43072
    ds_read_b64_tr_b16 a[118:119], v234 offset:44352
    v_cvt_pk_bf16_f32 v160, v176, v177
    v_cvt_pk_bf16_f32 v161, v178, v179
    v_cvt_pk_bf16_f32 v162, v180, v181
    v_cvt_pk_bf16_f32 v163, v182, v183
    v_mfma_f32_32x32x16_bf16 v[192:207], a[124:127], v[140:143], v[192:207]
    ds_read_b64_tr_b16 a[120:121], v234 offset:43136
    ds_read_b64_tr_b16 a[122:123], v234 offset:44416
    buffer_load_dwordx4 v224, s[12:15], s63 offen offset:0 lds
    v_cvt_pk_bf16_f32 v164, v184, v185
    v_cvt_pk_bf16_f32 v165, v186, v187
    v_cvt_pk_bf16_f32 v166, v188, v189
    v_mfma_f32_32x32x16_bf16 v[208:223], a[96:99], v[128:131], v[208:223]
    ds_read_b64_tr_b16 a[124:125], v234 offset:43200
    ds_read_b64_tr_b16 a[126:127], v234 offset:44480
    v_cvt_pk_bf16_f32 v167, v190, v191
    s_waitcnt lgkmcnt(8)
    v_mfma_f32_32x32x16_bf16 v[208:223], a[100:103], v[132:135], v[208:223]
    ds_read_b64_tr_b16 a[96:97], v234 offset:43264
    ds_read_b64_tr_b16 a[98:99], v234 offset:44544
    buffer_load_dwordx4 v225, s[12:15], s63 offen offset:1024 lds
    v_mfma_f32_32x32x16_bf16 v[208:223], a[104:107], v[136:139], v[208:223]
    ds_read_b64_tr_b16 a[100:101], v234 offset:48128
    ds_read_b64_tr_b16 a[102:103], v234 offset:49408
    v_cvt_pk_bf16_f32 v168, v192, v193
    v_cvt_pk_bf16_f32 v169, v194, v195
    v_cvt_pk_bf16_f32 v170, v196, v197
    v_cvt_pk_bf16_f32 v171, v198, v199
    v_mfma_f32_32x32x16_bf16 v[208:223], a[108:111], v[140:143], v[208:223]
    ds_read_b64_tr_b16 a[104:105], v234 offset:48192
    ds_read_b64_tr_b16 a[106:107], v234 offset:49472
    buffer_load_dwordx4 v226, s[12:15], s63 offen offset:2048 lds
    v_cvt_pk_bf16_f32 v172, v200, v201
    v_cvt_pk_bf16_f32 v173, v202, v203
    s_waitcnt lgkmcnt(8)
    v_mfma_f32_32x32x16_bf16 a[0:15], a[112:115], v[0:3], 0
    ds_read_b64_tr_b16 a[108:109], v234 offset:48256
    ds_read_b64_tr_b16 a[110:111], v234 offset:49536
    v_cvt_pk_bf16_f32 v174, v204, v205
    v_cvt_pk_bf16_f32 v175, v206, v207
    v_mfma_f32_32x32x16_bf16 a[16:31], a[116:119], v[0:3], 0
    ds_read_b64_tr_b16 a[112:113], v234 offset:48320
    ds_read_b64_tr_b16 a[114:115], v234 offset:49600
    buffer_load_dwordx4 v227, s[12:15], s63 offen offset:3072 lds
    s_add_u32 m0, s59, 43008
    v_mfma_f32_32x32x16_bf16 a[32:47], a[120:123], v[0:3], 0
    ds_read_b64_tr_b16 a[116:117], v234 offset:48384
    ds_read_b64_tr_b16 a[118:119], v234 offset:49664
    v_cvt_pk_bf16_f32 v176, v208, v209
    v_cvt_pk_bf16_f32 v177, v210, v211
    v_cvt_pk_bf16_f32 v178, v212, v213
    s_waitcnt lgkmcnt(8)
    v_mfma_f32_32x32x16_bf16 a[48:63], a[124:127], v[0:3], 0
    ds_read_b64_tr_b16 a[120:121], v234 offset:53248
    ds_read_b64_tr_b16 a[122:123], v234 offset:54528
    buffer_load_dwordx4 v228, s[12:15], s63 offen offset:0 lds
    v_cvt_pk_bf16_f32 v179, v214, v215
    v_mfma_f32_32x32x16_bf16 v[180:195], a[128:131], v[144:147], 0
    v_mfma_f32_32x32x16_bf16 v[180:195], a[132:135], v[148:151], v[180:195]
    v_bfe_u32 v254, v240, 4, 1
    v_lshl_add_u32 v254, v254, 2, v242
    v_lshl_add_u32 v254, v254, 1, v241
    v_and_b32 v255, 3, v240
    s_mul_i32 s42, s3, 40
    s_add_u32 s42, s42, 79872
    v_mfma_f32_32x32x16_bf16 a[64:79], a[96:99], v[0:3], 0
    ds_read_b64_tr_b16 a[124:125], v234 offset:53312
    ds_read_b64_tr_b16 a[126:127], v234 offset:54592
    v_mul_u32_u24 v246, 336, v254
    v_add_u32 v246, s42, v246
    v_lshl_add_u32 v218, v255, 3, v246
    v_add_u32 v219, 32, v246
    v_mfma_f32_32x32x16_bf16 a[0:15], a[100:103], v[4:7], a[0:15]
    ds_read_b64_tr_b16 a[96:97], v234 offset:53376
    ds_read_b64_tr_b16 a[98:99], v234 offset:54656
    s_lshl_b32 s42, s3, 6
    v_mul_u32_u24 v246, 304, v254
    v_lshl_add_u32 v220, v255, 3, v246
    s_waitcnt lgkmcnt(8)
    v_mfma_f32_32x32x16_bf16 a[16:31], a[104:107], v[4:7], a[16:31]
    ds_read_b64_tr_b16 a[100:101], v234 offset:53440
    ds_read_b64_tr_b16 a[102:103], v234 offset:54720
    v_add_u32 v220, s42, v220
    s_lshr_b32 s42, s3, 1
    s_lshl_b32 s42, s42, 3
    s_add_u32 s42, s42, 256
    v_mfma_f32_32x32x16_bf16 a[32:47], a[108:111], v[4:7], a[32:47]
    ds_read_b64_tr_b16 a[104:105], v234 offset:53504
    ds_read_b64_tr_b16 a[106:107], v234 offset:54784
    v_and_b32 v255, 1, v240
    v_lshl_add_u32 v221, v255, 4, v246
    v_add_u32 v221, s42, v221
    v_lshlrev_b32 v222, 2, v240
    v_mfma_f32_32x32x16_bf16 a[48:63], a[112:115], v[4:7], a[48:63]
    ds_read_b64_tr_b16 a[108:109], v234 offset:58368
    ds_read_b64_tr_b16 a[110:111], v234 offset:59648
    v_mov_b32 v223, 0x7ffffff0
    v_cmp_gt_u32 vcc, 32, v240
    s_nop 1
    v_cndmask_b32 v222, v223, v222, vcc
    s_waitcnt lgkmcnt(8)
    v_mfma_f32_32x32x16_bf16 a[64:79], a[116:119], v[4:7], a[64:79]
    ds_read_b64_tr_b16 a[112:113], v234 offset:58432
    ds_read_b64_tr_b16 a[114:115], v234 offset:59712
    v_mov_b32 v223, 1
    v_cndmask_b32 v188, v188, v189, s[46:47]
    v_max3_f32 v248, v180, v181, v182
    v_max3_f32 v249, -v180, -v181, -v182
    v_mfma_f32_32x32x16_bf16 a[0:15], a[120:123], v[8:11], a[0:15]
    ds_read_b64_tr_b16 a[116:117], v234 offset:58496
    ds_read_b64_tr_b16 a[118:119], v234 offset:59776
    v_max3_f32 v248, v248, v183, v184
    v_max3_f32 v249, v249, -v183, -v184
    v_max3_f32 v248, v248, v185, v186
    v_max3_f32 v249, v249, -v185, -v186
    v_mfma_f32_32x32x16_bf16 a[16:31], a[124:127], v[8:11], a[16:31]
    ds_read_b64_tr_b16 a[120:121], v234 offset:58560
    ds_read_b64_tr_b16 a[122:123], v234 offset:59840
    v_max3_f32 v248, v248, v187, v188
    v_max3_f32 v249, v249, -v187, -v188
    s_waitcnt lgkmcnt(8)
    v_mfma_f32_32x32x16_bf16 a[32:47], a[96:99], v[8:11], a[32:47]
    ds_read_b64_tr_b16 a[124:125], v234 offset:58624
    ds_read_b64_tr_b16 a[126:127], v234 offset:59904
    v_permlane32_swap_b32 v248, v249
    v_max_f32 v248, v248, v249
    v_mov_b32 v249, v248
    s_waitcnt vmcnt(15)
    s_barrier
    v_mfma_f32_32x32x16_bf16 a[48:63], a[100:103], v[8:11], a[48:63]
    ds_read_b64_tr_b16 a[96:97], v235 offset:0
    ds_read_b64_tr_b16 a[98:99], v235 offset:1280
    s_add_u32 m0, s59, 59392
    s_add_u32 s63, s69, 2304
    v_permlane32_swap_b32 v248, v249
    v_mfma_f32_32x32x16_bf16 a[64:79], a[104:107], v[8:11], a[64:79]
    ds_read_b64_tr_b16 a[100:101], v235 offset:64
    ds_read_b64_tr_b16 a[102:103], v235 offset:1344
    v_sub_f32 v196, v180, v248
    v_sub_f32_e64 v197, -v180, v249
    v_sub_f32 v198, v181, v248
    s_waitcnt lgkmcnt(8)
    v_mfma_f32_32x32x16_bf16 a[0:15], a[108:111], v[12:15], a[0:15]
    ds_read_b64_tr_b16 a[104:105], v235 offset:128
    ds_read_b64_tr_b16 a[106:107], v235 offset:1408
    buffer_load_dwordx4 v224, s[12:15], s63 offen offset:0 lds
    v_sub_f32_e64 v199, -v181, v249
    v_sub_f32 v200, v182, v248
    v_sub_f32_e64 v201, -v182, v249
    v_mfma_f32_32x32x16_bf16 a[16:31], a[112:115], v[12:15], a[16:31]
    ds_read_b64_tr_b16 a[108:109], v235 offset:192
    ds_read_b64_tr_b16 a[110:111], v235 offset:1472
    v_sub_f32 v202, v183, v248
    v_sub_f32_e64 v203, -v183, v249
    v_sub_f32 v204, v184, v248
    v_sub_f32_e64 v205, -v184, v249
    v_mfma_f32_32x32x16_bf16 a[32:47], a[116:119], v[12:15], a[32:47]
    ds_read_b64_tr_b16 a[112:113], v235 offset:256
    ds_read_b64_tr_b16 a[114:115], v235 offset:1536
    buffer_load_dwordx4 v225, s[12:15], s63 offen offset:1024 lds
    v_sub_f32 v206, v185, v248
    v_sub_f32_e64 v207, -v185, v249
    s_waitcnt lgkmcnt(8)
    v_mfma_f32_32x32x16_bf16 a[48:63], a[120:123], v[12:15], a[48:63]
    ds_read_b64_tr_b16 a[116:117], v235 offset:5120
    ds_read_b64_tr_b16 a[118:119], v235 offset:6400
    v_sub_f32 v208, v186, v248
    v_sub_f32_e64 v209, -v186, v249
    v_sub_f32 v210, v187, v248
    v_sub_f32_e64 v211, -v187, v249
    v_mfma_f32_32x32x16_bf16 a[64:79], a[124:127], v[12:15], a[64:79]
    ds_read_b64_tr_b16 a[120:121], v235 offset:5184
    ds_read_b64_tr_b16 a[122:123], v235 offset:6464
    buffer_load_dwordx4 v226, s[12:15], s63 offen offset:2048 lds
    v_sub_f32 v212, v188, v248
    v_sub_f32_e64 v213, -v188, v249
    v_mfma_f32_32x32x16_bf16 v[180:195], a[136:139], v[148:151], 0
    v_exp_f32 v196, v196
    v_exp_f32 v197, v197
    v_exp_f32 v198, v198
    v_mfma_f32_32x32x16_bf16 a[0:15], a[96:99], v[16:19], a[0:15]
    ds_read_b64_tr_b16 a[124:125], v235 offset:5248
    ds_read_b64_tr_b16 a[126:127], v235 offset:6528
    v_mfma_f32_32x32x16_bf16 v[180:195], a[140:143], v[152:155], v[180:195]
    v_exp_f32 v199, v199
    v_exp_f32 v200, v200
    v_exp_f32 v201, v201
    s_waitcnt lgkmcnt(8)
    v_mfma_f32_32x32x16_bf16 a[16:31], a[100:103], v[16:19], a[16:31]
    ds_read_b64_tr_b16 a[96:97], v235 offset:5312
    ds_read_b64_tr_b16 a[98:99], v235 offset:6592
    buffer_load_dwordx4 v227, s[12:15], s63 offen offset:3072 lds
    s_add_u32 m0, s59, 63488
    v_exp_f32 v202, v202
    v_mfma_f32_32x32x16_bf16 a[32:47], a[104:107], v[16:19], a[32:47]
    ds_read_b64_tr_b16 a[100:101], v235 offset:5376
    ds_read_b64_tr_b16 a[102:103], v235 offset:6656
    v_exp_f32 v203, v203
    v_exp_f32 v204, v204
    v_mfma_f32_32x32x16_bf16 a[48:63], a[108:111], v[16:19], a[48:63]
    ds_read_b64_tr_b16 a[104:105], v235 offset:10240
    ds_read_b64_tr_b16 a[106:107], v235 offset:11520
    buffer_load_dwordx4 v228, s[12:15], s63 offen offset:0 lds
    v_exp_f32 v205, v205
    s_waitcnt lgkmcnt(8)
    v_mfma_f32_32x32x16_bf16 a[64:79], a[112:115], v[16:19], a[64:79]
    ds_read_b64_tr_b16 a[108:109], v235 offset:10304
    ds_read_b64_tr_b16 a[110:111], v235 offset:11584
    v_exp_f32 v206, v206
    v_exp_f32 v207, v207
    v_mfma_f32_32x32x16_bf16 a[0:15], a[116:119], v[20:23], a[0:15]
    ds_read_b64_tr_b16 a[112:113], v235 offset:10368
    ds_read_b64_tr_b16 a[114:115], v235 offset:11648
    v_exp_f32 v208, v208
    v_exp_f32 v209, v209
    v_mfma_f32_32x32x16_bf16 a[16:31], a[120:123], v[20:23], a[16:31]
    ds_read_b64_tr_b16 a[116:117], v235 offset:10432
    ds_read_b64_tr_b16 a[118:119], v235 offset:11712
    v_exp_f32 v210, v210
    s_waitcnt lgkmcnt(8)
    v_mfma_f32_32x32x16_bf16 a[32:47], a[124:127], v[20:23], a[32:47]
    ds_read_b64_tr_b16 a[120:121], v235 offset:10496
    ds_read_b64_tr_b16 a[122:123], v235 offset:11776
    v_exp_f32 v211, v211
    v_exp_f32 v212, v212
    v_mfma_f32_32x32x16_bf16 a[48:63], a[96:99], v[20:23], a[48:63]
    ds_read_b64_tr_b16 a[124:125], v235 offset:15360
    ds_read_b64_tr_b16 a[126:127], v235 offset:16640
    v_exp_f32 v213, v213
    v_add_f32 v250, v196, v198
    v_add_f32 v251, v197, v199
    v_mfma_f32_32x32x16_bf16 a[64:79], a[100:103], v[20:23], a[64:79]
    ds_read_b64_tr_b16 a[96:97], v235 offset:15424
    ds_read_b64_tr_b16 a[98:99], v235 offset:16704
    v_add_f32 v250, v250, v200
    v_add_f32 v251, v251, v201
    v_add_f32 v250, v250, v202
    s_waitcnt lgkmcnt(8)
    v_mfma_f32_32x32x16_bf16 a[0:15], a[104:107], v[24:27], a[0:15]
    ds_read_b64_tr_b16 a[100:101], v235 offset:15488
    ds_read_b64_tr_b16 a[102:103], v235 offset:16768
    v_add_f32 v251, v251, v203
    v_add_f32 v250, v250, v204
    v_add_f32 v251, v251, v205
    v_add_f32 v250, v250, v206
    v_mfma_f32_32x32x16_bf16 a[16:31], a[108:111], v[24:27], a[16:31]
    ds_read_b64_tr_b16 a[104:105], v235 offset:15552
    ds_read_b64_tr_b16 a[106:107], v235 offset:16832
    v_add_f32 v251, v251, v207
    v_add_f32 v250, v250, v208
    v_add_f32 v251, v251, v209
    v_add_f32 v250, v250, v210
    v_mfma_f32_32x32x16_bf16 a[32:47], a[112:115], v[24:27], a[32:47]
    ds_read_b64_tr_b16 a[108:109], v235 offset:15616
    ds_read_b64_tr_b16 a[110:111], v235 offset:16896
    v_add_f32 v251, v251, v211
    v_add_f32 v250, v250, v212
    v_add_f32 v251, v251, v213
    s_waitcnt vmcnt(15)
    s_barrier
    s_waitcnt lgkmcnt(8)
    v_mfma_f32_32x32x16_bf16 a[48:63], a[116:119], v[24:27], a[48:63]
    ds_read_b64_tr_b16 a[112:113], v234 offset:0
    ds_read_b64_tr_b16 a[114:115], v234 offset:1280
    s_add_u32 m0, s59, 122880
    s_add_u32 s63, s70, 2304
    v_cndmask_b32 v188, v188, v189, s[46:47]
    v_max3_f32 v248, v180, v181, v182
    v_mfma_f32_32x32x16_bf16 a[64:79], a[120:123], v[24:27], a[64:79]
    ds_read_b64_tr_b16 a[116:117], v234 offset:64
    ds_read_b64_tr_b16 a[118:119], v234 offset:1344
    v_permlane32_swap_b32 v250, v251
    v_max3_f32 v249, -v180, -v181, -v182
    v_max3_f32 v248, v248, v183, v184
    v_mfma_f32_32x32x16_bf16 a[0:15], a[124:127], v[28:31], a[0:15]
    ds_read_b64_tr_b16 a[120:121], v234 offset:128
    ds_read_b64_tr_b16 a[122:123], v234 offset:1408
    buffer_load_dwordx4 v224, s[12:15], s63 offen offset:0 lds
    v_add_f32 v250, v250, v251
    v_max3_f32 v249, v249, -v183, -v184
    s_waitcnt lgkmcnt(8)
    v_mfma_f32_32x32x16_bf16 a[16:31], a[96:99], v[28:31], a[16:31]
    ds_read_b64_tr_b16 a[124:125], v234 offset:192
    ds_read_b64_tr_b16 a[126:127], v234 offset:1472
    v_max3_f32 v248, v248, v185, v186
    v_rcp_f32 v250, v250
    v_max3_f32 v249, v249, -v185, -v186
    v_mfma_f32_32x32x16_bf16 a[32:47], a[100:103], v[28:31], a[32:47]
    ds_read_b64_tr_b16 a[96:97], v234 offset:256
    ds_read_b64_tr_b16 a[98:99], v234 offset:1536
    buffer_load_dwordx4 v225, s[12:15], s63 offen offset:1024 lds
    v_max3_f32 v248, v248, v187, v188
    v_mov_b32 v251, v250
    v_max3_f32 v249, v249, -v187, -v188
    v_mfma_f32_32x32x16_bf16 a[48:63], a[104:107], v[28:31], a[48:63]
    ds_read_b64_tr_b16 a[100:101], v234 offset:5120
    ds_read_b64_tr_b16 a[102:103], v234 offset:6400
    v_permlane32_swap_b32 v250, v251
    s_waitcnt lgkmcnt(8)
    v_mfma_f32_32x32x16_bf16 a[64:79], a[108:111], v[28:31], a[64:79]
    ds_read_b64_tr_b16 a[104:105], v234 offset:5184
    ds_read_b64_tr_b16 a[106:107], v234 offset:6464
    buffer_load_dwordx4 v226, s[12:15], s63 offen offset:2048 lds
    v_permlane32_swap_b32 v248, v249
    v_mul_f32 v196, v196, v250
    v_mfma_f32_32x32x16_bf16 a[0:15], a[112:115], v[32:35], a[0:15]
    ds_read_b64_tr_b16 a[108:109], v234 offset:5248
    ds_read_b64_tr_b16 a[110:111], v234 offset:6528
    v_mul_f32 v197, v197, v251
    v_max_f32 v248, v248, v249
    v_mul_f32 v198, v198, v250
    v_mul_f32 v199, v199, v251
    v_mfma_f32_32x32x16_bf16 a[16:31], a[116:119], v[32:35], a[16:31]
    ds_read_b64_tr_b16 a[112:113], v234 offset:5312
    ds_read_b64_tr_b16 a[114:115], v234 offset:6592
    buffer_load_dwordx4 v227, s[12:15], s63 offen offset:3072 lds
    s_add_u32 m0, s59, 126976
    v_mov_b32 v249, v248
    v_mul_f32 v200, v200, v250
    s_waitcnt lgkmcnt(8)
    v_mfma_f32_32x32x16_bf16 a[32:47], a[120:123], v[32:35], a[32:47]
    ds_read_b64_tr_b16 a[116:117], v234 offset:5376
    ds_read_b64_tr_b16 a[118:119], v234 offset:6656
    v_mul_f32 v201, v201, v251
    v_permlane32_swap_b32 v248, v249
    v_mul_f32 v202, v202, v250
    v_mfma_f32_32x32x16_bf16 a[48:63], a[124:127], v[32:35], a[48:63]
    ds_read_b64_tr_b16 a[120:121], v234 offset:10240
    ds_read_b64_tr_b16 a[122:123], v234 offset:11520
    buffer_load_dwordx4 v228, s[12:15], s63 offen offset:0 lds
    v_mul_f32 v203, v203, v251
    v_mul_f32 v204, v204, v250
    v_mul_f32 v205, v205, v251
    v_mfma_f32_32x32x16_bf16 a[64:79], a[96:99], v[32:35], a[64:79]
    ds_read_b64_tr_b16 a[124:125], v234 offset:10304
    ds_read_b64_tr_b16 a[126:127], v234 offset:11584
    v_mul_f32 v206, v206, v250
    v_mul_f32 v207, v207, v251
    v_mul_f32 v208, v208, v250
    s_waitcnt lgkmcnt(8)
    v_mfma_f32_32x32x16_bf16 a[0:15], a[100:103], v[36:39], a[0:15]
    ds_read_b64_tr_b16 a[96:97], v234 offset:10368
    ds_read_b64_tr_b16 a[98:99], v234 offset:11648
    v_mul_f32 v209, v209, v251
    v_mul_f32 v210, v210, v250
    v_mul_f32 v211, v211, v251
    v_mul_f32 v212, v212, v250
    v_mfma_f32_32x32x16_bf16 a[16:31], a[104:107], v[36:39], a[16:31]
    ds_read_b64_tr_b16 a[100:101], v234 offset:10432
    ds_read_b64_tr_b16 a[102:103], v234 offset:11712
    v_mul_f32 v213, v213, v251
    v_cvt_pk_bf16_f32 v196, v196, v197
    v_cvt_pk_bf16_f32 v197, v198, v199
    v_cvt_pk_bf16_f32 v198, v200, v201
    v_mfma_f32_32x32x16_bf16 a[32:47], a[108:111], v[36:39], a[32:47]
    ds_read_b64_tr_b16 a[104:105], v234 offset:10496
    ds_read_b64_tr_b16 a[106:107], v234 offset:11776
    v_cvt_pk_bf16_f32 v199, v202, v203
    v_cvt_pk_bf16_f32 v200, v204, v205
    v_cvt_pk_bf16_f32 v201, v206, v207
    s_waitcnt lgkmcnt(8)
    v_mfma_f32_32x32x16_bf16 a[48:63], a[112:115], v[36:39], a[48:63]
    ds_read_b64_tr_b16 a[108:109], v234 offset:15360
    ds_read_b64_tr_b16 a[110:111], v234 offset:16640
    v_cvt_pk_bf16_f32 v202, v208, v209
    v_cvt_pk_bf16_f32 v203, v210, v211
    v_cvt_pk_bf16_f32 v214, v212, v213
    v_mfma_f32_32x32x16_bf16 a[64:79], a[116:119], v[36:39], a[64:79]
    ds_read_b64_tr_b16 a[112:113], v234 offset:15424
    ds_read_b64_tr_b16 a[114:115], v234 offset:16704
    ds_write_b128 v232, v[196:199] offset:0
    ds_write_b128 v232, v[200:203] offset:16
    v_mfma_f32_32x32x16_bf16 a[0:15], a[120:123], v[40:43], a[0:15]
    ds_read_b64_tr_b16 a[116:117], v234 offset:15488
    ds_read_b64_tr_b16 a[118:119], v234 offset:16768
    v_sub_f32 v196, v180, v248
    v_sub_f32_e64 v197, -v180, v249
    v_sub_f32 v198, v181, v248
    s_waitcnt lgkmcnt(10)
    v_mfma_f32_32x32x16_bf16 a[16:31], a[124:127], v[40:43], a[16:31]
    ds_read_b64_tr_b16 a[120:121], v234 offset:15552
    ds_read_b64_tr_b16 a[122:123], v234 offset:16832
    v_sub_f32_e64 v199, -v181, v249
    v_sub_f32 v200, v182, v248
    v_sub_f32_e64 v201, -v182, v249
    v_sub_f32 v202, v183, v248
    v_mfma_f32_32x32x16_bf16 a[32:47], a[96:99], v[40:43], a[32:47]
    ds_read_b64_tr_b16 a[124:125], v234 offset:15616
    ds_read_b64_tr_b16 a[126:127], v234 offset:16896
    v_sub_f32_e64 v203, -v183, v249
    v_sub_f32 v204, v184, v248
    v_sub_f32_e64 v205, -v184, v249
    v_sub_f32 v206, v185, v248
    s_waitcnt vmcnt(15)
    s_barrier
    v_mfma_f32_32x32x16_bf16 a[48:63], a[100:103], v[40:43], a[48:63]
    ds_read_b64_tr_b16 a[96:97], v234 offset:20480
    ds_read_b64_tr_b16 a[98:99], v234 offset:21760
    s_add_u32 m0, s59, 143360
    s_add_u32 s63, s71, 2304
    v_sub_f32_e64 v207, -v185, v249
    s_waitcnt lgkmcnt(10)
    v_mfma_f32_32x32x16_bf16 a[64:79], a[104:107], v[40:43], a[64:79]
    ds_read_b64_tr_b16 a[100:101], v234 offset:20544
    ds_read_b64_tr_b16 a[102:103], v234 offset:21824
    v_sub_f32 v208, v186, v248
    v_sub_f32_e64 v209, -v186, v249
    v_sub_f32 v210, v187, v248
    v_sub_f32_e64 v211, -v187, v249
    v_mfma_f32_32x32x16_bf16 a[0:15], a[108:111], v[44:47], a[0:15]
    ds_read_b64_tr_b16 a[104:105], v234 offset:20608
    ds_read_b64_tr_b16 a[106:107], v234 offset:21888
    buffer_load_dwordx4 v224, s[12:15], s63 offen offset:0 lds
    v_sub_f32 v212, v188, v248
    v_sub_f32_e64 v213, -v188, v249
    v_mfma_f32_32x32x16_bf16 v[180:195], a[144:147], v[152:155], 0
    v_exp_f32 v196, v196
    v_exp_f32 v197, v197
    v_exp_f32 v198, v198
    v_mfma_f32_32x32x16_bf16 a[16:31], a[112:115], v[44:47], a[16:31]
    ds_read_b64_tr_b16 a[108:109], v234 offset:20672
    ds_read_b64_tr_b16 a[110:111], v234 offset:21952
    v_mfma_f32_32x32x16_bf16 v[180:195], a[148:151], v[156:159], v[180:195]
    v_exp_f32 v199, v199
    v_exp_f32 v200, v200
    v_exp_f32 v201, v201
    s_waitcnt lgkmcnt(8)
    v_mfma_f32_32x32x16_bf16 a[32:47], a[116:119], v[44:47], a[32:47]
    ds_read_b64_tr_b16 a[112:113], v234 offset:20736
    ds_read_b64_tr_b16 a[114:115], v234 offset:22016
    buffer_load_dwordx4 v225, s[12:15], s63 offen offset:1024 lds
    v_exp_f32 v202, v202
    v_mfma_f32_32x32x16_bf16 a[48:63], a[120:123], v[44:47], a[48:63]
    ds_read_b64_tr_b16 a[116:117], v234 offset:25600
    ds_read_b64_tr_b16 a[118:119], v234 offset:26880
    v_exp_f32 v203, v203
    v_exp_f32 v204, v204
    v_mfma_f32_32x32x16_bf16 a[64:79], a[124:127], v[44:47], a[64:79]
    ds_read_b64_tr_b16 a[120:121], v234 offset:25664
    ds_read_b64_tr_b16 a[122:123], v234 offset:26944
    buffer_load_dwordx4 v226, s[12:15], s63 offen offset:2048 lds
    v_exp_f32 v205, v205
    s_waitcnt lgkmcnt(8)
    v_mfma_f32_32x32x16_bf16 a[0:15], a[96:99], v[48:51], a[0:15]
    ds_read_b64_tr_b16 a[124:125], v234 offset:25728
    ds_read_b64_tr_b16 a[126:127], v234 offset:27008
    v_exp_f32 v206, v206
    v_exp_f32 v207, v207
    v_mfma_f32_32x32x16_bf16 a[16:31], a[100:103], v[48:51], a[16:31]
    ds_read_b64_tr_b16 a[96:97], v234 offset:25792
    ds_read_b64_tr_b16 a[98:99], v234 offset:27072
    buffer_load_dwordx4 v227, s[12:15], s63 offen offset:3072 lds
    s_add_u32 m0, s59, 147456
    v_exp_f32 v208, v208
    v_mfma_f32_32x32x16_bf16 a[32:47], a[104:107], v[48:51], a[32:47]
L_sa4:
    s_cbranch_execz L_reta
    ds_read_b64_tr_b16 a[100:101], v234 offset:25856
    ds_read_b64_tr_b16 a[102:103], v234 offset:27136
    v_exp_f32 v209, v209
    s_waitcnt lgkmcnt(8)
    v_mfma_f32_32x32x16_bf16 a[48:63], a[108:111], v[48:51], a[48:63]
    ds_read_b64_tr_b16 a[104:105], v234 offset:30720
    ds_read_b64_tr_b16 a[106:107], v234 offset:32000
    buffer_load_dwordx4 v228, s[12:15], s63 offen offset:0 lds
    v_exp_f32 v210, v210
    v_mfma_f32_32x32x16_bf16 a[64:79], a[112:115], v[48:51], a[64:79]
    ds_read_b64_tr_b16 a[108:109], v234 offset:30784
    ds_read_b64_tr_b16 a[110:111], v234 offset:32064
    v_exp_f32 v211, v211
    v_exp_f32 v212, v212
    v_mfma_f32_32x32x16_bf16 a[0:15], a[116:119], v[52:55], a[0:15]
    ds_read_b64_tr_b16 a[112:113], v234 offset:30848
    ds_read_b64_tr_b16 a[114:115], v234 offset:32128
    v_exp_f32 v213, v213
    v_add_f32 v250, v196, v198
    s_waitcnt lgkmcnt(8)
    v_mfma_f32_32x32x16_bf16 a[16:31], a[120:123], v[52:55], a[16:31]
    ds_read_b64_tr_b16 a[116:117], v234 offset:30912
    ds_read_b64_tr_b16 a[118:119], v234 offset:32192
    v_add_f32 v251, v197, v199
    v_add_f32 v250, v250, v200
    v_add_f32 v251, v251, v201
    v_add_f32 v250, v250, v202
    v_mfma_f32_32x32x16_bf16 a[32:47], a[124:127], v[52:55], a[32:47]
    ds_read_b64_tr_b16 a[120:121], v234 offset:30976
    ds_read_b64_tr_b16 a[122:123], v234 offset:32256
    v_add_f32 v251, v251, v203
    v_add_f32 v250, v250, v204
    v_add_f32 v251, v251, v205
    v_add_f32 v250, v250, v206
    v_mfma_f32_32x32x16_bf16 a[48:63], a[96:99], v[52:55], a[48:63]
    ds_read_b64_tr_b16 a[124:125], v234 offset:35840
    ds_read_b64_tr_b16 a[126:127], v234 offset:37120
    v_add_f32 v251, v251, v207
    v_add_f32 v250, v250, v208
    v_add_f32 v251, v251, v209
    s_waitcnt lgkmcnt(8)
    v_mfma_f32_32x32x16_bf16 a[64:79], a[100:103], v[52:55], a[64:79]
    ds_read_b64_tr_b16 a[96:97], v234 offset:35904
    ds_read_b64_tr_b16 a[98:99], v234 offset:37184
    v_add_f32 v250, v250, v210
    v_add_f32 v251, v251, v211
    v_add_f32 v250, v250, v212
    v_add_f32 v251, v251, v213
    v_mfma_f32_32x32x16_bf16 a[0:15], a[104:107], v[56:59], a[0:15]
    ds_read_b64_tr_b16 a[100:101], v234 offset:35968
    ds_read_b64_tr_b16 a[102:103], v234 offset:37248
    v_cndmask_b32 v188, v188, v189, s[46:47]
    v_max3_f32 v248, v180, v181, v182
    v_permlane32_swap_b32 v250, v251
    v_mfma_f32_32x32x16_bf16 a[16:31], a[108:111], v[56:59], a[16:31]
    ds_read_b64_tr_b16 a[104:105], v234 offset:36032
    ds_read_b64_tr_b16 a[106:107], v234 offset:37312
    v_max3_f32 v249, -v180, -v181, -v182
    v_max3_f32 v248, v248, v183, v184
    v_add_f32 v250, v250, v251
    s_waitcnt lgkmcnt(8)
    v_mfma_f32_32x32x16_bf16 a[32:47], a[112:115], v[56:59], a[32:47]
    ds_read_b64_tr_b16 a[108:109], v234 offset:36096
    ds_read_b64_tr_b16 a[110:111], v234 offset:37376
    v_max3_f32 v249, v249, -v183, -v184
    v_max3_f32 v248, v248, v185, v186
    v_rcp_f32 v250, v250
    s_waitcnt vmcnt(15)
    s_barrier
    v_mfma_f32_32x32x16_bf16 a[48:63], a[116:119], v[56:59], a[48:63]
    ds_read_b64_tr_b16 a[112:113], v233 offset:22528
    ds_read_b64_tr_b16 a[114:115], v233 offset:23808
    v_max3_f32 v249, v249, -v185, -v186
    v_max3_f32 v248, v248, v187, v188
    v_mov_b32 v251, v250
    v_max3_f32 v249, v249, -v187, -v188
    v_mfma_f32_32x32x16_bf16 a[64:79], a[120:123], v[56:59], a[64:79]
    ds_read_b64_tr_b16 a[116:117], v233 offset:22592
    ds_read_b64_tr_b16 a[118:119], v233 offset:23872
    v_permlane32_swap_b32 v250, v251
    s_waitcnt lgkmcnt(8)
    v_mfma_f32_32x32x16_bf16 a[0:15], a[124:127], v[60:63], a[0:15]
    ds_read_b64_tr_b16 a[120:121], v233 offset:22656
    ds_read_b64_tr_b16 a[122:123], v233 offset:23936
    v_permlane32_swap_b32 v248, v249
    v_mul_f32 v196, v196, v250
    v_mul_f32 v197, v197, v251
    v_mfma_f32_32x32x16_bf16 a[16:31], a[96:99], v[60:63], a[16:31]
    ds_read_b64_tr_b16 a[124:125], v233 offset:22720
    ds_read_b64_tr_b16 a[126:127], v233 offset:24000
    v_max_f32 v248, v248, v249
    v_mul_f32 v198, v198, v250
    v_mul_f32 v199, v199, v251
    v_mov_b32 v249, v248
    v_mfma_f32_32x32x16_bf16 a[32:47], a[100:103], v[60:63], a[32:47]
    ds_read_b64_tr_b16 a[96:97], v233 offset:22784
    ds_read_b64_tr_b16 a[98:99], v233 offset:24064
    v_mul_f32 v200, v200, v250
    v_mul_f32 v201, v201, v251
    s_waitcnt lgkmcnt(8)
    v_mfma_f32_32x32x16_bf16 a[48:63], a[104:107], v[60:63], a[48:63]
    ds_read_b64_tr_b16 a[100:101], v233 offset:27648
    ds_read_b64_tr_b16 a[102:103], v233 offset:28928
    v_permlane32_swap_b32 v248, v249
    v_mul_f32 v202, v202, v250
    v_mul_f32 v203, v203, v251
    v_mfma_f32_32x32x16_bf16 a[64:79], a[108:111], v[60:63], a[64:79]
    ds_read_b64_tr_b16 a[104:105], v233 offset:27712
    ds_read_b64_tr_b16 a[106:107], v233 offset:28992
    v_mul_f32 v204, v204, v250
    v_mul_f32 v205, v205, v251
    v_mul_f32 v206, v206, v250
    v_mul_f32 v207, v207, v251
    v_mfma_f32_32x32x16_bf16 a[0:15], a[112:115], v[64:67], a[0:15]
    ds_read_b64_tr_b16 a[108:109], v233 offset:27776
    ds_read_b64_tr_b16 a[110:111], v233 offset:29056
    v_mul_f32 v208, v208, v250
    v_mul_f32 v209, v209, v251
    v_mul_f32 v210, v210, v250
    s_waitcnt lgkmcnt(8)
    v_mfma_f32_32x32x16_bf16 a[16:31], a[116:119], v[64:67], a[16:31]
    ds_read_b64_tr_b16 a[112:113], v233 offset:27840
    ds_read_b64_tr_b16 a[114:115], v233 offset:29120
    v_mul_f32 v211, v211, v251
    v_mul_f32 v212, v212, v250
    v_mul_f32 v213, v213, v251
    v_cvt_pk_bf16_f32 v196, v196, v197
    v_mfma_f32_32x32x16_bf16 a[32:47], a[120:123], v[64:67], a[32:47]
    ds_read_b64_tr_b16 a[116:117], v233 offset:27904
    ds_read_b64_tr_b16 a[118:119], v233 offset:29184
    v_cvt_pk_bf16_f32 v197, v198, v199
    v_cvt_pk_bf16_f32 v198, v200, v201
    v_cvt_pk_bf16_f32 v199, v202, v203
    v_cvt_pk_bf16_f32 v200, v204, v205
    v_mfma_f32_32x32x16_bf16 a[48:63], a[124:127], v[64:67], a[48:63]
    ds_read_b64_tr_b16 a[120:121], v233 offset:32768
    ds_read_b64_tr_b16 a[122:123], v233 offset:34048
    v_cvt_pk_bf16_f32 v201, v206, v207
    v_cvt_pk_bf16_f32 v202, v208, v209
    v_cvt_pk_bf16_f32 v203, v210, v211
    s_waitcnt lgkmcnt(8)
    v_mfma_f32_32x32x16_bf16 a[64:79], a[96:99], v[64:67], a[64:79]
    ds_read_b64_tr_b16 a[124:125], v233 offset:32832
    ds_read_b64_tr_b16 a[126:127], v233 offset:34112
    v_cvt_pk_bf16_f32 v215, v212, v213
    ds_write_b128 v232, v[196:199] offset:64
    ds_write_b128 v232, v[200:203] offset:80
    v_mfma_f32_32x32x16_bf16 a[0:15], a[100:103], v[68:71], a[0:15]
    ds_read_b64_tr_b16 a[96:97], v233 offset:32896
    ds_read_b64_tr_b16 a[98:99], v233 offset:34176
    v_mov_b32 v254, 0x7ffffff0
    v_mov_b32 v255, 0x1000000
    v_cmp_eq_u32 vcc, 0, v239
    s_nop 1
    v_cndmask_b32 v254, v254, 0, vcc
    buffer_atomic_add v255, v254, s[28:31], s60 offen sc1
    v_mov_b32 v255, 1
    s_lshl_b32 s43, s32, 4
    buffer_atomic_add v255, v254, s[28:31], s43 offen sc1
    v_mfma_f32_32x32x16_bf16 a[16:31], a[104:107], v[68:71], a[16:31]
    ds_read_b64_tr_b16 a[100:101], v233 offset:32960
    ds_read_b64_tr_b16 a[102:103], v233 offset:34240
    v_min_u32 v254, 20, v240
    v_lshlrev_b32 v254, 7, v254
    s_lshl_b32 s43, s33, 4
    s_add_u32 s43, s43, s32
    s_mul_i32 s43, s43, 10368
    s_mul_i32 s49, s3, 2560
    s_add_u32 s43, s43, s49
    buffer_load_dword v238, v254, s[16:19], s43 offen
    s_waitcnt lgkmcnt(10)
    v_mfma_f32_32x32x16_bf16 a[32:47], a[108:111], v[68:71], a[32:47]
    ds_read_b64_tr_b16 a[104:105], v233 offset:33024
    ds_read_b64_tr_b16 a[106:107], v233 offset:34304
    v_sub_f32 v196, v180, v248
    v_sub_f32_e64 v197, -v180, v249
    v_sub_f32 v198, v181, v248
    v_sub_f32_e64 v199, -v181, v249
    v_mfma_f32_32x32x16_bf16 a[48:63], a[112:115], v[68:71], a[48:63]
    ds_read_b64_tr_b16 a[108:109], v233 offset:37888
    ds_read_b64_tr_b16 a[110:111], v233 offset:39168
    v_sub_f32 v200, v182, v248
    v_sub_f32_e64 v201, -v182, v249
    v_sub_f32 v202, v183, v248
    v_sub_f32_e64 v203, -v183, v249
    v_mfma_f32_32x32x16_bf16 a[64:79], a[116:119], v[68:71], a[64:79]
    ds_read_b64_tr_b16 a[112:113], v233 offset:37952
    ds_read_b64_tr_b16 a[114:115], v233 offset:39232
    v_sub_f32 v204, v184, v248
    v_sub_f32_e64 v205, -v184, v249
    v_sub_f32 v206, v185, v248
    s_waitcnt lgkmcnt(8)
    v_mfma_f32_32x32x16_bf16 a[0:15], a[120:123], v[72:75], a[0:15]
    ds_read_b64_tr_b16 a[116:117], v233 offset:38016
    ds_read_b64_tr_b16 a[118:119], v233 offset:39296
    v_sub_f32_e64 v207, -v185, v249
    v_sub_f32 v208, v186, v248
    v_sub_f32_e64 v209, -v186, v249
    v_sub_f32 v210, v187, v248
    v_mfma_f32_32x32x16_bf16 a[16:31], a[124:127], v[72:75], a[16:31]
    ds_read_b64_tr_b16 a[120:121], v233 offset:38080
    ds_read_b64_tr_b16 a[122:123], v233 offset:39360
    v_sub_f32_e64 v211, -v187, v249
    v_sub_f32 v212, v188, v248
    v_sub_f32_e64 v213, -v188, v249
    v_mfma_f32_32x32x16_bf16 v[180:195], a[152:155], v[156:159], 0
    v_exp_f32 v196, v196
    v_exp_f32 v197, v197
    v_exp_f32 v198, v198
    v_mfma_f32_32x32x16_bf16 a[32:47], a[96:99], v[72:75], a[32:47]
    ds_read_b64_tr_b16 a[124:125], v233 offset:38144
    ds_read_b64_tr_b16 a[126:127], v233 offset:39424
    v_mfma_f32_32x32x16_bf16 v[180:195], a[156:159], v[160:163], v[180:195]
    v_exp_f32 v199, v199
    v_exp_f32 v200, v200
    v_exp_f32 v201, v201
    s_waitcnt vmcnt(13)
    s_barrier
    s_waitcnt lgkmcnt(8)
    v_mfma_f32_32x32x16_bf16 a[48:63], a[100:103], v[72:75], a[48:63]
    ds_read_b64_tr_b16 a[96:97], v233 offset:43008
    ds_read_b64_tr_b16 a[98:99], v233 offset:44288
    v_exp_f32 v202, v202
    v_exp_f32 v203, v203
    v_mfma_f32_32x32x16_bf16 a[64:79], a[104:107], v[72:75], a[64:79]
    ds_read_b64_tr_b16 a[100:101], v233 offset:43072
    ds_read_b64_tr_b16 a[102:103], v233 offset:44352
    v_exp_f32 v204, v204
    v_exp_f32 v205, v205
    v_mfma_f32_32x32x16_bf16 a[0:15], a[108:111], v[76:79], a[0:15]
    ds_read_b64_tr_b16 a[104:105], v233 offset:43136
    ds_read_b64_tr_b16 a[106:107], v233 offset:44416
    v_exp_f32 v206, v206
    s_waitcnt lgkmcnt(8)
    v_mfma_f32_32x32x16_bf16 a[16:31], a[112:115], v[76:79], a[16:31]
    ds_read_b64_tr_b16 a[108:109], v233 offset:43200
    ds_read_b64_tr_b16 a[110:111], v233 offset:44480
    v_exp_f32 v207, v207
    v_exp_f32 v208, v208
    v_mfma_f32_32x32x16_bf16 a[32:47], a[116:119], v[76:79], a[32:47]
    ds_read_b64_tr_b16 a[112:113], v233 offset:43264
    ds_read_b64_tr_b16 a[114:115], v233 offset:44544
    v_exp_f32 v209, v209
    v_exp_f32 v210, v210
    v_mfma_f32_32x32x16_bf16 a[48:63], a[120:123], v[76:79], a[48:63]
    ds_read_b64_tr_b16 a[116:117], v233 offset:48128
    ds_read_b64_tr_b16 a[118:119], v233 offset:49408
    v_exp_f32 v211, v211
    s_waitcnt lgkmcnt(8)
    v_mfma_f32_32x32x16_bf16 a[64:79], a[124:127], v[76:79], a[64:79]
    ds_read_b64_tr_b16 a[120:121], v233 offset:48192
    ds_read_b64_tr_b16 a[122:123], v233 offset:49472
    v_exp_f32 v212, v212
    v_exp_f32 v213, v213
    v_mfma_f32_32x32x16_bf16 a[0:15], a[96:99], v[80:83], a[0:15]
    ds_read_b64_tr_b16 a[124:125], v233 offset:48256
    ds_read_b64_tr_b16 a[126:127], v233 offset:49536
    v_add_f32 v250, v196, v198
    v_add_f32 v251, v197, v199
    v_add_f32 v250, v250, v200
    v_add_f32 v251, v251, v201
    v_mfma_f32_32x32x16_bf16 a[16:31], a[100:103], v[80:83], a[16:31]
    ds_read_b64_tr_b16 a[96:97], v233 offset:48320
    ds_read_b64_tr_b16 a[98:99], v233 offset:49600
    v_add_f32 v250, v250, v202
    v_add_f32 v251, v251, v203
    v_add_f32 v250, v250, v204
    s_waitcnt lgkmcnt(8)
    v_mfma_f32_32x32x16_bf16 a[32:47], a[104:107], v[80:83], a[32:47]
    ds_read_b64_tr_b16 a[100:101], v233 offset:48384
    ds_read_b64_tr_b16 a[102:103], v233 offset:49664
    v_add_f32 v251, v251, v205
    v_add_f32 v250, v250, v206
    v_add_f32 v251, v251, v207
    v_add_f32 v250, v250, v208
    v_mfma_f32_32x32x16_bf16 a[48:63], a[108:111], v[80:83], a[48:63]
    ds_read_b64_tr_b16 a[104:105], v233 offset:53248
    ds_read_b64_tr_b16 a[106:107], v233 offset:54528
    v_add_f32 v251, v251, v209
    v_add_f32 v250, v250, v210
    v_add_f32 v251, v251, v211
    v_add_f32 v250, v250, v212
    v_mfma_f32_32x32x16_bf16 a[64:79], a[112:115], v[80:83], a[64:79]
    ds_read_b64_tr_b16 a[108:109], v233 offset:53312
    ds_read_b64_tr_b16 a[110:111], v233 offset:54592
    v_add_f32 v251, v251, v213
    v_cndmask_b32 v188, v188, v189, s[46:47]
    v_max3_f32 v248, v180, v181, v182
    s_waitcnt lgkmcnt(8)
    v_mfma_f32_32x32x16_bf16 a[0:15], a[116:119], v[84:87], a[0:15]
    ds_read_b64_tr_b16 a[112:113], v233 offset:53376
    ds_read_b64_tr_b16 a[114:115], v233 offset:54656
    v_permlane32_swap_b32 v250, v251
    v_max3_f32 v249, -v180, -v181, -v182
    v_max3_f32 v248, v248, v183, v184
    v_mfma_f32_32x32x16_bf16 a[16:31], a[120:123], v[84:87], a[16:31]
    ds_read_b64_tr_b16 a[116:117], v233 offset:53440
    ds_read_b64_tr_b16 a[118:119], v233 offset:54720
    v_add_f32 v250, v250, v251
    v_max3_f32 v249, v249, -v183, -v184
    v_max3_f32 v248, v248, v185, v186
    v_mfma_f32_32x32x16_bf16 a[32:47], a[124:127], v[84:87], a[32:47]
    ds_read_b64_tr_b16 a[120:121], v233 offset:53504
    ds_read_b64_tr_b16 a[122:123], v233 offset:54784
    v_rcp_f32 v250, v250
    v_max3_f32 v249, v249, -v185, -v186
    s_waitcnt lgkmcnt(8)
    v_mfma_f32_32x32x16_bf16 a[48:63], a[96:99], v[84:87], a[48:63]
    ds_read_b64_tr_b16 a[124:125], v233 offset:58368
    ds_read_b64_tr_b16 a[126:127], v233 offset:59648
    v_max3_f32 v248, v248, v187, v188
    v_mov_b32 v251, v250
    v_max3_f32 v249, v249, -v187, -v188
    v_mfma_f32_32x32x16_bf16 a[64:79], a[100:103], v[84:87], a[64:79]
    ds_read_b64_tr_b16 a[96:97], v233 offset:58432
    ds_read_b64_tr_b16 a[98:99], v233 offset:59712
    v_permlane32_swap_b32 v250, v251
    v_permlane32_swap_b32 v248, v249
    v_mfma_f32_32x32x16_bf16 a[0:15], a[104:107], v[88:91], a[0:15]
    ds_read_b64_tr_b16 a[100:101], v233 offset:58496
    ds_read_b64_tr_b16 a[102:103], v233 offset:59776
    v_mul_f32 v196, v196, v250
    v_mul_f32 v197, v197, v251
    v_max_f32 v248, v248, v249
    s_waitcnt lgkmcnt(8)
    v_mfma_f32_32x32x16_bf16 a[16:31], a[108:111], v[88:91], a[16:31]
    ds_read_b64_tr_b16 a[104:105], v233 offset:58560
    ds_read_b64_tr_b16 a[106:107], v233 offset:59840
    v_mul_f32 v198, v198, v250
    v_mul_f32 v199, v199, v251
    v_mov_b32 v249, v248
    v_mul_f32 v200, v200, v250
    v_mfma_f32_32x32x16_bf16 a[32:47], a[112:115], v[88:91], a[32:47]
    ds_read_b64_tr_b16 a[108:109], v233 offset:58624
    ds_read_b64_tr_b16 a[110:111], v233 offset:59904
    v_mul_f32 v201, v201, v251
    v_permlane32_swap_b32 v248, v249
    v_mul_f32 v202, v202, v250
    s_waitcnt vmcnt(8)
    s_barrier
    v_mfma_f32_32x32x16_bf16 a[48:63], a[116:119], v[88:91], a[48:63]
    ds_read_b64_tr_b16 a[112:113], v234 offset:43008
    ds_read_b64_tr_b16 a[114:115], v234 offset:44288
    s_add_u32 m0, s59, 38912
    s_add_u32 s63, s72, 2304
    v_mul_f32 v203, v203, v251
    s_waitcnt lgkmcnt(8)
    v_mfma_f32_32x32x16_bf16 a[64:79], a[120:123], v[88:91], a[64:79]
    ds_read_b64_tr_b16 a[116:117], v234 offset:43072
    ds_read_b64_tr_b16 a[118:119], v234 offset:44352
    v_mul_f32 v204, v204, v250
    v_mul_f32 v205, v205, v251
    v_mul_f32 v206, v206, v250
    v_mul_f32 v207, v207, v251
    v_mfma_f32_32x32x16_bf16 a[0:15], a[124:127], v[92:95], a[0:15]
    ds_read_b64_tr_b16 a[120:121], v234 offset:43136
    ds_read_b64_tr_b16 a[122:123], v234 offset:44416
    buffer_load_dwordx4 v224, s[12:15], s63 offen offset:0 lds
    v_mul_f32 v208, v208, v250
    v_mul_f32 v209, v209, v251
    v_mul_f32 v210, v210, v250
    v_mfma_f32_32x32x16_bf16 a[16:31], a[96:99], v[92:95], a[16:31]
    ds_read_b64_tr_b16 a[124:125], v234 offset:43200
    ds_read_b64_tr_b16 a[126:127], v234 offset:44480
    v_mul_f32 v211, v211, v251
    v_mul_f32 v212, v212, v250
    v_mul_f32 v213, v213, v251
    s_waitcnt lgkmcnt(8)
    v_mfma_f32_32x32x16_bf16 a[32:47], a[100:103], v[92:95], a[32:47]
    ds_read_b64_tr_b16 a[96:97], v234 offset:43264
    ds_read_b64_tr_b16 a[98:99], v234 offset:44544
    buffer_load_dwordx4 v225, s[12:15], s63 offen offset:1024 lds
    v_cvt_pk_bf16_f32 v196, v196, v197
    v_cvt_pk_bf16_f32 v197, v198, v199
    v_cvt_pk_bf16_f32 v198, v200, v201
    v_mfma_f32_32x32x16_bf16 a[48:63], a[104:107], v[92:95], a[48:63]
    ds_read_b64_tr_b16 a[100:101], v234 offset:48128
    ds_read_b64_tr_b16 a[102:103], v234 offset:49408
    v_cvt_pk_bf16_f32 v199, v202, v203
    v_cvt_pk_bf16_f32 v200, v204, v205
    v_cvt_pk_bf16_f32 v201, v206, v207
    v_cvt_pk_bf16_f32 v202, v208, v209
    v_mfma_f32_32x32x16_bf16 a[64:79], a[108:111], v[92:95], a[64:79]
    ds_read_b64_tr_b16 a[104:105], v234 offset:48192
    ds_read_b64_tr_b16 a[106:107], v234 offset:49472
    buffer_load_dwordx4 v226, s[12:15], s63 offen offset:2048 lds
    v_cvt_pk_bf16_f32 v203, v210, v211
    v_cvt_pk_bf16_f32 v216, v212, v213
    s_waitcnt lgkmcnt(8)
    v_mfma_f32_32x32x16_bf16 a[0:15], a[112:115], v[96:99], a[0:15]
    ds_read_b64_tr_b16 a[108:109], v234 offset:48256
    ds_read_b64_tr_b16 a[110:111], v234 offset:49536
    ds_write_b128 v232, v[196:199] offset:128
    ds_write_b128 v232, v[200:203] offset:144
    v_mfma_f32_32x32x16_bf16 a[16:31], a[116:119], v[96:99], a[16:31]
    ds_read_b64_tr_b16 a[112:113], v234 offset:48320
    ds_read_b64_tr_b16 a[114:115], v234 offset:49600
    buffer_load_dwordx4 v227, s[12:15], s63 offen offset:3072 lds
    s_add_u32 m0, s59, 43008
    v_sub_f32 v196, v180, v248
    v_sub_f32_e64 v197, -v180, v249
    v_sub_f32 v198, v181, v248
    v_mfma_f32_32x32x16_bf16 a[32:47], a[120:123], v[96:99], a[32:47]
    ds_read_b64_tr_b16 a[116:117], v234 offset:48384
    ds_read_b64_tr_b16 a[118:119], v234 offset:49664
    v_sub_f32_e64 v199, -v181, v249
    v_sub_f32 v200, v182, v248
    v_sub_f32_e64 v201, -v182, v249
    s_waitcnt lgkmcnt(10)
    v_mfma_f32_32x32x16_bf16 a[48:63], a[124:127], v[96:99], a[48:63]
    ds_read_b64_tr_b16 a[120:121], v234 offset:53248
    ds_read_b64_tr_b16 a[122:123], v234 offset:54528
    buffer_load_dwordx4 v228, s[12:15], s63 offen offset:0 lds
    v_sub_f32 v202, v183, v248
    v_sub_f32_e64 v203, -v183, v249
    v_sub_f32 v204, v184, v248
    v_mfma_f32_32x32x16_bf16 a[64:79], a[96:99], v[96:99], a[64:79]
    ds_read_b64_tr_b16 a[124:125], v234 offset:53312
    ds_read_b64_tr_b16 a[126:127], v234 offset:54592
    v_sub_f32_e64 v205, -v184, v249
    v_sub_f32 v206, v185, v248
    v_sub_f32_e64 v207, -v185, v249
    v_sub_f32 v208, v186, v248
    v_mfma_f32_32x32x16_bf16 a[0:15], a[100:103], v[100:103], a[0:15]
    ds_read_b64_tr_b16 a[96:97], v234 offset:53376
    ds_read_b64_tr_b16 a[98:99], v234 offset:54656
    v_sub_f32_e64 v209, -v186, v249
    v_sub_f32 v210, v187, v248
    v_sub_f32_e64 v211, -v187, v249
    s_waitcnt lgkmcnt(8)
    v_mfma_f32_32x32x16_bf16 a[16:31], a[104:107], v[100:103], a[16:31]
    ds_read_b64_tr_b16 a[100:101], v234 offset:53440
    ds_read_b64_tr_b16 a[102:103], v234 offset:54720
    v_sub_f32 v212, v188, v248
    v_sub_f32_e64 v213, -v188, v249
    v_mfma_f32_32x32x16_bf16 v[180:195], a[160:163], v[160:163], 0
    v_exp_f32 v196, v196
    v_exp_f32 v197, v197
    v_exp_f32 v198, v198
    v_mfma_f32_32x32x16_bf16 a[32:47], a[108:111], v[100:103], a[32:47]
    ds_read_b64_tr_b16 a[104:105], v234 offset:53504
    ds_read_b64_tr_b16 a[106:107], v234 offset:54784
    v_mfma_f32_32x32x16_bf16 v[180:195], a[164:167], v[164:167], v[180:195]
    v_exp_f32 v199, v199
    v_exp_f32 v200, v200
    v_exp_f32 v201, v201
    v_mfma_f32_32x32x16_bf16 a[48:63], a[112:115], v[100:103], a[48:63]
    ds_read_b64_tr_b16 a[108:109], v234 offset:58368
    ds_read_b64_tr_b16 a[110:111], v234 offset:59648
    v_exp_f32 v202, v202
    s_waitcnt lgkmcnt(8)
    v_mfma_f32_32x32x16_bf16 a[64:79], a[116:119], v[100:103], a[64:79]
    ds_read_b64_tr_b16 a[112:113], v234 offset:58432
    ds_read_b64_tr_b16 a[114:115], v234 offset:59712
    v_exp_f32 v203, v203
    v_exp_f32 v204, v204
    v_mfma_f32_32x32x16_bf16 a[0:15], a[120:123], v[104:107], a[0:15]
    ds_read_b64_tr_b16 a[116:117], v234 offset:58496
    ds_read_b64_tr_b16 a[118:119], v234 offset:59776
    v_exp_f32 v205, v205
    v_exp_f32 v206, v206
    v_mfma_f32_32x32x16_bf16 a[16:31], a[124:127], v[104:107], a[16:31]
    ds_read_b64_tr_b16 a[120:121], v234 offset:58560
    ds_read_b64_tr_b16 a[122:123], v234 offset:59840
    v_exp_f32 v207, v207
    s_waitcnt lgkmcnt(8)
    v_mfma_f32_32x32x16_bf16 a[32:47], a[96:99], v[104:107], a[32:47]
    ds_read_b64_tr_b16 a[124:125], v234 offset:58624
    ds_read_b64_tr_b16 a[126:127], v234 offset:59904
    v_exp_f32 v208, v208
    v_exp_f32 v209, v209
    s_waitcnt vmcnt(8)
    s_barrier
    v_mfma_f32_32x32x16_bf16 a[48:63], a[100:103], v[104:107], a[48:63]
    ds_read_b64_tr_b16 a[96:97], v235 offset:0
    ds_read_b64_tr_b16 a[98:99], v235 offset:1280
    s_add_u32 m0, s59, 59392
    s_add_u32 s63, s64, 0
    v_exp_f32 v210, v210
    v_mfma_f32_32x32x16_bf16 a[64:79], a[104:107], v[104:107], a[64:79]
    ds_read_b64_tr_b16 a[100:101], v235 offset:64
    ds_read_b64_tr_b16 a[102:103], v235 offset:1344
    v_exp_f32 v211, v211
    s_waitcnt lgkmcnt(8)
    v_mfma_f32_32x32x16_bf16 a[0:15], a[108:111], v[108:111], a[0:15]
    ds_read_b64_tr_b16 a[104:105], v235 offset:128
    ds_read_b64_tr_b16 a[106:107], v235 offset:1408
    buffer_load_dwordx4 v224, s[12:15], s63 offen offset:0 lds
    v_exp_f32 v212, v212
    v_mfma_f32_32x32x16_bf16 a[16:31], a[112:115], v[108:111], a[16:31]
    ds_read_b64_tr_b16 a[108:109], v235 offset:192
    ds_read_b64_tr_b16 a[110:111], v235 offset:1472
    v_exp_f32 v213, v213
    v_add_f32 v250, v196, v198
    v_add_f32 v251, v197, v199
    v_mfma_f32_32x32x16_bf16 a[32:47], a[116:119], v[108:111], a[32:47]
    ds_read_b64_tr_b16 a[112:113], v235 offset:256
    ds_read_b64_tr_b16 a[114:115], v235 offset:1536
    buffer_load_dwordx4 v225, s[12:15], s63 offen offset:1024 lds
    v_add_f32 v250, v250, v200
    v_add_f32 v251, v251, v201
    s_waitcnt lgkmcnt(8)
    v_mfma_f32_32x32x16_bf16 a[48:63], a[120:123], v[108:111], a[48:63]
    ds_read_b64_tr_b16 a[116:117], v235 offset:5120
    ds_read_b64_tr_b16 a[118:119], v235 offset:6400
    v_add_f32 v250, v250, v202
    v_add_f32 v251, v251, v203
    v_add_f32 v250, v250, v204
    v_add_f32 v251, v251, v205
    v_mfma_f32_32x32x16_bf16 a[64:79], a[124:127], v[108:111], a[64:79]
    ds_read_b64_tr_b16 a[120:121], v235 offset:5184
    ds_read_b64_tr_b16 a[122:123], v235 offset:6464
    buffer_load_dwordx4 v226, s[12:15], s63 offen offset:2048 lds
    v_add_f32 v250, v250, v206
    v_add_f32 v251, v251, v207
    v_add_f32 v250, v250, v208
    v_mfma_f32_32x32x16_bf16 a[0:15], a[96:99], v[112:115], a[0:15]
    ds_read_b64_tr_b16 a[124:125], v235 offset:5248
    ds_read_b64_tr_b16 a[126:127], v235 offset:6528
    v_add_f32 v251, v251, v209
    v_add_f32 v250, v250, v210
    v_add_f32 v251, v251, v211
    s_waitcnt lgkmcnt(8)
    v_mfma_f32_32x32x16_bf16 a[16:31], a[100:103], v[112:115], a[16:31]
    ds_read_b64_tr_b16 a[96:97], v235 offset:5312
    ds_read_b64_tr_b16 a[98:99], v235 offset:6592
    buffer_load_dwordx4 v227, s[12:15], s63 offen offset:3072 lds
    s_add_u32 m0, s59, 63488
    v_add_f32 v250, v250, v212
    v_add_f32 v251, v251, v213
    v_cndmask_b32 v188, v188, v189, s[46:47]
    v_mfma_f32_32x32x16_bf16 a[32:47], a[104:107], v[112:115], a[32:47]
    ds_read_b64_tr_b16 a[100:101], v235 offset:5376
    ds_read_b64_tr_b16 a[102:103], v235 offset:6656
    v_max3_f32 v248, v180, v181, v182
    v_permlane32_swap_b32 v250, v251
    v_max3_f32 v249, -v180, -v181, -v182
    v_mfma_f32_32x32x16_bf16 a[48:63], a[108:111], v[112:115], a[48:63]
    ds_read_b64_tr_b16 a[104:105], v235 offset:10240
    ds_read_b64_tr_b16 a[106:107], v235 offset:11520
    buffer_load_dwordx4 v228, s[12:15], s63 offen offset:0 lds
    v_max3_f32 v248, v248, v183, v184
    v_add_f32 v250, v250, v251
    s_waitcnt lgkmcnt(8)
    v_mfma_f32_32x32x16_bf16 a[64:79], a[112:115], v[112:115], a[64:79]
    ds_read_b64_tr_b16 a[108:109], v235 offset:10304
    ds_read_b64_tr_b16 a[110:111], v235 offset:11584
    v_max3_f32 v249, v249, -v183, -v184
    v_max3_f32 v248, v248, v185, v186
    v_rcp_f32 v250, v250
    v_mfma_f32_32x32x16_bf16 a[0:15], a[116:119], v[116:119], a[0:15]
    ds_read_b64_tr_b16 a[112:113], v235 offset:10368
    ds_read_b64_tr_b16 a[114:115], v235 offset:11648
    buffer_load_dword v238, v237, s[28:31], s60 offen sc1
    v_max3_f32 v249, v249, -v185, -v186
    v_max3_f32 v248, v248, v187, v188
    v_mov_b32 v251, v250
    v_mfma_f32_32x32x16_bf16 a[16:31], a[120:123], v[116:119], a[16:31]
    ds_read_b64_tr_b16 a[116:117], v235 offset:10432
    ds_read_b64_tr_b16 a[118:119], v235 offset:11712
    v_max3_f32 v249, v249, -v187, -v188
    v_permlane32_swap_b32 v250, v251
    s_waitcnt lgkmcnt(8)
    v_mfma_f32_32x32x16_bf16 a[32:47], a[124:127], v[116:119], a[32:47]
    ds_read_b64_tr_b16 a[120:121], v235 offset:10496
    ds_read_b64_tr_b16 a[122:123], v235 offset:11776
    v_permlane32_swap_b32 v248, v249
    v_mul_f32 v196, v196, v250
    v_mul_f32 v197, v197, v251
    v_mfma_f32_32x32x16_bf16 a[48:63], a[96:99], v[116:119], a[48:63]
    ds_read_b64_tr_b16 a[124:125], v235 offset:15360
    ds_read_b64_tr_b16 a[126:127], v235 offset:16640
    v_max_f32 v248, v248, v249
    v_mul_f32 v198, v198, v250
    v_mul_f32 v199, v199, v251
    v_mov_b32 v249, v248
    v_mfma_f32_32x32x16_bf16 a[64:79], a[100:103], v[116:119], a[64:79]
    ds_read_b64_tr_b16 a[96:97], v235 offset:15424
    ds_read_b64_tr_b16 a[98:99], v235 offset:16704
    v_mul_f32 v200, v200, v250
    v_mul_f32 v201, v201, v251
    s_waitcnt lgkmcnt(8)
    v_mfma_f32_32x32x16_bf16 a[0:15], a[104:107], v[120:123], a[0:15]
    ds_read_b64_tr_b16 a[100:101], v235 offset:15488
    ds_read_b64_tr_b16 a[102:103], v235 offset:16768
    v_permlane32_swap_b32 v248, v249
    v_mul_f32 v202, v202, v250
    v_mul_f32 v203, v203, v251
    v_mfma_f32_32x32x16_bf16 a[16:31], a[108:111], v[120:123], a[16:31]
    ds_read_b64_tr_b16 a[104:105], v235 offset:15552
    ds_read_b64_tr_b16 a[106:107], v235 offset:16832
    v_mul_f32 v204, v204, v250
    v_mul_f32 v205, v205, v251
    v_mul_f32 v206, v206, v250
    v_mul_f32 v207, v207, v251
    v_mfma_f32_32x32x16_bf16 a[32:47], a[112:115], v[120:123], a[32:47]
    ds_read_b64_tr_b16 a[108:109], v235 offset:15616
    ds_read_b64_tr_b16 a[110:111], v235 offset:16896
    v_mul_f32 v208, v208, v250
    v_mul_f32 v209, v209, v251
    v_mul_f32 v210, v210, v250
    s_waitcnt vmcnt(6)
    s_barrier
    s_waitcnt lgkmcnt(8)
    v_mfma_f32_32x32x16_bf16 a[48:63], a[116:119], v[120:123], a[48:63]
    ds_read_b64_tr_b16 a[112:113], v233 offset:22528
    ds_read_b64_tr_b16 a[114:115], v233 offset:23808
    v_mov_b32 v254, 0x3f80
    ds_write_b32 v236, v254 offset:36
    ds_write_b32 v236, v254 offset:76
    ds_write_b32 v236, v254 offset:116
    ds_write_b32 v236, v254 offset:156
    s_add_u32 m0, s59, 122880
    s_add_u32 s63, s65, 0
    v_mfma_f32_32x32x16_bf16 a[64:79], a[120:123], v[120:123], a[64:79]
    ds_read_b64_tr_b16 a[116:117], v233 offset:27648
    ds_read_b64_tr_b16 a[118:119], v233 offset:28928
    v_mul_f32 v211, v211, v251
    v_mul_f32 v212, v212, v250
    v_mul_f32 v213, v213, v251
    v_cvt_pk_bf16_f32 v196, v196, v197
    v_mfma_f32_32x32x16_bf16 a[0:15], a[124:127], v[124:127], a[0:15]
    ds_read_b64_tr_b16 a[120:121], v233 offset:32768
    ds_read_b64_tr_b16 a[122:123], v233 offset:34048
    buffer_load_dwordx4 v224, s[12:15], s63 offen offset:0 lds
    v_cvt_pk_bf16_f32 v197, v198, v199
    v_cvt_pk_bf16_f32 v198, v200, v201
    s_waitcnt lgkmcnt(12)
    v_mfma_f32_32x32x16_bf16 a[16:31], a[96:99], v[124:127], a[16:31]
    ds_read_b64_tr_b16 a[124:125], v233 offset:37888
    ds_read_b64_tr_b16 a[126:127], v233 offset:39168
    v_cvt_pk_bf16_f32 v199, v202, v203
L_sa5:
    s_cbranch_execz L_reta
    v_cvt_pk_bf16_f32 v200, v204, v205
    v_cvt_pk_bf16_f32 v201, v206, v207
    v_cvt_pk_bf16_f32 v202, v208, v209
    v_mfma_f32_32x32x16_bf16 a[32:47], a[100:103], v[124:127], a[32:47]
    ds_read_b64_tr_b16 a[96:97], v233 offset:22592
    ds_read_b64_tr_b16 a[98:99], v233 offset:23872
    buffer_load_dwordx4 v225, s[12:15], s63 offen offset:1024 lds
    v_cvt_pk_bf16_f32 v203, v210, v211
    v_cvt_pk_bf16_f32 v217, v212, v213
    v_mfma_f32_32x32x16_bf16 a[48:63], a[104:107], v[124:127], a[48:63]
    ds_read_b64_tr_b16 a[100:101], v233 offset:27712
    ds_read_b64_tr_b16 a[102:103], v233 offset:28992
    ds_write_b128 v232, v[196:199] offset:192
    ds_write_b128 v232, v[200:203] offset:208
    ds_write_b128 v231, v[214:217]
    s_waitcnt lgkmcnt(11)
    v_mfma_f32_32x32x16_bf16 a[64:79], a[108:111], v[124:127], a[64:79]
    ds_read_b64_tr_b16 a[104:105], v233 offset:32832
    ds_read_b64_tr_b16 a[106:107], v233 offset:34112
    buffer_load_dwordx4 v226, s[12:15], s63 offen offset:2048 lds
    v_sub_f32 v196, v180, v248
    v_sub_f32_e64 v197, -v180, v249
    v_sub_f32 v198, v181, v248
    v_mfma_f32_32x32x16_bf16 a[0:15], a[112:115], v[128:131], a[0:15]
    ds_read_b64_tr_b16 a[108:109], v233 offset:37952
    ds_read_b64_tr_b16 a[110:111], v233 offset:39232
    v_sub_f32_e64 v199, -v181, v249
    v_sub_f32 v200, v182, v248
    v_sub_f32_e64 v201, -v182, v249
    v_sub_f32 v202, v183, v248
    v_mfma_f32_32x32x16_bf16 a[0:15], a[116:119], v[132:135], a[0:15]
    ds_read_b64_tr_b16 a[112:113], v233 offset:22656
    ds_read_b64_tr_b16 a[114:115], v233 offset:23936
    buffer_load_dwordx4 v227, s[12:15], s63 offen offset:3072 lds
    s_add_u32 m0, s59, 126976
    v_sub_f32_e64 v203, -v183, v249
    v_sub_f32 v204, v184, v248
    s_waitcnt lgkmcnt(11)
    v_mfma_f32_32x32x16_bf16 a[0:15], a[120:123], v[136:139], a[0:15]
    ds_read_b64_tr_b16 a[116:117], v233 offset:27776
    ds_read_b64_tr_b16 a[118:119], v233 offset:29056
    v_sub_f32_e64 v205, -v184, v249
    v_sub_f32 v206, v185, v248
    v_sub_f32_e64 v207, -v185, v249
    v_sub_f32 v208, v186, v248
    v_mfma_f32_32x32x16_bf16 a[0:15], a[124:127], v[140:143], a[0:15]
    ds_read_b64_tr_b16 a[120:121], v233 offset:32896
    ds_read_b64_tr_b16 a[122:123], v233 offset:34176
    buffer_load_dwordx4 v228, s[12:15], s63 offen offset:0 lds
    v_sub_f32_e64 v209, -v186, v249
    v_sub_f32 v210, v187, v248
    v_sub_f32_e64 v211, -v187, v249
    v_mfma_f32_32x32x16_bf16 a[16:31], a[96:99], v[128:131], a[16:31]
    ds_read_b64_tr_b16 a[124:125], v233 offset:38016
    ds_read_b64_tr_b16 a[126:127], v233 offset:39296
    v_sub_f32 v212, v188, v248
    v_sub_f32_e64 v213, -v188, v249
    v_mfma_f32_32x32x16_bf16 v[180:195], a[168:171], v[164:167], 0
    v_exp_f32 v196, v196
    v_exp_f32 v197, v197
    v_exp_f32 v198, v198
    s_waitcnt lgkmcnt(8)
    v_mfma_f32_32x32x16_bf16 a[16:31], a[100:103], v[132:135], a[16:31]
    ds_read_b64_tr_b16 a[96:97], v233 offset:22720
    ds_read_b64_tr_b16 a[98:99], v233 offset:24000
    v_mfma_f32_32x32x16_bf16 v[180:195], a[172:175], v[168:171], v[180:195]
    v_exp_f32 v199, v199
    v_exp_f32 v200, v200
    v_exp_f32 v201, v201
    v_mfma_f32_32x32x16_bf16 a[16:31], a[104:107], v[136:139], a[16:31]
    ds_read_b64_tr_b16 a[100:101], v233 offset:27840
    ds_read_b64_tr_b16 a[102:103], v233 offset:29120
    v_accvgpr_read_b32 v254, a0
    v_accvgpr_read_b32 v255, a1
    v_cvt_pk_bf16_f32 v246, v254, v255
    v_mfma_f32_32x32x16_bf16 a[16:31], a[108:111], v[140:143], a[16:31]
    ds_read_b64_tr_b16 a[104:105], v233 offset:32960
    ds_read_b64_tr_b16 a[106:107], v233 offset:34240
    ds_write_b32 v244, v246 offset:0
    v_accvgpr_read_b32 v254, a2
    v_accvgpr_read_b32 v255, a3
    v_cvt_pk_bf16_f32 v247, v254, v255
    s_waitcnt lgkmcnt(9)
    v_mfma_f32_32x32x16_bf16 a[32:47], a[112:115], v[128:131], a[32:47]
    ds_read_b64_tr_b16 a[108:109], v233 offset:38080
    ds_read_b64_tr_b16 a[110:111], v233 offset:39360
    ds_write_b32 v244, v247 offset:4
    v_accvgpr_read_b32 v254, a4
    v_accvgpr_read_b32 v255, a5
    v_cvt_pk_bf16_f32 v252, v254, v255
    v_mfma_f32_32x32x16_bf16 a[32:47], a[116:119], v[132:135], a[32:47]
    ds_read_b64_tr_b16 a[112:113], v233 offset:22784
    ds_read_b64_tr_b16 a[114:115], v233 offset:24064
    ds_write_b32 v244, v252 offset:16
    v_accvgpr_read_b32 v254, a6
    v_accvgpr_read_b32 v255, a7
    v_cvt_pk_bf16_f32 v253, v254, v255
    v_mfma_f32_32x32x16_bf16 a[32:47], a[120:123], v[136:139], a[32:47]
    ds_read_b64_tr_b16 a[116:117], v233 offset:27904
    ds_read_b64_tr_b16 a[118:119], v233 offset:29184
    ds_write_b32 v244, v253 offset:20
    v_accvgpr_read_b32 v254, a8
    v_accvgpr_read_b32 v255, a9
    v_cvt_pk_bf16_f32 v246, v254, v255
    s_waitcnt lgkmcnt(12)
    v_mfma_f32_32x32x16_bf16 a[32:47], a[124:127], v[140:143], a[32:47]
    ds_read_b64_tr_b16 a[120:121], v233 offset:33024
    ds_read_b64_tr_b16 a[122:123], v233 offset:34304
    ds_write_b32 v245, v246 offset:32
    v_accvgpr_read_b32 v254, a10
    v_accvgpr_read_b32 v255, a11
    v_cvt_pk_bf16_f32 v247, v254, v255
    v_mfma_f32_32x32x16_bf16 a[48:63], a[96:99], v[128:131], a[48:63]
    ds_read_b64_tr_b16 a[124:125], v233 offset:38144
    ds_read_b64_tr_b16 a[126:127], v233 offset:39424
    ds_write_b32 v244, v247 offset:40
    v_accvgpr_read_b32 v254, a12
    v_accvgpr_read_b32 v255, a13
    v_cvt_pk_bf16_f32 v252, v254, v255
    s_waitcnt vmcnt(6)
    s_barrier
    v_mfma_f32_32x32x16_bf16 a[48:63], a[100:103], v[132:135], a[48:63]
    ds_read_b64_tr_b16 a[96:97], v233 offset:43008
    ds_read_b64_tr_b16 a[98:99], v233 offset:44288
    ds_write_b32 v244, v252 offset:52
    v_accvgpr_read_b32 v254, a14
    v_accvgpr_read_b32 v255, a15
    v_cvt_pk_bf16_f32 v253, v254, v255
    s_add_u32 m0, s59, 143360
    s_add_u32 s63, s66, 0
    s_waitcnt lgkmcnt(13)
    v_mfma_f32_32x32x16_bf16 a[48:63], a[104:107], v[136:139], a[48:63]
    ds_read_b64_tr_b16 a[100:101], v233 offset:43072
    ds_read_b64_tr_b16 a[102:103], v233 offset:44352
    ds_write_b32 v244, v253 offset:56
    v_accvgpr_read_b32 v254, a16
    v_accvgpr_read_b32 v255, a17
    v_cvt_pk_bf16_f32 v246, v254, v255
    v_mfma_f32_32x32x16_bf16 a[48:63], a[108:111], v[140:143], a[48:63]
    ds_read_b64_tr_b16 a[104:105], v233 offset:43136
    ds_read_b64_tr_b16 a[106:107], v233 offset:44416
    ds_write_b32 v245, v246 offset:68
    v_accvgpr_read_b32 v254, a18
    v_accvgpr_read_b32 v255, a19
    v_cvt_pk_bf16_f32 v247, v254, v255
    buffer_load_dwordx4 v224, s[12:15], s63 offen offset:0 lds
    v_mfma_f32_32x32x16_bf16 a[64:79], a[112:115], v[128:131], a[64:79]
    ds_read_b64_tr_b16 a[108:109], v233 offset:43200
    ds_read_b64_tr_b16 a[110:111], v233 offset:44480
    ds_write_b32 v245, v247 offset:72
    v_accvgpr_read_b32 v254, a20
    v_accvgpr_read_b32 v255, a21
    v_cvt_pk_bf16_f32 v252, v254, v255
    s_waitcnt lgkmcnt(13)
    v_mfma_f32_32x32x16_bf16 a[64:79], a[116:119], v[132:135], a[64:79]
    ds_read_b64_tr_b16 a[112:113], v233 offset:43264
    ds_read_b64_tr_b16 a[114:115], v233 offset:44544
    ds_write_b32 v244, v252 offset:88
    v_accvgpr_read_b32 v254, a22
    v_accvgpr_read_b32 v255, a23
    v_cvt_pk_bf16_f32 v253, v254, v255
    buffer_load_dwordx4 v225, s[12:15], s63 offen offset:1024 lds
    v_mfma_f32_32x32x16_bf16 a[64:79], a[120:123], v[136:139], a[64:79]
    ds_read_b64_tr_b16 a[116:117], v233 offset:48128
    ds_read_b64_tr_b16 a[118:119], v233 offset:49408
    ds_write_b32 v244, v253 offset:92
    v_accvgpr_read_b32 v254, a24
    v_accvgpr_read_b32 v255, a25
    v_cvt_pk_bf16_f32 v246, v254, v255
    v_mfma_f32_32x32x16_bf16 a[64:79], a[124:127], v[140:143], a[64:79]
    ds_read_b64_tr_b16 a[120:121], v233 offset:48192
    ds_read_b64_tr_b16 a[122:123], v233 offset:49472
    ds_write_b32 v244, v246 offset:104
    v_accvgpr_read_b32 v254, a26
    v_accvgpr_read_b32 v255, a27
    v_cvt_pk_bf16_f32 v247, v254, v255
    buffer_load_dwordx4 v226, s[12:15], s63 offen offset:2048 lds
    s_waitcnt lgkmcnt(13)
    v_mfma_f32_32x32x16_bf16 a[192:207], a[96:99], v[0:3], 0
    ds_read_b64_tr_b16 a[124:125], v233 offset:48256
    ds_read_b64_tr_b16 a[126:127], v233 offset:49536
    ds_write_b32 v245, v247 offset:108
    v_accvgpr_read_b32 v254, a28
    v_accvgpr_read_b32 v255, a29
    v_cvt_pk_bf16_f32 v252, v254, v255
    v_mfma_f32_32x32x16_bf16 a[208:223], a[100:103], v[0:3], 0
    ds_read_b64_tr_b16 a[96:97], v233 offset:48320
    ds_read_b64_tr_b16 a[98:99], v233 offset:49600
    ds_write_b32 v244, v252 offset:124
    v_accvgpr_read_b32 v254, a30
    v_accvgpr_read_b32 v255, a31
    v_cvt_pk_bf16_f32 v253, v254, v255
    buffer_load_dwordx4 v227, s[12:15], s63 offen offset:3072 lds
    s_add_u32 m0, s59, 147456
    v_mfma_f32_32x32x16_bf16 a[224:239], a[104:107], v[0:3], 0
    ds_read_b64_tr_b16 a[100:101], v233 offset:48384
    ds_read_b64_tr_b16 a[102:103], v233 offset:49664
    ds_write_b32 v244, v253 offset:128
    v_accvgpr_read_b32 v254, a32
    v_accvgpr_read_b32 v255, a33
    v_cvt_pk_bf16_f32 v246, v254, v255
    s_waitcnt lgkmcnt(13)
    v_mfma_f32_32x32x16_bf16 a[240:255], a[108:111], v[0:3], 0
    ds_read_b64_tr_b16 a[104:105], v233 offset:53248
    ds_read_b64_tr_b16 a[106:107], v233 offset:54528
    ds_write_b32 v244, v246 offset:140
    v_accvgpr_read_b32 v254, a34
    v_accvgpr_read_b32 v255, a35
    v_cvt_pk_bf16_f32 v247, v254, v255
    buffer_load_dwordx4 v228, s[12:15], s63 offen offset:0 lds
    v_mfma_f32_32x32x16_bf16 a[80:95], a[112:115], v[0:3], 0
    ds_read_b64_tr_b16 a[108:109], v233 offset:53312
    ds_read_b64_tr_b16 a[110:111], v233 offset:54592
    ds_write_b32 v244, v247 offset:144
    v_accvgpr_read_b32 v254, a36
    v_accvgpr_read_b32 v255, a37
    v_cvt_pk_bf16_f32 v252, v254, v255
    v_mfma_f32_32x32x16_bf16 a[192:207], a[116:119], v[4:7], a[192:207]
    ds_read_b64_tr_b16 a[112:113], v233 offset:53376
    ds_read_b64_tr_b16 a[114:115], v233 offset:54656
    ds_write_b32 v244, v252 offset:160
    v_accvgpr_read_b32 v254, a38
    v_accvgpr_read_b32 v255, a39
    v_cvt_pk_bf16_f32 v253, v254, v255
    s_waitcnt lgkmcnt(13)
    v_mfma_f32_32x32x16_bf16 a[208:223], a[120:123], v[4:7], a[208:223]
    ds_read_b64_tr_b16 a[116:117], v233 offset:53440
    ds_read_b64_tr_b16 a[118:119], v233 offset:54720
    ds_write_b32 v244, v253 offset:164
    v_accvgpr_read_b32 v254, a40
    v_accvgpr_read_b32 v255, a41
    v_cvt_pk_bf16_f32 v246, v254, v255
    v_mfma_f32_32x32x16_bf16 a[224:239], a[124:127], v[4:7], a[224:239]
    ds_read_b64_tr_b16 a[120:121], v233 offset:53504
    ds_read_b64_tr_b16 a[122:123], v233 offset:54784
    ds_write_b32 v244, v246 offset:176
    v_accvgpr_read_b32 v254, a42
    v_accvgpr_read_b32 v255, a43
    v_cvt_pk_bf16_f32 v247, v254, v255
    v_mfma_f32_32x32x16_bf16 a[240:255], a[96:99], v[4:7], a[240:255]
    ds_read_b64_tr_b16 a[124:125], v233 offset:58368
    ds_read_b64_tr_b16 a[126:127], v233 offset:59648
    ds_write_b32 v244, v247 offset:180
    v_accvgpr_read_b32 v254, a44
    v_accvgpr_read_b32 v255, a45
    v_cvt_pk_bf16_f32 v252, v254, v255
    s_waitcnt lgkmcnt(13)
    v_mfma_f32_32x32x16_bf16 a[80:95], a[100:103], v[4:7], a[80:95]
    ds_read_b64_tr_b16 a[96:97], v233 offset:58432
    ds_read_b64_tr_b16 a[98:99], v233 offset:59712
    ds_write_b32 v245, v252 offset:192
    v_accvgpr_read_b32 v254, a46
    v_accvgpr_read_b32 v255, a47
    v_cvt_pk_bf16_f32 v253, v254, v255
    v_mfma_f32_32x32x16_bf16 a[192:207], a[104:107], v[8:11], a[192:207]
    ds_read_b64_tr_b16 a[100:101], v233 offset:58496
    ds_read_b64_tr_b16 a[102:103], v233 offset:59776
    ds_write_b32 v244, v253 offset:200
    v_accvgpr_read_b32 v254, a48
    v_accvgpr_read_b32 v255, a49
    v_cvt_pk_bf16_f32 v246, v254, v255
    v_mfma_f32_32x32x16_bf16 a[208:223], a[108:111], v[8:11], a[208:223]
    ds_read_b64_tr_b16 a[104:105], v233 offset:58560
    ds_read_b64_tr_b16 a[106:107], v233 offset:59840
    ds_write_b32 v244, v246 offset:212
    v_accvgpr_read_b32 v254, a50
    v_accvgpr_read_b32 v255, a51
    v_cvt_pk_bf16_f32 v247, v254, v255
    s_waitcnt lgkmcnt(13)
    v_mfma_f32_32x32x16_bf16 a[224:239], a[112:115], v[8:11], a[224:239]
    ds_read_b64_tr_b16 a[108:109], v233 offset:58624
    ds_read_b64_tr_b16 a[110:111], v233 offset:59904
    ds_write_b32 v244, v247 offset:216
    v_accvgpr_read_b32 v254, a52
    v_accvgpr_read_b32 v255, a53
    v_cvt_pk_bf16_f32 v252, v254, v255
    s_waitcnt vmcnt(5)
    s_barrier
    v_mfma_f32_32x32x16_bf16 a[240:255], a[116:119], v[8:11], a[240:255]
    ds_read_b64_tr_b16 a[112:113], v234 offset:43008
    ds_read_b64_tr_b16 a[114:115], v234 offset:44288
    ds_write_b32 v245, v252 offset:228
    v_accvgpr_read_b32 v254, a54
    v_accvgpr_read_b32 v255, a55
    v_cvt_pk_bf16_f32 v253, v254, v255
    s_add_u32 m0, s59, 38912
    s_add_u32 s63, s67, 0
    v_mfma_f32_32x32x16_bf16 a[80:95], a[120:123], v[8:11], a[80:95]
    ds_read_b64_tr_b16 a[116:117], v234 offset:43072
    ds_read_b64_tr_b16 a[118:119], v234 offset:44352
    ds_write_b32 v245, v253 offset:232
    v_accvgpr_read_b32 v254, a56
    v_accvgpr_read_b32 v255, a57
    v_cvt_pk_bf16_f32 v246, v254, v255
    s_waitcnt lgkmcnt(13)
    v_mfma_f32_32x32x16_bf16 a[192:207], a[124:127], v[12:15], a[192:207]
    ds_read_b64_tr_b16 a[120:121], v234 offset:43136
    ds_read_b64_tr_b16 a[122:123], v234 offset:44416
    ds_write_b32 v244, v246 offset:248
    v_accvgpr_read_b32 v254, a58
    v_accvgpr_read_b32 v255, a59
    v_cvt_pk_bf16_f32 v247, v254, v255
    buffer_load_dwordx4 v224, s[12:15], s63 offen offset:0 lds
    v_mfma_f32_32x32x16_bf16 a[208:223], a[96:99], v[12:15], a[208:223]
    ds_read_b64_tr_b16 a[124:125], v234 offset:43200
    ds_read_b64_tr_b16 a[126:127], v234 offset:44480
    ds_write_b32 v244, v247 offset:252
    v_accvgpr_read_b32 v254, a60
    v_accvgpr_read_b32 v255, a61
    v_cvt_pk_bf16_f32 v252, v254, v255
    v_mfma_f32_32x32x16_bf16 a[224:239], a[100:103], v[12:15], a[224:239]
    ds_read_b64_tr_b16 a[96:97], v234 offset:43264
    ds_read_b64_tr_b16 a[98:99], v234 offset:44544
    ds_write_b32 v244, v252 offset:264
    v_accvgpr_read_b32 v254, a62
    v_accvgpr_read_b32 v255, a63
    v_cvt_pk_bf16_f32 v253, v254, v255
    buffer_load_dwordx4 v225, s[12:15], s63 offen offset:1024 lds
    s_waitcnt lgkmcnt(13)
    v_mfma_f32_32x32x16_bf16 a[240:255], a[104:107], v[12:15], a[240:255]
    ds_read_b64_tr_b16 a[100:101], v234 offset:48128
    ds_read_b64_tr_b16 a[102:103], v234 offset:49408
    ds_write_b32 v245, v253 offset:268
    v_accvgpr_read_b32 v254, a64
    v_accvgpr_read_b32 v255, a65
    v_cvt_pk_bf16_f32 v246, v254, v255
    v_mfma_f32_32x32x16_bf16 a[80:95], a[108:111], v[12:15], a[80:95]
    ds_read_b64_tr_b16 a[104:105], v234 offset:48192
    ds_read_b64_tr_b16 a[106:107], v234 offset:49472
    ds_write_b32 v244, v246 offset:284
    v_accvgpr_read_b32 v254, a66
    v_accvgpr_read_b32 v255, a67
    v_cvt_pk_bf16_f32 v247, v254, v255
    buffer_load_dwordx4 v226, s[12:15], s63 offen offset:2048 lds
    v_mfma_f32_32x32x16_bf16 a[192:207], a[112:115], v[16:19], a[192:207]
    ds_read_b64_tr_b16 a[108:109], v234 offset:48256
    ds_read_b64_tr_b16 a[110:111], v234 offset:49536
    ds_write_b32 v244, v247 offset:288
    v_accvgpr_read_b32 v254, a68
    v_accvgpr_read_b32 v255, a69
    v_cvt_pk_bf16_f32 v252, v254, v255
    s_waitcnt lgkmcnt(13)
    v_mfma_f32_32x32x16_bf16 a[208:223], a[116:119], v[16:19], a[208:223]
    ds_read_b64_tr_b16 a[112:113], v234 offset:48320
    ds_read_b64_tr_b16 a[114:115], v234 offset:49600
    ds_write_b32 v244, v252 offset:300
    v_accvgpr_read_b32 v254, a70
    v_accvgpr_read_b32 v255, a71
    v_cvt_pk_bf16_f32 v253, v254, v255
    buffer_load_dwordx4 v227, s[12:15], s63 offen offset:3072 lds
    s_add_u32 m0, s59, 43008
    v_mfma_f32_32x32x16_bf16 a[224:239], a[120:123], v[16:19], a[224:239]
    ds_read_b64_tr_b16 a[116:117], v234 offset:48384
    ds_read_b64_tr_b16 a[118:119], v234 offset:49664
    ds_write_b32 v244, v253 offset:304
    v_exp_f32 v202, v202
    v_mfma_f32_32x32x16_bf16 a[240:255], a[124:127], v[16:19], a[240:255]
    ds_read_b64_tr_b16 a[120:121], v234 offset:53248
    ds_read_b64_tr_b16 a[122:123], v234 offset:54528
    buffer_load_dwordx4 v228, s[12:15], s63 offen offset:0 lds
    v_exp_f32 v203, v203
    s_waitcnt lgkmcnt(12)
    v_mfma_f32_32x32x16_bf16 a[80:95], a[96:99], v[16:19], a[80:95]
    ds_read_b64_tr_b16 a[124:125], v234 offset:53312
    ds_read_b64_tr_b16 a[126:127], v234 offset:54592
    v_exp_f32 v204, v204
    v_exp_f32 v205, v205
    v_mfma_f32_32x32x16_bf16 a[192:207], a[100:103], v[20:23], a[192:207]
    ds_read_b64_tr_b16 a[96:97], v234 offset:53376
    ds_read_b64_tr_b16 a[98:99], v234 offset:54656
    v_exp_f32 v206, v206
    v_exp_f32 v207, v207
    v_mfma_f32_32x32x16_bf16 a[208:223], a[104:107], v[20:23], a[208:223]
    ds_read_b64_tr_b16 a[100:101], v234 offset:53440
    ds_read_b64_tr_b16 a[102:103], v234 offset:54720
    v_exp_f32 v208, v208
    s_waitcnt lgkmcnt(9)
    v_mfma_f32_32x32x16_bf16 a[224:239], a[108:111], v[20:23], a[224:239]
    ds_read_b64_tr_b16 a[104:105], v234 offset:53504
    ds_read_b64_tr_b16 a[106:107], v234 offset:54784
    v_exp_f32 v209, v209
    v_exp_f32 v210, v210
    v_mfma_f32_32x32x16_bf16 a[240:255], a[112:115], v[20:23], a[240:255]
    ds_read_b64_tr_b16 a[108:109], v234 offset:58368
    ds_read_b64_tr_b16 a[110:111], v234 offset:59648
    v_exp_f32 v211, v211
    v_exp_f32 v212, v212
    v_mfma_f32_32x32x16_bf16 a[80:95], a[116:119], v[20:23], a[80:95]
    ds_read_b64_tr_b16 a[112:113], v234 offset:58432
    ds_read_b64_tr_b16 a[114:115], v234 offset:59712
    v_exp_f32 v213, v213
    v_add_f32 v250, v196, v198
    s_waitcnt lgkmcnt(8)
    v_mfma_f32_32x32x16_bf16 a[192:207], a[120:123], v[24:27], a[192:207]
    ds_read_b64_tr_b16 a[116:117], v234 offset:58496
    ds_read_b64_tr_b16 a[118:119], v234 offset:59776
    v_add_f32 v251, v197, v199
    v_add_f32 v250, v250, v200
    v_add_f32 v251, v251, v201
    v_add_f32 v250, v250, v202
    v_mfma_f32_32x32x16_bf16 a[208:223], a[124:127], v[24:27], a[208:223]
    ds_read_b64_tr_b16 a[120:121], v234 offset:58560
    ds_read_b64_tr_b16 a[122:123], v234 offset:59840
    v_add_f32 v251, v251, v203
    v_add_f32 v250, v250, v204
    v_add_f32 v251, v251, v205
    v_add_f32 v250, v250, v206
    v_mfma_f32_32x32x16_bf16 a[224:239], a[96:99], v[24:27], a[224:239]
    ds_read_b64_tr_b16 a[124:125], v234 offset:58624
    ds_read_b64_tr_b16 a[126:127], v234 offset:59904
    v_add_f32 v251, v251, v207
    v_add_f32 v250, v250, v208
    v_add_f32 v251, v251, v209
    s_waitcnt vmcnt(5)
    s_barrier
    s_waitcnt lgkmcnt(8)
    v_mfma_f32_32x32x16_bf16 a[240:255], a[100:103], v[24:27], a[240:255]
    ds_read_b64_tr_b16 a[96:97], v235 offset:0
    ds_read_b64_tr_b16 a[98:99], v235 offset:1280
    s_add_u32 m0, s59, 59392
    s_add_u32 s63, s68, 0
    v_add_f32 v250, v250, v210
    v_add_f32 v251, v251, v211
    v_mfma_f32_32x32x16_bf16 a[80:95], a[104:107], v[24:27], a[80:95]
    ds_read_b64_tr_b16 a[100:101], v235 offset:64
    ds_read_b64_tr_b16 a[102:103], v235 offset:1344
    v_add_f32 v250, v250, v212
    v_add_f32 v251, v251, v213
    v_cndmask_b32 v188, v188, v189, s[46:47]
    v_max3_f32 v248, v180, v181, v182
    v_mfma_f32_32x32x16_bf16 a[192:207], a[108:111], v[28:31], a[192:207]
    ds_read_b64_tr_b16 a[104:105], v235 offset:128
    ds_read_b64_tr_b16 a[106:107], v235 offset:1408
    buffer_load_dwordx4 v224, s[12:15], s63 offen offset:0 lds
    v_permlane32_swap_b32 v250, v251
    s_waitcnt lgkmcnt(8)
    v_mfma_f32_32x32x16_bf16 a[208:223], a[112:115], v[28:31], a[208:223]
    ds_read_b64_tr_b16 a[108:109], v235 offset:192
    ds_read_b64_tr_b16 a[110:111], v235 offset:1472
    v_max3_f32 v249, -v180, -v181, -v182
    v_max3_f32 v248, v248, v183, v184
    v_add_f32 v250, v250, v251
    v_max3_f32 v249, v249, -v183, -v184
    v_mfma_f32_32x32x16_bf16 a[224:239], a[116:119], v[28:31], a[224:239]
    ds_read_b64_tr_b16 a[112:113], v235 offset:256
    ds_read_b64_tr_b16 a[114:115], v235 offset:1536
    buffer_load_dwordx4 v225, s[12:15], s63 offen offset:1024 lds
    v_max3_f32 v248, v248, v185, v186
    v_rcp_f32 v250, v250
    v_mfma_f32_32x32x16_bf16 a[240:255], a[120:123], v[28:31], a[240:255]
    ds_read_b64_tr_b16 a[116:117], v235 offset:5120
    ds_read_b64_tr_b16 a[118:119], v235 offset:6400
    v_max3_f32 v249, v249, -v185, -v186
    v_max3_f32 v248, v248, v187, v188
    v_mov_b32 v251, v250
    s_waitcnt lgkmcnt(8)
    v_mfma_f32_32x32x16_bf16 a[80:95], a[124:127], v[28:31], a[80:95]
    ds_read_b64_tr_b16 a[120:121], v235 offset:5184
    ds_read_b64_tr_b16 a[122:123], v235 offset:6464
    buffer_load_dwordx4 v226, s[12:15], s63 offen offset:2048 lds
    v_max3_f32 v249, v249, -v187, -v188
    v_permlane32_swap_b32 v250, v251
    v_mfma_f32_32x32x16_bf16 a[192:207], a[96:99], v[32:35], a[192:207]
    ds_read_b64_tr_b16 a[124:125], v235 offset:5248
    ds_read_b64_tr_b16 a[126:127], v235 offset:6528
    v_permlane32_swap_b32 v248, v249
    v_mul_f32 v196, v196, v250
    v_mul_f32 v197, v197, v251
    v_mfma_f32_32x32x16_bf16 a[208:223], a[100:103], v[32:35], a[208:223]
    ds_read_b64_tr_b16 a[96:97], v235 offset:5312
    ds_read_b64_tr_b16 a[98:99], v235 offset:6592
    buffer_load_dwordx4 v227, s[12:15], s63 offen offset:3072 lds
    s_add_u32 m0, s59, 63488
    v_max_f32 v248, v248, v249
    v_mul_f32 v198, v198, v250
    s_waitcnt lgkmcnt(8)
    v_mfma_f32_32x32x16_bf16 a[224:239], a[104:107], v[32:35], a[224:239]
    ds_read_b64_tr_b16 a[100:101], v235 offset:5376
    ds_read_b64_tr_b16 a[102:103], v235 offset:6656
    v_mul_f32 v199, v199, v251
    v_mov_b32 v249, v248
    v_mul_f32 v200, v200, v250
    v_mul_f32 v201, v201, v251
    v_mfma_f32_32x32x16_bf16 a[240:255], a[108:111], v[32:35], a[240:255]
    ds_read_b64_tr_b16 a[104:105], v235 offset:10240
    ds_read_b64_tr_b16 a[106:107], v235 offset:11520
    buffer_load_dwordx4 v228, s[12:15], s63 offen offset:0 lds
    v_permlane32_swap_b32 v248, v249
    v_mul_f32 v202, v202, v250
    v_mfma_f32_32x32x16_bf16 a[80:95], a[112:115], v[32:35], a[80:95]
    ds_read_b64_tr_b16 a[108:109], v235 offset:10304
    ds_read_b64_tr_b16 a[110:111], v235 offset:11584
    v_mul_f32 v203, v203, v251
    v_mul_f32 v204, v204, v250
    v_mul_f32 v205, v205, v251
    s_waitcnt lgkmcnt(8)
    v_mfma_f32_32x32x16_bf16 a[192:207], a[116:119], v[36:39], a[192:207]
    ds_read_b64_tr_b16 a[112:113], v235 offset:10368
    ds_read_b64_tr_b16 a[114:115], v235 offset:11648
    v_mul_f32 v206, v206, v250
    v_mul_f32 v207, v207, v251
    v_mul_f32 v208, v208, v250
    v_mul_f32 v209, v209, v251
    v_mfma_f32_32x32x16_bf16 a[208:223], a[120:123], v[36:39], a[208:223]
    ds_read_b64_tr_b16 a[116:117], v235 offset:10432
    ds_read_b64_tr_b16 a[118:119], v235 offset:11712
    v_mul_f32 v210, v210, v250
    v_mul_f32 v211, v211, v251
    v_mul_f32 v212, v212, v250
    v_mul_f32 v213, v213, v251
    v_mfma_f32_32x32x16_bf16 a[224:239], a[124:127], v[36:39], a[224:239]
    ds_read_b64_tr_b16 a[120:121], v235 offset:10496
    ds_read_b64_tr_b16 a[122:123], v235 offset:11776
    v_cvt_pk_bf16_f32 v196, v196, v197
    v_cvt_pk_bf16_f32 v197, v198, v199
    v_cvt_pk_bf16_f32 v198, v200, v201
    s_waitcnt lgkmcnt(8)
    v_mfma_f32_32x32x16_bf16 a[240:255], a[96:99], v[36:39], a[240:255]
    ds_read_b64_tr_b16 a[124:125], v235 offset:15360
    ds_read_b64_tr_b16 a[126:127], v235 offset:16640
    v_cvt_pk_bf16_f32 v199, v202, v203
    v_cvt_pk_bf16_f32 v200, v204, v205
    v_cvt_pk_bf16_f32 v201, v206, v207
    v_cvt_pk_bf16_f32 v202, v208, v209
    v_mfma_f32_32x32x16_bf16 a[80:95], a[100:103], v[36:39], a[80:95]
    ds_read_b64_tr_b16 a[96:97], v235 offset:15424
    ds_read_b64_tr_b16 a[98:99], v235 offset:16704
    v_cvt_pk_bf16_f32 v203, v210, v211
    v_cvt_pk_bf16_f32 v214, v212, v213
    v_mfma_f32_32x32x16_bf16 a[192:207], a[104:107], v[40:43], a[192:207]
    ds_read_b64_tr_b16 a[100:101], v235 offset:15488
    ds_read_b64_tr_b16 a[102:103], v235 offset:16768
    s_waitcnt lgkmcnt(8)
    v_mfma_f32_32x32x16_bf16 a[208:223], a[108:111], v[40:43], a[208:223]
    ds_read_b64_tr_b16 a[104:105], v235 offset:15552
    ds_read_b64_tr_b16 a[106:107], v235 offset:16832
    v_mfma_f32_32x32x16_bf16 a[224:239], a[112:115], v[40:43], a[224:239]
    ds_read_b64_tr_b16 a[108:109], v235 offset:15616
    ds_read_b64_tr_b16 a[110:111], v235 offset:16896
    s_waitcnt lgkmcnt(0)
    s_mov_b32 s5, 0
    v_readfirstlane_b32 s4, v238
    s_nop 0
    s_cmp_ge_u32 s4, 268435456
    s_cbranch_scc1 L_pollz_ok
L_pollz:
    buffer_load_dword v238, v237, s[28:31], s60 offen offset:0 sc1
    s_waitcnt vmcnt(0)
    v_readfirstlane_b32 s4, v238
    s_nop 0
    s_cmp_ge_u32 s4, 268435456
    s_cbranch_scc1 L_pollz_ok
    s_sleep 2
    s_add_u32 s5, s5, 1
    s_cmp_lt_u32 s5, 0x40000
    s_cbranch_scc1 L_pollz
L_pollz_ok:
    s_waitcnt vmcnt(5)
    s_barrier
    ds_read_b64_tr_b16 a[24:25], v218 offset:0
    ds_read_b64_tr_b16 a[26:27], v218 offset:5376
    ds_read_b64_tr_b16 a[32:33], v220 offset:0
    ds_read_b64_tr_b16 a[34:35], v220 offset:4864
    ds_read_b64_tr_b16 a[28:29], v219 offset:0
    ds_read_b64_tr_b16 a[30:31], v219 offset:5376
    ds_read_b64_tr_b16 a[36:37], v220 offset:32
    ds_read_b64_tr_b16 a[38:39], v220 offset:4896
    ds_read_b64_tr_b16 a[40:41], v221 offset:0
    ds_read_b64_tr_b16 a[42:43], v221 offset:4864
    ds_read_b64_tr_b16 a[44:45], v218 offset:10752
    ds_read_b64_tr_b16 a[46:47], v218 offset:16128
    ds_read_b64_tr_b16 a[52:53], v220 offset:9728
    s_nop 0
L_sa6:
    s_cbranch_execz L_reta
    ds_read_b64_tr_b16 a[54:55], v220 offset:14592
    ds_read_b64_tr_b16 a[48:49], v219 offset:10752
    ds_read_b64_tr_b16 a[50:51], v219 offset:16128
    ds_read_b64_tr_b16 a[56:57], v220 offset:9760
    ds_read_b64_tr_b16 a[58:59], v220 offset:14624
    ds_read_b64_tr_b16 a[60:61], v221 offset:9728
    ds_read_b64_tr_b16 a[62:63], v221 offset:14592
    s_waitcnt lgkmcnt(10)
    v_mfma_f32_16x16x32_bf16 a[0:3], a[24:27], a[32:35], 0
    v_mfma_f32_16x16x32_bf16 a[4:7], a[28:31], a[32:35], 0
    v_mfma_f32_16x16x32_bf16 a[8:11], a[24:27], a[36:39], 0
    v_mfma_f32_16x16x32_bf16 a[12:15], a[28:31], a[36:39], 0
    v_mfma_f32_16x16x32_bf16 a[16:19], a[24:27], a[40:43], 0
    v_mfma_f32_16x16x32_bf16 a[20:23], a[28:31], a[40:43], 0
    ds_read_b64_tr_b16 a[24:25], v218 offset:21504
    ds_read_b64_tr_b16 a[26:27], v218 offset:26880
    ds_read_b64_tr_b16 a[32:33], v220 offset:19456
    ds_read_b64_tr_b16 a[34:35], v220 offset:24320
    ds_read_b64_tr_b16 a[28:29], v219 offset:21504
    ds_read_b64_tr_b16 a[30:31], v219 offset:26880
    ds_read_b64_tr_b16 a[36:37], v220 offset:19488
    ds_read_b64_tr_b16 a[38:39], v220 offset:24352
    ds_read_b64_tr_b16 a[40:41], v221 offset:19456
    ds_read_b64_tr_b16 a[42:43], v221 offset:24320
    s_waitcnt lgkmcnt(10)
    v_mfma_f32_16x16x32_bf16 a[0:3], a[44:47], a[52:55], a[0:3]
    v_mfma_f32_16x16x32_bf16 a[4:7], a[48:51], a[52:55], a[4:7]
    v_mfma_f32_16x16x32_bf16 a[8:11], a[44:47], a[56:59], a[8:11]
    v_mfma_f32_16x16x32_bf16 a[12:15], a[48:51], a[56:59], a[12:15]
    v_mfma_f32_16x16x32_bf16 a[16:19], a[44:47], a[60:63], a[16:19]
    v_mfma_f32_16x16x32_bf16 a[20:23], a[48:51], a[60:63], a[20:23]
    ds_read_b64_tr_b16 a[44:45], v218 offset:32256
    ds_read_b64_tr_b16 a[46:47], v218 offset:37632
    ds_read_b64_tr_b16 a[52:53], v220 offset:29184
    ds_read_b64_tr_b16 a[54:55], v220 offset:34048
    ds_read_b64_tr_b16 a[48:49], v219 offset:32256
    ds_read_b64_tr_b16 a[50:51], v219 offset:37632
    ds_read_b64_tr_b16 a[56:57], v220 offset:29216
    ds_read_b64_tr_b16 a[58:59], v220 offset:34080
    ds_read_b64_tr_b16 a[60:61], v221 offset:29184
    ds_read_b64_tr_b16 a[62:63], v221 offset:34048
    s_waitcnt lgkmcnt(10)
    v_mfma_f32_16x16x32_bf16 a[0:3], a[24:27], a[32:35], a[0:3]
    v_mfma_f32_16x16x32_bf16 a[4:7], a[28:31], a[32:35], a[4:7]
    v_mfma_f32_16x16x32_bf16 a[8:11], a[24:27], a[36:39], a[8:11]
    v_mfma_f32_16x16x32_bf16 a[12:15], a[28:31], a[36:39], a[12:15]
    v_mfma_f32_16x16x32_bf16 a[16:19], a[24:27], a[40:43], a[16:19]
    v_mfma_f32_16x16x32_bf16 a[20:23], a[28:31], a[40:43], a[20:23]
    s_waitcnt lgkmcnt(0)
    v_mfma_f32_16x16x32_bf16 a[0:3], a[44:47], a[52:55], a[0:3]
    v_mfma_f32_16x16x32_bf16 a[4:7], a[48:51], a[52:55], a[4:7]
    v_mfma_f32_16x16x32_bf16 a[8:11], a[44:47], a[56:59], a[8:11]
    v_mfma_f32_16x16x32_bf16 a[12:15], a[48:51], a[56:59], a[12:15]
    v_mfma_f32_16x16x32_bf16 a[16:19], a[44:47], a[60:63], a[16:19]
    v_mfma_f32_16x16x32_bf16 a[20:23], a[48:51], a[60:63], a[20:23]
    v_mfma_f32_32x32x16_bf16 a[240:255], a[116:119], v[40:43], a[240:255]
    ds_read_b64_tr_b16 a[112:113], v233 offset:22528
    ds_read_b64_tr_b16 a[114:115], v233 offset:23808
    s_add_u32 m0, s59, 122880
    s_add_u32 s63, s69, 0
    v_mfma_f32_32x32x16_bf16 a[80:95], a[120:123], v[40:43], a[80:95]
    ds_read_b64_tr_b16 a[116:117], v233 offset:22592
    ds_read_b64_tr_b16 a[118:119], v233 offset:23872
    v_mfma_f32_32x32x16_bf16 a[192:207], a[124:127], v[44:47], a[192:207]
    ds_read_b64_tr_b16 a[120:121], v233 offset:22656
    ds_read_b64_tr_b16 a[122:123], v233 offset:23936
    buffer_load_dwordx4 v224, s[12:15], s63 offen offset:0 lds
    v_mfma_f32_32x32x16_bf16 a[208:223], a[96:99], v[44:47], a[208:223]
    ds_read_b64_tr_b16 a[124:125], v233 offset:22720
    ds_read_b64_tr_b16 a[126:127], v233 offset:24000
    v_mfma_f32_32x32x16_bf16 a[224:239], a[100:103], v[44:47], a[224:239]
    ds_read_b64_tr_b16 a[96:97], v233 offset:22784
    ds_read_b64_tr_b16 a[98:99], v233 offset:24064
    buffer_load_dwordx4 v225, s[12:15], s63 offen offset:1024 lds
    v_mfma_f32_32x32x16_bf16 a[240:255], a[104:107], v[44:47], a[240:255]
    ds_read_b64_tr_b16 a[100:101], v233 offset:27648
    ds_read_b64_tr_b16 a[102:103], v233 offset:28928
    v_mfma_f32_32x32x16_bf16 a[80:95], a[108:111], v[44:47], a[80:95]
    ds_read_b64_tr_b16 a[104:105], v233 offset:27712
    ds_read_b64_tr_b16 a[106:107], v233 offset:28992
    buffer_load_dwordx4 v226, s[12:15], s63 offen offset:2048 lds
    s_waitcnt lgkmcnt(8)
    v_mfma_f32_32x32x16_bf16 a[192:207], a[112:115], v[48:51], a[192:207]
    ds_read_b64_tr_b16 a[108:109], v233 offset:27776
    ds_read_b64_tr_b16 a[110:111], v233 offset:29056
    v_mfma_f32_32x32x16_bf16 a[208:223], a[116:119], v[48:51], a[208:223]
    ds_read_b64_tr_b16 a[112:113], v233 offset:27840
    ds_read_b64_tr_b16 a[114:115], v233 offset:29120
    buffer_load_dwordx4 v227, s[12:15], s63 offen offset:3072 lds
    s_add_u32 m0, s59, 126976
    v_mfma_f32_32x32x16_bf16 a[224:239], a[120:123], v[48:51], a[224:239]
    ds_read_b64_tr_b16 a[116:117], v233 offset:27904
    ds_read_b64_tr_b16 a[118:119], v233 offset:29184
    s_waitcnt lgkmcnt(8)
    v_mfma_f32_32x32x16_bf16 a[240:255], a[124:127], v[48:51], a[240:255]
    ds_read_b64_tr_b16 a[120:121], v233 offset:32768
    ds_read_b64_tr_b16 a[122:123], v233 offset:34048
    buffer_load_dwordx4 v228, s[12:15], s63 offen offset:0 lds
    v_mfma_f32_32x32x16_bf16 a[80:95], a[96:99], v[48:51], a[80:95]
    ds_read_b64_tr_b16 a[124:125], v233 offset:32832
    ds_read_b64_tr_b16 a[126:127], v233 offset:34112
    v_mfma_f32_32x32x16_bf16 a[192:207], a[100:103], v[52:55], a[192:207]
    ds_read_b64_tr_b16 a[96:97], v233 offset:32896
    ds_read_b64_tr_b16 a[98:99], v233 offset:34176
    s_waitcnt lgkmcnt(8)
    v_mfma_f32_32x32x16_bf16 a[208:223], a[104:107], v[52:55], a[208:223]
    ds_read_b64_tr_b16 a[100:101], v233 offset:32960
    ds_read_b64_tr_b16 a[102:103], v233 offset:34240
    buffer_atomic_add_f32 a0, v229, s[24:27], s40 offen offset:0
    v_mfma_f32_32x32x16_bf16 a[224:239], a[108:111], v[52:55], a[224:239]
    ds_read_b64_tr_b16 a[104:105], v233 offset:33024
    ds_read_b64_tr_b16 a[106:107], v233 offset:34304
    v_mfma_f32_32x32x16_bf16 a[240:255], a[112:115], v[52:55], a[240:255]
    ds_read_b64_tr_b16 a[108:109], v233 offset:37888
    ds_read_b64_tr_b16 a[110:111], v233 offset:39168
    buffer_atomic_add_f32 a1, v229, s[24:27], s40 offen offset:64
    s_waitcnt lgkmcnt(8)
    v_mfma_f32_32x32x16_bf16 a[80:95], a[116:119], v[52:55], a[80:95]
    ds_read_b64_tr_b16 a[112:113], v233 offset:37952
    ds_read_b64_tr_b16 a[114:115], v233 offset:39232
    v_mfma_f32_32x32x16_bf16 a[192:207], a[120:123], v[56:59], a[192:207]
    ds_read_b64_tr_b16 a[116:117], v233 offset:38016
    ds_read_b64_tr_b16 a[118:119], v233 offset:39296
    buffer_atomic_add_f32 a2, v229, s[24:27], s40 offen offset:128
    v_mfma_f32_32x32x16_bf16 a[208:223], a[124:127], v[56:59], a[208:223]
    ds_read_b64_tr_b16 a[120:121], v233 offset:38080
    ds_read_b64_tr_b16 a[122:123], v233 offset:39360
    s_waitcnt lgkmcnt(8)
    v_mfma_f32_32x32x16_bf16 a[224:239], a[96:99], v[56:59], a[224:239]
    ds_read_b64_tr_b16 a[124:125], v233 offset:38144
    ds_read_b64_tr_b16 a[126:127], v233 offset:39424
    buffer_atomic_add_f32 a3, v229, s[24:27], s40 offen offset:192
    s_waitcnt vmcnt(9)
    s_barrier
    v_mfma_f32_32x32x16_bf16 a[240:255], a[100:103], v[56:59], a[240:255]
    ds_read_b64_tr_b16 a[96:97], v233 offset:43008
    ds_read_b64_tr_b16 a[98:99], v233 offset:44288
    s_add_u32 m0, s59, 143360
    s_add_u32 s63, s70, 0
    v_mfma_f32_32x32x16_bf16 a[80:95], a[104:107], v[56:59], a[80:95]
    ds_read_b64_tr_b16 a[100:101], v233 offset:43072
    ds_read_b64_tr_b16 a[102:103], v233 offset:44352
    buffer_atomic_add_f32 a4, v230, s[24:27], s40 offen offset:1024
    s_waitcnt lgkmcnt(8)
    v_mfma_f32_32x32x16_bf16 a[192:207], a[108:111], v[60:63], a[192:207]
    ds_read_b64_tr_b16 a[104:105], v233 offset:43136
    ds_read_b64_tr_b16 a[106:107], v233 offset:44416
    buffer_load_dwordx4 v224, s[12:15], s63 offen offset:0 lds
    ds_write_b128 v232, v[196:199] offset:0
    ds_write_b128 v232, v[200:203] offset:16
    v_mfma_f32_32x32x16_bf16 a[208:223], a[112:115], v[60:63], a[208:223]
    ds_read_b64_tr_b16 a[108:109], v233 offset:43200
    ds_read_b64_tr_b16 a[110:111], v233 offset:44480
    buffer_atomic_add_f32 a5, v230, s[24:27], s40 offen offset:1088
    v_sub_f32 v196, v180, v248
    v_sub_f32_e64 v197, -v180, v249
    v_sub_f32 v198, v181, v248
    v_mfma_f32_32x32x16_bf16 a[224:239], a[116:119], v[60:63], a[224:239]
    ds_read_b64_tr_b16 a[112:113], v233 offset:43264
    ds_read_b64_tr_b16 a[114:115], v233 offset:44544
    buffer_load_dwordx4 v225, s[12:15], s63 offen offset:1024 lds
    v_sub_f32_e64 v199, -v181, v249
    v_sub_f32 v200, v182, v248
    s_waitcnt lgkmcnt(10)
    v_mfma_f32_32x32x16_bf16 a[240:255], a[120:123], v[60:63], a[240:255]
    ds_read_b64_tr_b16 a[116:117], v233 offset:48128
    ds_read_b64_tr_b16 a[118:119], v233 offset:49408
    buffer_atomic_add_f32 a6, v230, s[24:27], s40 offen offset:1152
    v_sub_f32_e64 v201, -v182, v249
    v_sub_f32 v202, v183, v248
    v_sub_f32_e64 v203, -v183, v249
    v_mfma_f32_32x32x16_bf16 a[80:95], a[124:127], v[60:63], a[80:95]
    ds_read_b64_tr_b16 a[120:121], v233 offset:48192
    ds_read_b64_tr_b16 a[122:123], v233 offset:49472
    buffer_load_dwordx4 v226, s[12:15], s63 offen offset:2048 lds
    v_sub_f32 v204, v184, v248
    v_sub_f32_e64 v205, -v184, v249
    v_sub_f32 v206, v185, v248
    v_mfma_f32_32x32x16_bf16 a[192:207], a[96:99], v[64:67], a[192:207]
    ds_read_b64_tr_b16 a[124:125], v233 offset:48256
    ds_read_b64_tr_b16 a[126:127], v233 offset:49536
    buffer_atomic_add_f32 a8, v229, s[24:27], s40 offen offset:1280
    v_sub_f32_e64 v207, -v185, v249
    v_sub_f32 v208, v186, v248
    s_waitcnt lgkmcnt(8)
    v_mfma_f32_32x32x16_bf16 a[208:223], a[100:103], v[64:67], a[208:223]
    ds_read_b64_tr_b16 a[96:97], v233 offset:48320
    ds_read_b64_tr_b16 a[98:99], v233 offset:49600
    buffer_load_dwordx4 v227, s[12:15], s63 offen offset:3072 lds
    s_add_u32 m0, s59, 147456
    v_sub_f32_e64 v209, -v186, v249
    v_sub_f32 v210, v187, v248
    v_sub_f32_e64 v211, -v187, v249
    v_mfma_f32_32x32x16_bf16 a[224:239], a[104:107], v[64:67], a[224:239]
    ds_read_b64_tr_b16 a[100:101], v233 offset:48384
    ds_read_b64_tr_b16 a[102:103], v233 offset:49664
    buffer_atomic_add_f32 a9, v229, s[24:27], s40 offen offset:1344
    v_sub_f32 v212, v188, v248
    v_sub_f32_e64 v213, -v188, v249
    v_mfma_f32_32x32x16_bf16 v[180:195], a[176:179], v[168:171], 0
    v_exp_f32 v196, v196
    v_exp_f32 v197, v197
    v_exp_f32 v198, v198
    v_mfma_f32_32x32x16_bf16 a[240:255], a[108:111], v[64:67], a[240:255]
    ds_read_b64_tr_b16 a[104:105], v233 offset:53248
    ds_read_b64_tr_b16 a[106:107], v233 offset:54528
    buffer_load_dwordx4 v228, s[12:15], s63 offen offset:0 lds
    v_mfma_f32_32x32x16_bf16 v[180:195], a[180:183], v[172:175], v[180:195]
    v_exp_f32 v199, v199
    v_exp_f32 v200, v200
    v_exp_f32 v201, v201
    s_waitcnt lgkmcnt(8)
    v_mfma_f32_32x32x16_bf16 a[80:95], a[112:115], v[64:67], a[80:95]
    ds_read_b64_tr_b16 a[108:109], v233 offset:53312
    ds_read_b64_tr_b16 a[110:111], v233 offset:54592
    buffer_atomic_add_f32 a10, v229, s[24:27], s40 offen offset:1408
    v_exp_f32 v202, v202
    v_mfma_f32_32x32x16_bf16 a[192:207], a[116:119], v[68:71], a[192:207]
    ds_read_b64_tr_b16 a[112:113], v233 offset:53376
    ds_read_b64_tr_b16 a[114:115], v233 offset:54656
    v_exp_f32 v203, v203
    v_exp_f32 v204, v204
    v_mfma_f32_32x32x16_bf16 a[208:223], a[120:123], v[68:71], a[208:223]
    ds_read_b64_tr_b16 a[116:117], v233 offset:53440
    ds_read_b64_tr_b16 a[118:119], v233 offset:54720
    buffer_atomic_add_f32 a11, v229, s[24:27], s40 offen offset:1472
    v_exp_f32 v205, v205
    s_waitcnt lgkmcnt(8)
    v_mfma_f32_32x32x16_bf16 a[224:239], a[124:127], v[68:71], a[224:239]
    ds_read_b64_tr_b16 a[120:121], v233 offset:53504
    ds_read_b64_tr_b16 a[122:123], v233 offset:54784
    v_exp_f32 v206, v206
    v_exp_f32 v207, v207
    v_mfma_f32_32x32x16_bf16 a[240:255], a[96:99], v[68:71], a[240:255]
    ds_read_b64_tr_b16 a[124:125], v233 offset:58368
    ds_read_b64_tr_b16 a[126:127], v233 offset:59648
    buffer_atomic_add_f32 a12, v230, s[24:27], s40 offen offset:2304
    v_exp_f32 v208, v208
    v_mfma_f32_32x32x16_bf16 a[80:95], a[100:103], v[68:71], a[80:95]
    ds_read_b64_tr_b16 a[96:97], v233 offset:58432
    ds_read_b64_tr_b16 a[98:99], v233 offset:59712
    v_exp_f32 v209, v209
    s_waitcnt lgkmcnt(8)
    v_mfma_f32_32x32x16_bf16 a[192:207], a[104:107], v[72:75], a[192:207]
    ds_read_b64_tr_b16 a[100:101], v233 offset:58496
    ds_read_b64_tr_b16 a[102:103], v233 offset:59776
    buffer_atomic_add_f32 a13, v230, s[24:27], s40 offen offset:2368
    v_exp_f32 v210, v210
    v_mfma_f32_32x32x16_bf16 a[208:223], a[108:111], v[72:75], a[208:223]
    ds_read_b64_tr_b16 a[104:105], v233 offset:58560
    ds_read_b64_tr_b16 a[106:107], v233 offset:59840
    v_exp_f32 v211, v211
    v_exp_f32 v212, v212
    v_mfma_f32_32x32x16_bf16 a[224:239], a[112:115], v[72:75], a[224:239]
    ds_read_b64_tr_b16 a[108:109], v233 offset:58624
    ds_read_b64_tr_b16 a[110:111], v233 offset:59904
    buffer_atomic_add_f32 a14, v230, s[24:27], s40 offen offset:2432
    v_exp_f32 v213, v213
    s_waitcnt vmcnt(19)
    s_barrier
    s_waitcnt lgkmcnt(8)
    v_mfma_f32_32x32x16_bf16 a[240:255], a[116:119], v[72:75], a[240:255]
    ds_read_b64_tr_b16 a[112:113], v234 offset:43008
    ds_read_b64_tr_b16 a[114:115], v234 offset:44288
    s_add_u32 m0, s59, 38912
    s_add_u32 s63, s71, 0
    v_add_f32 v250, v196, v198
    v_add_f32 v251, v197, v199
    v_mfma_f32_32x32x16_bf16 a[80:95], a[120:123], v[72:75], a[80:95]
    ds_read_b64_tr_b16 a[116:117], v234 offset:43072
    ds_read_b64_tr_b16 a[118:119], v234 offset:44352
    buffer_atomic_add_f32 a16, v229, s[24:27], s40 offen offset:2560
    v_add_f32 v250, v250, v200
    v_add_f32 v251, v251, v201
    v_add_f32 v250, v250, v202
    v_mfma_f32_32x32x16_bf16 a[192:207], a[124:127], v[76:79], a[192:207]
    ds_read_b64_tr_b16 a[120:121], v234 offset:43136
    ds_read_b64_tr_b16 a[122:123], v234 offset:44416
    buffer_load_dwordx4 v224, s[12:15], s63 offen offset:0 lds
    v_add_f32 v251, v251, v203
    v_add_f32 v250, v250, v204
    s_waitcnt lgkmcnt(8)
    v_mfma_f32_32x32x16_bf16 a[208:223], a[96:99], v[76:79], a[208:223]
    ds_read_b64_tr_b16 a[124:125], v234 offset:43200
    ds_read_b64_tr_b16 a[126:127], v234 offset:44480
    buffer_atomic_add_f32 a17, v229, s[24:27], s40 offen offset:2624
    v_add_f32 v251, v251, v205
    v_add_f32 v250, v250, v206
    v_add_f32 v251, v251, v207
    v_mfma_f32_32x32x16_bf16 a[224:239], a[100:103], v[76:79], a[224:239]
    ds_read_b64_tr_b16 a[96:97], v234 offset:43264
    ds_read_b64_tr_b16 a[98:99], v234 offset:44544
    buffer_load_dwordx4 v225, s[12:15], s63 offen offset:1024 lds
    v_add_f32 v250, v250, v208
    v_add_f32 v251, v251, v209
    v_add_f32 v250, v250, v210
    v_mfma_f32_32x32x16_bf16 a[240:255], a[104:107], v[76:79], a[240:255]
    ds_read_b64_tr_b16 a[100:101], v234 offset:48128
    ds_read_b64_tr_b16 a[102:103], v234 offset:49408
    buffer_atomic_add_f32 a18, v229, s[24:27], s40 offen offset:2688
    v_add_f32 v251, v251, v211
    v_add_f32 v250, v250, v212
    s_waitcnt lgkmcnt(8)
    v_mfma_f32_32x32x16_bf16 a[80:95], a[108:111], v[76:79], a[80:95]
    ds_read_b64_tr_b16 a[104:105], v234 offset:48192
    ds_read_b64_tr_b16 a[106:107], v234 offset:49472
    buffer_load_dwordx4 v226, s[12:15], s63 offen offset:2048 lds
    v_add_f32 v251, v251, v213
    v_cndmask_b32 v188, v188, v189, s[46:47]
    v_max3_f32 v248, v180, v181, v182
    v_mfma_f32_32x32x16_bf16 a[192:207], a[112:115], v[80:83], a[192:207]
    ds_read_b64_tr_b16 a[108:109], v234 offset:48256
    ds_read_b64_tr_b16 a[110:111], v234 offset:49536
    buffer_atomic_add_f32 a19, v229, s[24:27], s40 offen offset:2752
    v_permlane32_swap_b32 v250, v251
    v_max3_f32 v249, -v180, -v181, -v182
    v_mfma_f32_32x32x16_bf16 a[208:223], a[116:119], v[80:83], a[208:223]
    ds_read_b64_tr_b16 a[112:113], v234 offset:48320
    ds_read_b64_tr_b16 a[114:115], v234 offset:49600
    buffer_load_dwordx4 v227, s[12:15], s63 offen offset:3072 lds
    s_add_u32 m0, s59, 43008
    v_max3_f32 v248, v248, v183, v184
    v_add_f32 v250, v250, v251
    s_waitcnt lgkmcnt(8)
    v_mfma_f32_32x32x16_bf16 a[224:239], a[120:123], v[80:83], a[224:239]
    ds_read_b64_tr_b16 a[116:117], v234 offset:48384
    ds_read_b64_tr_b16 a[118:119], v234 offset:49664
    buffer_atomic_add_f32 a20, v230, s[24:27], s40 offen offset:3584
    v_max3_f32 v249, v249, -v183, -v184
    v_max3_f32 v248, v248, v185, v186
    v_mfma_f32_32x32x16_bf16 a[240:255], a[124:127], v[80:83], a[240:255]
    ds_read_b64_tr_b16 a[120:121], v234 offset:53248
    ds_read_b64_tr_b16 a[122:123], v234 offset:54528
    buffer_load_dwordx4 v228, s[12:15], s63 offen offset:0 lds
    v_rcp_f32 v250, v250
    v_max3_f32 v249, v249, -v185, -v186
    v_mfma_f32_32x32x16_bf16 a[80:95], a[96:99], v[80:83], a[80:95]
    ds_read_b64_tr_b16 a[124:125], v234 offset:53312
    ds_read_b64_tr_b16 a[126:127], v234 offset:54592
    buffer_atomic_add_f32 a21, v230, s[24:27], s40 offen offset:3648
    v_max3_f32 v248, v248, v187, v188
    v_mov_b32 v251, v250
    s_waitcnt lgkmcnt(8)
    v_mfma_f32_32x32x16_bf16 a[192:207], a[100:103], v[84:87], a[192:207]
    ds_read_b64_tr_b16 a[96:97], v234 offset:53376
    ds_read_b64_tr_b16 a[98:99], v234 offset:54656
    v_max3_f32 v249, v249, -v187, -v188
    v_permlane32_swap_b32 v250, v251
    v_mfma_f32_32x32x16_bf16 a[208:223], a[104:107], v[84:87], a[208:223]
    ds_read_b64_tr_b16 a[100:101], v234 offset:53440
    ds_read_b64_tr_b16 a[102:103], v234 offset:54720
    buffer_atomic_add_f32 a22, v230, s[24:27], s40 offen offset:3712
    v_permlane32_swap_b32 v248, v249
    v_mul_f32 v196, v196, v250
    v_mfma_f32_32x32x16_bf16 a[224:239], a[108:111], v[84:87], a[224:239]
    ds_read_b64_tr_b16 a[104:105], v234 offset:53504
    ds_read_b64_tr_b16 a[106:107], v234 offset:54784
    v_mul_f32 v197, v197, v251
    v_max_f32 v248, v248, v249
    v_mul_f32 v198, v198, v250
    s_waitcnt lgkmcnt(8)
    v_mfma_f32_32x32x16_bf16 a[240:255], a[112:115], v[84:87], a[240:255]
    ds_read_b64_tr_b16 a[108:109], v234 offset:58368
    ds_read_b64_tr_b16 a[110:111], v234 offset:59648
    v_mul_f32 v199, v199, v251
    v_mov_b32 v249, v248
    v_mul_f32 v200, v200, v250
    v_mul_f32 v201, v201, v251
    v_mfma_f32_32x32x16_bf16 a[80:95], a[116:119], v[84:87], a[80:95]
    ds_read_b64_tr_b16 a[112:113], v234 offset:58432
    ds_read_b64_tr_b16 a[114:115], v234 offset:59712
    v_permlane32_swap_b32 v248, v249
    v_mul_f32 v202, v202, v250
    v_mul_f32 v203, v203, v251
    v_mfma_f32_32x32x16_bf16 a[192:207], a[120:123], v[88:91], a[192:207]
    ds_read_b64_tr_b16 a[116:117], v234 offset:58496
    ds_read_b64_tr_b16 a[118:119], v234 offset:59776
    v_mul_f32 v204, v204, v250
    v_mul_f32 v205, v205, v251
    v_mul_f32 v206, v206, v250
    s_waitcnt lgkmcnt(8)
    v_mfma_f32_32x32x16_bf16 a[208:223], a[124:127], v[88:91], a[208:223]
    ds_read_b64_tr_b16 a[120:121], v234 offset:58560
    ds_read_b64_tr_b16 a[122:123], v234 offset:59840
    v_mul_f32 v207, v207, v251
    v_mul_f32 v208, v208, v250
    v_mul_f32 v209, v209, v251
    v_mul_f32 v210, v210, v250
    v_mfma_f32_32x32x16_bf16 a[224:239], a[96:99], v[88:91], a[224:239]
    ds_read_b64_tr_b16 a[124:125], v234 offset:58624
    ds_read_b64_tr_b16 a[126:127], v234 offset:59904
    v_mul_f32 v211, v211, v251
    v_mul_f32 v212, v212, v250
    v_mul_f32 v213, v213, v251
    v_cvt_pk_bf16_f32 v196, v196, v197
    s_waitcnt vmcnt(17)
    s_barrier
    v_mfma_f32_32x32x16_bf16 a[240:255], a[100:103], v[88:91], a[240:255]
    ds_read_b64_tr_b16 a[96:97], v235 offset:0
    ds_read_b64_tr_b16 a[98:99], v235 offset:1280
    s_add_u32 m0, s59, 59392
    s_add_u32 s63, s72, 0
    v_cvt_pk_bf16_f32 v197, v198, v199
    s_waitcnt lgkmcnt(8)
    v_mfma_f32_32x32x16_bf16 a[80:95], a[104:107], v[88:91], a[80:95]
    ds_read_b64_tr_b16 a[100:101], v235 offset:64
    ds_read_b64_tr_b16 a[102:103], v235 offset:1344
    v_cvt_pk_bf16_f32 v198, v200, v201
    v_cvt_pk_bf16_f32 v199, v202, v203
    v_cvt_pk_bf16_f32 v200, v204, v205
    v_cvt_pk_bf16_f32 v201, v206, v207
    v_mfma_f32_32x32x16_bf16 a[192:207], a[108:111], v[92:95], a[192:207]
    ds_read_b64_tr_b16 a[104:105], v235 offset:128
    ds_read_b64_tr_b16 a[106:107], v235 offset:1408
    buffer_load_dwordx4 v224, s[12:15], s63 offen offset:0 lds
    v_cvt_pk_bf16_f32 v202, v208, v209
    v_cvt_pk_bf16_f32 v203, v210, v211
    v_cvt_pk_bf16_f32 v215, v212, v213
    v_mfma_f32_32x32x16_bf16 a[208:223], a[112:115], v[92:95], a[208:223]
    ds_read_b64_tr_b16 a[108:109], v235 offset:192
    ds_read_b64_tr_b16 a[110:111], v235 offset:1472
    ds_write_b128 v232, v[196:199] offset:64
    ds_write_b128 v232, v[200:203] offset:80
    s_waitcnt lgkmcnt(10)
    v_mfma_f32_32x32x16_bf16 a[224:239], a[116:119], v[92:95], a[224:239]
    ds_read_b64_tr_b16 a[112:113], v235 offset:256
    ds_read_b64_tr_b16 a[114:115], v235 offset:1536
    buffer_load_dwordx4 v225, s[12:15], s63 offen offset:1024 lds
    v_sub_f32 v196, v180, v248
    v_sub_f32_e64 v197, -v180, v249
    v_sub_f32 v198, v181, v248
    v_mfma_f32_32x32x16_bf16 a[240:255], a[120:123], v[92:95], a[240:255]
    ds_read_b64_tr_b16 a[116:117], v235 offset:5120
    ds_read_b64_tr_b16 a[118:119], v235 offset:6400
    v_sub_f32_e64 v199, -v181, v249
    v_sub_f32 v200, v182, v248
    v_sub_f32_e64 v201, -v182, v249
    v_sub_f32 v202, v183, v248
    v_mfma_f32_32x32x16_bf16 a[80:95], a[124:127], v[92:95], a[80:95]
    ds_read_b64_tr_b16 a[120:121], v235 offset:5184
    ds_read_b64_tr_b16 a[122:123], v235 offset:6464
    buffer_load_dwordx4 v226, s[12:15], s63 offen offset:2048 lds
    v_sub_f32_e64 v203, -v183, v249
    v_sub_f32 v204, v184, v248
    s_waitcnt lgkmcnt(10)
    v_mfma_f32_32x32x16_bf16 a[192:207], a[96:99], v[96:99], a[192:207]
    ds_read_b64_tr_b16 a[124:125], v235 offset:5248
    ds_read_b64_tr_b16 a[126:127], v235 offset:6528
    v_sub_f32_e64 v205, -v184, v249
    v_sub_f32 v206, v185, v248
    v_sub_f32_e64 v207, -v185, v249
    v_sub_f32 v208, v186, v248
    v_mfma_f32_32x32x16_bf16 a[208:223], a[100:103], v[96:99], a[208:223]
    ds_read_b64_tr_b16 a[96:97], v235 offset:5312
    ds_read_b64_tr_b16 a[98:99], v235 offset:6592
    buffer_load_dwordx4 v227, s[12:15], s63 offen offset:3072 lds
    s_add_u32 m0, s59, 63488
    v_sub_f32_e64 v209, -v186, v249
    v_sub_f32 v210, v187, v248
    v_sub_f32_e64 v211, -v187, v249
    v_mfma_f32_32x32x16_bf16 a[224:239], a[104:107], v[96:99], a[224:239]
    ds_read_b64_tr_b16 a[100:101], v235 offset:5376
    ds_read_b64_tr_b16 a[102:103], v235 offset:6656
    v_sub_f32 v212, v188, v248
    v_sub_f32_e64 v213, -v188, v249
    v_mfma_f32_32x32x16_bf16 v[180:195], a[184:187], v[172:175], 0
    v_exp_f32 v196, v196
    v_exp_f32 v197, v197
    v_exp_f32 v198, v198
    s_waitcnt lgkmcnt(8)
    v_mfma_f32_32x32x16_bf16 a[240:255], a[108:111], v[96:99], a[240:255]
    ds_read_b64_tr_b16 a[104:105], v235 offset:10240
    ds_read_b64_tr_b16 a[106:107], v235 offset:11520
    buffer_load_dwordx4 v228, s[12:15], s63 offen offset:0 lds
    v_mfma_f32_32x32x16_bf16 v[180:195], a[188:191], v[176:179], v[180:195]
    v_exp_f32 v199, v199
    v_exp_f32 v200, v200
    v_exp_f32 v201, v201
    v_mfma_f32_32x32x16_bf16 a[80:95], a[112:115], v[96:99], a[80:95]
    ds_read_b64_tr_b16 a[108:109], v235 offset:10304
    ds_read_b64_tr_b16 a[110:111], v235 offset:11584
    v_exp_f32 v202, v202
    v_exp_f32 v203, v203
    v_mfma_f32_32x32x16_bf16 a[192:207], a[116:119], v[100:103], a[192:207]
    ds_read_b64_tr_b16 a[112:113], v235 offset:10368
    ds_read_b64_tr_b16 a[114:115], v235 offset:11648
    v_exp_f32 v204, v204
    s_waitcnt lgkmcnt(8)
    v_mfma_f32_32x32x16_bf16 a[208:223], a[120:123], v[100:103], a[208:223]
    ds_read_b64_tr_b16 a[116:117], v235 offset:10432
    ds_read_b64_tr_b16 a[118:119], v235 offset:11712
    v_exp_f32 v205, v205
    v_exp_f32 v206, v206
    v_mfma_f32_32x32x16_bf16 a[224:239], a[124:127], v[100:103], a[224:239]
    ds_read_b64_tr_b16 a[120:121], v235 offset:10496
    ds_read_b64_tr_b16 a[122:123], v235 offset:11776
    v_exp_f32 v207, v207
    v_exp_f32 v208, v208
    v_mfma_f32_32x32x16_bf16 a[240:255], a[96:99], v[100:103], a[240:255]
    ds_read_b64_tr_b16 a[124:125], v235 offset:15360
    ds_read_b64_tr_b16 a[126:127], v235 offset:16640
    v_exp_f32 v209, v209
    s_waitcnt lgkmcnt(8)
    v_mfma_f32_32x32x16_bf16 a[80:95], a[100:103], v[100:103], a[80:95]
    ds_read_b64_tr_b16 a[96:97], v235 offset:15424
    ds_read_b64_tr_b16 a[98:99], v235 offset:16704
    v_exp_f32 v210, v210
    v_exp_f32 v211, v211
    v_mfma_f32_32x32x16_bf16 a[192:207], a[104:107], v[104:107], a[192:207]
    ds_read_b64_tr_b16 a[100:101], v235 offset:15488
    ds_read_b64_tr_b16 a[102:103], v235 offset:16768
    v_exp_f32 v212, v212
    v_exp_f32 v213, v213
    v_mfma_f32_32x32x16_bf16 a[208:223], a[108:111], v[104:107], a[208:223]
    ds_read_b64_tr_b16 a[104:105], v235 offset:15552
    ds_read_b64_tr_b16 a[106:107], v235 offset:16832
    v_add_f32 v250, v196, v198
    v_add_f32 v251, v197, v199
    v_add_f32 v250, v250, v200
    s_waitcnt lgkmcnt(8)
    v_mfma_f32_32x32x16_bf16 a[224:239], a[112:115], v[104:107], a[224:239]
    ds_read_b64_tr_b16 a[108:109], v235 offset:15616
    ds_read_b64_tr_b16 a[110:111], v235 offset:16896
    v_add_f32 v251, v251, v201
    v_add_f32 v250, v250, v202
    v_add_f32 v251, v251, v203
    v_add_f32 v250, v250, v204
    s_waitcnt vmcnt(7)
    s_barrier
    v_mfma_f32_32x32x16_bf16 a[240:255], a[116:119], v[104:107], a[240:255]
    ds_read_b64_tr_b16 a[112:113], v233 offset:22528
    ds_read_b64_tr_b16 a[114:115], v233 offset:23808
    v_add_f32 v251, v251, v205
    v_add_f32 v250, v250, v206
    v_add_f32 v251, v251, v207
    v_add_f32 v250, v250, v208
    v_mfma_f32_32x32x16_bf16 a[80:95], a[120:123], v[104:107], a[80:95]
    ds_read_b64_tr_b16 a[116:117], v233 offset:22592
    ds_read_b64_tr_b16 a[118:119], v233 offset:23872
    v_add_f32 v251, v251, v209
    v_add_f32 v250, v250, v210
    v_add_f32 v251, v251, v211
    s_waitcnt lgkmcnt(8)
    v_mfma_f32_32x32x16_bf16 a[192:207], a[124:127], v[108:111], a[192:207]
    ds_read_b64_tr_b16 a[120:121], v233 offset:22656
    ds_read_b64_tr_b16 a[122:123], v233 offset:23936
    v_add_f32 v250, v250, v212
    v_add_f32 v251, v251, v213
    v_cndmask_b32 v188, v188, v189, s[46:47]
    v_max3_f32 v248, v180, v181, v182
    v_mfma_f32_32x32x16_bf16 a[208:223], a[96:99], v[108:111], a[208:223]
    ds_read_b64_tr_b16 a[124:125], v233 offset:22720
    ds_read_b64_tr_b16 a[126:127], v233 offset:24000
    v_permlane32_swap_b32 v250, v251
    v_max3_f32 v249, -v180, -v181, -v182
    v_max3_f32 v248, v248, v183, v184
    v_mfma_f32_32x32x16_bf16 a[224:239], a[100:103], v[108:111], a[224:239]
    ds_read_b64_tr_b16 a[96:97], v233 offset:22784
    ds_read_b64_tr_b16 a[98:99], v233 offset:24064
    v_add_f32 v250, v250, v251
    v_max3_f32 v249, v249, -v183, -v184
    v_max3_f32 v248, v248, v185, v186
    s_waitcnt lgkmcnt(8)
    v_mfma_f32_32x32x16_bf16 a[240:255], a[104:107], v[108:111], a[240:255]
    ds_read_b64_tr_b16 a[100:101], v233 offset:27648
    ds_read_b64_tr_b16 a[102:103], v233 offset:28928
    v_rcp_f32 v250, v250
    v_max3_f32 v249, v249, -v185, -v186
    v_max3_f32 v248, v248, v187, v188
    v_mfma_f32_32x32x16_bf16 a[80:95], a[108:111], v[108:111], a[80:95]
    ds_read_b64_tr_b16 a[104:105], v233 offset:27712
    ds_read_b64_tr_b16 a[106:107], v233 offset:28992
    v_mov_b32 v251, v250
    v_max3_f32 v249, v249, -v187, -v188
    s_nop 0
    v_permlane32_swap_b32 v250, v251
    v_mfma_f32_32x32x16_bf16 a[192:207], a[112:115], v[112:115], a[192:207]
    ds_read_b64_tr_b16 a[108:109], v233 offset:27776
    ds_read_b64_tr_b16 a[110:111], v233 offset:29056
    v_permlane32_swap_b32 v248, v249
    v_mul_f32 v196, v196, v250
    s_waitcnt lgkmcnt(8)
    v_mfma_f32_32x32x16_bf16 a[208:223], a[116:119], v[112:115], a[208:223]
    ds_read_b64_tr_b16 a[112:113], v233 offset:27840
    ds_read_b64_tr_b16 a[114:115], v233 offset:29120
    v_mul_f32 v197, v197, v251
    v_max_f32 v248, v248, v249
    v_mul_f32 v198, v198, v250
    v_mul_f32 v199, v199, v251
    v_mfma_f32_32x32x16_bf16 a[224:239], a[120:123], v[112:115], a[224:239]
    ds_read_b64_tr_b16 a[116:117], v233 offset:27904
    ds_read_b64_tr_b16 a[118:119], v233 offset:29184
    v_mov_b32 v249, v248
    v_mul_f32 v200, v200, v250
    v_mul_f32 v201, v201, v251
    v_mfma_f32_32x32x16_bf16 a[240:255], a[124:127], v[112:115], a[240:255]
    ds_read_b64_tr_b16 a[120:121], v233 offset:32768
    s_nop 0
L_sa7:
    s_cbranch_execz L_reta
    ds_read_b64_tr_b16 a[122:123], v233 offset:34048
    v_permlane32_swap_b32 v248, v249
    v_mul_f32 v202, v202, v250
    s_waitcnt lgkmcnt(8)
    v_mfma_f32_32x32x16_bf16 a[80:95], a[96:99], v[112:115], a[80:95]
    ds_read_b64_tr_b16 a[124:125], v233 offset:32832
    ds_read_b64_tr_b16 a[126:127], v233 offset:34112
    v_mul_f32 v203, v203, v251
    v_mul_f32 v204, v204, v250
    v_mul_f32 v205, v205, v251
    v_mul_f32 v206, v206, v250
    v_mfma_f32_32x32x16_bf16 a[192:207], a[100:103], v[116:119], a[192:207]
    ds_read_b64_tr_b16 a[96:97], v233 offset:32896
    ds_read_b64_tr_b16 a[98:99], v233 offset:34176
    v_mul_f32 v207, v207, v251
    v_mul_f32 v208, v208, v250
    v_mul_f32 v209, v209, v251
    v_mul_f32 v210, v210, v250
    v_mfma_f32_32x32x16_bf16 a[208:223], a[104:107], v[116:119], a[208:223]
    ds_read_b64_tr_b16 a[100:101], v233 offset:32960
    ds_read_b64_tr_b16 a[102:103], v233 offset:34240
    v_mul_f32 v211, v211, v251
    v_mul_f32 v212, v212, v250
    v_mul_f32 v213, v213, v251
    s_waitcnt lgkmcnt(8)
    v_mfma_f32_32x32x16_bf16 a[224:239], a[108:111], v[116:119], a[224:239]
    ds_read_b64_tr_b16 a[104:105], v233 offset:33024
    ds_read_b64_tr_b16 a[106:107], v233 offset:34304
    v_cvt_pk_bf16_f32 v196, v196, v197
    v_cvt_pk_bf16_f32 v197, v198, v199
    v_cvt_pk_bf16_f32 v198, v200, v201
    v_cvt_pk_bf16_f32 v199, v202, v203
    v_mfma_f32_32x32x16_bf16 a[240:255], a[112:115], v[116:119], a[240:255]
    ds_read_b64_tr_b16 a[108:109], v233 offset:37888
    ds_read_b64_tr_b16 a[110:111], v233 offset:39168
    v_cvt_pk_bf16_f32 v200, v204, v205
    v_cvt_pk_bf16_f32 v201, v206, v207
    v_cvt_pk_bf16_f32 v202, v208, v209
    v_cvt_pk_bf16_f32 v203, v210, v211
    v_mfma_f32_32x32x16_bf16 a[80:95], a[116:119], v[116:119], a[80:95]
    ds_read_b64_tr_b16 a[112:113], v233 offset:37952
    ds_read_b64_tr_b16 a[114:115], v233 offset:39232
    v_cvt_pk_bf16_f32 v216, v212, v213
    s_waitcnt lgkmcnt(8)
    v_mfma_f32_32x32x16_bf16 a[192:207], a[120:123], v[120:123], a[192:207]
    ds_read_b64_tr_b16 a[116:117], v233 offset:38016
    ds_read_b64_tr_b16 a[118:119], v233 offset:39296
    ds_write_b128 v232, v[196:199] offset:128
    ds_write_b128 v232, v[200:203] offset:144
    v_mfma_f32_32x32x16_bf16 a[208:223], a[124:127], v[120:123], a[208:223]
    ds_read_b64_tr_b16 a[120:121], v233 offset:38080
    ds_read_b64_tr_b16 a[122:123], v233 offset:39360
    v_sub_f32 v196, v180, v248
    v_sub_f32_e64 v197, -v180, v249
    v_sub_f32 v198, v181, v248
    v_sub_f32_e64 v199, -v181, v249
    v_mfma_f32_32x32x16_bf16 a[224:239], a[96:99], v[120:123], a[224:239]
    ds_read_b64_tr_b16 a[124:125], v233 offset:38144
    ds_read_b64_tr_b16 a[126:127], v233 offset:39424
    v_sub_f32 v200, v182, v248
    v_sub_f32_e64 v201, -v182, v249
    v_sub_f32 v202, v183, v248
    s_waitcnt vmcnt(0)
    s_barrier
    s_waitcnt lgkmcnt(10)
    v_mfma_f32_32x32x16_bf16 a[240:255], a[100:103], v[120:123], a[240:255]
    ds_read_b64_tr_b16 a[96:97], v233 offset:43008
    ds_read_b64_tr_b16 a[98:99], v233 offset:44288
    v_sub_f32_e64 v203, -v183, v249
    v_sub_f32 v204, v184, v248
    v_sub_f32_e64 v205, -v184, v249
    v_sub_f32 v206, v185, v248
    v_mfma_f32_32x32x16_bf16 a[80:95], a[104:107], v[120:123], a[80:95]
    ds_read_b64_tr_b16 a[100:101], v233 offset:43072
    ds_read_b64_tr_b16 a[102:103], v233 offset:44352
    v_sub_f32_e64 v207, -v185, v249
    v_sub_f32 v208, v186, v248
    v_sub_f32_e64 v209, -v186, v249
    v_sub_f32 v210, v187, v248
    v_mfma_f32_32x32x16_bf16 a[192:207], a[108:111], v[124:127], a[192:207]
    ds_read_b64_tr_b16 a[104:105], v233 offset:43136
    ds_read_b64_tr_b16 a[106:107], v233 offset:44416
    v_sub_f32_e64 v211, -v187, v249
    v_sub_f32 v212, v188, v248
    v_sub_f32_e64 v213, -v188, v249
    s_waitcnt lgkmcnt(8)
    v_mfma_f32_32x32x16_bf16 a[208:223], a[112:115], v[124:127], a[208:223]
    ds_read_b64_tr_b16 a[108:109], v233 offset:43200
    ds_read_b64_tr_b16 a[110:111], v233 offset:44480
    v_exp_f32 v196, v196
    v_exp_f32 v197, v197
    v_mfma_f32_32x32x16_bf16 a[224:239], a[116:119], v[124:127], a[224:239]
    ds_read_b64_tr_b16 a[112:113], v233 offset:43264
    ds_read_b64_tr_b16 a[114:115], v233 offset:44544
    v_exp_f32 v198, v198
    v_exp_f32 v199, v199
    v_mfma_f32_32x32x16_bf16 a[240:255], a[120:123], v[124:127], a[240:255]
    ds_read_b64_tr_b16 a[116:117], v233 offset:48128
    ds_read_b64_tr_b16 a[118:119], v233 offset:49408
    v_exp_f32 v200, v200
    s_waitcnt lgkmcnt(8)
    v_mfma_f32_32x32x16_bf16 a[80:95], a[124:127], v[124:127], a[80:95]
    ds_read_b64_tr_b16 a[120:121], v233 offset:48192
    ds_read_b64_tr_b16 a[122:123], v233 offset:49472
    v_exp_f32 v201, v201
    v_exp_f32 v202, v202
    v_mfma_f32_32x32x16_bf16 a[192:207], a[96:99], v[128:131], a[192:207]
    ds_read_b64_tr_b16 a[124:125], v233 offset:48256
    ds_read_b64_tr_b16 a[126:127], v233 offset:49536
    v_exp_f32 v203, v203
    v_exp_f32 v204, v204
    v_mfma_f32_32x32x16_bf16 a[208:223], a[100:103], v[128:131], a[208:223]
    ds_read_b64_tr_b16 a[96:97], v233 offset:48320
    ds_read_b64_tr_b16 a[98:99], v233 offset:49600
    v_exp_f32 v205, v205
    s_waitcnt lgkmcnt(8)
    v_mfma_f32_32x32x16_bf16 a[224:239], a[104:107], v[128:131], a[224:239]
    ds_read_b64_tr_b16 a[100:101], v233 offset:48384
    ds_read_b64_tr_b16 a[102:103], v233 offset:49664
    v_exp_f32 v206, v206
    v_exp_f32 v207, v207
    v_mfma_f32_32x32x16_bf16 a[240:255], a[108:111], v[128:131], a[240:255]
    ds_read_b64_tr_b16 a[104:105], v233 offset:53248
    ds_read_b64_tr_b16 a[106:107], v233 offset:54528
    buffer_store_dword v223, v222, s[24:27], s44 offen offset:128 sc1
    v_exp_f32 v208, v208
    v_mfma_f32_32x32x16_bf16 a[80:95], a[112:115], v[128:131], a[80:95]
    ds_read_b64_tr_b16 a[108:109], v233 offset:53312
    ds_read_b64_tr_b16 a[110:111], v233 offset:54592
    v_exp_f32 v209, v209
    s_waitcnt lgkmcnt(8)
    v_mfma_f32_32x32x16_bf16 a[192:207], a[116:119], v[132:135], a[192:207]
    ds_read_b64_tr_b16 a[112:113], v233 offset:53376
    ds_read_b64_tr_b16 a[114:115], v233 offset:54656
    v_exp_f32 v210, v210
    v_exp_f32 v211, v211
    v_mfma_f32_32x32x16_bf16 a[208:223], a[120:123], v[132:135], a[208:223]
    ds_read_b64_tr_b16 a[116:117], v233 offset:53440
    ds_read_b64_tr_b16 a[118:119], v233 offset:54720
    v_exp_f32 v212, v212
    v_exp_f32 v213, v213
    v_mfma_f32_32x32x16_bf16 a[224:239], a[124:127], v[132:135], a[224:239]
    ds_read_b64_tr_b16 a[120:121], v233 offset:53504
    ds_read_b64_tr_b16 a[122:123], v233 offset:54784
    v_add_f32 v250, v196, v198
    v_add_f32 v251, v197, v199
    v_add_f32 v250, v250, v200
    s_waitcnt lgkmcnt(8)
    v_mfma_f32_32x32x16_bf16 a[240:255], a[96:99], v[132:135], a[240:255]
    ds_read_b64_tr_b16 a[124:125], v233 offset:58368
    ds_read_b64_tr_b16 a[126:127], v233 offset:59648
    v_add_f32 v251, v251, v201
    v_add_f32 v250, v250, v202
    v_add_f32 v251, v251, v203
    v_add_f32 v250, v250, v204
    v_mfma_f32_32x32x16_bf16 a[80:95], a[100:103], v[132:135], a[80:95]
    ds_read_b64_tr_b16 a[96:97], v233 offset:58432
    ds_read_b64_tr_b16 a[98:99], v233 offset:59712
    v_add_f32 v251, v251, v205
    v_add_f32 v250, v250, v206
    v_add_f32 v251, v251, v207
    v_add_f32 v250, v250, v208
    v_mfma_f32_32x32x16_bf16 a[192:207], a[104:107], v[136:139], a[192:207]
    ds_read_b64_tr_b16 a[100:101], v233 offset:58496
    ds_read_b64_tr_b16 a[102:103], v233 offset:59776
    v_add_f32 v251, v251, v209
    v_add_f32 v250, v250, v210
    v_add_f32 v251, v251, v211
    s_waitcnt lgkmcnt(8)
    v_mfma_f32_32x32x16_bf16 a[208:223], a[108:111], v[136:139], a[208:223]
    ds_read_b64_tr_b16 a[104:105], v233 offset:58560
    ds_read_b64_tr_b16 a[106:107], v233 offset:59840
    v_add_f32 v250, v250, v212
    v_add_f32 v251, v251, v213
    s_nop 1
    v_permlane32_swap_b32 v250, v251
    v_mfma_f32_32x32x16_bf16 a[224:239], a[112:115], v[136:139], a[224:239]
    ds_read_b64_tr_b16 a[108:109], v233 offset:58624
    ds_read_b64_tr_b16 a[110:111], v233 offset:59904
    v_add_f32 v250, v250, v251
    v_rcp_f32 v250, v250
    s_nop 0
    v_mov_b32 v251, v250
    v_mfma_f32_32x32x16_bf16 a[240:255], a[116:119], v[136:139], a[240:255]
    s_nop 0
    v_permlane32_swap_b32 v250, v251
    v_mul_f32 v196, v196, v250
    s_waitcnt lgkmcnt(6)
    v_mfma_f32_32x32x16_bf16 a[80:95], a[120:123], v[136:139], a[80:95]
    v_mul_f32 v197, v197, v251
    v_mul_f32 v198, v198, v250
    v_mul_f32 v199, v199, v251
    v_mul_f32 v200, v200, v250
    v_mfma_f32_32x32x16_bf16 a[192:207], a[124:127], v[140:143], a[192:207]
    v_mul_f32 v201, v201, v251
    v_mul_f32 v202, v202, v250
    v_mul_f32 v203, v203, v251
    v_mul_f32 v204, v204, v250
    v_mfma_f32_32x32x16_bf16 a[208:223], a[96:99], v[140:143], a[208:223]
    v_mul_f32 v205, v205, v251
    v_mul_f32 v206, v206, v250
    v_mul_f32 v207, v207, v251
    s_waitcnt lgkmcnt(0)
    v_mfma_f32_32x32x16_bf16 a[224:239], a[100:103], v[140:143], a[224:239]
    v_mul_f32 v208, v208, v250
    v_mul_f32 v209, v209, v251
    v_mul_f32 v210, v210, v250
    v_mul_f32 v211, v211, v251
    v_mfma_f32_32x32x16_bf16 a[240:255], a[104:107], v[140:143], a[240:255]
    v_mul_f32 v212, v212, v250
    v_mul_f32 v213, v213, v251
    v_cvt_pk_bf16_f32 v196, v196, v197
    v_cvt_pk_bf16_f32 v197, v198, v199
    v_mfma_f32_32x32x16_bf16 a[80:95], a[108:111], v[140:143], a[80:95]
    v_cvt_pk_bf16_f32 v198, v200, v201
    v_cvt_pk_bf16_f32 v199, v202, v203
    v_cvt_pk_bf16_f32 v200, v204, v205
    v_cvt_pk_bf16_f32 v201, v206, v207
    v_cvt_pk_bf16_f32 v202, v208, v209
    v_cvt_pk_bf16_f32 v203, v210, v211
    v_cvt_pk_bf16_f32 v217, v212, v213
    ds_write_b128 v232, v[196:199] offset:192
    ds_write_b128 v232, v[200:203] offset:208
    ds_write_b128 v231, v[214:217]
    v_and_b32 v254, 31, v240
    v_mov_b32 v255, 19
    v_cmp_eq_u32 vcc, 16, v254
    s_nop 1
    v_cndmask_b32 v255, v255, 16, vcc
    v_cmp_eq_u32 vcc, 20, v254
    s_nop 1
    v_cndmask_b32 v255, v255, 17, vcc
    v_cmp_eq_u32 vcc, 17, v254
    s_nop 1
    v_cndmask_b32 v255, v255, 18, vcc
    v_cmp_eq_u32 vcc, 21, v254
    s_nop 1
    v_cndmask_b32 v255, v255, 18, vcc
    v_cmp_gt_u32 vcc, 16, v254
    s_nop 1
    v_cndmask_b32 v255, v255, v254, vcc
    v_lshlrev_b32 v255, 6, v255
    v_mul_u32_u24 v254, 1280, v241
    v_add_u32 v244, v255, v254
    v_lshl_add_u32 v245, v241, 4, v255
    s_and_b32 s42, s3, 1
    s_lshl_b32 s42, s42, 3
    v_add_u32 v245, s42, v245
    s_mul_i32 s42, s3, 3072
    s_add_u32 s42, s42, 122880
    v_lshlrev_b32 v236, 4, v240
    v_add_u32 v246, s42, v236
    s_lshl_b32 s42, s3, 2
    v_add_u32 v247, s42, v246
    v_add_u32 v233, 122880, v236
    s_mul_i32 s38, s35, 36864
    s_mul_i32 s42, s33, 9216
    s_add_u32 s38, s38, s42
    s_add_u32 s38, s38, 42991616
    s_lshl_b32 s42, s33, 14
    s_lshl_b32 s43, s3, 10
    s_add_u32 s42, s42, s43
    s_add_u32 s42, s42, 48234496
    v_and_b32 v234, 15, v240
    v_lshl_add_u32 v234, v234, 16, s42
    s_waitcnt lgkmcnt(0)
    s_barrier
    ds_read_b64_tr_b16 a[24:25], v218 offset:160
    ds_read_b64_tr_b16 a[26:27], v218 offset:5536
    ds_read_b64_tr_b16 a[32:33], v220 offset:0
    ds_read_b64_tr_b16 a[34:35], v220 offset:4864
    ds_read_b64_tr_b16 a[28:29], v219 offset:160
    ds_read_b64_tr_b16 a[30:31], v219 offset:5536
    ds_read_b64_tr_b16 a[36:37], v220 offset:32
    ds_read_b64_tr_b16 a[38:39], v220 offset:4896
    ds_read_b64_tr_b16 a[40:41], v221 offset:0
    ds_read_b64_tr_b16 a[42:43], v221 offset:4864
    ds_read_b64_tr_b16 a[44:45], v218 offset:10912
    ds_read_b64_tr_b16 a[46:47], v218 offset:16288
    ds_read_b64_tr_b16 a[52:53], v220 offset:9728
    ds_read_b64_tr_b16 a[54:55], v220 offset:14592
    ds_read_b64_tr_b16 a[48:49], v219 offset:10912
    ds_read_b64_tr_b16 a[50:51], v219 offset:16288
    ds_read_b64_tr_b16 a[56:57], v220 offset:9760
    ds_read_b64_tr_b16 a[58:59], v220 offset:14624
    ds_read_b64_tr_b16 a[60:61], v221 offset:9728
    ds_read_b64_tr_b16 a[62:63], v221 offset:14592
    s_waitcnt lgkmcnt(10)
    v_mfma_f32_16x16x32_bf16 a[0:3], a[24:27], a[32:35], 0
    v_mfma_f32_16x16x32_bf16 a[4:7], a[28:31], a[32:35], 0
    v_mfma_f32_16x16x32_bf16 a[8:11], a[24:27], a[36:39], 0
    v_mfma_f32_16x16x32_bf16 a[12:15], a[28:31], a[36:39], 0
    v_mfma_f32_16x16x32_bf16 a[16:19], a[24:27], a[40:43], 0
    v_mfma_f32_16x16x32_bf16 a[20:23], a[28:31], a[40:43], 0
    ds_read_b64_tr_b16 a[24:25], v218 offset:21664
    ds_read_b64_tr_b16 a[26:27], v218 offset:27040
    ds_read_b64_tr_b16 a[32:33], v220 offset:19456
    ds_read_b64_tr_b16 a[34:35], v220 offset:24320
    ds_read_b64_tr_b16 a[28:29], v219 offset:21664
    ds_read_b64_tr_b16 a[30:31], v219 offset:27040
    ds_read_b64_tr_b16 a[36:37], v220 offset:19488
    ds_read_b64_tr_b16 a[38:39], v220 offset:24352
    ds_read_b64_tr_b16 a[40:41], v221 offset:19456
    ds_read_b64_tr_b16 a[42:43], v221 offset:24320
    s_waitcnt lgkmcnt(10)
    v_mfma_f32_16x16x32_bf16 a[0:3], a[44:47], a[52:55], a[0:3]
    v_mfma_f32_16x16x32_bf16 a[4:7], a[48:51], a[52:55], a[4:7]
    v_mfma_f32_16x16x32_bf16 a[8:11], a[44:47], a[56:59], a[8:11]
    v_mfma_f32_16x16x32_bf16 a[12:15], a[48:51], a[56:59], a[12:15]
    v_mfma_f32_16x16x32_bf16 a[16:19], a[44:47], a[60:63], a[16:19]
    v_mfma_f32_16x16x32_bf16 a[20:23], a[48:51], a[60:63], a[20:23]
    ds_read_b64_tr_b16 a[44:45], v218 offset:32416
    ds_read_b64_tr_b16 a[46:47], v218 offset:37792
    ds_read_b64_tr_b16 a[52:53], v220 offset:29184
    ds_read_b64_tr_b16 a[54:55], v220 offset:34048
    ds_read_b64_tr_b16 a[48:49], v219 offset:32416
    ds_read_b64_tr_b16 a[50:51], v219 offset:37792
    ds_read_b64_tr_b16 a[56:57], v220 offset:29216
    ds_read_b64_tr_b16 a[58:59], v220 offset:34080
    ds_read_b64_tr_b16 a[60:61], v221 offset:29184
    ds_read_b64_tr_b16 a[62:63], v221 offset:34048
    s_waitcnt lgkmcnt(10)
    v_mfma_f32_16x16x32_bf16 a[0:3], a[24:27], a[32:35], a[0:3]
    v_mfma_f32_16x16x32_bf16 a[4:7], a[28:31], a[32:35], a[4:7]
    v_mfma_f32_16x16x32_bf16 a[8:11], a[24:27], a[36:39], a[8:11]
    v_mfma_f32_16x16x32_bf16 a[12:15], a[28:31], a[36:39], a[12:15]
    v_mfma_f32_16x16x32_bf16 a[16:19], a[24:27], a[40:43], a[16:19]
    v_mfma_f32_16x16x32_bf16 a[20:23], a[28:31], a[40:43], a[20:23]
    s_waitcnt lgkmcnt(0)
    v_mfma_f32_16x16x32_bf16 a[0:3], a[44:47], a[52:55], a[0:3]
    v_mfma_f32_16x16x32_bf16 a[4:7], a[48:51], a[52:55], a[4:7]
    v_mfma_f32_16x16x32_bf16 a[8:11], a[44:47], a[56:59], a[8:11]
    v_mfma_f32_16x16x32_bf16 a[12:15], a[48:51], a[56:59], a[12:15]
    v_mfma_f32_16x16x32_bf16 a[16:19], a[44:47], a[60:63], a[16:19]
    v_mfma_f32_16x16x32_bf16 a[20:23], a[48:51], a[60:63], a[20:23]
    v_mov_b32 v214, 0
    v_mov_b32 v215, 0
    v_mov_b32 v216, 0
    v_mov_b32 v217, 0
    v_accvgpr_read_b32 v252, a192
    v_accvgpr_read_b32 v253, a193
    v_cvt_pk_bf16_f32 v144, v252, v253
    buffer_atomic_add_f32 a0, v229, s[24:27], s41 offen offset:0
    v_accvgpr_read_b32 v254, a194
    v_accvgpr_read_b32 v255, a195
    v_cvt_pk_bf16_f32 v145, v254, v255
    v_accvgpr_read_b32 v252, a196
    v_accvgpr_read_b32 v253, a197
    v_cvt_pk_bf16_f32 v146, v252, v253
    buffer_atomic_add_f32 a1, v229, s[24:27], s41 offen offset:64
    v_accvgpr_read_b32 v254, a198
    v_accvgpr_read_b32 v255, a199
    v_cvt_pk_bf16_f32 v147, v254, v255
    buffer_atomic_add_f32 a2, v229, s[24:27], s41 offen offset:128
    v_accvgpr_read_b32 v252, a200
    v_accvgpr_read_b32 v253, a201
    v_cvt_pk_bf16_f32 v148, v252, v253
    buffer_atomic_add_f32 a3, v229, s[24:27], s41 offen offset:192
    v_accvgpr_read_b32 v254, a202
    v_accvgpr_read_b32 v255, a203
    v_cvt_pk_bf16_f32 v149, v254, v255
    v_accvgpr_read_b32 v252, a204
    v_accvgpr_read_b32 v253, a205
    v_cvt_pk_bf16_f32 v150, v252, v253
    buffer_atomic_add_f32 a4, v230, s[24:27], s41 offen offset:1024
    v_accvgpr_read_b32 v254, a206
    v_accvgpr_read_b32 v255, a207
    v_cvt_pk_bf16_f32 v151, v254, v255
    buffer_atomic_add_f32 a5, v230, s[24:27], s41 offen offset:1088
    v_mfma_f32_32x32x16_bf16 v[180:195], a[128:131], v[144:147], 0
    v_mfma_f32_32x32x16_bf16 v[180:195], a[132:135], v[148:151], v[180:195]
    v_accvgpr_read_b32 v252, a208
    v_accvgpr_read_b32 v253, a209
    v_cvt_pk_bf16_f32 v152, v252, v253
    buffer_atomic_add_f32 a6, v230, s[24:27], s41 offen offset:1152
    v_accvgpr_read_b32 v254, a210
    v_accvgpr_read_b32 v255, a211
    v_cvt_pk_bf16_f32 v153, v254, v255
    v_accvgpr_read_b32 v252, a212
    v_accvgpr_read_b32 v253, a213
    v_cvt_pk_bf16_f32 v154, v252, v253
    buffer_atomic_add_f32 a8, v229, s[24:27], s41 offen offset:1280
    v_accvgpr_read_b32 v254, a214
    v_accvgpr_read_b32 v255, a215
    v_cvt_pk_bf16_f32 v155, v254, v255
    buffer_atomic_add_f32 a9, v229, s[24:27], s41 offen offset:1344
    v_accvgpr_read_b32 v252, a216
    v_accvgpr_read_b32 v253, a217
    v_cvt_pk_bf16_f32 v156, v252, v253
    buffer_atomic_add_f32 a10, v229, s[24:27], s41 offen offset:1408
    v_accvgpr_read_b32 v254, a218
    v_accvgpr_read_b32 v255, a219
    v_cvt_pk_bf16_f32 v157, v254, v255
    v_accvgpr_read_b32 v252, a220
    v_accvgpr_read_b32 v253, a221
    v_cvt_pk_bf16_f32 v158, v252, v253
    buffer_atomic_add_f32 a11, v229, s[24:27], s41 offen offset:1472
    v_accvgpr_read_b32 v254, a222
    v_accvgpr_read_b32 v255, a223
    v_cvt_pk_bf16_f32 v159, v254, v255
    buffer_atomic_add_f32 a12, v230, s[24:27], s41 offen offset:2304
    v_accvgpr_read_b32 v252, a224
    v_accvgpr_read_b32 v253, a225
    v_cvt_pk_bf16_f32 v160, v252, v253
    buffer_atomic_add_f32 a13, v230, s[24:27], s41 offen offset:2368
    v_accvgpr_read_b32 v254, a226
    v_accvgpr_read_b32 v255, a227
    v_cvt_pk_bf16_f32 v161, v254, v255
    v_accvgpr_read_b32 v252, a228
    v_accvgpr_read_b32 v253, a229
    v_cvt_pk_bf16_f32 v162, v252, v253
    buffer_atomic_add_f32 a14, v230, s[24:27], s41 offen offset:2432
    v_accvgpr_read_b32 v254, a230
    v_accvgpr_read_b32 v255, a231
    v_cvt_pk_bf16_f32 v163, v254, v255
    buffer_atomic_add_f32 a16, v229, s[24:27], s41 offen offset:2560
    v_accvgpr_read_b32 v252, a232
    v_accvgpr_read_b32 v253, a233
    v_cvt_pk_bf16_f32 v164, v252, v253
    buffer_atomic_add_f32 a17, v229, s[24:27], s41 offen offset:2624
    v_accvgpr_read_b32 v254, a234
    v_accvgpr_read_b32 v255, a235
    v_cvt_pk_bf16_f32 v165, v254, v255
    v_accvgpr_read_b32 v252, a236
    v_accvgpr_read_b32 v253, a237
    v_cvt_pk_bf16_f32 v166, v252, v253
    buffer_atomic_add_f32 a18, v229, s[24:27], s41 offen offset:2688
    v_accvgpr_read_b32 v254, a238
    v_accvgpr_read_b32 v255, a239
    v_cvt_pk_bf16_f32 v167, v254, v255
    buffer_atomic_add_f32 a19, v229, s[24:27], s41 offen offset:2752
    v_accvgpr_read_b32 v252, a240
    v_accvgpr_read_b32 v253, a241
    v_cvt_pk_bf16_f32 v168, v252, v253
    buffer_atomic_add_f32 a20, v230, s[24:27], s41 offen offset:3584
    v_accvgpr_read_b32 v254, a242
    v_accvgpr_read_b32 v255, a243
    v_cvt_pk_bf16_f32 v169, v254, v255
    v_accvgpr_read_b32 v252, a244
    v_accvgpr_read_b32 v253, a245
    v_cvt_pk_bf16_f32 v170, v252, v253
    buffer_atomic_add_f32 a21, v230, s[24:27], s41 offen offset:3648
    v_accvgpr_read_b32 v254, a246
    v_accvgpr_read_b32 v255, a247
    v_cvt_pk_bf16_f32 v171, v254, v255
    buffer_atomic_add_f32 a22, v230, s[24:27], s41 offen offset:3712
    v_accvgpr_read_b32 v252, a248
    v_accvgpr_read_b32 v253, a249
    v_cvt_pk_bf16_f32 v172, v252, v253
    v_accvgpr_read_b32 v254, a250
    v_accvgpr_read_b32 v255, a251
    v_cvt_pk_bf16_f32 v173, v254, v255
    v_accvgpr_read_b32 v252, a252
    v_accvgpr_read_b32 v253, a253
    v_cvt_pk_bf16_f32 v174, v252, v253
    v_accvgpr_read_b32 v254, a254
    v_accvgpr_read_b32 v255, a255
    v_cvt_pk_bf16_f32 v175, v254, v255
    v_accvgpr_read_b32 v252, a80
    v_accvgpr_read_b32 v253, a81
    v_cvt_pk_bf16_f32 v176, v252, v253
    v_accvgpr_read_b32 v254, a82
    v_accvgpr_read_b32 v255, a83
    v_cvt_pk_bf16_f32 v177, v254, v255
    v_accvgpr_read_b32 v252, a84
    v_accvgpr_read_b32 v253, a85
    v_cvt_pk_bf16_f32 v178, v252, v253
    v_accvgpr_read_b32 v254, a86
    v_accvgpr_read_b32 v255, a87
    v_cvt_pk_bf16_f32 v179, v254, v255
    v_cndmask_b32 v188, v188, v189, s[46:47]
    v_max3_f32 v248, v180, v181, v182
    v_max3_f32 v249, -v180, -v181, -v182
    v_max3_f32 v248, v248, v183, v184
    v_max3_f32 v249, v249, -v183, -v184
    v_max3_f32 v248, v248, v185, v186
    v_max3_f32 v249, v249, -v185, -v186
    v_max3_f32 v248, v248, v187, v188
    v_max3_f32 v249, v249, -v187, -v188
    s_nop 1
    v_permlane32_swap_b32 v248, v249
    v_max_f32 v248, v248, v249
    v_mov_b32 v249, v248
    s_nop 1
    v_permlane32_swap_b32 v248, v249
    v_pk_add_f32 v[196:197], v[180:181], v[248:249] op_sel:[0,0] op_sel_hi:[0,1] neg_lo:[0,1] neg_hi:[1,1]
    v_pk_add_f32 v[198:199], v[180:181], v[248:249] op_sel:[1,0] op_sel_hi:[1,1] neg_lo:[0,1] neg_hi:[1,1]
    v_pk_add_f32 v[200:201], v[182:183], v[248:249] op_sel:[0,0] op_sel_hi:[0,1] neg_lo:[0,1] neg_hi:[1,1]
    v_pk_add_f32 v[202:203], v[182:183], v[248:249] op_sel:[1,0] op_sel_hi:[1,1] neg_lo:[0,1] neg_hi:[1,1]
    v_pk_add_f32 v[204:205], v[184:185], v[248:249] op_sel:[0,0] op_sel_hi:[0,1] neg_lo:[0,1] neg_hi:[1,1]
    v_pk_add_f32 v[206:207], v[184:185], v[248:249] op_sel:[1,0] op_sel_hi:[1,1] neg_lo:[0,1] neg_hi:[1,1]
    v_pk_add_f32 v[208:209], v[186:187], v[248:249] op_sel:[0,0] op_sel_hi:[0,1] neg_lo:[0,1] neg_hi:[1,1]
    v_pk_add_f32 v[210:211], v[186:187], v[248:249] op_sel:[1,0] op_sel_hi:[1,1] neg_lo:[0,1] neg_hi:[1,1]
    v_pk_add_f32 v[212:213], v[188:189], v[248:249] op_sel:[0,0] op_sel_hi:[0,1] neg_lo:[0,1] neg_hi:[1,1]
    v_mfma_f32_32x32x16_bf16 v[180:195], a[136:139], v[148:151], 0
    v_exp_f32 v196, v196
    v_exp_f32 v197, v197
    v_exp_f32 v198, v198
    v_mfma_f32_32x32x16_bf16 v[180:195], a[140:143], v[152:155], v[180:195]
    v_exp_f32 v199, v199
    v_exp_f32 v200, v200
    v_exp_f32 v201, v201
    v_exp_f32 v202, v202
    v_exp_f32 v203, v203
    v_exp_f32 v204, v204
    v_exp_f32 v205, v205
    v_exp_f32 v206, v206
    v_exp_f32 v207, v207
    v_exp_f32 v208, v208
    v_exp_f32 v209, v209
    v_exp_f32 v210, v210
    v_exp_f32 v211, v211
    v_exp_f32 v212, v212
    v_exp_f32 v213, v213
    v_pk_add_f32 v[250:251], v[196:197], v[198:199]
    v_pk_add_f32 v[252:253], v[200:201], v[202:203]
    v_pk_add_f32 v[250:251], v[250:251], v[204:205]
    v_pk_add_f32 v[252:253], v[252:253], v[206:207]
    v_pk_add_f32 v[250:251], v[250:251], v[208:209]
    v_pk_add_f32 v[252:253], v[252:253], v[210:211]
    v_pk_add_f32 v[250:251], v[250:251], v[212:213]
    v_pk_add_f32 v[250:251], v[250:251], v[252:253]
    s_nop 1
    v_permlane32_swap_b32 v250, v251
    v_add_f32 v250, v250, v251
    v_rcp_f32 v250, v250
    s_nop 0
    v_mov_b32 v251, v250
    s_nop 1
    v_permlane32_swap_b32 v250, v251
    v_pk_mul_f32 v[196:197], v[196:197], v[250:251]
    v_pk_mul_f32 v[198:199], v[198:199], v[250:251]
    v_pk_mul_f32 v[200:201], v[200:201], v[250:251]
    v_pk_mul_f32 v[202:203], v[202:203], v[250:251]
    v_pk_mul_f32 v[204:205], v[204:205], v[250:251]
    v_pk_mul_f32 v[206:207], v[206:207], v[250:251]
    v_pk_mul_f32 v[208:209], v[208:209], v[250:251]
    v_pk_mul_f32 v[210:211], v[210:211], v[250:251]
    v_pk_mul_f32 v[212:213], v[212:213], v[250:251]
    v_cvt_pk_bf16_f32 v0, v196, v197
    v_cvt_pk_bf16_f32 v1, v198, v199
    v_cvt_pk_bf16_f32 v2, v200, v201
    v_cvt_pk_bf16_f32 v3, v202, v203
    v_cvt_pk_bf16_f32 v4, v204, v205
    v_cvt_pk_bf16_f32 v5, v206, v207
    v_cvt_pk_bf16_f32 v6, v208, v209
    v_cvt_pk_bf16_f32 v7, v210, v211
    v_cvt_pk_bf16_f32 v64, v212, v213
    v_cndmask_b32 v188, v188, v189, s[46:47]
    v_max3_f32 v248, v180, v181, v182
    v_max3_f32 v249, -v180, -v181, -v182
    v_max3_f32 v248, v248, v183, v184
    v_max3_f32 v249, v249, -v183, -v184
    v_max3_f32 v248, v248, v185, v186
    v_max3_f32 v249, v249, -v185, -v186
    v_max3_f32 v248, v248, v187, v188
    v_max3_f32 v249, v249, -v187, -v188
    s_nop 1
    v_permlane32_swap_b32 v248, v249
    v_max_f32 v248, v248, v249
    v_mov_b32 v249, v248
    s_nop 1
    v_permlane32_swap_b32 v248, v249
    v_pk_add_f32 v[196:197], v[180:181], v[248:249] op_sel:[0,0] op_sel_hi:[0,1] neg_lo:[0,1] neg_hi:[1,1]
    v_pk_add_f32 v[198:199], v[180:181], v[248:249] op_sel:[1,0] op_sel_hi:[1,1] neg_lo:[0,1] neg_hi:[1,1]
    v_pk_add_f32 v[200:201], v[182:183], v[248:249] op_sel:[0,0] op_sel_hi:[0,1] neg_lo:[0,1] neg_hi:[1,1]
    v_pk_add_f32 v[202:203], v[182:183], v[248:249] op_sel:[1,0] op_sel_hi:[1,1] neg_lo:[0,1] neg_hi:[1,1]
    v_pk_add_f32 v[204:205], v[184:185], v[248:249] op_sel:[0,0] op_sel_hi:[0,1] neg_lo:[0,1] neg_hi:[1,1]
    v_pk_add_f32 v[206:207], v[184:185], v[248:249] op_sel:[1,0] op_sel_hi:[1,1] neg_lo:[0,1] neg_hi:[1,1]
    v_pk_add_f32 v[208:209], v[186:187], v[248:249] op_sel:[0,0] op_sel_hi:[0,1] neg_lo:[0,1] neg_hi:[1,1]
    v_pk_add_f32 v[210:211], v[186:187], v[248:249] op_sel:[1,0] op_sel_hi:[1,1] neg_lo:[0,1] neg_hi:[1,1]
    v_pk_add_f32 v[212:213], v[188:189], v[248:249] op_sel:[0,0] op_sel_hi:[0,1] neg_lo:[0,1] neg_hi:[1,1]
    v_mfma_f32_32x32x16_bf16 v[180:195], a[144:147], v[152:155], 0
    v_exp_f32 v196, v196
    v_exp_f32 v197, v197
    v_exp_f32 v198, v198
    v_mfma_f32_32x32x16_bf16 v[180:195], a[148:151], v[156:159], v[180:195]
    v_exp_f32 v199, v199
    v_exp_f32 v200, v200
    v_exp_f32 v201, v201
    v_exp_f32 v202, v202
    v_exp_f32 v203, v203
    v_exp_f32 v204, v204
    v_exp_f32 v205, v205
    v_exp_f32 v206, v206
    v_exp_f32 v207, v207
    v_exp_f32 v208, v208
    v_exp_f32 v209, v209
    v_exp_f32 v210, v210
    v_exp_f32 v211, v211
    v_exp_f32 v212, v212
    v_exp_f32 v213, v213
    v_pk_add_f32 v[250:251], v[196:197], v[198:199]
    v_pk_add_f32 v[252:253], v[200:201], v[202:203]
    v_pk_add_f32 v[250:251], v[250:251], v[204:205]
    v_pk_add_f32 v[252:253], v[252:253], v[206:207]
    v_pk_add_f32 v[250:251], v[250:251], v[208:209]
    v_pk_add_f32 v[252:253], v[252:253], v[210:211]
    v_pk_add_f32 v[250:251], v[250:251], v[212:213]
    v_pk_add_f32 v[250:251], v[250:251], v[252:253]
    s_nop 1
    v_permlane32_swap_b32 v250, v251
    v_add_f32 v250, v250, v251
    v_rcp_f32 v250, v250
    s_nop 0
    v_mov_b32 v251, v250
    s_nop 1
    v_permlane32_swap_b32 v250, v251
    v_pk_mul_f32 v[196:197], v[196:197], v[250:251]
    v_pk_mul_f32 v[198:199], v[198:199], v[250:251]
L_sa8:
    s_cbranch_execz L_reta
    v_pk_mul_f32 v[200:201], v[200:201], v[250:251]
    v_pk_mul_f32 v[202:203], v[202:203], v[250:251]
    v_pk_mul_f32 v[204:205], v[204:205], v[250:251]
    v_pk_mul_f32 v[206:207], v[206:207], v[250:251]
    v_pk_mul_f32 v[208:209], v[208:209], v[250:251]
    v_pk_mul_f32 v[210:211], v[210:211], v[250:251]
    v_pk_mul_f32 v[212:213], v[212:213], v[250:251]
    v_cvt_pk_bf16_f32 v8, v196, v197
    v_cvt_pk_bf16_f32 v9, v198, v199
    v_cvt_pk_bf16_f32 v10, v200, v201
    v_cvt_pk_bf16_f32 v11, v202, v203
    v_cvt_pk_bf16_f32 v12, v204, v205
    v_cvt_pk_bf16_f32 v13, v206, v207
    v_cvt_pk_bf16_f32 v14, v208, v209
    v_cvt_pk_bf16_f32 v15, v210, v211
    v_cvt_pk_bf16_f32 v65, v212, v213
    buffer_load_dword v238, v234, s[24:27], 0 offen offset:128 sc1
    s_waitcnt vmcnt(1)
    buffer_store_dword v223, v222, s[24:27], s44 offen offset:256 sc1
    v_cndmask_b32 v188, v188, v189, s[46:47]
    v_max3_f32 v248, v180, v181, v182
    v_max3_f32 v249, -v180, -v181, -v182
    v_max3_f32 v248, v248, v183, v184
    v_max3_f32 v249, v249, -v183, -v184
    v_max3_f32 v248, v248, v185, v186
    v_max3_f32 v249, v249, -v185, -v186
    v_max3_f32 v248, v248, v187, v188
    v_max3_f32 v249, v249, -v187, -v188
    s_nop 1
    v_permlane32_swap_b32 v248, v249
    v_max_f32 v248, v248, v249
    v_mov_b32 v249, v248
    s_nop 1
    v_permlane32_swap_b32 v248, v249
    v_pk_add_f32 v[196:197], v[180:181], v[248:249] op_sel:[0,0] op_sel_hi:[0,1] neg_lo:[0,1] neg_hi:[1,1]
    v_pk_add_f32 v[198:199], v[180:181], v[248:249] op_sel:[1,0] op_sel_hi:[1,1] neg_lo:[0,1] neg_hi:[1,1]
    v_pk_add_f32 v[200:201], v[182:183], v[248:249] op_sel:[0,0] op_sel_hi:[0,1] neg_lo:[0,1] neg_hi:[1,1]
    v_pk_add_f32 v[202:203], v[182:183], v[248:249] op_sel:[1,0] op_sel_hi:[1,1] neg_lo:[0,1] neg_hi:[1,1]
    v_pk_add_f32 v[204:205], v[184:185], v[248:249] op_sel:[0,0] op_sel_hi:[0,1] neg_lo:[0,1] neg_hi:[1,1]
    v_pk_add_f32 v[206:207], v[184:185], v[248:249] op_sel:[1,0] op_sel_hi:[1,1] neg_lo:[0,1] neg_hi:[1,1]
    v_pk_add_f32 v[208:209], v[186:187], v[248:249] op_sel:[0,0] op_sel_hi:[0,1] neg_lo:[0,1] neg_hi:[1,1]
    v_pk_add_f32 v[210:211], v[186:187], v[248:249] op_sel:[1,0] op_sel_hi:[1,1] neg_lo:[0,1] neg_hi:[1,1]
    v_pk_add_f32 v[212:213], v[188:189], v[248:249] op_sel:[0,0] op_sel_hi:[0,1] neg_lo:[0,1] neg_hi:[1,1]
    v_mfma_f32_32x32x16_bf16 v[180:195], a[152:155], v[156:159], 0
    v_exp_f32 v196, v196
    v_exp_f32 v197, v197
    v_exp_f32 v198, v198
    v_mfma_f32_32x32x16_bf16 v[180:195], a[156:159], v[160:163], v[180:195]
    v_exp_f32 v199, v199
    v_exp_f32 v200, v200
    v_exp_f32 v201, v201
    v_exp_f32 v202, v202
    v_exp_f32 v203, v203
    v_exp_f32 v204, v204
    v_exp_f32 v205, v205
    v_exp_f32 v206, v206
    v_exp_f32 v207, v207
    v_exp_f32 v208, v208
    v_exp_f32 v209, v209
    v_exp_f32 v210, v210
    v_exp_f32 v211, v211
    v_exp_f32 v212, v212
    v_exp_f32 v213, v213
    v_pk_add_f32 v[250:251], v[196:197], v[198:199]
    v_pk_add_f32 v[252:253], v[200:201], v[202:203]
    v_pk_add_f32 v[250:251], v[250:251], v[204:205]
    v_pk_add_f32 v[252:253], v[252:253], v[206:207]
    v_pk_add_f32 v[250:251], v[250:251], v[208:209]
    v_pk_add_f32 v[252:253], v[252:253], v[210:211]
    v_pk_add_f32 v[250:251], v[250:251], v[212:213]
    v_pk_add_f32 v[250:251], v[250:251], v[252:253]
    s_nop 1
    v_permlane32_swap_b32 v250, v251
    v_add_f32 v250, v250, v251
    v_rcp_f32 v250, v250
    s_nop 0
    v_mov_b32 v251, v250
    s_nop 1
    v_permlane32_swap_b32 v250, v251
    v_pk_mul_f32 v[196:197], v[196:197], v[250:251]
    v_pk_mul_f32 v[198:199], v[198:199], v[250:251]
    v_pk_mul_f32 v[200:201], v[200:201], v[250:251]
    v_pk_mul_f32 v[202:203], v[202:203], v[250:251]
    v_pk_mul_f32 v[204:205], v[204:205], v[250:251]
    v_pk_mul_f32 v[206:207], v[206:207], v[250:251]
    v_pk_mul_f32 v[208:209], v[208:209], v[250:251]
    v_pk_mul_f32 v[210:211], v[210:211], v[250:251]
    v_pk_mul_f32 v[212:213], v[212:213], v[250:251]
    v_cvt_pk_bf16_f32 v16, v196, v197
    v_cvt_pk_bf16_f32 v17, v198, v199
    v_cvt_pk_bf16_f32 v18, v200, v201
    v_cvt_pk_bf16_f32 v19, v202, v203
    v_cvt_pk_bf16_f32 v20, v204, v205
    v_cvt_pk_bf16_f32 v21, v206, v207
    v_cvt_pk_bf16_f32 v22, v208, v209
    v_cvt_pk_bf16_f32 v23, v210, v211
    v_cvt_pk_bf16_f32 v66, v212, v213
    s_waitcnt vmcnt(1)
    v_cmp_ne_u32 vcc, 1, v238
    s_cbranch_vccnz L_slowr0
L_backr0:
    buffer_load_dwordx4 v[72:75], v244, s[24:27], s40 offen offset:0 sc1
    buffer_load_dwordx4 v[76:79], v244, s[24:27], s40 offen offset:16 sc1
    buffer_load_dwordx4 v[80:83], v244, s[24:27], s40 offen offset:32 sc1
    buffer_load_dwordx4 v[84:87], v244, s[24:27], s40 offen offset:48 sc1
    buffer_load_dwordx2 v[88:89], v245, s[24:27], s40 offen offset:2560 sc1
    v_cndmask_b32 v188, v188, v189, s[46:47]
    v_max3_f32 v248, v180, v181, v182
    v_max3_f32 v249, -v180, -v181, -v182
    v_max3_f32 v248, v248, v183, v184
    v_max3_f32 v249, v249, -v183, -v184
    v_max3_f32 v248, v248, v185, v186
    v_max3_f32 v249, v249, -v185, -v186
    v_max3_f32 v248, v248, v187, v188
    v_max3_f32 v249, v249, -v187, -v188
    s_nop 1
    v_permlane32_swap_b32 v248, v249
    v_max_f32 v248, v248, v249
    v_mov_b32 v249, v248
    s_nop 1
    v_permlane32_swap_b32 v248, v249
    v_pk_add_f32 v[196:197], v[180:181], v[248:249] op_sel:[0,0] op_sel_hi:[0,1] neg_lo:[0,1] neg_hi:[1,1]
    v_pk_add_f32 v[198:199], v[180:181], v[248:249] op_sel:[1,0] op_sel_hi:[1,1] neg_lo:[0,1] neg_hi:[1,1]
    v_pk_add_f32 v[200:201], v[182:183], v[248:249] op_sel:[0,0] op_sel_hi:[0,1] neg_lo:[0,1] neg_hi:[1,1]
    v_pk_add_f32 v[202:203], v[182:183], v[248:249] op_sel:[1,0] op_sel_hi:[1,1] neg_lo:[0,1] neg_hi:[1,1]
    v_pk_add_f32 v[204:205], v[184:185], v[248:249] op_sel:[0,0] op_sel_hi:[0,1] neg_lo:[0,1] neg_hi:[1,1]
    v_pk_add_f32 v[206:207], v[184:185], v[248:249] op_sel:[1,0] op_sel_hi:[1,1] neg_lo:[0,1] neg_hi:[1,1]
    v_pk_add_f32 v[208:209], v[186:187], v[248:249] op_sel:[0,0] op_sel_hi:[0,1] neg_lo:[0,1] neg_hi:[1,1]
    v_pk_add_f32 v[210:211], v[186:187], v[248:249] op_sel:[1,0] op_sel_hi:[1,1] neg_lo:[0,1] neg_hi:[1,1]
    v_pk_add_f32 v[212:213], v[188:189], v[248:249] op_sel:[0,0] op_sel_hi:[0,1] neg_lo:[0,1] neg_hi:[1,1]
    v_mfma_f32_32x32x16_bf16 v[180:195], a[160:163], v[160:163], 0
    v_exp_f32 v196, v196
    v_exp_f32 v197, v197
    v_exp_f32 v198, v198
    v_mfma_f32_32x32x16_bf16 v[180:195], a[164:167], v[164:167], v[180:195]
    v_exp_f32 v199, v199
    v_exp_f32 v200, v200
    v_exp_f32 v201, v201
    v_exp_f32 v202, v202
    v_exp_f32 v203, v203
    v_exp_f32 v204, v204
    v_exp_f32 v205, v205
    v_exp_f32 v206, v206
    v_exp_f32 v207, v207
    v_exp_f32 v208, v208
    v_exp_f32 v209, v209
    v_exp_f32 v210, v210
    v_exp_f32 v211, v211
    v_exp_f32 v212, v212
    v_exp_f32 v213, v213
    v_pk_add_f32 v[250:251], v[196:197], v[198:199]
    v_pk_add_f32 v[252:253], v[200:201], v[202:203]
    v_pk_add_f32 v[250:251], v[250:251], v[204:205]
    v_pk_add_f32 v[252:253], v[252:253], v[206:207]
    v_pk_add_f32 v[250:251], v[250:251], v[208:209]
    v_pk_add_f32 v[252:253], v[252:253], v[210:211]
    v_pk_add_f32 v[250:251], v[250:251], v[212:213]
    v_pk_add_f32 v[250:251], v[250:251], v[252:253]
    s_nop 1
    v_permlane32_swap_b32 v250, v251
    v_add_f32 v250, v250, v251
    v_rcp_f32 v250, v250
    s_nop 0
    v_mov_b32 v251, v250
    s_nop 1
    v_permlane32_swap_b32 v250, v251
    v_pk_mul_f32 v[196:197], v[196:197], v[250:251]
    v_pk_mul_f32 v[198:199], v[198:199], v[250:251]
    v_pk_mul_f32 v[200:201], v[200:201], v[250:251]
    v_pk_mul_f32 v[202:203], v[202:203], v[250:251]
    v_pk_mul_f32 v[204:205], v[204:205], v[250:251]
    v_pk_mul_f32 v[206:207], v[206:207], v[250:251]
    v_pk_mul_f32 v[208:209], v[208:209], v[250:251]
    v_pk_mul_f32 v[210:211], v[210:211], v[250:251]
    v_pk_mul_f32 v[212:213], v[212:213], v[250:251]
    v_cvt_pk_bf16_f32 v24, v196, v197
    v_cvt_pk_bf16_f32 v25, v198, v199
    v_cvt_pk_bf16_f32 v26, v200, v201
    v_cvt_pk_bf16_f32 v27, v202, v203
    v_cvt_pk_bf16_f32 v28, v204, v205
    v_cvt_pk_bf16_f32 v29, v206, v207
    v_cvt_pk_bf16_f32 v30, v208, v209
    v_cvt_pk_bf16_f32 v31, v210, v211
    v_cvt_pk_bf16_f32 v67, v212, v213
    buffer_load_dword v238, v234, s[24:27], 0 offen offset:256 sc1
    v_cndmask_b32 v188, v188, v189, s[46:47]
    v_max3_f32 v248, v180, v181, v182
    v_max3_f32 v249, -v180, -v181, -v182
    v_max3_f32 v248, v248, v183, v184
    v_max3_f32 v249, v249, -v183, -v184
    v_max3_f32 v248, v248, v185, v186
    v_max3_f32 v249, v249, -v185, -v186
    v_max3_f32 v248, v248, v187, v188
    v_max3_f32 v249, v249, -v187, -v188
    s_nop 1
    v_permlane32_swap_b32 v248, v249
    v_max_f32 v248, v248, v249
    v_mov_b32 v249, v248
    s_nop 1
    v_permlane32_swap_b32 v248, v249
    v_pk_add_f32 v[196:197], v[180:181], v[248:249] op_sel:[0,0] op_sel_hi:[0,1] neg_lo:[0,1] neg_hi:[1,1]
    v_pk_add_f32 v[198:199], v[180:181], v[248:249] op_sel:[1,0] op_sel_hi:[1,1] neg_lo:[0,1] neg_hi:[1,1]
    v_pk_add_f32 v[200:201], v[182:183], v[248:249] op_sel:[0,0] op_sel_hi:[0,1] neg_lo:[0,1] neg_hi:[1,1]
    v_pk_add_f32 v[202:203], v[182:183], v[248:249] op_sel:[1,0] op_sel_hi:[1,1] neg_lo:[0,1] neg_hi:[1,1]
    v_pk_add_f32 v[204:205], v[184:185], v[248:249] op_sel:[0,0] op_sel_hi:[0,1] neg_lo:[0,1] neg_hi:[1,1]
    v_pk_add_f32 v[206:207], v[184:185], v[248:249] op_sel:[1,0] op_sel_hi:[1,1] neg_lo:[0,1] neg_hi:[1,1]
    v_pk_add_f32 v[208:209], v[186:187], v[248:249] op_sel:[0,0] op_sel_hi:[0,1] neg_lo:[0,1] neg_hi:[1,1]
    v_pk_add_f32 v[210:211], v[186:187], v[248:249] op_sel:[1,0] op_sel_hi:[1,1] neg_lo:[0,1] neg_hi:[1,1]
    v_pk_add_f32 v[212:213], v[188:189], v[248:249] op_sel:[0,0] op_sel_hi:[0,1] neg_lo:[0,1] neg_hi:[1,1]
    v_mfma_f32_32x32x16_bf16 v[180:195], a[168:171], v[164:167], 0
    v_exp_f32 v196, v196
    v_exp_f32 v197, v197
    v_exp_f32 v198, v198
    v_mfma_f32_32x32x16_bf16 v[180:195], a[172:175], v[168:171], v[180:195]
    v_exp_f32 v199, v199
    v_exp_f32 v200, v200
    v_exp_f32 v201, v201
    v_exp_f32 v202, v202
    v_exp_f32 v203, v203
    v_exp_f32 v204, v204
    v_exp_f32 v205, v205
    v_exp_f32 v206, v206
    v_exp_f32 v207, v207
    v_exp_f32 v208, v208
    v_exp_f32 v209, v209
    v_exp_f32 v210, v210
    v_exp_f32 v211, v211
    v_exp_f32 v212, v212
    v_exp_f32 v213, v213
    v_pk_add_f32 v[250:251], v[196:197], v[198:199]
    v_pk_add_f32 v[252:253], v[200:201], v[202:203]
    v_pk_add_f32 v[250:251], v[250:251], v[204:205]
    v_pk_add_f32 v[252:253], v[252:253], v[206:207]
    v_pk_add_f32 v[250:251], v[250:251], v[208:209]
    v_pk_add_f32 v[252:253], v[252:253], v[210:211]
    v_pk_add_f32 v[250:251], v[250:251], v[212:213]
    v_pk_add_f32 v[250:251], v[250:251], v[252:253]
    s_nop 1
    v_permlane32_swap_b32 v250, v251
    v_add_f32 v250, v250, v251
    v_rcp_f32 v250, v250
    s_nop 0
    v_mov_b32 v251, v250
    s_nop 1
    v_permlane32_swap_b32 v250, v251
    v_pk_mul_f32 v[196:197], v[196:197], v[250:251]
    v_pk_mul_f32 v[198:199], v[198:199], v[250:251]
    v_pk_mul_f32 v[200:201], v[200:201], v[250:251]
    v_pk_mul_f32 v[202:203], v[202:203], v[250:251]
    v_pk_mul_f32 v[204:205], v[204:205], v[250:251]
    v_pk_mul_f32 v[206:207], v[206:207], v[250:251]
    v_pk_mul_f32 v[208:209], v[208:209], v[250:251]
    v_pk_mul_f32 v[210:211], v[210:211], v[250:251]
    v_pk_mul_f32 v[212:213], v[212:213], v[250:251]
    v_cvt_pk_bf16_f32 v32, v196, v197
    v_cvt_pk_bf16_f32 v33, v198, v199
    v_cvt_pk_bf16_f32 v34, v200, v201
    v_cvt_pk_bf16_f32 v35, v202, v203
    v_cvt_pk_bf16_f32 v36, v204, v205
    v_cvt_pk_bf16_f32 v37, v206, v207
    v_cvt_pk_bf16_f32 v38, v208, v209
    v_cvt_pk_bf16_f32 v39, v210, v211
    v_cvt_pk_bf16_f32 v68, v212, v213
    s_waitcnt vmcnt(1)
    v_cvt_pk_bf16_f32 v72, v72, v73
    v_cvt_pk_bf16_f32 v73, v74, v75
    v_cvt_pk_bf16_f32 v74, v76, v77
    v_cvt_pk_bf16_f32 v75, v78, v79
    v_cvt_pk_bf16_f32 v76, v80, v81
    v_cvt_pk_bf16_f32 v77, v82, v83
    v_cvt_pk_bf16_f32 v78, v84, v85
    v_cvt_pk_bf16_f32 v79, v86, v87
    v_cvt_pk_bf16_f32 v80, v88, v89
    ds_write_b128 v246, v[72:75] offset:0
    ds_write_b128 v246, v[76:79] offset:1024
    ds_write_b128 v246, v[214:217] offset:2048
    ds_write_b32 v247, v80 offset:2048
    s_waitcnt lgkmcnt(0)
    s_barrier
    ds_read_b128 a[24:27], v233 offset:0
    ds_read_b128 a[28:31], v233 offset:1024
    ds_read_b128 a[32:35], v233 offset:2048
    ds_read_b128 a[36:39], v233 offset:3072
    ds_read_b128 a[40:43], v233 offset:4096
    ds_read_b128 a[44:47], v233 offset:5120
    ds_read_b128 a[48:51], v233 offset:6144
    ds_read_b128 a[52:55], v233 offset:7168
    ds_read_b128 a[56:59], v233 offset:8192
    ds_read_b128 a[60:63], v233 offset:9216
    ds_read_b128 a[64:67], v233 offset:10240
    ds_read_b128 a[68:71], v233 offset:11264
    v_cndmask_b32 v188, v188, v189, s[46:47]
    v_max3_f32 v248, v180, v181, v182
    v_max3_f32 v249, -v180, -v181, -v182
    v_max3_f32 v248, v248, v183, v184
    v_max3_f32 v249, v249, -v183, -v184
    v_max3_f32 v248, v248, v185, v186
    v_max3_f32 v249, v249, -v185, -v186
    v_max3_f32 v248, v248, v187, v188
    v_max3_f32 v249, v249, -v187, -v188
    s_nop 1
    v_permlane32_swap_b32 v248, v249
    v_max_f32 v248, v248, v249
    v_mov_b32 v249, v248
    s_nop 1
    v_permlane32_swap_b32 v248, v249
    v_pk_add_f32 v[196:197], v[180:181], v[248:249] op_sel:[0,0] op_sel_hi:[0,1] neg_lo:[0,1] neg_hi:[1,1]
    v_pk_add_f32 v[198:199], v[180:181], v[248:249] op_sel:[1,0] op_sel_hi:[1,1] neg_lo:[0,1] neg_hi:[1,1]
    v_pk_add_f32 v[200:201], v[182:183], v[248:249] op_sel:[0,0] op_sel_hi:[0,1] neg_lo:[0,1] neg_hi:[1,1]
    v_pk_add_f32 v[202:203], v[182:183], v[248:249] op_sel:[1,0] op_sel_hi:[1,1] neg_lo:[0,1] neg_hi:[1,1]
    v_pk_add_f32 v[204:205], v[184:185], v[248:249] op_sel:[0,0] op_sel_hi:[0,1] neg_lo:[0,1] neg_hi:[1,1]
    v_pk_add_f32 v[206:207], v[184:185], v[248:249] op_sel:[1,0] op_sel_hi:[1,1] neg_lo:[0,1] neg_hi:[1,1]
    v_pk_add_f32 v[208:209], v[186:187], v[248:249] op_sel:[0,0] op_sel_hi:[0,1] neg_lo:[0,1] neg_hi:[1,1]
    v_pk_add_f32 v[210:211], v[186:187], v[248:249] op_sel:[1,0] op_sel_hi:[1,1] neg_lo:[0,1] neg_hi:[1,1]
    v_pk_add_f32 v[212:213], v[188:189], v[248:249] op_sel:[0,0] op_sel_hi:[0,1] neg_lo:[0,1] neg_hi:[1,1]
    v_mfma_f32_32x32x16_bf16 v[180:195], a[176:179], v[168:171], 0
    v_exp_f32 v196, v196
    v_exp_f32 v197, v197
    v_exp_f32 v198, v198
    v_mfma_f32_32x32x16_bf16 v[180:195], a[180:183], v[172:175], v[180:195]
    v_exp_f32 v199, v199
    v_exp_f32 v200, v200
    v_exp_f32 v201, v201
    s_waitcnt lgkmcnt(9)
    v_mfma_f32_32x32x16_bf16 v[112:127], a[24:27], v[0:3], 0
    v_exp_f32 v202, v202
    v_exp_f32 v203, v203
    v_exp_f32 v204, v204
    v_mfma_f32_32x32x16_bf16 v[112:127], a[28:31], v[4:7], v[112:127]
    v_exp_f32 v205, v205
    v_exp_f32 v206, v206
    v_exp_f32 v207, v207
    v_mfma_f32_32x32x16_bf16 v[112:127], a[32:35], v[64:67], v[112:127]
    v_exp_f32 v208, v208
    v_exp_f32 v209, v209
    v_exp_f32 v210, v210
    v_exp_f32 v211, v211
    v_exp_f32 v212, v212
    v_exp_f32 v213, v213
    v_pk_add_f32 v[250:251], v[196:197], v[198:199]
    v_pk_add_f32 v[252:253], v[200:201], v[202:203]
    v_pk_add_f32 v[250:251], v[250:251], v[204:205]
    v_pk_add_f32 v[252:253], v[252:253], v[206:207]
    v_pk_add_f32 v[250:251], v[250:251], v[208:209]
    v_pk_add_f32 v[252:253], v[252:253], v[210:211]
    v_pk_add_f32 v[250:251], v[250:251], v[212:213]
    v_pk_add_f32 v[250:251], v[250:251], v[252:253]
    s_nop 1
    v_permlane32_swap_b32 v250, v251
    v_add_f32 v250, v250, v251
    v_rcp_f32 v250, v250
    s_nop 0
    v_mov_b32 v251, v250
    s_nop 1
    v_permlane32_swap_b32 v250, v251
    v_pk_mul_f32 v[196:197], v[196:197], v[250:251]
    v_pk_mul_f32 v[198:199], v[198:199], v[250:251]
    v_pk_mul_f32 v[200:201], v[200:201], v[250:251]
    v_pk_mul_f32 v[202:203], v[202:203], v[250:251]
    v_pk_mul_f32 v[204:205], v[204:205], v[250:251]
    v_pk_mul_f32 v[206:207], v[206:207], v[250:251]
    v_pk_mul_f32 v[208:209], v[208:209], v[250:251]
    v_pk_mul_f32 v[210:211], v[210:211], v[250:251]
    v_pk_mul_f32 v[212:213], v[212:213], v[250:251]
    v_cvt_pk_bf16_f32 v40, v196, v197
    v_cvt_pk_bf16_f32 v41, v198, v199
    v_cvt_pk_bf16_f32 v42, v200, v201
    v_cvt_pk_bf16_f32 v43, v202, v203
    v_cvt_pk_bf16_f32 v44, v204, v205
    v_cvt_pk_bf16_f32 v45, v206, v207
    v_cvt_pk_bf16_f32 v46, v208, v209
    v_cvt_pk_bf16_f32 v47, v210, v211
    v_cvt_pk_bf16_f32 v69, v212, v213
    s_waitcnt vmcnt(0)
    v_cmp_ne_u32 vcc, 1, v238
    s_cbranch_vccnz L_slowr1
L_backr1:
    buffer_load_dwordx4 v[92:95], v244, s[24:27], s41 offen offset:0 sc1
    buffer_load_dwordx4 v[96:99], v244, s[24:27], s41 offen offset:16 sc1
    buffer_load_dwordx4 v[100:103], v244, s[24:27], s41 offen offset:32 sc1
    buffer_load_dwordx4 v[104:107], v244, s[24:27], s41 offen offset:48 sc1
    buffer_load_dwordx2 v[108:109], v245, s[24:27], s41 offen offset:2560 sc1
    v_cndmask_b32 v188, v188, v189, s[46:47]
    v_max3_f32 v248, v180, v181, v182
    v_max3_f32 v249, -v180, -v181, -v182
    v_max3_f32 v248, v248, v183, v184
    v_max3_f32 v249, v249, -v183, -v184
    v_max3_f32 v248, v248, v185, v186
    v_max3_f32 v249, v249, -v185, -v186
    v_max3_f32 v248, v248, v187, v188
    v_max3_f32 v249, v249, -v187, -v188
    v_add_f32 v121, 0x358637bd, v121
    v_rcp_f32 v121, v121
    s_nop 0
    v_mul_f32 v112, v112, v121
    v_mul_f32 v113, v113, v121
    v_permlane32_swap_b32 v248, v249
    v_max_f32 v248, v248, v249
    v_mov_b32 v249, v248
    v_mul_f32 v114, v114, v121
    v_mul_f32 v115, v115, v121
    v_mul_f32 v116, v116, v121
    v_mul_f32 v117, v117, v121
    v_permlane32_swap_b32 v248, v249
    v_pk_add_f32 v[196:197], v[180:181], v[248:249] op_sel:[0,0] op_sel_hi:[0,1] neg_lo:[0,1] neg_hi:[1,1]
    v_pk_add_f32 v[198:199], v[180:181], v[248:249] op_sel:[1,0] op_sel_hi:[1,1] neg_lo:[0,1] neg_hi:[1,1]
    v_pk_add_f32 v[200:201], v[182:183], v[248:249] op_sel:[0,0] op_sel_hi:[0,1] neg_lo:[0,1] neg_hi:[1,1]
    v_pk_add_f32 v[202:203], v[182:183], v[248:249] op_sel:[1,0] op_sel_hi:[1,1] neg_lo:[0,1] neg_hi:[1,1]
    v_pk_add_f32 v[204:205], v[184:185], v[248:249] op_sel:[0,0] op_sel_hi:[0,1] neg_lo:[0,1] neg_hi:[1,1]
    v_pk_add_f32 v[206:207], v[184:185], v[248:249] op_sel:[1,0] op_sel_hi:[1,1] neg_lo:[0,1] neg_hi:[1,1]
    v_pk_add_f32 v[208:209], v[186:187], v[248:249] op_sel:[0,0] op_sel_hi:[0,1] neg_lo:[0,1] neg_hi:[1,1]
    v_pk_add_f32 v[210:211], v[186:187], v[248:249] op_sel:[1,0] op_sel_hi:[1,1] neg_lo:[0,1] neg_hi:[1,1]
    v_pk_add_f32 v[212:213], v[188:189], v[248:249] op_sel:[0,0] op_sel_hi:[0,1] neg_lo:[0,1] neg_hi:[1,1]
    v_mfma_f32_32x32x16_bf16 v[180:195], a[184:187], v[172:175], 0
    v_exp_f32 v196, v196
    v_exp_f32 v197, v197
    v_exp_f32 v198, v198
    v_mfma_f32_32x32x16_bf16 v[180:195], a[188:191], v[176:179], v[180:195]
    v_exp_f32 v199, v199
    v_exp_f32 v200, v200
    v_exp_f32 v201, v201
    v_mul_f32 v118, v118, v121
    v_mul_f32 v119, v119, v121
    v_mul_f32 v4, v120, v121
    v_cvt_pk_bf16_f32 v0, v112, v113
    v_cvt_pk_bf16_f32 v1, v114, v115
    v_cvt_pk_bf16_f32 v2, v116, v117
    v_cvt_pk_bf16_f32 v3, v118, v119
    buffer_store_dwordx4 v[0:3], v236, s[24:27], s38 offen offset:0 sc1
    s_waitcnt lgkmcnt(6)
    v_mfma_f32_32x32x16_bf16 v[128:143], a[36:39], v[8:11], 0
    v_exp_f32 v202, v202
    v_exp_f32 v203, v203
    v_exp_f32 v204, v204
    v_mfma_f32_32x32x16_bf16 v[128:143], a[40:43], v[12:15], v[128:143]
    v_exp_f32 v205, v205
    v_exp_f32 v206, v206
    v_exp_f32 v207, v207
    v_mfma_f32_32x32x16_bf16 v[128:143], a[44:47], v[64:67], v[128:143]
    v_exp_f32 v208, v208
    v_exp_f32 v209, v209
    v_exp_f32 v210, v210
    s_waitcnt lgkmcnt(3)
    v_mfma_f32_32x32x16_bf16 v[112:127], a[48:51], v[16:19], 0
    v_exp_f32 v211, v211
    v_exp_f32 v212, v212
    v_exp_f32 v213, v213
    v_pk_add_f32 v[250:251], v[196:197], v[198:199]
    v_pk_add_f32 v[252:253], v[200:201], v[202:203]
    v_pk_add_f32 v[250:251], v[250:251], v[204:205]
    v_pk_add_f32 v[252:253], v[252:253], v[206:207]
    v_pk_add_f32 v[250:251], v[250:251], v[208:209]
    v_pk_add_f32 v[252:253], v[252:253], v[210:211]
    v_pk_add_f32 v[250:251], v[250:251], v[212:213]
    v_pk_add_f32 v[250:251], v[250:251], v[252:253]
    s_nop 1
    v_permlane32_swap_b32 v250, v251
    v_add_f32 v250, v250, v251
    v_rcp_f32 v250, v250
    s_nop 0
    v_mov_b32 v251, v250
    s_nop 1
    v_permlane32_swap_b32 v250, v251
    v_pk_mul_f32 v[196:197], v[196:197], v[250:251]
    v_pk_mul_f32 v[198:199], v[198:199], v[250:251]
    v_pk_mul_f32 v[200:201], v[200:201], v[250:251]
    v_pk_mul_f32 v[202:203], v[202:203], v[250:251]
    v_pk_mul_f32 v[204:205], v[204:205], v[250:251]
    v_pk_mul_f32 v[206:207], v[206:207], v[250:251]
    v_pk_mul_f32 v[208:209], v[208:209], v[250:251]
    v_pk_mul_f32 v[210:211], v[210:211], v[250:251]
    v_pk_mul_f32 v[212:213], v[212:213], v[250:251]
    v_mfma_f32_32x32x16_bf16 v[112:127], a[52:55], v[20:23], v[112:127]
    v_cvt_pk_bf16_f32 v48, v196, v197
    v_cvt_pk_bf16_f32 v49, v198, v199
    v_cvt_pk_bf16_f32 v50, v200, v201
    v_cvt_pk_bf16_f32 v51, v202, v203
    v_cvt_pk_bf16_f32 v52, v204, v205
    v_cvt_pk_bf16_f32 v53, v206, v207
    v_cvt_pk_bf16_f32 v54, v208, v209
    v_cvt_pk_bf16_f32 v55, v210, v211
    v_cvt_pk_bf16_f32 v70, v212, v213
    v_mfma_f32_32x32x16_bf16 v[112:127], a[56:59], v[64:67], v[112:127]
    v_cndmask_b32 v188, v188, v189, s[46:47]
    v_max3_f32 v248, v180, v181, v182
    v_max3_f32 v249, -v180, -v181, -v182
    v_max3_f32 v248, v248, v183, v184
    v_max3_f32 v249, v249, -v183, -v184
    v_max3_f32 v248, v248, v185, v186
    v_max3_f32 v249, v249, -v185, -v186
    v_max3_f32 v248, v248, v187, v188
    v_max3_f32 v249, v249, -v187, -v188
    v_add_f32 v137, 0x358637bd, v137
    v_rcp_f32 v137, v137
    s_nop 0
    v_mul_f32 v128, v128, v137
    v_mul_f32 v129, v129, v137
    v_permlane32_swap_b32 v248, v249
    v_max_f32 v248, v248, v249
    v_mov_b32 v249, v248
    v_mul_f32 v130, v130, v137
    v_mul_f32 v131, v131, v137
    v_mul_f32 v132, v132, v137
    v_mul_f32 v133, v133, v137
    v_permlane32_swap_b32 v248, v249
    v_pk_add_f32 v[196:197], v[180:181], v[248:249] op_sel:[0,0] op_sel_hi:[0,1] neg_lo:[0,1] neg_hi:[1,1]
    v_pk_add_f32 v[198:199], v[180:181], v[248:249] op_sel:[1,0] op_sel_hi:[1,1] neg_lo:[0,1] neg_hi:[1,1]
    v_pk_add_f32 v[200:201], v[182:183], v[248:249] op_sel:[0,0] op_sel_hi:[0,1] neg_lo:[0,1] neg_hi:[1,1]
    v_pk_add_f32 v[202:203], v[182:183], v[248:249] op_sel:[1,0] op_sel_hi:[1,1] neg_lo:[0,1] neg_hi:[1,1]
    v_pk_add_f32 v[204:205], v[184:185], v[248:249] op_sel:[0,0] op_sel_hi:[0,1] neg_lo:[0,1] neg_hi:[1,1]
    v_pk_add_f32 v[206:207], v[184:185], v[248:249] op_sel:[1,0] op_sel_hi:[1,1] neg_lo:[0,1] neg_hi:[1,1]
    v_pk_add_f32 v[208:209], v[186:187], v[248:249] op_sel:[0,0] op_sel_hi:[0,1] neg_lo:[0,1] neg_hi:[1,1]
    v_pk_add_f32 v[210:211], v[186:187], v[248:249] op_sel:[1,0] op_sel_hi:[1,1] neg_lo:[0,1] neg_hi:[1,1]
    v_pk_add_f32 v[212:213], v[188:189], v[248:249] op_sel:[0,0] op_sel_hi:[0,1] neg_lo:[0,1] neg_hi:[1,1]
    v_mul_f32 v134, v134, v137
    v_mul_f32 v135, v135, v137
    v_mul_f32 v12, v136, v137
    v_cvt_pk_bf16_f32 v8, v128, v129
    v_cvt_pk_bf16_f32 v9, v130, v131
    v_cvt_pk_bf16_f32 v10, v132, v133
    v_cvt_pk_bf16_f32 v11, v134, v135
    v_cvt_pk_bf16_f32 v218, v4, v12
    buffer_store_dwordx4 v[8:11], v236, s[24:27], s38 offen offset:1024 sc1
    v_add_f32 v121, 0x358637bd, v121
    v_rcp_f32 v121, v121
    s_nop 0
    v_mul_f32 v112, v112, v121
    v_mul_f32 v113, v113, v121
    v_mul_f32 v114, v114, v121
    v_mul_f32 v115, v115, v121
    v_mul_f32 v116, v116, v121
    v_mul_f32 v117, v117, v121
    v_mul_f32 v118, v118, v121
    v_mul_f32 v119, v119, v121
    v_mul_f32 v20, v120, v121
    v_cvt_pk_bf16_f32 v16, v112, v113
    v_cvt_pk_bf16_f32 v17, v114, v115
    v_cvt_pk_bf16_f32 v18, v116, v117
    v_cvt_pk_bf16_f32 v19, v118, v119
    buffer_store_dwordx4 v[16:19], v236, s[24:27], s38 offen offset:2048 sc1
    s_waitcnt lgkmcnt(0)
    v_mfma_f32_32x32x16_bf16 v[128:143], a[60:63], v[24:27], 0
    v_exp_f32 v196, v196
    v_exp_f32 v197, v197
    v_exp_f32 v198, v198
    v_mfma_f32_32x32x16_bf16 v[128:143], a[64:67], v[28:31], v[128:143]
    v_exp_f32 v199, v199
    v_exp_f32 v200, v200
    v_exp_f32 v201, v201
    v_mfma_f32_32x32x16_bf16 v[128:143], a[68:71], v[64:67], v[128:143]
    v_exp_f32 v202, v202
    v_exp_f32 v203, v203
    v_exp_f32 v204, v204
    v_exp_f32 v205, v205
    v_exp_f32 v206, v206
    v_exp_f32 v207, v207
    v_exp_f32 v208, v208
    v_exp_f32 v209, v209
    v_exp_f32 v210, v210
    v_exp_f32 v211, v211
    v_exp_f32 v212, v212
    v_exp_f32 v213, v213
    v_pk_add_f32 v[250:251], v[196:197], v[198:199]
    v_pk_add_f32 v[252:253], v[200:201], v[202:203]
    v_pk_add_f32 v[250:251], v[250:251], v[204:205]
    v_pk_add_f32 v[252:253], v[252:253], v[206:207]
    v_pk_add_f32 v[250:251], v[250:251], v[208:209]
    v_pk_add_f32 v[252:253], v[252:253], v[210:211]
    v_pk_add_f32 v[250:251], v[250:251], v[212:213]
    v_pk_add_f32 v[250:251], v[250:251], v[252:253]
    s_nop 1
    v_permlane32_swap_b32 v250, v251
    v_add_f32 v250, v250, v251
    v_rcp_f32 v250, v250
    s_nop 0
    v_mov_b32 v251, v250
    s_nop 1
    v_permlane32_swap_b32 v250, v251
    v_pk_mul_f32 v[196:197], v[196:197], v[250:251]
    v_pk_mul_f32 v[198:199], v[198:199], v[250:251]
    v_pk_mul_f32 v[200:201], v[200:201], v[250:251]
    v_pk_mul_f32 v[202:203], v[202:203], v[250:251]
    v_pk_mul_f32 v[204:205], v[204:205], v[250:251]
    v_pk_mul_f32 v[206:207], v[206:207], v[250:251]
    v_pk_mul_f32 v[208:209], v[208:209], v[250:251]
    v_pk_mul_f32 v[210:211], v[210:211], v[250:251]
    v_pk_mul_f32 v[212:213], v[212:213], v[250:251]
    v_cvt_pk_bf16_f32 v56, v196, v197
    v_cvt_pk_bf16_f32 v57, v198, v199
    v_cvt_pk_bf16_f32 v58, v200, v201
    v_cvt_pk_bf16_f32 v59, v202, v203
    v_cvt_pk_bf16_f32 v60, v204, v205
    v_cvt_pk_bf16_f32 v61, v206, v207
    v_cvt_pk_bf16_f32 v62, v208, v209
    v_cvt_pk_bf16_f32 v63, v210, v211
    v_cvt_pk_bf16_f32 v71, v212, v213
    s_waitcnt vmcnt(3)
    v_cvt_pk_bf16_f32 v92, v92, v93
    v_cvt_pk_bf16_f32 v93, v94, v95
    v_cvt_pk_bf16_f32 v94, v96, v97
    v_cvt_pk_bf16_f32 v95, v98, v99
    v_cvt_pk_bf16_f32 v96, v100, v101
    v_cvt_pk_bf16_f32 v97, v102, v103
    v_cvt_pk_bf16_f32 v98, v104, v105
    v_cvt_pk_bf16_f32 v99, v106, v107
    v_cvt_pk_bf16_f32 v100, v108, v109
    ds_write_b128 v246, v[92:95] offset:12288
    ds_write_b128 v246, v[96:99] offset:13312
    ds_write_b128 v246, v[214:217] offset:14336
    ds_write_b32 v247, v100 offset:14336
    s_waitcnt lgkmcnt(0)
    s_barrier
    ds_read_b128 a[72:75], v233 offset:12288
    ds_read_b128 a[76:79], v233 offset:13312
    ds_read_b128 a[80:83], v233 offset:14336
    ds_read_b128 a[84:87], v233 offset:15360
    ds_read_b128 a[88:91], v233 offset:16384
    ds_read_b128 a[92:95], v233 offset:17408
    ds_read_b128 a[96:99], v233 offset:18432
    ds_read_b128 a[100:103], v233 offset:19456
    ds_read_b128 a[104:107], v233 offset:20480
    ds_read_b128 a[108:111], v233 offset:21504
    ds_read_b128 a[112:115], v233 offset:22528
    ds_read_b128 a[116:119], v233 offset:23552
    v_add_f32 v137, 0x358637bd, v137
    v_rcp_f32 v137, v137
    s_nop 0
    v_mul_f32 v128, v128, v137
    v_mul_f32 v129, v129, v137
    v_mul_f32 v130, v130, v137
    v_mul_f32 v131, v131, v137
    v_mul_f32 v132, v132, v137
    v_mul_f32 v133, v133, v137
    v_mul_f32 v134, v134, v137
    v_mul_f32 v135, v135, v137
    v_mul_f32 v28, v136, v137
    v_cvt_pk_bf16_f32 v24, v128, v129
    v_cvt_pk_bf16_f32 v25, v130, v131
L_sa9:
    s_cbranch_execz L_reta
    v_cvt_pk_bf16_f32 v26, v132, v133
    v_cvt_pk_bf16_f32 v27, v134, v135
    v_cvt_pk_bf16_f32 v219, v20, v28
    buffer_store_dwordx4 v[24:27], v236, s[24:27], s38 offen offset:3072 sc1
    s_waitcnt lgkmcnt(9)
    v_mfma_f32_32x32x16_bf16 v[112:127], a[72:75], v[32:35], 0
    v_mfma_f32_32x32x16_bf16 v[112:127], a[76:79], v[36:39], v[112:127]
    v_mfma_f32_32x32x16_bf16 v[112:127], a[80:83], v[68:71], v[112:127]
    s_waitcnt lgkmcnt(6)
    v_mfma_f32_32x32x16_bf16 v[128:143], a[84:87], v[40:43], 0
    v_mfma_f32_32x32x16_bf16 v[128:143], a[88:91], v[44:47], v[128:143]
    v_mfma_f32_32x32x16_bf16 v[128:143], a[92:95], v[68:71], v[128:143]
    s_nop 7
    v_add_f32 v121, 0x358637bd, v121
    v_rcp_f32 v121, v121
    s_nop 0
    v_mul_f32 v112, v112, v121
    v_mul_f32 v113, v113, v121
    v_mul_f32 v114, v114, v121
    v_mul_f32 v115, v115, v121
    v_mul_f32 v116, v116, v121
    v_mul_f32 v117, v117, v121
    v_mul_f32 v118, v118, v121
    v_mul_f32 v119, v119, v121
    v_mul_f32 v36, v120, v121
    v_cvt_pk_bf16_f32 v32, v112, v113
    v_cvt_pk_bf16_f32 v33, v114, v115
    v_cvt_pk_bf16_f32 v34, v116, v117
    v_cvt_pk_bf16_f32 v35, v118, v119
    s_add_u32 s38, s38, 4096
    buffer_store_dwordx4 v[32:35], v236, s[24:27], s38 offen offset:0 sc1
    v_add_f32 v137, 0x358637bd, v137
    v_rcp_f32 v137, v137
    s_nop 0
    v_mul_f32 v128, v128, v137
    v_mul_f32 v129, v129, v137
    v_mul_f32 v130, v130, v137
    v_mul_f32 v131, v131, v137
    v_mul_f32 v132, v132, v137
    v_mul_f32 v133, v133, v137
    v_mul_f32 v134, v134, v137
    v_mul_f32 v135, v135, v137
    v_mul_f32 v44, v136, v137
    v_cvt_pk_bf16_f32 v40, v128, v129
    v_cvt_pk_bf16_f32 v41, v130, v131
    v_cvt_pk_bf16_f32 v42, v132, v133
    v_cvt_pk_bf16_f32 v43, v134, v135
    v_cvt_pk_bf16_f32 v220, v36, v44
    buffer_store_dwordx4 v[40:43], v236, s[24:27], s38 offen offset:1024 sc1
    s_waitcnt lgkmcnt(3)
    v_mfma_f32_32x32x16_bf16 v[112:127], a[96:99], v[48:51], 0
    v_mfma_f32_32x32x16_bf16 v[112:127], a[100:103], v[52:55], v[112:127]
    v_mfma_f32_32x32x16_bf16 v[112:127], a[104:107], v[68:71], v[112:127]
    s_waitcnt lgkmcnt(0)
    v_mfma_f32_32x32x16_bf16 v[128:143], a[108:111], v[56:59], 0
    v_mfma_f32_32x32x16_bf16 v[128:143], a[112:115], v[60:63], v[128:143]
    v_mfma_f32_32x32x16_bf16 v[128:143], a[116:119], v[68:71], v[128:143]
    s_nop 7
    v_add_f32 v121, 0x358637bd, v121
    v_rcp_f32 v121, v121
    s_nop 0
    v_mul_f32 v112, v112, v121
    v_mul_f32 v113, v113, v121
    v_mul_f32 v114, v114, v121
    v_mul_f32 v115, v115, v121
    v_mul_f32 v116, v116, v121
    v_mul_f32 v117, v117, v121
    v_mul_f32 v118, v118, v121
    v_mul_f32 v119, v119, v121
    v_mul_f32 v52, v120, v121
    v_cvt_pk_bf16_f32 v48, v112, v113
    v_cvt_pk_bf16_f32 v49, v114, v115
    v_cvt_pk_bf16_f32 v50, v116, v117
    v_cvt_pk_bf16_f32 v51, v118, v119
    buffer_store_dwordx4 v[48:51], v236, s[24:27], s38 offen offset:2048 sc1
    v_add_f32 v137, 0x358637bd, v137
    v_rcp_f32 v137, v137
    s_nop 0
    v_mul_f32 v128, v128, v137
    v_mul_f32 v129, v129, v137
    v_mul_f32 v130, v130, v137
    v_mul_f32 v131, v131, v137
    v_mul_f32 v132, v132, v137
    v_mul_f32 v133, v133, v137
    v_mul_f32 v134, v134, v137
    v_mul_f32 v135, v135, v137
    v_mul_f32 v60, v136, v137
    v_cvt_pk_bf16_f32 v56, v128, v129
    v_cvt_pk_bf16_f32 v57, v130, v131
    v_cvt_pk_bf16_f32 v58, v132, v133
    v_cvt_pk_bf16_f32 v59, v134, v135
    v_cvt_pk_bf16_f32 v221, v52, v60
    buffer_store_dwordx4 v[56:59], v236, s[24:27], s38 offen offset:3072 sc1
    s_add_u32 s38, s38, 4096
    buffer_store_dwordx4 v[218:221], v236, s[24:27], s38 offen offset:0 sc1
    s_waitcnt vmcnt(0)
    buffer_store_dword v223, v222, s[24:27], s44 offen offset:0 sc1
    s_endpgm
L_slowr0:
    s_mov_b32 s5, 0
L_spinr0:
    s_sleep 2
    buffer_load_dword v238, v234, s[24:27], 0 offen offset:128 sc1
    s_waitcnt vmcnt(0)
    v_cmp_ne_u32 vcc, 1, v238
    s_cbranch_vccz L_finr0
    s_add_u32 s5, s5, 1
    s_cmp_lt_u32 s5, 0x40000
    s_cbranch_scc1 L_spinr0
L_finr0:
    s_branch L_backr0
L_slowr1:
    s_mov_b32 s5, 0
L_spinr1:
    s_sleep 2
    buffer_load_dword v238, v234, s[24:27], 0 offen offset:256 sc1
    s_waitcnt vmcnt(0)
    v_cmp_ne_u32 vcc, 1, v238
    s_cbranch_vccz L_finr1
    s_add_u32 s5, s5, 1
    s_cmp_lt_u32 s5, 0x40000
    s_cbranch_scc1 L_spinr1
L_finr1:
    s_branch L_backr1
L1_done:
    s_endpgm
L_sa10:
    s_branch L_reta
L_sa11:
    s_branch L_reta
L_sa12:
    s_branch L_reta
.p2align 12
L1_mlp:
    s_add_u32 m0, s36, 8192
    s_add_u32 s52, s52, 128
    s_cmp_eq_u32 s52, 1152
    s_cselect_b32 s52, 0, s52
    buffer_load_dwordx4 v244, s[8:11], s52 offen offset:0 lds
    s_mul_i32 s37, s33, 3
    s_add_u32 s37, s37, s55
    s_mul_i32 s34, s3, 6144
    s_mov_b64 s[0:1], s[80:81]
    s_mov_b32 s12, s74
    s_and_b32 s13, s75, 0xffff
    s_mov_b32 s14, 5308416
    s_mov_b32 s15, 0x20000
    s_mov_b32 s16, s78
    s_and_b32 s17, s79, 0xffff
    s_mov_b32 s18, 5308416
    s_mov_b32 s19, 0x20000
    s_mov_b32 s20, s76
    s_and_b32 s21, s77, 0xffff
    s_mov_b32 s22, 9216
    s_mov_b32 s23, 0x20000
    buffer_load_dwordx4 v245, s[8:11], s52 offen offset:1024 lds
    s_mov_b32 s28, s82
    s_and_b32 s29, s83, 0xffff
    s_mov_b32 s30, 256
    s_mov_b32 s31, 0x20000
    s_sub_u32 s53, s6, 6
    s_cmp_lt_u32 s6, 6
    s_cselect_b32 s53, s6, s53
    s_lshl_b32 s4, s53, 7
    v_lshl_add_u32 v251, v239, 2, s4
    v_subrev_u32 v250, 768, v251
    v_min_u32 v251, v251, v250
    s_mul_i32 s4, s37, 768
    buffer_load_dword v226, v251, s[20:23], s4 offen
    s_mov_b32 s20, s70
    s_and_b32 s21, s71, 0xffff
    s_mov_b32 s22, 663552
    s_mov_b32 s23, 0x20000
    buffer_load_dwordx4 v246, s[8:11], s52 offen offset:2048 lds
    v_lshrrev_b32 v242, 3, v240
    v_and_b32 v243, 7, v240
    v_and_b32 v248, 2, v242
    v_xor_b32 v243, v243, v248
    v_lshlrev_b32 v243, 4, v243
    v_lshrrev_b32 v248, 2, v242
    v_and_b32 v249, 3, v242
    v_lshl_add_u32 v250, v248, 3, v249
    v_mul_u32_u24 v234, 9216, v250
    v_add_u32 v234, v234, v243
    s_mul_i32 s4, s3, 442368
    s_mul_i32 s5, s37, 768
    s_add_u32 s4, s4, s5
    v_add_u32 v234, s4, v234
    v_lshl_add_u32 v250, v248, 5, v249
    v_mul_u32_u24 v235, 1152, v250
    buffer_load_dwordx4 v247, s[8:11], s52 offen offset:3072 lds
    v_add_u32 v235, v235, v243
    s_mul_i32 s4, s3, 9216
    s_mul_i32 s5, s37, 442368
    s_add_u32 s4, s4, s5
    v_add_u32 v235, s4, v235
    s_mov_b32 s79, 0
    s_mov_b32 s80, 35840
    s_mov_b32 s81, 145408
    s_mov_b32 s82, 181248
    s_mov_b32 s83, 294912
    s_mov_b32 s84, 330752
    s_mul_i32 s4, s55, 1769472
    s_mov_b32 s56, s4
    s_add_u32 s57, s56, 1769472
    s_cmp_eq_u32 s57, 5308416
    s_cselect_b32 s57, 0, s57
    s_add_u32 s58, s57, 1769472
    s_add_u32 m0, s36, 12288
    s_add_u32 s52, s52, 128
    s_cmp_eq_u32 s52, 1152
    s_cselect_b32 s52, 0, s52
    buffer_load_dwordx4 v244, s[8:11], s52 offen offset:0 lds
    s_cmp_eq_u32 s58, 5308416
    s_cselect_b32 s58, 0, s58
    s_lshl_b32 s4, s53, 7
    s_mov_b32 s64, s4
    s_add_u32 s65, s64, 128
    s_cmp_eq_u32 s65, 768
    s_cselect_b32 s65, 0, s65
    s_add_u32 s66, s65, 128
    s_cmp_eq_u32 s66, 768
    s_cselect_b32 s66, 0, s66
    s_add_u32 s67, s66, 128
    s_cmp_eq_u32 s67, 768
    s_cselect_b32 s67, 0, s67
    s_add_u32 s68, s67, 128
    s_cmp_eq_u32 s68, 768
    s_cselect_b32 s68, 0, s68
    s_add_u32 s69, s68, 128
    s_cmp_eq_u32 s69, 768
    s_cselect_b32 s69, 0, s69
    v_lshrrev_b32 v236, 5, v240
    v_lshlrev_b32 v236, 7, v236
    v_add_u32 v236, 147456, v236
    buffer_load_dwordx4 v245, s[8:11], s52 offen offset:1024 lds
    v_lshrrev_b32 v242, 5, v240
    v_bfe_u32 v243, v240, 2, 2
    v_lshl_add_u32 v242, v242, 2, v243
    v_lshlrev_b32 v242, 7, v242
    v_and_b32 v248, 1, v240
    v_lshl_add_u32 v242, v248, 6, v242
    v_bfe_u32 v248, v240, 4, 1
    v_lshl_add_u32 v242, v248, 4, v242
    v_bfe_u32 v248, v240, 1, 1
    v_lshl_add_u32 v242, v248, 3, v242
    v_bfe_u32 v248, v240, 3, 1
    v_lshl_add_u32 v242, v248, 5, v242
    v_xor_b32 v243, 32, v242
    v_add_u32 v228, 0, v242
    v_add_u32 v229, 0, v243
    v_add_u32 v230, 49152, v242
    buffer_load_dwordx4 v246, s[8:11], s52 offen offset:2048 lds
    v_add_u32 v231, 49152, v243
    v_add_u32 v232, 98304, v242
    v_add_u32 v233, 98304, v243
    buffer_load_dwordx4 v247, s[8:11], s52 offen offset:3072 lds
    s_waitcnt vmcnt(13)
    ds_read_b128 v[0:3], v252 offset:0
    ds_read_b128 v[4:7], v253 offset:0
    ds_read_b128 v[8:11], v254 offset:0
    ds_read_b128 v[12:15], v255 offset:0
    s_waitcnt lgkmcnt(0)
    s_add_u32 m0, s36, 0
    s_add_u32 s52, s52, 128
    s_cmp_eq_u32 s52, 1152
    s_cselect_b32 s52, 0, s52
    buffer_load_dwordx4 v244, s[8:11], s52 offen offset:0 lds
    v_dot2c_f32_bf16 v220, v0, v219
    v_dot2c_f32_bf16 v222, v0, v0
    v_dot2c_f32_bf16 v221, v1, v219
    v_dot2c_f32_bf16 v223, v1, v1
    v_dot2c_f32_bf16 v220, v2, v219
    buffer_load_dwordx4 v245, s[8:11], s52 offen offset:1024 lds
    v_dot2c_f32_bf16 v222, v2, v2
    v_dot2c_f32_bf16 v221, v3, v219
    v_dot2c_f32_bf16 v223, v3, v3
    v_dot2c_f32_bf16 v220, v4, v219
    v_dot2c_f32_bf16 v222, v4, v4
    buffer_load_dwordx4 v246, s[8:11], s52 offen offset:2048 lds
    v_dot2c_f32_bf16 v221, v5, v219
    v_dot2c_f32_bf16 v223, v5, v5
    v_dot2c_f32_bf16 v220, v6, v219
    v_dot2c_f32_bf16 v222, v6, v6
    v_dot2c_f32_bf16 v221, v7, v219
    buffer_load_dwordx4 v247, s[8:11], s52 offen offset:3072 lds
    v_dot2c_f32_bf16 v223, v7, v7
    v_dot2c_f32_bf16 v220, v8, v219
    v_dot2c_f32_bf16 v222, v8, v8
    v_dot2c_f32_bf16 v221, v9, v219
    v_dot2c_f32_bf16 v223, v9, v9
    s_mov_b32 s54, 0
    s_mov_b64 exec, 0
    s_cmp_eq_u32 s3, 0
    s_cbranch_scc1 L_sm1
    s_cmp_eq_u32 s3, 1
    s_cbranch_scc1 L_sm2
    s_cmp_eq_u32 s3, 2
    s_cbranch_scc1 L_sm3
    s_branch L_sm4
L_retm:
    s_cmp_eq_u32 s54, 1
    s_cbranch_scc1 L_hbm1
    s_cmp_eq_u32 s54, 2
    s_cbranch_scc1 L_hbm2
L_hbm0:
    s_mov_b64 exec, -1
    s_waitcnt vmcnt(13)
    ds_read_b128 v[16:19], v252 offset:4096
    ds_read_b128 v[20:23], v253 offset:4096
    ds_read_b128 v[24:27], v254 offset:4096
    ds_read_b128 v[28:31], v255 offset:4096
    v_dot2c_f32_bf16 v220, v10, v219
    v_dot2c_f32_bf16 v222, v10, v10
    v_dot2c_f32_bf16 v221, v11, v219
    v_dot2c_f32_bf16 v223, v11, v11
    v_dot2c_f32_bf16 v220, v12, v219
    v_dot2c_f32_bf16 v222, v12, v12
    v_dot2c_f32_bf16 v221, v13, v219
    v_dot2c_f32_bf16 v223, v13, v13
    v_dot2c_f32_bf16 v220, v14, v219
    v_dot2c_f32_bf16 v222, v14, v14
    v_dot2c_f32_bf16 v221, v15, v219
    v_dot2c_f32_bf16 v223, v15, v15
    s_waitcnt lgkmcnt(0)
    s_add_u32 m0, s36, 4096
    s_add_u32 s52, s52, 128
    s_cmp_eq_u32 s52, 1152
    s_cselect_b32 s52, 0, s52
    buffer_load_dwordx4 v244, s[8:11], s52 offen offset:0 lds
    v_dot2c_f32_bf16 v220, v16, v219
    v_dot2c_f32_bf16 v222, v16, v16
    v_dot2c_f32_bf16 v221, v17, v219
    v_dot2c_f32_bf16 v223, v17, v17
    v_dot2c_f32_bf16 v220, v18, v219
    buffer_load_dwordx4 v245, s[8:11], s52 offen offset:1024 lds
    v_dot2c_f32_bf16 v222, v18, v18
    v_dot2c_f32_bf16 v221, v19, v219
    v_dot2c_f32_bf16 v223, v19, v19
    v_dot2c_f32_bf16 v220, v20, v219
    v_dot2c_f32_bf16 v222, v20, v20
    buffer_load_dwordx4 v246, s[8:11], s52 offen offset:2048 lds
    v_dot2c_f32_bf16 v221, v21, v219
    v_dot2c_f32_bf16 v223, v21, v21
    v_dot2c_f32_bf16 v220, v22, v219
    v_dot2c_f32_bf16 v222, v22, v22
    v_dot2c_f32_bf16 v221, v23, v219
    buffer_load_dwordx4 v247, s[8:11], s52 offen offset:3072 lds
    v_dot2c_f32_bf16 v223, v23, v23
    v_dot2c_f32_bf16 v220, v24, v219
    v_dot2c_f32_bf16 v222, v24, v24
    v_dot2c_f32_bf16 v221, v25, v219
    v_dot2c_f32_bf16 v223, v25, v25
    s_waitcnt vmcnt(12)
    ds_read_b128 v[32:35], v252 offset:8192
    ds_read_b128 v[36:39], v253 offset:8192
    ds_read_b128 v[40:43], v254 offset:8192
    ds_read_b128 v[44:47], v255 offset:8192
    v_dot2c_f32_bf16 v220, v26, v219
    v_dot2c_f32_bf16 v222, v26, v26
    v_dot2c_f32_bf16 v221, v27, v219
    v_dot2c_f32_bf16 v223, v27, v27
    v_dot2c_f32_bf16 v220, v28, v219
    v_dot2c_f32_bf16 v222, v28, v28
    v_dot2c_f32_bf16 v221, v29, v219
    v_dot2c_f32_bf16 v223, v29, v29
    v_dot2c_f32_bf16 v220, v30, v219
    v_dot2c_f32_bf16 v222, v30, v30
    v_dot2c_f32_bf16 v221, v31, v219
    v_dot2c_f32_bf16 v223, v31, v31
    s_waitcnt lgkmcnt(0)
    s_add_u32 m0, s36, 8192
    s_add_u32 s52, s52, 128
    s_cmp_eq_u32 s52, 1152
    s_cselect_b32 s52, 0, s52
    buffer_load_dwordx4 v244, s[8:11], s52 offen offset:0 lds
    v_dot2c_f32_bf16 v220, v32, v219
    v_dot2c_f32_bf16 v222, v32, v32
    v_dot2c_f32_bf16 v221, v33, v219
    v_dot2c_f32_bf16 v223, v33, v33
    v_dot2c_f32_bf16 v220, v34, v219
    buffer_load_dwordx4 v245, s[8:11], s52 offen offset:1024 lds
    v_dot2c_f32_bf16 v222, v34, v34
    v_dot2c_f32_bf16 v221, v35, v219
    v_dot2c_f32_bf16 v223, v35, v35
    v_dot2c_f32_bf16 v220, v36, v219
    v_dot2c_f32_bf16 v222, v36, v36
    buffer_load_dwordx4 v246, s[8:11], s52 offen offset:2048 lds
    v_dot2c_f32_bf16 v221, v37, v219
    v_dot2c_f32_bf16 v223, v37, v37
    v_dot2c_f32_bf16 v220, v38, v219
    v_dot2c_f32_bf16 v222, v38, v38
    v_dot2c_f32_bf16 v221, v39, v219
    buffer_load_dwordx4 v247, s[8:11], s52 offen offset:3072 lds
    v_dot2c_f32_bf16 v223, v39, v39
    v_dot2c_f32_bf16 v220, v40, v219
    v_dot2c_f32_bf16 v222, v40, v40
    v_dot2c_f32_bf16 v221, v41, v219
    v_dot2c_f32_bf16 v223, v41, v41
    s_mov_b32 s54, 1
    s_mov_b64 exec, 0
    s_cmp_eq_u32 s3, 0
    s_cbranch_scc1 L_sm5
    s_cmp_eq_u32 s3, 1
    s_cbranch_scc1 L_sm6
    s_cmp_eq_u32 s3, 2
    s_cbranch_scc1 L_sm7
    s_branch L_sm8
L_hbm1:
    s_mov_b64 exec, -1
    s_waitcnt vmcnt(12)
    ds_read_b128 v[48:51], v252 offset:12288
    ds_read_b128 v[52:55], v253 offset:12288
    ds_read_b128 v[56:59], v254 offset:12288
    ds_read_b128 v[60:63], v255 offset:12288
    v_dot2c_f32_bf16 v220, v42, v219
    v_dot2c_f32_bf16 v222, v42, v42
    v_dot2c_f32_bf16 v221, v43, v219
    v_dot2c_f32_bf16 v223, v43, v43
    v_dot2c_f32_bf16 v220, v44, v219
    v_dot2c_f32_bf16 v222, v44, v44
    v_dot2c_f32_bf16 v221, v45, v219
    v_dot2c_f32_bf16 v223, v45, v45
    v_dot2c_f32_bf16 v220, v46, v219
    v_dot2c_f32_bf16 v222, v46, v46
    v_dot2c_f32_bf16 v221, v47, v219
    v_dot2c_f32_bf16 v223, v47, v47
    s_waitcnt lgkmcnt(0)
    s_add_u32 m0, s36, 12288
    s_add_u32 s52, s52, 128
    s_cmp_eq_u32 s52, 1152
    s_cselect_b32 s52, 0, s52
    buffer_load_dwordx4 v244, s[8:11], s52 offen offset:0 lds
    v_dot2c_f32_bf16 v220, v48, v219
    v_dot2c_f32_bf16 v222, v48, v48
    v_dot2c_f32_bf16 v221, v49, v219
    v_dot2c_f32_bf16 v223, v49, v49
    v_dot2c_f32_bf16 v220, v50, v219
    buffer_load_dwordx4 v245, s[8:11], s52 offen offset:1024 lds
    v_dot2c_f32_bf16 v222, v50, v50
    v_dot2c_f32_bf16 v221, v51, v219
    v_dot2c_f32_bf16 v223, v51, v51
    v_dot2c_f32_bf16 v220, v52, v219
    v_dot2c_f32_bf16 v222, v52, v52
    buffer_load_dwordx4 v246, s[8:11], s52 offen offset:2048 lds
    v_dot2c_f32_bf16 v221, v53, v219
    v_dot2c_f32_bf16 v223, v53, v53
    v_dot2c_f32_bf16 v220, v54, v219
    v_dot2c_f32_bf16 v222, v54, v54
    v_dot2c_f32_bf16 v221, v55, v219
    buffer_load_dwordx4 v247, s[8:11], s52 offen offset:3072 lds
    v_dot2c_f32_bf16 v223, v55, v55
    v_dot2c_f32_bf16 v220, v56, v219
    v_dot2c_f32_bf16 v222, v56, v56
    v_dot2c_f32_bf16 v221, v57, v219
    v_dot2c_f32_bf16 v223, v57, v57
    s_waitcnt vmcnt(12)
    ds_read_b128 v[64:67], v252 offset:0
    ds_read_b128 v[68:71], v253 offset:0
    ds_read_b128 v[72:75], v254 offset:0
    ds_read_b128 v[76:79], v255 offset:0
    v_dot2c_f32_bf16 v220, v58, v219
    v_dot2c_f32_bf16 v222, v58, v58
    v_dot2c_f32_bf16 v221, v59, v219
    v_dot2c_f32_bf16 v223, v59, v59
    v_dot2c_f32_bf16 v220, v60, v219
    v_dot2c_f32_bf16 v222, v60, v60
    v_dot2c_f32_bf16 v221, v61, v219
    v_dot2c_f32_bf16 v223, v61, v61
    v_dot2c_f32_bf16 v220, v62, v219
    v_dot2c_f32_bf16 v222, v62, v62
    v_dot2c_f32_bf16 v221, v63, v219
    v_dot2c_f32_bf16 v223, v63, v63
    s_waitcnt lgkmcnt(0)
    s_add_u32 m0, s36, 0
    s_add_u32 s52, s52, 128
    s_cmp_eq_u32 s52, 1152
    s_cselect_b32 s52, 0, s52
    buffer_load_dwordx4 v244, s[8:11], s52 offen offset:0 lds
    v_dot2c_f32_bf16 v220, v64, v219
    v_dot2c_f32_bf16 v222, v64, v64
    v_dot2c_f32_bf16 v221, v65, v219
    v_dot2c_f32_bf16 v223, v65, v65
    v_dot2c_f32_bf16 v220, v66, v219
    buffer_load_dwordx4 v245, s[8:11], s52 offen offset:1024 lds
    v_dot2c_f32_bf16 v222, v66, v66
    v_dot2c_f32_bf16 v221, v67, v219
    v_dot2c_f32_bf16 v223, v67, v67
    v_dot2c_f32_bf16 v220, v68, v219
    v_dot2c_f32_bf16 v222, v68, v68
    buffer_load_dwordx4 v246, s[8:11], s52 offen offset:2048 lds
    v_dot2c_f32_bf16 v221, v69, v219
    v_dot2c_f32_bf16 v223, v69, v69
    v_dot2c_f32_bf16 v220, v70, v219
    v_dot2c_f32_bf16 v222, v70, v70
    v_dot2c_f32_bf16 v221, v71, v219
    buffer_load_dwordx4 v247, s[8:11], s52 offen offset:3072 lds
    v_dot2c_f32_bf16 v223, v71, v71
    v_dot2c_f32_bf16 v220, v72, v219
    v_dot2c_f32_bf16 v222, v72, v72
    v_dot2c_f32_bf16 v221, v73, v219
    v_dot2c_f32_bf16 v223, v73, v73
    s_mov_b32 s54, 2
    s_mov_b64 exec, 0
    s_cmp_eq_u32 s3, 0
    s_cbranch_scc1 L_sm9
    s_cmp_eq_u32 s3, 1
    s_cbranch_scc1 L_sm10
    s_cmp_eq_u32 s3, 2
    s_cbranch_scc1 L_sm11
    s_branch L_sm12
L_hbm2:
    s_mov_b64 exec, -1
    s_waitcnt vmcnt(12)
    ds_read_b128 v[80:83], v252 offset:4096
    ds_read_b128 v[84:87], v253 offset:4096
    ds_read_b128 v[88:91], v254 offset:4096
    ds_read_b128 v[92:95], v255 offset:4096
    v_dot2c_f32_bf16 v220, v74, v219
    v_dot2c_f32_bf16 v222, v74, v74
    v_dot2c_f32_bf16 v221, v75, v219
    v_dot2c_f32_bf16 v223, v75, v75
    v_dot2c_f32_bf16 v220, v76, v219
    v_dot2c_f32_bf16 v222, v76, v76
    v_dot2c_f32_bf16 v221, v77, v219
    v_dot2c_f32_bf16 v223, v77, v77
    v_dot2c_f32_bf16 v220, v78, v219
    v_dot2c_f32_bf16 v222, v78, v78
    v_dot2c_f32_bf16 v221, v79, v219
    v_dot2c_f32_bf16 v223, v79, v79
    s_waitcnt lgkmcnt(0)
    s_add_u32 m0, s34, 0
    s_add_u32 s4, s56, s64
    v_add_u32 v227, s4, v234
    v_dot2c_f32_bf16 v220, v80, v219
    v_dot2c_f32_bf16 v222, v80, v80
    v_dot2c_f32_bf16 v221, v81, v219
    v_dot2c_f32_bf16 v223, v81, v81
    v_dot2c_f32_bf16 v220, v82, v219
    buffer_load_dwordx4 v227, s[12:15], s79 offen offset:0 lds
    v_dot2c_f32_bf16 v222, v82, v82
    v_dot2c_f32_bf16 v221, v83, v219
    v_dot2c_f32_bf16 v223, v83, v83
    v_dot2c_f32_bf16 v220, v84, v219
    v_dot2c_f32_bf16 v222, v84, v84
    buffer_load_dwordx4 v227, s[12:15], s80 offen offset:1024 lds
    v_dot2c_f32_bf16 v221, v85, v219
    v_dot2c_f32_bf16 v223, v85, v85
    v_dot2c_f32_bf16 v220, v86, v219
    v_dot2c_f32_bf16 v222, v86, v86
    v_dot2c_f32_bf16 v221, v87, v219
    buffer_load_dwordx4 v227, s[12:15], s81 offen offset:2048 lds
    v_dot2c_f32_bf16 v223, v87, v87
    v_dot2c_f32_bf16 v220, v88, v219
    v_dot2c_f32_bf16 v222, v88, v88
    v_dot2c_f32_bf16 v221, v89, v219
    v_dot2c_f32_bf16 v223, v89, v89
    s_waitcnt vmcnt(11)
    ds_read_b128 v[96:99], v252 offset:8192
    ds_read_b128 v[100:103], v253 offset:8192
    ds_read_b128 v[104:107], v254 offset:8192
    ds_read_b128 v[108:111], v255 offset:8192
    v_dot2c_f32_bf16 v220, v90, v219
    v_dot2c_f32_bf16 v222, v90, v90
    v_dot2c_f32_bf16 v221, v91, v219
    v_dot2c_f32_bf16 v223, v91, v91
    v_dot2c_f32_bf16 v220, v92, v219
    v_dot2c_f32_bf16 v222, v92, v92
    v_dot2c_f32_bf16 v221, v93, v219
    v_dot2c_f32_bf16 v223, v93, v93
    v_dot2c_f32_bf16 v220, v94, v219
    v_dot2c_f32_bf16 v222, v94, v94
    v_dot2c_f32_bf16 v221, v95, v219
    v_dot2c_f32_bf16 v223, v95, v95
    s_waitcnt lgkmcnt(0)
    buffer_load_dwordx4 v227, s[12:15], s82 offen offset:3072 lds
    s_add_u32 m0, s34, 4096
    v_dot2c_f32_bf16 v220, v96, v219
    v_dot2c_f32_bf16 v222, v96, v96
    v_dot2c_f32_bf16 v221, v97, v219
    v_dot2c_f32_bf16 v223, v97, v97
    v_dot2c_f32_bf16 v220, v98, v219
    buffer_load_dwordx4 v227, s[12:15], s83 offen offset:0 lds
    v_dot2c_f32_bf16 v222, v98, v98
    v_dot2c_f32_bf16 v221, v99, v219
    v_dot2c_f32_bf16 v223, v99, v99
    v_dot2c_f32_bf16 v220, v100, v219
    v_dot2c_f32_bf16 v222, v100, v100
    buffer_load_dwordx4 v227, s[12:15], s84 offen offset:1024 lds
    v_dot2c_f32_bf16 v221, v101, v219
    v_dot2c_f32_bf16 v223, v101, v101
    v_dot2c_f32_bf16 v220, v102, v219
    v_dot2c_f32_bf16 v222, v102, v102
    v_dot2c_f32_bf16 v221, v103, v219
    s_add_u32 m0, s34, 24576
    s_add_u32 s4, s57, s64
    v_add_u32 v227, s4, v234
    v_dot2c_f32_bf16 v223, v103, v103
    v_dot2c_f32_bf16 v220, v104, v219
    v_dot2c_f32_bf16 v222, v104, v104
    v_dot2c_f32_bf16 v221, v105, v219
    v_dot2c_f32_bf16 v223, v105, v105
    s_waitcnt vmcnt(10)
    ds_read_b128 v[112:115], v252 offset:12288
    ds_read_b128 v[116:119], v253 offset:12288
    ds_read_b128 v[120:123], v254 offset:12288
    ds_read_b128 v[124:127], v255 offset:12288
    v_dot2c_f32_bf16 v220, v106, v219
    v_dot2c_f32_bf16 v222, v106, v106
    v_dot2c_f32_bf16 v221, v107, v219
    v_dot2c_f32_bf16 v223, v107, v107
    v_dot2c_f32_bf16 v220, v108, v219
    v_dot2c_f32_bf16 v222, v108, v108
    v_dot2c_f32_bf16 v221, v109, v219
    v_dot2c_f32_bf16 v223, v109, v109
    v_dot2c_f32_bf16 v220, v110, v219
    v_dot2c_f32_bf16 v222, v110, v110
    v_dot2c_f32_bf16 v221, v111, v219
    v_dot2c_f32_bf16 v223, v111, v111
    s_waitcnt lgkmcnt(0)
    buffer_load_dwordx4 v227, s[12:15], s79 offen offset:0 lds
    v_dot2c_f32_bf16 v220, v112, v219
    v_dot2c_f32_bf16 v222, v112, v112
    v_dot2c_f32_bf16 v221, v113, v219
    v_dot2c_f32_bf16 v223, v113, v113
    v_dot2c_f32_bf16 v220, v114, v219
    buffer_load_dwordx4 v227, s[12:15], s80 offen offset:1024 lds
    v_dot2c_f32_bf16 v222, v114, v114
    v_dot2c_f32_bf16 v221, v115, v219
    v_dot2c_f32_bf16 v223, v115, v115
    v_dot2c_f32_bf16 v220, v116, v219
    v_dot2c_f32_bf16 v222, v116, v116
    buffer_load_dwordx4 v227, s[12:15], s81 offen offset:2048 lds
    v_dot2c_f32_bf16 v221, v117, v219
    v_dot2c_f32_bf16 v223, v117, v117
    v_dot2c_f32_bf16 v220, v118, v219
    v_dot2c_f32_bf16 v222, v118, v118
    v_dot2c_f32_bf16 v221, v119, v219
    buffer_load_dwordx4 v227, s[12:15], s82 offen offset:3072 lds
    s_add_u32 m0, s34, 28672
    v_dot2c_f32_bf16 v223, v119, v119
    v_dot2c_f32_bf16 v220, v120, v219
    v_dot2c_f32_bf16 v222, v120, v120
    v_dot2c_f32_bf16 v221, v121, v219
    v_dot2c_f32_bf16 v223, v121, v121
    s_waitcnt vmcnt(10)
    ds_read_b128 v[128:131], v252 offset:0
    ds_read_b128 v[132:135], v253 offset:0
    ds_read_b128 v[136:139], v254 offset:0
    ds_read_b128 v[140:143], v255 offset:0
    v_dot2c_f32_bf16 v220, v122, v219
    v_dot2c_f32_bf16 v222, v122, v122
    v_dot2c_f32_bf16 v221, v123, v219
    v_dot2c_f32_bf16 v223, v123, v123
    v_dot2c_f32_bf16 v220, v124, v219
    v_dot2c_f32_bf16 v222, v124, v124
    v_dot2c_f32_bf16 v221, v125, v219
    v_dot2c_f32_bf16 v223, v125, v125
    v_dot2c_f32_bf16 v220, v126, v219
    v_dot2c_f32_bf16 v222, v126, v126
    v_dot2c_f32_bf16 v221, v127, v219
    v_dot2c_f32_bf16 v223, v127, v127
    s_waitcnt lgkmcnt(0)
    v_dot2c_f32_bf16 v220, v128, v219
    v_dot2c_f32_bf16 v222, v128, v128
    v_dot2c_f32_bf16 v221, v129, v219
    v_dot2c_f32_bf16 v223, v129, v129
    v_dot2c_f32_bf16 v220, v130, v219
    v_dot2c_f32_bf16 v222, v130, v130
    v_dot2c_f32_bf16 v221, v131, v219
    v_dot2c_f32_bf16 v223, v131, v131
    v_dot2c_f32_bf16 v220, v132, v219
    v_dot2c_f32_bf16 v222, v132, v132
    v_dot2c_f32_bf16 v221, v133, v219
    v_dot2c_f32_bf16 v223, v133, v133
    v_dot2c_f32_bf16 v220, v134, v219
    v_dot2c_f32_bf16 v222, v134, v134
    v_dot2c_f32_bf16 v221, v135, v219
    v_dot2c_f32_bf16 v223, v135, v135
    v_dot2c_f32_bf16 v220, v136, v219
    v_dot2c_f32_bf16 v222, v136, v136
    v_dot2c_f32_bf16 v221, v137, v219
    v_dot2c_f32_bf16 v223, v137, v137
    v_dot2c_f32_bf16 v220, v138, v219
    v_dot2c_f32_bf16 v222, v138, v138
    v_dot2c_f32_bf16 v221, v139, v219
    v_dot2c_f32_bf16 v223, v139, v139
    v_dot2c_f32_bf16 v220, v140, v219
    v_dot2c_f32_bf16 v222, v140, v140
    v_dot2c_f32_bf16 v221, v141, v219
    v_dot2c_f32_bf16 v223, v141, v141
    v_dot2c_f32_bf16 v220, v142, v219
    v_dot2c_f32_bf16 v222, v142, v142
    v_dot2c_f32_bf16 v221, v143, v219
    v_dot2c_f32_bf16 v223, v143, v143
    v_lshlrev_b32 v250, 16, v226
    v_and_b32 v251, 0xffff0000, v226
    v_mul_f32 v250, 1069066811, v250
    v_mul_f32 v251, 1069066811, v251
    v_lshlrev_b32 v226, 3, v239
    v_add_u32 v226, 147456, v226
    ds_write_b64 v226, v[250:251]
    v_add_f32 v220, v220, v221
    v_add_f32 v222, v222, v223
    s_nop 1
    v_permlane32_swap_b32 v220, v222
    v_add_f32 v220, v220, v222
    v_mov_b32 v222, v220
    s_nop 1
    v_permlane32_swap_b32 v220, v222
    v_mul_f32 v220, 0x3ae38e39, v220
    v_mul_f32 v222, 0x3ae38e39, v222
    v_fma_f32 v222, -v220, v220, v222
    v_max_f32 v222, 0, v222
    v_add_f32 v222, 0x3727c5ac, v222
    v_rsq_f32 v222, v222
    s_nop 0
    v_mul_f32 v222, 1069066811, v222
    v_cvt_pk_bf16_f32 v222, v222, v222
    v_and_b32 v223, 0xffff0000, v222
    v_and_b32 v222, 0xffff, v222
    v_mul_f32 v220, v220, v223
    v_sub_f32 v220, 0, v220
    v_dot2_f32_bf16 v208, v0, v222, v220
    v_dot2_f32_bf16 v209, v0, v223, v220
    v_dot2_f32_bf16 v210, v1, v222, v220
    v_dot2_f32_bf16 v211, v1, v223, v220
    v_dot2_f32_bf16 v212, v2, v222, v220
    v_dot2_f32_bf16 v213, v2, v223, v220
    v_cvt_pk_bf16_f32 v0, v208, v209
    v_dot2_f32_bf16 v214, v3, v222, v220
    v_dot2_f32_bf16 v215, v3, v223, v220
    v_cvt_pk_bf16_f32 v1, v210, v211
    v_dot2_f32_bf16 v216, v4, v222, v220
    v_dot2_f32_bf16 v217, v4, v223, v220
    v_cvt_pk_bf16_f32 v2, v212, v213
    v_dot2_f32_bf16 v218, v5, v222, v220
    v_dot2_f32_bf16 v219, v5, v223, v220
    v_cvt_pk_bf16_f32 v3, v214, v215
    v_dot2_f32_bf16 v208, v6, v222, v220
    v_dot2_f32_bf16 v209, v6, v223, v220
    v_cvt_pk_bf16_f32 v4, v216, v217
    v_dot2_f32_bf16 v210, v7, v222, v220
    v_dot2_f32_bf16 v211, v7, v223, v220
    v_cvt_pk_bf16_f32 v5, v218, v219
    v_dot2_f32_bf16 v212, v8, v222, v220
    v_dot2_f32_bf16 v213, v8, v223, v220
    v_cvt_pk_bf16_f32 v6, v208, v209
    v_dot2_f32_bf16 v214, v9, v222, v220
    v_dot2_f32_bf16 v215, v9, v223, v220
    v_cvt_pk_bf16_f32 v7, v210, v211
    buffer_load_dwordx4 v227, s[12:15], s83 offen offset:0 lds
    v_dot2_f32_bf16 v216, v10, v222, v220
    v_dot2_f32_bf16 v217, v10, v223, v220
    v_cvt_pk_bf16_f32 v8, v212, v213
    v_dot2_f32_bf16 v218, v11, v222, v220
    v_dot2_f32_bf16 v219, v11, v223, v220
    v_cvt_pk_bf16_f32 v9, v214, v215
    v_dot2_f32_bf16 v208, v12, v222, v220
    v_dot2_f32_bf16 v209, v12, v223, v220
    v_cvt_pk_bf16_f32 v10, v216, v217
    v_dot2_f32_bf16 v210, v13, v222, v220
    v_dot2_f32_bf16 v211, v13, v223, v220
    v_cvt_pk_bf16_f32 v11, v218, v219
    v_dot2_f32_bf16 v212, v14, v222, v220
    v_dot2_f32_bf16 v213, v14, v223, v220
    v_cvt_pk_bf16_f32 v12, v208, v209
    v_dot2_f32_bf16 v214, v15, v222, v220
    v_dot2_f32_bf16 v215, v15, v223, v220
    v_cvt_pk_bf16_f32 v13, v210, v211
    v_dot2_f32_bf16 v216, v16, v222, v220
    v_dot2_f32_bf16 v217, v16, v223, v220
    v_cvt_pk_bf16_f32 v14, v212, v213
    v_dot2_f32_bf16 v218, v17, v222, v220
    v_dot2_f32_bf16 v219, v17, v223, v220
    v_cvt_pk_bf16_f32 v15, v214, v215
    v_dot2_f32_bf16 v208, v18, v222, v220
    v_dot2_f32_bf16 v209, v18, v223, v220
    v_cvt_pk_bf16_f32 v16, v216, v217
    v_dot2_f32_bf16 v210, v19, v222, v220
    v_dot2_f32_bf16 v211, v19, v223, v220
    v_cvt_pk_bf16_f32 v17, v218, v219
    buffer_load_dwordx4 v227, s[12:15], s84 offen offset:1024 lds
    v_dot2_f32_bf16 v212, v20, v222, v220
    v_dot2_f32_bf16 v213, v20, v223, v220
    v_cvt_pk_bf16_f32 v18, v208, v209
    v_dot2_f32_bf16 v214, v21, v222, v220
    v_dot2_f32_bf16 v215, v21, v223, v220
    v_cvt_pk_bf16_f32 v19, v210, v211
    v_dot2_f32_bf16 v216, v22, v222, v220
    v_dot2_f32_bf16 v217, v22, v223, v220
    v_cvt_pk_bf16_f32 v20, v212, v213
    v_dot2_f32_bf16 v218, v23, v222, v220
    v_dot2_f32_bf16 v219, v23, v223, v220
    v_cvt_pk_bf16_f32 v21, v214, v215
    v_dot2_f32_bf16 v208, v24, v222, v220
    v_dot2_f32_bf16 v209, v24, v223, v220
    v_cvt_pk_bf16_f32 v22, v216, v217
    v_dot2_f32_bf16 v210, v25, v222, v220
    v_dot2_f32_bf16 v211, v25, v223, v220
    v_cvt_pk_bf16_f32 v23, v218, v219
    v_dot2_f32_bf16 v212, v26, v222, v220
    v_dot2_f32_bf16 v213, v26, v223, v220
    v_cvt_pk_bf16_f32 v24, v208, v209
    v_dot2_f32_bf16 v214, v27, v222, v220
    v_dot2_f32_bf16 v215, v27, v223, v220
    v_cvt_pk_bf16_f32 v25, v210, v211
    v_dot2_f32_bf16 v216, v28, v222, v220
    v_dot2_f32_bf16 v217, v28, v223, v220
    v_cvt_pk_bf16_f32 v26, v212, v213
    v_dot2_f32_bf16 v218, v29, v222, v220
    v_dot2_f32_bf16 v219, v29, v223, v220
    v_cvt_pk_bf16_f32 v27, v214, v215
    s_add_u32 m0, s34, 49152
    s_add_u32 s4, s58, s64
    v_add_u32 v227, s4, v234
    v_dot2_f32_bf16 v208, v30, v222, v220
    v_dot2_f32_bf16 v209, v30, v223, v220
    v_cvt_pk_bf16_f32 v28, v216, v217
    v_dot2_f32_bf16 v210, v31, v222, v220
    v_dot2_f32_bf16 v211, v31, v223, v220
    v_cvt_pk_bf16_f32 v29, v218, v219
    v_dot2_f32_bf16 v212, v32, v222, v220
    v_dot2_f32_bf16 v213, v32, v223, v220
    v_cvt_pk_bf16_f32 v30, v208, v209
    v_dot2_f32_bf16 v214, v33, v222, v220
    v_dot2_f32_bf16 v215, v33, v223, v220
    v_cvt_pk_bf16_f32 v31, v210, v211
    v_dot2_f32_bf16 v216, v34, v222, v220
    v_dot2_f32_bf16 v217, v34, v223, v220
    v_cvt_pk_bf16_f32 v32, v212, v213
    v_dot2_f32_bf16 v218, v35, v222, v220
    v_dot2_f32_bf16 v219, v35, v223, v220
    v_cvt_pk_bf16_f32 v33, v214, v215
    v_dot2_f32_bf16 v208, v36, v222, v220
    v_dot2_f32_bf16 v209, v36, v223, v220
    v_cvt_pk_bf16_f32 v34, v216, v217
    v_dot2_f32_bf16 v210, v37, v222, v220
    v_dot2_f32_bf16 v211, v37, v223, v220
    v_cvt_pk_bf16_f32 v35, v218, v219
    v_dot2_f32_bf16 v212, v38, v222, v220
    v_dot2_f32_bf16 v213, v38, v223, v220
    v_cvt_pk_bf16_f32 v36, v208, v209
    v_dot2_f32_bf16 v214, v39, v222, v220
    v_dot2_f32_bf16 v215, v39, v223, v220
    v_cvt_pk_bf16_f32 v37, v210, v211
    buffer_load_dwordx4 v227, s[12:15], s79 offen offset:0 lds
    v_dot2_f32_bf16 v216, v40, v222, v220
    v_dot2_f32_bf16 v217, v40, v223, v220
    v_cvt_pk_bf16_f32 v38, v212, v213
    v_dot2_f32_bf16 v218, v41, v222, v220
    v_dot2_f32_bf16 v219, v41, v223, v220
    v_cvt_pk_bf16_f32 v39, v214, v215
    v_dot2_f32_bf16 v208, v42, v222, v220
    v_dot2_f32_bf16 v209, v42, v223, v220
    v_cvt_pk_bf16_f32 v40, v216, v217
    v_dot2_f32_bf16 v210, v43, v222, v220
    v_dot2_f32_bf16 v211, v43, v223, v220
L_sm1:
    s_cbranch_execz L_retm
    v_cvt_pk_bf16_f32 v41, v218, v219
    v_dot2_f32_bf16 v212, v44, v222, v220
    v_dot2_f32_bf16 v213, v44, v223, v220
    v_cvt_pk_bf16_f32 v42, v208, v209
    v_dot2_f32_bf16 v214, v45, v222, v220
    v_dot2_f32_bf16 v215, v45, v223, v220
    v_cvt_pk_bf16_f32 v43, v210, v211
    v_dot2_f32_bf16 v216, v46, v222, v220
    v_dot2_f32_bf16 v217, v46, v223, v220
    v_cvt_pk_bf16_f32 v44, v212, v213
    v_dot2_f32_bf16 v218, v47, v222, v220
    v_dot2_f32_bf16 v219, v47, v223, v220
    v_cvt_pk_bf16_f32 v45, v214, v215
    v_dot2_f32_bf16 v208, v48, v222, v220
    v_dot2_f32_bf16 v209, v48, v223, v220
    v_cvt_pk_bf16_f32 v46, v216, v217
    v_dot2_f32_bf16 v210, v49, v222, v220
    v_dot2_f32_bf16 v211, v49, v223, v220
    v_cvt_pk_bf16_f32 v47, v218, v219
    buffer_load_dwordx4 v227, s[12:15], s80 offen offset:1024 lds
    v_dot2_f32_bf16 v212, v50, v222, v220
    v_dot2_f32_bf16 v213, v50, v223, v220
    v_cvt_pk_bf16_f32 v48, v208, v209
    v_dot2_f32_bf16 v214, v51, v222, v220
    v_dot2_f32_bf16 v215, v51, v223, v220
    v_cvt_pk_bf16_f32 v49, v210, v211
    v_dot2_f32_bf16 v216, v52, v222, v220
    v_dot2_f32_bf16 v217, v52, v223, v220
    v_cvt_pk_bf16_f32 v50, v212, v213
    v_dot2_f32_bf16 v218, v53, v222, v220
    v_dot2_f32_bf16 v219, v53, v223, v220
    v_cvt_pk_bf16_f32 v51, v214, v215
    v_dot2_f32_bf16 v208, v54, v222, v220
    v_dot2_f32_bf16 v209, v54, v223, v220
    v_cvt_pk_bf16_f32 v52, v216, v217
    v_dot2_f32_bf16 v210, v55, v222, v220
    v_dot2_f32_bf16 v211, v55, v223, v220
    v_cvt_pk_bf16_f32 v53, v218, v219
    v_dot2_f32_bf16 v212, v56, v222, v220
    v_dot2_f32_bf16 v213, v56, v223, v220
    v_cvt_pk_bf16_f32 v54, v208, v209
    v_dot2_f32_bf16 v214, v57, v222, v220
    v_dot2_f32_bf16 v215, v57, v223, v220
    v_cvt_pk_bf16_f32 v55, v210, v211
    v_dot2_f32_bf16 v216, v58, v222, v220
    v_dot2_f32_bf16 v217, v58, v223, v220
    v_cvt_pk_bf16_f32 v56, v212, v213
    v_dot2_f32_bf16 v218, v59, v222, v220
    v_dot2_f32_bf16 v219, v59, v223, v220
    v_cvt_pk_bf16_f32 v57, v214, v215
    buffer_load_dwordx4 v227, s[12:15], s81 offen offset:2048 lds
    v_dot2_f32_bf16 v208, v60, v222, v220
    v_dot2_f32_bf16 v209, v60, v223, v220
    v_cvt_pk_bf16_f32 v58, v216, v217
    v_dot2_f32_bf16 v210, v61, v222, v220
    v_dot2_f32_bf16 v211, v61, v223, v220
    v_cvt_pk_bf16_f32 v59, v218, v219
    v_dot2_f32_bf16 v212, v62, v222, v220
    v_dot2_f32_bf16 v213, v62, v223, v220
    v_cvt_pk_bf16_f32 v60, v208, v209
    v_dot2_f32_bf16 v214, v63, v222, v220
    v_dot2_f32_bf16 v215, v63, v223, v220
    v_cvt_pk_bf16_f32 v61, v210, v211
    v_dot2_f32_bf16 v216, v64, v222, v220
    v_dot2_f32_bf16 v217, v64, v223, v220
    v_cvt_pk_bf16_f32 v62, v212, v213
    v_dot2_f32_bf16 v218, v65, v222, v220
    v_dot2_f32_bf16 v219, v65, v223, v220
    v_cvt_pk_bf16_f32 v63, v214, v215
    v_dot2_f32_bf16 v208, v66, v222, v220
    v_dot2_f32_bf16 v209, v66, v223, v220
    v_cvt_pk_bf16_f32 v64, v216, v217
    v_dot2_f32_bf16 v210, v67, v222, v220
    v_dot2_f32_bf16 v211, v67, v223, v220
    v_cvt_pk_bf16_f32 v65, v218, v219
    v_dot2_f32_bf16 v212, v68, v222, v220
    v_dot2_f32_bf16 v213, v68, v223, v220
    v_cvt_pk_bf16_f32 v66, v208, v209
    v_dot2_f32_bf16 v214, v69, v222, v220
    v_dot2_f32_bf16 v215, v69, v223, v220
    v_cvt_pk_bf16_f32 v67, v210, v211
    buffer_load_dwordx4 v227, s[12:15], s82 offen offset:3072 lds
    s_add_u32 m0, s34, 53248
    v_dot2_f32_bf16 v216, v70, v222, v220
    v_dot2_f32_bf16 v217, v70, v223, v220
    v_cvt_pk_bf16_f32 v68, v212, v213
    v_dot2_f32_bf16 v218, v71, v222, v220
    v_dot2_f32_bf16 v219, v71, v223, v220
    v_cvt_pk_bf16_f32 v69, v214, v215
    v_dot2_f32_bf16 v208, v72, v222, v220
    v_dot2_f32_bf16 v209, v72, v223, v220
    v_cvt_pk_bf16_f32 v70, v216, v217
    v_dot2_f32_bf16 v210, v73, v222, v220
    v_dot2_f32_bf16 v211, v73, v223, v220
    v_cvt_pk_bf16_f32 v71, v218, v219
    v_dot2_f32_bf16 v212, v74, v222, v220
    v_dot2_f32_bf16 v213, v74, v223, v220
    v_cvt_pk_bf16_f32 v72, v208, v209
    v_dot2_f32_bf16 v214, v75, v222, v220
    v_dot2_f32_bf16 v215, v75, v223, v220
    v_cvt_pk_bf16_f32 v73, v210, v211
    v_dot2_f32_bf16 v216, v76, v222, v220
    v_dot2_f32_bf16 v217, v76, v223, v220
    v_cvt_pk_bf16_f32 v74, v212, v213
    v_dot2_f32_bf16 v218, v77, v222, v220
    v_dot2_f32_bf16 v219, v77, v223, v220
    v_cvt_pk_bf16_f32 v75, v214, v215
    v_dot2_f32_bf16 v208, v78, v222, v220
    v_dot2_f32_bf16 v209, v78, v223, v220
    v_cvt_pk_bf16_f32 v76, v216, v217
    v_dot2_f32_bf16 v210, v79, v222, v220
    v_dot2_f32_bf16 v211, v79, v223, v220
    v_cvt_pk_bf16_f32 v77, v218, v219
    buffer_load_dwordx4 v227, s[12:15], s83 offen offset:0 lds
    v_dot2_f32_bf16 v212, v80, v222, v220
    v_dot2_f32_bf16 v213, v80, v223, v220
    v_cvt_pk_bf16_f32 v78, v208, v209
    v_dot2_f32_bf16 v214, v81, v222, v220
    v_dot2_f32_bf16 v215, v81, v223, v220
    v_cvt_pk_bf16_f32 v79, v210, v211
    v_dot2_f32_bf16 v216, v82, v222, v220
    v_dot2_f32_bf16 v217, v82, v223, v220
    v_cvt_pk_bf16_f32 v80, v212, v213
    v_dot2_f32_bf16 v218, v83, v222, v220
    v_dot2_f32_bf16 v219, v83, v223, v220
    v_cvt_pk_bf16_f32 v81, v214, v215
    v_dot2_f32_bf16 v208, v84, v222, v220
    v_dot2_f32_bf16 v209, v84, v223, v220
    v_cvt_pk_bf16_f32 v82, v216, v217
    v_dot2_f32_bf16 v210, v85, v222, v220
    v_dot2_f32_bf16 v211, v85, v223, v220
    v_cvt_pk_bf16_f32 v83, v218, v219
    v_dot2_f32_bf16 v212, v86, v222, v220
    v_dot2_f32_bf16 v213, v86, v223, v220
    v_cvt_pk_bf16_f32 v84, v208, v209
    v_dot2_f32_bf16 v214, v87, v222, v220
    v_dot2_f32_bf16 v215, v87, v223, v220
    v_cvt_pk_bf16_f32 v85, v210, v211
    v_dot2_f32_bf16 v216, v88, v222, v220
    v_dot2_f32_bf16 v217, v88, v223, v220
    v_cvt_pk_bf16_f32 v86, v212, v213
    v_dot2_f32_bf16 v218, v89, v222, v220
    v_dot2_f32_bf16 v219, v89, v223, v220
    v_cvt_pk_bf16_f32 v87, v214, v215
    buffer_load_dwordx4 v227, s[12:15], s84 offen offset:1024 lds
    v_dot2_f32_bf16 v208, v90, v222, v220
    v_dot2_f32_bf16 v209, v90, v223, v220
    v_cvt_pk_bf16_f32 v88, v216, v217
    v_dot2_f32_bf16 v210, v91, v222, v220
    v_dot2_f32_bf16 v211, v91, v223, v220
    v_cvt_pk_bf16_f32 v89, v218, v219
    v_dot2_f32_bf16 v212, v92, v222, v220
    v_dot2_f32_bf16 v213, v92, v223, v220
    v_cvt_pk_bf16_f32 v90, v208, v209
    v_dot2_f32_bf16 v214, v93, v222, v220
    v_dot2_f32_bf16 v215, v93, v223, v220
    v_cvt_pk_bf16_f32 v91, v210, v211
    v_dot2_f32_bf16 v216, v94, v222, v220
    v_dot2_f32_bf16 v217, v94, v223, v220
    v_cvt_pk_bf16_f32 v92, v212, v213
    v_dot2_f32_bf16 v218, v95, v222, v220
    v_dot2_f32_bf16 v219, v95, v223, v220
    v_cvt_pk_bf16_f32 v93, v214, v215
    v_dot2_f32_bf16 v208, v96, v222, v220
    v_dot2_f32_bf16 v209, v96, v223, v220
    v_cvt_pk_bf16_f32 v94, v216, v217
    v_dot2_f32_bf16 v210, v97, v222, v220
    v_dot2_f32_bf16 v211, v97, v223, v220
    v_cvt_pk_bf16_f32 v95, v218, v219
    v_dot2_f32_bf16 v212, v98, v222, v220
    v_dot2_f32_bf16 v213, v98, v223, v220
    v_cvt_pk_bf16_f32 v96, v208, v209
    v_dot2_f32_bf16 v214, v99, v222, v220
    v_dot2_f32_bf16 v215, v99, v223, v220
    v_cvt_pk_bf16_f32 v97, v210, v211
    v_dot2_f32_bf16 v216, v100, v222, v220
    v_dot2_f32_bf16 v217, v100, v223, v220
    v_cvt_pk_bf16_f32 v98, v212, v213
    v_dot2_f32_bf16 v218, v101, v222, v220
    v_dot2_f32_bf16 v219, v101, v223, v220
    v_cvt_pk_bf16_f32 v99, v214, v215
    v_dot2_f32_bf16 v208, v102, v222, v220
    v_dot2_f32_bf16 v209, v102, v223, v220
    v_cvt_pk_bf16_f32 v100, v216, v217
    v_dot2_f32_bf16 v210, v103, v222, v220
    v_dot2_f32_bf16 v211, v103, v223, v220
    v_cvt_pk_bf16_f32 v101, v218, v219
    v_dot2_f32_bf16 v212, v104, v222, v220
    v_dot2_f32_bf16 v213, v104, v223, v220
    v_cvt_pk_bf16_f32 v102, v208, v209
    v_dot2_f32_bf16 v214, v105, v222, v220
    v_dot2_f32_bf16 v215, v105, v223, v220
    v_cvt_pk_bf16_f32 v103, v210, v211
    v_dot2_f32_bf16 v216, v106, v222, v220
    v_dot2_f32_bf16 v217, v106, v223, v220
    v_cvt_pk_bf16_f32 v104, v212, v213
    v_dot2_f32_bf16 v218, v107, v222, v220
    v_dot2_f32_bf16 v219, v107, v223, v220
    v_cvt_pk_bf16_f32 v105, v214, v215
    v_dot2_f32_bf16 v208, v108, v222, v220
    v_dot2_f32_bf16 v209, v108, v223, v220
    v_cvt_pk_bf16_f32 v106, v216, v217
    v_dot2_f32_bf16 v210, v109, v222, v220
    v_dot2_f32_bf16 v211, v109, v223, v220
    v_cvt_pk_bf16_f32 v107, v218, v219
    v_dot2_f32_bf16 v212, v110, v222, v220
    v_dot2_f32_bf16 v213, v110, v223, v220
    v_cvt_pk_bf16_f32 v108, v208, v209
    v_dot2_f32_bf16 v214, v111, v222, v220
    v_dot2_f32_bf16 v215, v111, v223, v220
    v_cvt_pk_bf16_f32 v109, v210, v211
    v_dot2_f32_bf16 v216, v112, v222, v220
    v_dot2_f32_bf16 v217, v112, v223, v220
    v_cvt_pk_bf16_f32 v110, v212, v213
    v_dot2_f32_bf16 v218, v113, v222, v220
    v_dot2_f32_bf16 v219, v113, v223, v220
    v_cvt_pk_bf16_f32 v111, v214, v215
    v_dot2_f32_bf16 v208, v114, v222, v220
    v_dot2_f32_bf16 v209, v114, v223, v220
    v_cvt_pk_bf16_f32 v112, v216, v217
    v_dot2_f32_bf16 v210, v115, v222, v220
    v_dot2_f32_bf16 v211, v115, v223, v220
    v_cvt_pk_bf16_f32 v113, v218, v219
    v_dot2_f32_bf16 v212, v116, v222, v220
    v_dot2_f32_bf16 v213, v116, v223, v220
    v_cvt_pk_bf16_f32 v114, v208, v209
    v_dot2_f32_bf16 v214, v117, v222, v220
    v_dot2_f32_bf16 v215, v117, v223, v220
    v_cvt_pk_bf16_f32 v115, v210, v211
    v_dot2_f32_bf16 v216, v118, v222, v220
    v_dot2_f32_bf16 v217, v118, v223, v220
    v_cvt_pk_bf16_f32 v116, v212, v213
    v_dot2_f32_bf16 v218, v119, v222, v220
    v_dot2_f32_bf16 v219, v119, v223, v220
    v_cvt_pk_bf16_f32 v117, v214, v215
    v_dot2_f32_bf16 v208, v120, v222, v220
    v_dot2_f32_bf16 v209, v120, v223, v220
    v_cvt_pk_bf16_f32 v118, v216, v217
    v_dot2_f32_bf16 v210, v121, v222, v220
    v_dot2_f32_bf16 v211, v121, v223, v220
    v_cvt_pk_bf16_f32 v119, v218, v219
    v_dot2_f32_bf16 v212, v122, v222, v220
    v_dot2_f32_bf16 v213, v122, v223, v220
    v_cvt_pk_bf16_f32 v120, v208, v209
    v_dot2_f32_bf16 v214, v123, v222, v220
    v_dot2_f32_bf16 v215, v123, v223, v220
    v_cvt_pk_bf16_f32 v121, v210, v211
    v_dot2_f32_bf16 v216, v124, v222, v220
    v_dot2_f32_bf16 v217, v124, v223, v220
    v_cvt_pk_bf16_f32 v122, v212, v213
    v_dot2_f32_bf16 v218, v125, v222, v220
    v_dot2_f32_bf16 v219, v125, v223, v220
    v_cvt_pk_bf16_f32 v123, v214, v215
    v_dot2_f32_bf16 v208, v126, v222, v220
    v_dot2_f32_bf16 v209, v126, v223, v220
    v_cvt_pk_bf16_f32 v124, v216, v217
    v_dot2_f32_bf16 v210, v127, v222, v220
    v_dot2_f32_bf16 v211, v127, v223, v220
    v_cvt_pk_bf16_f32 v125, v218, v219
    v_dot2_f32_bf16 v212, v128, v222, v220
    v_dot2_f32_bf16 v213, v128, v223, v220
    v_cvt_pk_bf16_f32 v126, v208, v209
    v_dot2_f32_bf16 v214, v129, v222, v220
    v_dot2_f32_bf16 v215, v129, v223, v220
    v_cvt_pk_bf16_f32 v127, v210, v211
    v_dot2_f32_bf16 v216, v130, v222, v220
    v_dot2_f32_bf16 v217, v130, v223, v220
    v_cvt_pk_bf16_f32 v128, v212, v213
    v_dot2_f32_bf16 v218, v131, v222, v220
    v_dot2_f32_bf16 v219, v131, v223, v220
    v_cvt_pk_bf16_f32 v129, v214, v215
    v_dot2_f32_bf16 v208, v132, v222, v220
    v_dot2_f32_bf16 v209, v132, v223, v220
    v_cvt_pk_bf16_f32 v130, v216, v217
    v_dot2_f32_bf16 v210, v133, v222, v220
    v_dot2_f32_bf16 v211, v133, v223, v220
    v_cvt_pk_bf16_f32 v131, v218, v219
    v_dot2_f32_bf16 v212, v134, v222, v220
    v_dot2_f32_bf16 v213, v134, v223, v220
    v_cvt_pk_bf16_f32 v132, v208, v209
    v_dot2_f32_bf16 v214, v135, v222, v220
    v_dot2_f32_bf16 v215, v135, v223, v220
    v_cvt_pk_bf16_f32 v133, v210, v211
    v_dot2_f32_bf16 v216, v136, v222, v220
    v_dot2_f32_bf16 v217, v136, v223, v220
    v_cvt_pk_bf16_f32 v134, v212, v213
    v_dot2_f32_bf16 v218, v137, v222, v220
    v_dot2_f32_bf16 v219, v137, v223, v220
    v_cvt_pk_bf16_f32 v135, v214, v215
    v_dot2_f32_bf16 v208, v138, v222, v220
    v_dot2_f32_bf16 v209, v138, v223, v220
    v_cvt_pk_bf16_f32 v136, v216, v217
    v_dot2_f32_bf16 v210, v139, v222, v220
    v_dot2_f32_bf16 v211, v139, v223, v220
    v_cvt_pk_bf16_f32 v137, v218, v219
    v_dot2_f32_bf16 v212, v140, v222, v220
    v_dot2_f32_bf16 v213, v140, v223, v220
    v_cvt_pk_bf16_f32 v138, v208, v209
    v_dot2_f32_bf16 v214, v141, v222, v220
    v_dot2_f32_bf16 v215, v141, v223, v220
    v_cvt_pk_bf16_f32 v139, v210, v211
    v_dot2_f32_bf16 v216, v142, v222, v220
    v_dot2_f32_bf16 v217, v142, v223, v220
    v_cvt_pk_bf16_f32 v140, v212, v213
    v_dot2_f32_bf16 v218, v143, v222, v220
    v_dot2_f32_bf16 v219, v143, v223, v220
    v_cvt_pk_bf16_f32 v141, v214, v215
    v_cvt_pk_bf16_f32 v142, v216, v217
    s_nop 0
    v_cvt_pk_bf16_f32 v143, v218, v219
    s_waitcnt lgkmcnt(0)
    s_waitcnt vmcnt(12)
    s_barrier
    ds_read_b128 v[144:147], v236 offset:0
    ds_read_b128 v[148:151], v236 offset:16
    ds_read_b128 v[152:155], v236 offset:32
    ds_read_b128 v[156:159], v236 offset:48
    ds_read_b64_tr_b16 a[96:97], v228 offset:0
    ds_read_b64_tr_b16 a[98:99], v228 offset:1024
    ds_read_b64_tr_b16 a[100:101], v228 offset:2048
    ds_read_b64_tr_b16 a[102:103], v228 offset:3072
    ds_read_b64_tr_b16 a[104:105], v228 offset:4096
    ds_read_b64_tr_b16 a[106:107], v228 offset:5120
    ds_read_b64_tr_b16 a[108:109], v228 offset:6144
    ds_read_b64_tr_b16 a[110:111], v228 offset:7168
    ds_read_b64_tr_b16 a[112:113], v228 offset:8192
    ds_read_b64_tr_b16 a[114:115], v228 offset:9216
    ds_read_b64_tr_b16 a[116:117], v228 offset:10240
    ds_read_b64_tr_b16 a[118:119], v228 offset:11264
    ds_read_b64_tr_b16 a[120:121], v228 offset:12288
    ds_read_b64_tr_b16 a[122:123], v228 offset:13312
    ds_read_b64_tr_b16 a[124:125], v228 offset:14336
    ds_read_b64_tr_b16 a[126:127], v228 offset:15360
    ds_read_b64_tr_b16 a[128:129], v228 offset:16384
    ds_read_b64_tr_b16 a[130:131], v228 offset:17408
    ds_read_b64_tr_b16 a[132:133], v228 offset:18432
    ds_read_b64_tr_b16 a[134:135], v228 offset:19456
    s_waitcnt lgkmcnt(15)
    s_waitcnt lgkmcnt(12)
    v_mfma_f32_32x32x16_bf16 v[144:159], a[96:99], v[0:3], v[144:159]
    ds_read_b64_tr_b16 a[136:137], v228 offset:20480
    ds_read_b64_tr_b16 a[138:139], v228 offset:21504
    ds_read_b128 v[160:163], v236 offset:64
    v_mfma_f32_32x32x16_bf16 v[144:159], a[100:103], v[4:7], v[144:159]
    ds_read_b64_tr_b16 a[140:141], v228 offset:22528
    ds_read_b64_tr_b16 a[142:143], v228 offset:23552
    ds_read_b128 v[164:167], v236 offset:80
    v_mfma_f32_32x32x16_bf16 v[144:159], a[104:107], v[8:11], v[144:159]
    ds_read_b64_tr_b16 a[96:97], v229 offset:0
    ds_read_b64_tr_b16 a[98:99], v229 offset:1024
    ds_read_b128 v[168:171], v236 offset:96
    s_mul_i32 s40, s64, 576
    s_add_u32 s41, s40, 3584
    s_mul_i32 s42, s65, 576
    v_mfma_f32_32x32x16_bf16 v[144:159], a[108:111], v[12:15], v[144:159]
    ds_read_b64_tr_b16 a[100:101], v229 offset:2048
    ds_read_b64_tr_b16 a[102:103], v229 offset:3072
    ds_read_b128 v[172:175], v236 offset:112
    s_add_u32 s43, s42, 3584
    s_mul_i32 s44, s66, 576
    s_waitcnt lgkmcnt(15)
    v_mfma_f32_32x32x16_bf16 v[144:159], a[112:115], v[16:19], v[144:159]
    ds_read_b64_tr_b16 a[104:105], v229 offset:4096
    ds_read_b64_tr_b16 a[106:107], v229 offset:5120
    ds_read_b128 v[176:179], v236 offset:256
    s_add_u32 s45, s44, 3584
    s_mul_i32 s46, s67, 576
    s_add_u32 s47, s46, 3584
    v_mfma_f32_32x32x16_bf16 v[144:159], a[116:119], v[20:23], v[144:159]
    ds_read_b64_tr_b16 a[108:109], v229 offset:6144
    ds_read_b64_tr_b16 a[110:111], v229 offset:7168
    ds_read_b128 v[180:183], v236 offset:272
    s_mul_i32 s48, s68, 576
    s_add_u32 s49, s48, 3584
    s_mul_i32 s50, s69, 576
    v_mfma_f32_32x32x16_bf16 v[144:159], a[120:123], v[24:27], v[144:159]
    ds_read_b64_tr_b16 a[112:113], v229 offset:8192
    ds_read_b64_tr_b16 a[114:115], v229 offset:9216
    ds_read_b128 v[184:187], v236 offset:288
    s_add_u32 s51, s50, 3584
    s_mul_i32 s36, s55, 3
    s_add_u32 s36, s36, s6
    v_mfma_f32_32x32x16_bf16 v[144:159], a[124:127], v[28:31], v[144:159]
    ds_read_b64_tr_b16 a[116:117], v229 offset:10240
    ds_read_b64_tr_b16 a[118:119], v229 offset:11264
    ds_read_b128 v[188:191], v236 offset:304
    s_sub_u32 s39, s36, 9
    s_cmp_lt_u32 s36, 9
    s_cselect_b32 s36, s36, s39
    s_waitcnt lgkmcnt(15)
    v_mfma_f32_32x32x16_bf16 v[144:159], a[128:131], v[32:35], v[144:159]
    ds_read_b64_tr_b16 a[120:121], v229 offset:12288
    ds_read_b64_tr_b16 a[122:123], v229 offset:13312
    ds_read_b128 v[192:195], v236 offset:320
    s_lshl_b32 s36, s36, 7
    s_mov_b32 s70, s36
    s_add_u32 s71, s70, 128
    v_mfma_f32_32x32x16_bf16 v[144:159], a[132:135], v[36:39], v[144:159]
    ds_read_b64_tr_b16 a[124:125], v229 offset:14336
    ds_read_b64_tr_b16 a[126:127], v229 offset:15360
    ds_read_b128 v[196:199], v236 offset:336
    s_cmp_eq_u32 s71, 1152
    s_cselect_b32 s71, 0, s71
    s_add_u32 s72, s71, 128
    v_mfma_f32_32x32x16_bf16 v[144:159], a[136:139], v[40:43], v[144:159]
    ds_read_b64_tr_b16 a[128:129], v229 offset:16384
    ds_read_b64_tr_b16 a[130:131], v229 offset:17408
    ds_read_b128 v[200:203], v236 offset:352
    s_cmp_eq_u32 s72, 1152
    s_cselect_b32 s72, 0, s72
    s_add_u32 s73, s72, 128
    v_mfma_f32_32x32x16_bf16 v[144:159], a[140:143], v[44:47], v[144:159]
    ds_read_b64_tr_b16 a[132:133], v229 offset:18432
    ds_read_b64_tr_b16 a[134:135], v229 offset:19456
    ds_read_b128 v[204:207], v236 offset:368
    s_cmp_eq_u32 s73, 1152
    s_cselect_b32 s73, 0, s73
    s_waitcnt lgkmcnt(15)
    v_mfma_f32_32x32x16_bf16 v[160:175], a[96:99], v[0:3], v[160:175]
    ds_read_b64_tr_b16 a[136:137], v229 offset:20480
    ds_read_b64_tr_b16 a[138:139], v229 offset:21504
    s_add_u32 m0, s34, 73728
    s_add_u32 s4, s56, s65
    v_add_u32 v227, s4, v234
    s_add_u32 s74, s73, 128
    v_mfma_f32_32x32x16_bf16 v[160:175], a[100:103], v[4:7], v[160:175]
    ds_read_b64_tr_b16 a[140:141], v229 offset:22528
    ds_read_b64_tr_b16 a[142:143], v229 offset:23552
    buffer_load_dwordx4 v227, s[12:15], s79 offen offset:0 lds
    s_cmp_eq_u32 s74, 1152
    s_cselect_b32 s74, 0, s74
    s_add_u32 s75, s74, 128
    s_waitcnt vmcnt(7)
    s_barrier
    v_mfma_f32_32x32x16_bf16 v[160:175], a[104:107], v[8:11], v[160:175]
    ds_read_b64_tr_b16 a[96:97], v228 offset:24576
    ds_read_b64_tr_b16 a[98:99], v228 offset:25600
    buffer_load_dwordx4 v227, s[12:15], s80 offen offset:1024 lds
    s_cmp_eq_u32 s75, 1152
    s_cselect_b32 s75, 0, s75
    s_add_u32 s76, s75, 128
    v_mfma_f32_32x32x16_bf16 v[160:175], a[108:111], v[12:15], v[160:175]
    ds_read_b64_tr_b16 a[100:101], v228 offset:26624
    ds_read_b64_tr_b16 a[102:103], v228 offset:27648
    buffer_load_dwordx4 v227, s[12:15], s81 offen offset:2048 lds
    s_cmp_eq_u32 s76, 1152
    s_cselect_b32 s76, 0, s76
    s_waitcnt lgkmcnt(15)
    v_mfma_f32_32x32x16_bf16 v[160:175], a[112:115], v[16:19], v[160:175]
    ds_read_b64_tr_b16 a[104:105], v228 offset:28672
    ds_read_b64_tr_b16 a[106:107], v228 offset:29696
    buffer_load_dwordx4 v227, s[12:15], s82 offen offset:3072 lds
    s_add_u32 m0, s34, 77824
    s_add_u32 s77, s76, 128
    s_cmp_eq_u32 s77, 1152
    s_cselect_b32 s77, 0, s77
    v_mfma_f32_32x32x16_bf16 v[160:175], a[116:119], v[20:23], v[160:175]
    ds_read_b64_tr_b16 a[108:109], v228 offset:30720
    ds_read_b64_tr_b16 a[110:111], v228 offset:31744
    s_add_u32 s78, s77, 128
    s_cmp_eq_u32 s78, 1152
    s_cselect_b32 s78, 0, s78
    v_lshlrev_b32 v237, 4, v240
    v_mfma_f32_32x32x16_bf16 v[160:175], a[120:123], v[24:27], v[160:175]
    ds_read_b64_tr_b16 a[112:113], v228 offset:32768
    ds_read_b64_tr_b16 a[114:115], v228 offset:33792
    buffer_load_dwordx4 v227, s[12:15], s83 offen offset:0 lds
    s_mul_i32 s39, s35, 36864
    s_mul_i32 s59, s33, 2359296
    s_add_u32 s59, s59, s39
    v_mfma_f32_32x32x16_bf16 v[160:175], a[124:127], v[28:31], v[160:175]
    ds_read_b64_tr_b16 a[116:117], v228 offset:34816
    ds_read_b64_tr_b16 a[118:119], v228 offset:35840
    s_add_u32 s62, s55, 2
    s_sub_u32 s36, s62, 3
    s_cmp_lt_u32 s62, 3
    s_cselect_b32 s62, s62, s36
    s_waitcnt lgkmcnt(12)
    v_mfma_f32_32x32x16_bf16 v[160:175], a[128:131], v[32:35], v[160:175]
    ds_read_b64_tr_b16 a[120:121], v228 offset:36864
    ds_read_b64_tr_b16 a[122:123], v228 offset:37888
    buffer_load_dwordx4 v227, s[12:15], s84 offen offset:1024 lds
    s_add_u32 s63, s55, 1
    s_cmp_lt_u32 s63, 3
    s_cselect_b32 s63, s63, 0
    v_mfma_f32_32x32x16_bf16 v[160:175], a[132:135], v[36:39], v[160:175]
    ds_read_b64_tr_b16 a[124:125], v228 offset:38912
    ds_read_b64_tr_b16 a[126:127], v228 offset:39936
    s_lshl_b32 s36, s32, 2
    s_add_u32 s36, s36, s33
    s_mul_i32 s52, s36, 36864
    s_mul_i32 s36, s36, 442368
    v_mfma_f32_32x32x16_bf16 v[160:175], a[136:139], v[40:43], v[160:175]
    ds_read_b64_tr_b16 a[128:129], v228 offset:40960
    ds_read_b64_tr_b16 a[130:131], v228 offset:41984
    s_add_u32 m0, s34, 98304
    s_add_u32 s4, s57, s65
    v_add_u32 v227, s4, v234
    s_mul_i32 s39, s3, 36864
    v_mfma_f32_32x32x16_bf16 v[160:175], a[140:143], v[44:47], v[160:175]
    ds_read_b64_tr_b16 a[132:133], v228 offset:43008
    ds_read_b64_tr_b16 a[134:135], v228 offset:44032
    s_add_u32 s36, s36, s39
    s_add_u32 s36, s36, 9437184
    s_mul_i32 s38, s55, 147456
    s_waitcnt lgkmcnt(12)
    v_mfma_f32_32x32x16_bf16 v[144:159], a[96:99], v[48:51], v[144:159]
    ds_read_b64_tr_b16 a[136:137], v228 offset:45056
    ds_read_b64_tr_b16 a[138:139], v228 offset:46080
    buffer_load_dwordx4 v227, s[12:15], s79 offen offset:0 lds
    s_add_u32 s38, s38, s36
    s_mul_i32 s60, s62, 147456
    s_add_u32 s60, s60, s36
    v_mfma_f32_32x32x16_bf16 v[144:159], a[100:103], v[52:55], v[144:159]
    ds_read_b64_tr_b16 a[140:141], v228 offset:47104
    ds_read_b64_tr_b16 a[142:143], v228 offset:48128
    s_mul_i32 s61, s63, 147456
    s_add_u32 s61, s61, s36
    s_lshl_b32 s53, s32, 4
    s_lshl_b32 s39, s32, 16
    v_mfma_f32_32x32x16_bf16 v[144:159], a[104:107], v[56:59], v[144:159]
    ds_read_b64_tr_b16 a[96:97], v229 offset:24576
    ds_read_b64_tr_b16 a[98:99], v229 offset:25600
    buffer_load_dwordx4 v227, s[12:15], s80 offen offset:1024 lds
    s_add_u32 s39, s39, 48234496
    s_lshl_b32 s36, s33, 14
    s_add_u32 s36, s36, s39
    v_mfma_f32_32x32x16_bf16 v[144:159], a[108:111], v[60:63], v[144:159]
    ds_read_b64_tr_b16 a[100:101], v229 offset:26624
    ds_read_b64_tr_b16 a[102:103], v229 offset:27648
    s_lshl_b32 s85, s3, 10
    s_add_u32 s36, s36, s85
    s_add_u32 s36, s36, 4096
    s_waitcnt lgkmcnt(12)
    v_mfma_f32_32x32x16_bf16 v[144:159], a[112:115], v[64:67], v[144:159]
    ds_read_b64_tr_b16 a[104:105], v229 offset:28672
    ds_read_b64_tr_b16 a[106:107], v229 offset:29696
    buffer_load_dwordx4 v227, s[12:15], s81 offen offset:2048 lds
    s_lshl_b32 s62, s62, 12
    s_add_u32 s62, s62, s36
L_sm2:
    s_cbranch_execz L_retm
    s_lshl_b32 s63, s63, 12
    v_mfma_f32_32x32x16_bf16 v[144:159], a[116:119], v[68:71], v[144:159]
    ds_read_b64_tr_b16 a[108:109], v229 offset:30720
    ds_read_b64_tr_b16 a[110:111], v229 offset:31744
    s_add_u32 s63, s63, s36
    s_lshl_b32 s85, s55, 12
    s_add_u32 s85, s85, s36
    v_lshlrev_b32 v250, 2, v240
    v_mfma_f32_32x32x16_bf16 v[144:159], a[120:123], v[72:75], v[144:159]
    ds_read_b64_tr_b16 a[112:113], v229 offset:32768
    ds_read_b64_tr_b16 a[114:115], v229 offset:33792
    buffer_load_dwordx4 v227, s[12:15], s82 offen offset:3072 lds
    s_add_u32 m0, s34, 102400
    v_mov_b32 v225, 0x7ffffff0
    v_cmp_gt_u32 vcc, 32, v240
    s_nop 1
    v_cndmask_b32 v225, v225, v250, vcc
    v_mfma_f32_32x32x16_bf16 v[144:159], a[124:127], v[76:79], v[144:159]
    ds_read_b64_tr_b16 a[116:117], v229 offset:34816
    ds_read_b64_tr_b16 a[118:119], v229 offset:35840
    v_mov_b32 v241, 0
    v_accvgpr_write_b32 a192, 0
    v_accvgpr_write_b32 a193, 0
    s_waitcnt lgkmcnt(12)
    v_mfma_f32_32x32x16_bf16 v[144:159], a[128:131], v[80:83], v[144:159]
    ds_read_b64_tr_b16 a[120:121], v229 offset:36864
    ds_read_b64_tr_b16 a[122:123], v229 offset:37888
    buffer_load_dwordx4 v227, s[12:15], s83 offen offset:0 lds
    v_accvgpr_write_b32 a194, 0
    v_accvgpr_write_b32 a195, 0
    buffer_store_dwordx4 a[192:195], v237, s[24:27], s85 offen sc1
    v_mfma_f32_32x32x16_bf16 v[144:159], a[132:135], v[84:87], v[144:159]
    ds_read_b64_tr_b16 a[124:125], v229 offset:38912
    ds_read_b64_tr_b16 a[126:127], v229 offset:39936
    s_lshl_b32 s36, s33, 10
    s_add_u32 s39, s39, s36
    s_lshl_b32 s36, s55, 12
    s_add_u32 s36, s36, s39
    v_mfma_f32_32x32x16_bf16 v[144:159], a[136:139], v[88:91], v[144:159]
    ds_read_b64_tr_b16 a[128:129], v229 offset:40960
    ds_read_b64_tr_b16 a[130:131], v229 offset:41984
    buffer_load_dwordx4 v227, s[12:15], s84 offen offset:1024 lds
    s_add_u32 s36, s36, 4096
    v_and_b32 v250, 3, v240
    v_xor_b32 v251, 1, v250
    v_mfma_f32_32x32x16_bf16 v[144:159], a[140:143], v[92:95], v[144:159]
    ds_read_b64_tr_b16 a[132:133], v229 offset:43008
    ds_read_b64_tr_b16 a[134:135], v229 offset:44032
    v_cmp_eq_u32 vcc, s33, v250
    s_nop 1
    v_cndmask_b32 v250, v250, v251, vcc
    v_lshl_add_u32 v244, v250, 14, s36
    s_waitcnt lgkmcnt(12)
    v_mfma_f32_32x32x16_bf16 v[160:175], a[96:99], v[48:51], v[160:175]
    ds_read_b64_tr_b16 a[136:137], v229 offset:45056
    ds_read_b64_tr_b16 a[138:139], v229 offset:46080
    s_add_u32 m0, s34, 122880
    s_add_u32 s4, s58, s65
    v_add_u32 v227, s4, v234
    s_lshl_b32 s36, s3, 14
    v_mfma_f32_32x32x16_bf16 v[160:175], a[100:103], v[52:55], v[160:175]
    ds_read_b64_tr_b16 a[140:141], v229 offset:47104
    ds_read_b64_tr_b16 a[142:143], v229 offset:48128
    s_add_u32 s36, s36, s39
    v_mov_b32 v245, s36
    v_mov_b32 v249, 1
    v_lshrrev_b32 v242, 3, v240
    s_waitcnt vmcnt(13)
    s_barrier
    v_mfma_f32_32x32x16_bf16 v[160:175], a[104:107], v[56:59], v[160:175]
    ds_read_b64_tr_b16 a[96:97], v230 offset:0
    ds_read_b64_tr_b16 a[98:99], v230 offset:1024
    v_and_b32 v243, 7, v240
    v_and_b32 v250, 2, v242
    v_xor_b32 v243, v243, v250
    v_lshlrev_b32 v243, 4, v243
    v_mfma_f32_32x32x16_bf16 v[160:175], a[108:111], v[60:63], v[160:175]
    ds_read_b64_tr_b16 a[100:101], v230 offset:2048
    ds_read_b64_tr_b16 a[102:103], v230 offset:3072
    buffer_load_dwordx4 v227, s[12:15], s79 offen offset:0 lds
    s_mul_i32 s36, s3, 165888
    v_mul_u32_u24 v246, 1152, v242
    s_waitcnt lgkmcnt(12)
    v_mfma_f32_32x32x16_bf16 v[160:175], a[112:115], v[64:67], v[160:175]
    ds_read_b64_tr_b16 a[104:105], v230 offset:4096
    ds_read_b64_tr_b16 a[106:107], v230 offset:5120
    v_add3_u32 v246, v246, v243, s36
    s_add_u32 s36, s36, 18432
    v_and_b32 v250, 3, v242
    v_mul_u32_u24 v250, 18, v250
    v_mfma_f32_32x32x16_bf16 v[160:175], a[116:119], v[68:71], v[160:175]
    ds_read_b64_tr_b16 a[108:109], v230 offset:6144
    ds_read_b64_tr_b16 a[110:111], v230 offset:7168
    v_lshrrev_b32 v251, 2, v242
    v_add_u32 v250, v250, v251
    v_mul_u32_u24 v247, 1152, v250
    v_add3_u32 v247, v247, v243, s36
    v_mfma_f32_32x32x16_bf16 v[160:175], a[120:123], v[72:75], v[160:175]
    ds_read_b64_tr_b16 a[112:113], v230 offset:8192
    ds_read_b64_tr_b16 a[114:115], v230 offset:9216
    buffer_load_dwordx4 v227, s[12:15], s80 offen offset:1024 lds
    v_and_b32 v252, 31, v240
    v_mul_u32_u24 v252, 1152, v252
    v_lshrrev_b32 v250, 5, v240
    v_mfma_f32_32x32x16_bf16 v[160:175], a[124:127], v[76:79], v[160:175]
    ds_read_b64_tr_b16 a[116:117], v230 offset:10240
    ds_read_b64_tr_b16 a[118:119], v230 offset:11264
    v_lshl_add_u32 v252, v250, 6, v252
    s_lshl_b32 s36, s3, 4
    s_add_u32 s36, s36, s52
    s_waitcnt lgkmcnt(12)
    v_mfma_f32_32x32x16_bf16 v[160:175], a[128:131], v[80:83], v[160:175]
    ds_read_b64_tr_b16 a[120:121], v230 offset:12288
    ds_read_b64_tr_b16 a[122:123], v230 offset:13312
    v_add_u32 v252, s36, v252
    s_lshl_b32 s36, s55, 3
    s_add_u32 s36, s36, s6
    s_lshl_b32 s36, s36, 2
    v_mfma_f32_32x32x16_bf16 v[160:175], a[132:135], v[84:87], v[160:175]
    ds_read_b64_tr_b16 a[124:125], v230 offset:14336
    ds_read_b64_tr_b16 a[126:127], v230 offset:15360
    buffer_load_dwordx4 v227, s[12:15], s81 offen offset:2048 lds
    s_add_u32 s36, s36, s3
    s_mul_i32 s36, s36, 6912
    v_min_u32 v224, 13, v240
    v_mfma_f32_32x32x16_bf16 v[160:175], a[136:139], v[88:91], v[160:175]
    ds_read_b64_tr_b16 a[128:129], v230 offset:16384
    ds_read_b64_tr_b16 a[130:131], v230 offset:17408
    v_lshl_add_u32 v224, v224, 7, s36
    v_mfma_f32_32x32x16_bf16 v[160:175], a[140:143], v[92:95], v[160:175]
    ds_read_b64_tr_b16 a[132:133], v230 offset:18432
    ds_read_b64_tr_b16 a[134:135], v230 offset:19456
    s_waitcnt lgkmcnt(12)
    v_mfma_f32_32x32x16_bf16 v[144:159], a[96:99], v[96:99], v[144:159]
    ds_read_b64_tr_b16 a[136:137], v230 offset:20480
    ds_read_b64_tr_b16 a[138:139], v230 offset:21504
    buffer_load_dwordx4 v227, s[12:15], s82 offen offset:3072 lds
    s_add_u32 m0, s34, 126976
    v_mfma_f32_32x32x16_bf16 v[144:159], a[100:103], v[100:103], v[144:159]
    ds_read_b64_tr_b16 a[140:141], v230 offset:22528
    ds_read_b64_tr_b16 a[142:143], v230 offset:23552
    v_mfma_f32_32x32x16_bf16 v[144:159], a[104:107], v[104:107], v[144:159]
    ds_read_b64_tr_b16 a[96:97], v231 offset:0
    ds_read_b64_tr_b16 a[98:99], v231 offset:1024
    v_mfma_f32_32x32x16_bf16 v[144:159], a[108:111], v[108:111], v[144:159]
    ds_read_b64_tr_b16 a[100:101], v231 offset:2048
    ds_read_b64_tr_b16 a[102:103], v231 offset:3072
    buffer_load_dwordx4 v227, s[12:15], s83 offen offset:0 lds
    s_waitcnt lgkmcnt(12)
    v_mfma_f32_32x32x16_bf16 v[144:159], a[112:115], v[112:115], v[144:159]
    ds_read_b64_tr_b16 a[104:105], v231 offset:4096
    ds_read_b64_tr_b16 a[106:107], v231 offset:5120
    v_mfma_f32_32x32x16_bf16 v[144:159], a[116:119], v[116:119], v[144:159]
    ds_read_b64_tr_b16 a[108:109], v231 offset:6144
    ds_read_b64_tr_b16 a[110:111], v231 offset:7168
    v_mfma_f32_32x32x16_bf16 v[144:159], a[120:123], v[120:123], v[144:159]
    ds_read_b64_tr_b16 a[112:113], v231 offset:8192
    ds_read_b64_tr_b16 a[114:115], v231 offset:9216
    buffer_load_dwordx4 v227, s[12:15], s84 offen offset:1024 lds
    v_mfma_f32_32x32x16_bf16 v[144:159], a[124:127], v[124:127], v[144:159]
    ds_read_b64_tr_b16 a[116:117], v231 offset:10240
    ds_read_b64_tr_b16 a[118:119], v231 offset:11264
    s_waitcnt lgkmcnt(12)
    v_mfma_f32_32x32x16_bf16 v[144:159], a[128:131], v[128:131], v[144:159]
    ds_read_b64_tr_b16 a[120:121], v231 offset:12288
    ds_read_b64_tr_b16 a[122:123], v231 offset:13312
    s_add_u32 m0, s34, 0
    s_add_u32 s4, s56, s66
    v_add_u32 v227, s4, v234
    v_mfma_f32_32x32x16_bf16 v[144:159], a[132:135], v[132:135], v[144:159]
    ds_read_b64_tr_b16 a[124:125], v231 offset:14336
    ds_read_b64_tr_b16 a[126:127], v231 offset:15360
    v_mfma_f32_32x32x16_bf16 v[144:159], a[136:139], v[136:139], v[144:159]
    ds_read_b64_tr_b16 a[128:129], v231 offset:16384
    ds_read_b64_tr_b16 a[130:131], v231 offset:17408
    v_mfma_f32_32x32x16_bf16 v[144:159], a[140:143], v[140:143], v[144:159]
    ds_read_b64_tr_b16 a[132:133], v231 offset:18432
    ds_read_b64_tr_b16 a[134:135], v231 offset:19456
    buffer_load_dwordx4 v227, s[12:15], s79 offen offset:0 lds
    s_waitcnt lgkmcnt(12)
    v_mfma_f32_32x32x16_bf16 v[160:175], a[96:99], v[96:99], v[160:175]
    ds_read_b64_tr_b16 a[136:137], v231 offset:20480
    ds_read_b64_tr_b16 a[138:139], v231 offset:21504
    v_mfma_f32_32x32x16_bf16 v[160:175], a[100:103], v[100:103], v[160:175]
    ds_read_b64_tr_b16 a[140:141], v231 offset:22528
    ds_read_b64_tr_b16 a[142:143], v231 offset:23552
    s_waitcnt vmcnt(14)
    s_barrier
    v_mfma_f32_32x32x16_bf16 v[160:175], a[104:107], v[104:107], v[160:175]
    ds_read_b64_tr_b16 a[96:97], v230 offset:24576
    ds_read_b64_tr_b16 a[98:99], v230 offset:25600
    buffer_load_dwordx4 v227, s[12:15], s80 offen offset:1024 lds
    v_exp_f32 v208, v144
    v_exp_f32 v209, v145
    v_mfma_f32_32x32x16_bf16 v[160:175], a[108:111], v[108:111], v[160:175]
    ds_read_b64_tr_b16 a[100:101], v230 offset:26624
    ds_read_b64_tr_b16 a[102:103], v230 offset:27648
    v_fma_f32 v210, v208, 0.5, 1.0
    v_fma_f32 v211, v209, 0.5, 1.0
    v_fma_f32 v210, v208, v210, 1.0
    s_waitcnt lgkmcnt(12)
    v_mfma_f32_32x32x16_bf16 v[160:175], a[112:115], v[112:115], v[160:175]
    ds_read_b64_tr_b16 a[104:105], v230 offset:28672
    ds_read_b64_tr_b16 a[106:107], v230 offset:29696
    v_fma_f32 v211, v209, v211, 1.0
    v_rcp_f32 v210, v210
    v_rcp_f32 v211, v211
    v_mfma_f32_32x32x16_bf16 v[160:175], a[116:119], v[116:119], v[160:175]
    ds_read_b64_tr_b16 a[108:109], v230 offset:30720
    ds_read_b64_tr_b16 a[110:111], v230 offset:31744
    buffer_load_dwordx4 v227, s[12:15], s81 offen offset:2048 lds
    v_fma_f32 v208, -v144, v210, v144
    v_fma_f32 v209, -v145, v211, v145
    v_cvt_pk_bf16_f32 v212, v208, v209
    v_mfma_f32_32x32x16_bf16 v[160:175], a[120:123], v[120:123], v[160:175]
    ds_read_b64_tr_b16 a[112:113], v230 offset:32768
    ds_read_b64_tr_b16 a[114:115], v230 offset:33792
    v_accvgpr_write_b32 a0, v212
    v_exp_f32 v213, v146
    v_exp_f32 v214, v147
    v_mfma_f32_32x32x16_bf16 v[160:175], a[124:127], v[124:127], v[160:175]
    ds_read_b64_tr_b16 a[116:117], v230 offset:34816
    ds_read_b64_tr_b16 a[118:119], v230 offset:35840
    v_fma_f32 v215, v213, 0.5, 1.0
    v_fma_f32 v216, v214, 0.5, 1.0
    v_fma_f32 v215, v213, v215, 1.0
    s_waitcnt lgkmcnt(12)
    v_mfma_f32_32x32x16_bf16 v[160:175], a[128:131], v[128:131], v[160:175]
    ds_read_b64_tr_b16 a[120:121], v230 offset:36864
    ds_read_b64_tr_b16 a[122:123], v230 offset:37888
    buffer_load_dwordx4 v227, s[12:15], s82 offen offset:3072 lds
    s_add_u32 m0, s34, 4096
    v_fma_f32 v216, v214, v216, 1.0
    v_rcp_f32 v215, v215
    v_mfma_f32_32x32x16_bf16 v[160:175], a[132:135], v[132:135], v[160:175]
    ds_read_b64_tr_b16 a[124:125], v230 offset:38912
    ds_read_b64_tr_b16 a[126:127], v230 offset:39936
    v_rcp_f32 v216, v216
    v_fma_f32 v213, -v146, v215, v146
    v_fma_f32 v214, -v147, v216, v147
    v_mfma_f32_32x32x16_bf16 v[160:175], a[136:139], v[136:139], v[160:175]
    ds_read_b64_tr_b16 a[128:129], v230 offset:40960
    ds_read_b64_tr_b16 a[130:131], v230 offset:41984
    v_cvt_pk_bf16_f32 v217, v213, v214
    v_accvgpr_write_b32 a1, v217
    v_exp_f32 v208, v148
    v_mfma_f32_32x32x16_bf16 v[160:175], a[140:143], v[140:143], v[160:175]
    ds_read_b64_tr_b16 a[132:133], v230 offset:43008
    ds_read_b64_tr_b16 a[134:135], v230 offset:44032
    ds_read_b128 v[144:147], v236 offset:512
    v_exp_f32 v209, v149
    s_waitcnt lgkmcnt(13)
    v_mfma_f32_32x32x16_bf16 v[176:191], a[96:99], v[0:3], v[176:191]
    ds_read_b64_tr_b16 a[136:137], v230 offset:45056
    ds_read_b64_tr_b16 a[138:139], v230 offset:46080
    buffer_load_dwordx4 v227, s[12:15], s83 offen offset:0 lds
    v_fma_f32 v210, v208, 0.5, 1.0
    v_fma_f32 v211, v209, 0.5, 1.0
    v_fma_f32 v210, v208, v210, 1.0
    v_mfma_f32_32x32x16_bf16 v[176:191], a[100:103], v[4:7], v[176:191]
    ds_read_b64_tr_b16 a[140:141], v230 offset:47104
    ds_read_b64_tr_b16 a[142:143], v230 offset:48128
    v_fma_f32 v211, v209, v211, 1.0
    v_rcp_f32 v210, v210
    v_rcp_f32 v211, v211
    v_mfma_f32_32x32x16_bf16 v[176:191], a[104:107], v[8:11], v[176:191]
    ds_read_b64_tr_b16 a[96:97], v231 offset:24576
    ds_read_b64_tr_b16 a[98:99], v231 offset:25600
    buffer_load_dwordx4 v227, s[12:15], s84 offen offset:1024 lds
    v_fma_f32 v208, -v148, v210, v148
    v_fma_f32 v209, -v149, v211, v149
    v_cvt_pk_bf16_f32 v212, v208, v209
    v_mfma_f32_32x32x16_bf16 v[176:191], a[108:111], v[12:15], v[176:191]
    ds_read_b64_tr_b16 a[100:101], v231 offset:26624
    ds_read_b64_tr_b16 a[102:103], v231 offset:27648
    v_accvgpr_write_b32 a2, v212
    v_exp_f32 v213, v150
    s_waitcnt lgkmcnt(13)
    v_mfma_f32_32x32x16_bf16 v[176:191], a[112:115], v[16:19], v[176:191]
    ds_read_b64_tr_b16 a[104:105], v231 offset:28672
    ds_read_b64_tr_b16 a[106:107], v231 offset:29696
    s_add_u32 m0, s34, 24576
    s_add_u32 s4, s57, s66
    v_add_u32 v227, s4, v234
    v_exp_f32 v214, v151
    v_mfma_f32_32x32x16_bf16 v[176:191], a[116:119], v[20:23], v[176:191]
    ds_read_b64_tr_b16 a[108:109], v231 offset:30720
    ds_read_b64_tr_b16 a[110:111], v231 offset:31744
    v_fma_f32 v215, v213, 0.5, 1.0
    v_fma_f32 v216, v214, 0.5, 1.0
    v_fma_f32 v215, v213, v215, 1.0
    v_fma_f32 v216, v214, v216, 1.0
    v_mfma_f32_32x32x16_bf16 v[176:191], a[120:123], v[24:27], v[176:191]
    ds_read_b64_tr_b16 a[112:113], v231 offset:32768
    ds_read_b64_tr_b16 a[114:115], v231 offset:33792
    v_rcp_f32 v215, v215
    v_rcp_f32 v216, v216
    v_mfma_f32_32x32x16_bf16 v[176:191], a[124:127], v[28:31], v[176:191]
    ds_read_b64_tr_b16 a[116:117], v231 offset:34816
    ds_read_b64_tr_b16 a[118:119], v231 offset:35840
    buffer_load_dwordx4 v227, s[12:15], s79 offen offset:0 lds
    v_fma_f32 v213, -v150, v215, v150
    v_fma_f32 v214, -v151, v216, v151
    s_waitcnt lgkmcnt(12)
    v_mfma_f32_32x32x16_bf16 v[176:191], a[128:131], v[32:35], v[176:191]
    ds_read_b64_tr_b16 a[120:121], v231 offset:36864
    ds_read_b64_tr_b16 a[122:123], v231 offset:37888
    v_cvt_pk_bf16_f32 v217, v213, v214
    v_accvgpr_write_b32 a3, v217
    v_exp_f32 v208, v152
    v_mfma_f32_32x32x16_bf16 v[176:191], a[132:135], v[36:39], v[176:191]
    ds_read_b64_tr_b16 a[124:125], v231 offset:38912
    ds_read_b64_tr_b16 a[126:127], v231 offset:39936
    ds_read_b128 v[148:151], v236 offset:528
    v_exp_f32 v209, v153
    v_fma_f32 v210, v208, 0.5, 1.0
    v_mfma_f32_32x32x16_bf16 v[176:191], a[136:139], v[40:43], v[176:191]
    ds_read_b64_tr_b16 a[128:129], v231 offset:40960
    ds_read_b64_tr_b16 a[130:131], v231 offset:41984
    buffer_load_dwordx4 v227, s[12:15], s80 offen offset:1024 lds
    v_fma_f32 v211, v209, 0.5, 1.0
    v_fma_f32 v210, v208, v210, 1.0
    v_fma_f32 v211, v209, v211, 1.0
    v_mfma_f32_32x32x16_bf16 v[176:191], a[140:143], v[44:47], v[176:191]
    ds_read_b64_tr_b16 a[132:133], v231 offset:43008
    ds_read_b64_tr_b16 a[134:135], v231 offset:44032
    v_rcp_f32 v210, v210
    v_rcp_f32 v211, v211
    s_waitcnt lgkmcnt(13)
    v_mfma_f32_32x32x16_bf16 v[192:207], a[96:99], v[0:3], v[192:207]
    ds_read_b64_tr_b16 a[136:137], v231 offset:45056
    ds_read_b64_tr_b16 a[138:139], v231 offset:46080
    v_fma_f32 v208, -v152, v210, v152
    v_fma_f32 v209, -v153, v211, v153
    v_cvt_pk_bf16_f32 v212, v208, v209
    v_accvgpr_write_b32 a4, v212
    v_mfma_f32_32x32x16_bf16 v[192:207], a[100:103], v[4:7], v[192:207]
    ds_read_b64_tr_b16 a[140:141], v231 offset:47104
    ds_read_b64_tr_b16 a[142:143], v231 offset:48128
    buffer_load_dwordx4 v227, s[12:15], s81 offen offset:2048 lds
    v_exp_f32 v213, v154
    v_exp_f32 v214, v155
    s_waitcnt vmcnt(15)
    s_barrier
    v_mfma_f32_32x32x16_bf16 v[192:207], a[104:107], v[8:11], v[192:207]
    ds_read_b64_tr_b16 a[96:97], v232 offset:0
    ds_read_b64_tr_b16 a[98:99], v232 offset:1024
    v_fma_f32 v215, v213, 0.5, 1.0
    v_fma_f32 v216, v214, 0.5, 1.0
    v_fma_f32 v215, v213, v215, 1.0
    v_fma_f32 v216, v214, v216, 1.0
    v_mfma_f32_32x32x16_bf16 v[192:207], a[108:111], v[12:15], v[192:207]
    ds_read_b64_tr_b16 a[100:101], v232 offset:2048
    ds_read_b64_tr_b16 a[102:103], v232 offset:3072
    v_rcp_f32 v215, v215
    v_rcp_f32 v216, v216
    s_waitcnt lgkmcnt(13)
    v_mfma_f32_32x32x16_bf16 v[192:207], a[112:115], v[16:19], v[192:207]
    ds_read_b64_tr_b16 a[104:105], v232 offset:4096
    ds_read_b64_tr_b16 a[106:107], v232 offset:5120
    buffer_load_dwordx4 v227, s[12:15], s82 offen offset:3072 lds
    s_add_u32 m0, s34, 28672
    v_fma_f32 v213, -v154, v215, v154
    v_fma_f32 v214, -v155, v216, v155
    v_mfma_f32_32x32x16_bf16 v[192:207], a[116:119], v[20:23], v[192:207]
    ds_read_b64_tr_b16 a[108:109], v232 offset:6144
    ds_read_b64_tr_b16 a[110:111], v232 offset:7168
    v_cvt_pk_bf16_f32 v217, v213, v214
    v_accvgpr_write_b32 a5, v217
    v_exp_f32 v208, v156
    v_mfma_f32_32x32x16_bf16 v[192:207], a[120:123], v[24:27], v[192:207]
    ds_read_b64_tr_b16 a[112:113], v232 offset:8192
    ds_read_b64_tr_b16 a[114:115], v232 offset:9216
    ds_read_b128 v[152:155], v236 offset:544
    v_exp_f32 v209, v157
    v_fma_f32 v210, v208, 0.5, 1.0
    v_mfma_f32_32x32x16_bf16 v[192:207], a[124:127], v[28:31], v[192:207]
    ds_read_b64_tr_b16 a[116:117], v232 offset:10240
    ds_read_b64_tr_b16 a[118:119], v232 offset:11264
    buffer_load_dwordx4 v227, s[12:15], s83 offen offset:0 lds
    v_fma_f32 v211, v209, 0.5, 1.0
    v_fma_f32 v210, v208, v210, 1.0
    s_waitcnt lgkmcnt(13)
    v_mfma_f32_32x32x16_bf16 v[192:207], a[128:131], v[32:35], v[192:207]
    ds_read_b64_tr_b16 a[120:121], v232 offset:12288
    ds_read_b64_tr_b16 a[122:123], v232 offset:13312
    v_fma_f32 v211, v209, v211, 1.0
    v_rcp_f32 v210, v210
    v_rcp_f32 v211, v211
    v_mfma_f32_32x32x16_bf16 v[192:207], a[132:135], v[36:39], v[192:207]
    ds_read_b64_tr_b16 a[124:125], v232 offset:14336
    ds_read_b64_tr_b16 a[126:127], v232 offset:15360
    v_fma_f32 v208, -v156, v210, v156
    v_fma_f32 v209, -v157, v211, v157
    v_cvt_pk_bf16_f32 v212, v208, v209
    v_accvgpr_write_b32 a6, v212
    v_mfma_f32_32x32x16_bf16 v[192:207], a[136:139], v[40:43], v[192:207]
    ds_read_b64_tr_b16 a[128:129], v232 offset:16384
    ds_read_b64_tr_b16 a[130:131], v232 offset:17408
    buffer_load_dwordx4 v227, s[12:15], s84 offen offset:1024 lds
    v_exp_f32 v213, v158
    v_exp_f32 v214, v159
    v_mfma_f32_32x32x16_bf16 v[192:207], a[140:143], v[44:47], v[192:207]
    ds_read_b64_tr_b16 a[132:133], v232 offset:18432
    ds_read_b64_tr_b16 a[134:135], v232 offset:19456
    v_fma_f32 v215, v213, 0.5, 1.0
    v_fma_f32 v216, v214, 0.5, 1.0
    v_fma_f32 v215, v213, v215, 1.0
    s_waitcnt lgkmcnt(13)
    v_mfma_f32_32x32x16_bf16 v[176:191], a[96:99], v[48:51], v[176:191]
    ds_read_b64_tr_b16 a[136:137], v232 offset:20480
    ds_read_b64_tr_b16 a[138:139], v232 offset:21504
    s_add_u32 m0, s34, 49152
    s_add_u32 s4, s58, s66
    v_add_u32 v227, s4, v234
    v_fma_f32 v216, v214, v216, 1.0
    v_mfma_f32_32x32x16_bf16 v[176:191], a[100:103], v[52:55], v[176:191]
    ds_read_b64_tr_b16 a[140:141], v232 offset:22528
    ds_read_b64_tr_b16 a[142:143], v232 offset:23552
    v_rcp_f32 v215, v215
    v_rcp_f32 v216, v216
    v_mfma_f32_32x32x16_bf16 v[176:191], a[104:107], v[56:59], v[176:191]
    ds_read_b64_tr_b16 a[96:97], v233 offset:0
    ds_read_b64_tr_b16 a[98:99], v233 offset:1024
    v_fma_f32 v213, -v158, v215, v158
    v_fma_f32 v214, -v159, v216, v159
    v_cvt_pk_bf16_f32 v217, v213, v214
    v_accvgpr_write_b32 a7, v217
    v_mfma_f32_32x32x16_bf16 v[176:191], a[108:111], v[60:63], v[176:191]
    ds_read_b64_tr_b16 a[100:101], v233 offset:2048
    ds_read_b64_tr_b16 a[102:103], v233 offset:3072
    ds_read_b128 v[156:159], v236 offset:560
    v_exp_f32 v208, v160
    s_waitcnt lgkmcnt(13)
    v_mfma_f32_32x32x16_bf16 v[176:191], a[112:115], v[64:67], v[176:191]
    ds_read_b64_tr_b16 a[104:105], v233 offset:4096
    ds_read_b64_tr_b16 a[106:107], v233 offset:5120
    buffer_load_dwordx4 v227, s[12:15], s79 offen offset:0 lds
    v_exp_f32 v209, v161
    v_fma_f32 v210, v208, 0.5, 1.0
    v_mfma_f32_32x32x16_bf16 v[176:191], a[116:119], v[68:71], v[176:191]
    ds_read_b64_tr_b16 a[108:109], v233 offset:6144
    ds_read_b64_tr_b16 a[110:111], v233 offset:7168
    v_fma_f32 v211, v209, 0.5, 1.0
    v_fma_f32 v210, v208, v210, 1.0
    v_fma_f32 v211, v209, v211, 1.0
    v_rcp_f32 v210, v210
    v_mfma_f32_32x32x16_bf16 v[176:191], a[120:123], v[72:75], v[176:191]
    ds_read_b64_tr_b16 a[112:113], v233 offset:8192
    ds_read_b64_tr_b16 a[114:115], v233 offset:9216
    buffer_load_dwordx4 v227, s[12:15], s80 offen offset:1024 lds
    v_rcp_f32 v211, v211
    v_fma_f32 v208, -v160, v210, v160
    v_mfma_f32_32x32x16_bf16 v[176:191], a[124:127], v[76:79], v[176:191]
    ds_read_b64_tr_b16 a[116:117], v233 offset:10240
    ds_read_b64_tr_b16 a[118:119], v233 offset:11264
    v_fma_f32 v209, -v161, v211, v161
    v_cvt_pk_bf16_f32 v212, v208, v209
    v_accvgpr_write_b32 a8, v212
    s_waitcnt lgkmcnt(13)
    v_mfma_f32_32x32x16_bf16 v[176:191], a[128:131], v[80:83], v[176:191]
    ds_read_b64_tr_b16 a[120:121], v233 offset:12288
    ds_read_b64_tr_b16 a[122:123], v233 offset:13312
    v_exp_f32 v213, v162
    v_exp_f32 v214, v163
    v_mfma_f32_32x32x16_bf16 v[176:191], a[132:135], v[84:87], v[176:191]
    ds_read_b64_tr_b16 a[124:125], v233 offset:14336
    ds_read_b64_tr_b16 a[126:127], v233 offset:15360
    buffer_load_dwordx4 v227, s[12:15], s81 offen offset:2048 lds
    v_fma_f32 v215, v213, 0.5, 1.0
    v_fma_f32 v216, v214, 0.5, 1.0
    v_fma_f32 v215, v213, v215, 1.0
    v_mfma_f32_32x32x16_bf16 v[176:191], a[136:139], v[88:91], v[176:191]
    ds_read_b64_tr_b16 a[128:129], v233 offset:16384
    ds_read_b64_tr_b16 a[130:131], v233 offset:17408
    v_fma_f32 v216, v214, v216, 1.0
    v_rcp_f32 v215, v215
    v_rcp_f32 v216, v216
    v_mfma_f32_32x32x16_bf16 v[176:191], a[140:143], v[92:95], v[176:191]
    ds_read_b64_tr_b16 a[132:133], v233 offset:18432
    ds_read_b64_tr_b16 a[134:135], v233 offset:19456
    v_fma_f32 v213, -v162, v215, v162
    v_fma_f32 v214, -v163, v216, v163
    v_cvt_pk_bf16_f32 v217, v213, v214
    s_waitcnt lgkmcnt(12)
    v_mfma_f32_32x32x16_bf16 v[192:207], a[96:99], v[48:51], v[192:207]
    ds_read_b64_tr_b16 a[136:137], v233 offset:20480
    ds_read_b64_tr_b16 a[138:139], v233 offset:21504
    buffer_load_dwordx4 v227, s[12:15], s82 offen offset:3072 lds
    s_add_u32 m0, s34, 53248
    v_accvgpr_write_b32 a9, v217
    v_exp_f32 v208, v164
    v_mfma_f32_32x32x16_bf16 v[192:207], a[100:103], v[52:55], v[192:207]
    ds_read_b64_tr_b16 a[140:141], v233 offset:22528
    ds_read_b64_tr_b16 a[142:143], v233 offset:23552
    ds_read_b128 v[160:163], v236 offset:576
    v_exp_f32 v209, v165
    v_fma_f32 v210, v208, 0.5, 1.0
    s_waitcnt vmcnt(16)
    s_barrier
    v_mfma_f32_32x32x16_bf16 v[192:207], a[104:107], v[56:59], v[192:207]
    ds_read_b64_tr_b16 a[96:97], v232 offset:24576
    ds_read_b64_tr_b16 a[98:99], v232 offset:25600
    v_fma_f32 v211, v209, 0.5, 1.0
    v_fma_f32 v210, v208, v210, 1.0
    v_fma_f32 v211, v209, v211, 1.0
    v_rcp_f32 v210, v210
    v_mfma_f32_32x32x16_bf16 v[192:207], a[108:111], v[60:63], v[192:207]
    ds_read_b64_tr_b16 a[100:101], v232 offset:26624
    ds_read_b64_tr_b16 a[102:103], v232 offset:27648
    buffer_load_dwordx4 v227, s[12:15], s83 offen offset:0 lds
    v_rcp_f32 v211, v211
    s_waitcnt lgkmcnt(13)
    v_mfma_f32_32x32x16_bf16 v[192:207], a[112:115], v[64:67], v[192:207]
    ds_read_b64_tr_b16 a[104:105], v232 offset:28672
    ds_read_b64_tr_b16 a[106:107], v232 offset:29696
    v_fma_f32 v208, -v164, v210, v164
    v_fma_f32 v209, -v165, v211, v165
    v_cvt_pk_bf16_f32 v212, v208, v209
    v_accvgpr_write_b32 a10, v212
    v_mfma_f32_32x32x16_bf16 v[192:207], a[116:119], v[68:71], v[192:207]
    ds_read_b64_tr_b16 a[108:109], v232 offset:30720
    ds_read_b64_tr_b16 a[110:111], v232 offset:31744
    v_exp_f32 v213, v166
    v_exp_f32 v214, v167
    v_mfma_f32_32x32x16_bf16 v[192:207], a[120:123], v[72:75], v[192:207]
    ds_read_b64_tr_b16 a[112:113], v232 offset:32768
    ds_read_b64_tr_b16 a[114:115], v232 offset:33792
    buffer_load_dwordx4 v227, s[12:15], s84 offen offset:1024 lds
    v_fma_f32 v215, v213, 0.5, 1.0
    v_fma_f32 v216, v214, 0.5, 1.0
    v_fma_f32 v215, v213, v215, 1.0
    v_mfma_f32_32x32x16_bf16 v[192:207], a[124:127], v[76:79], v[192:207]
    ds_read_b64_tr_b16 a[116:117], v232 offset:34816
    ds_read_b64_tr_b16 a[118:119], v232 offset:35840
    v_fma_f32 v216, v214, v216, 1.0
    v_rcp_f32 v215, v215
    s_waitcnt lgkmcnt(13)
    v_mfma_f32_32x32x16_bf16 v[192:207], a[128:131], v[80:83], v[192:207]
    ds_read_b64_tr_b16 a[120:121], v232 offset:36864
    ds_read_b64_tr_b16 a[122:123], v232 offset:37888
    s_add_u32 m0, s34, 73728
    s_add_u32 s4, s56, s67
    v_add_u32 v227, s4, v234
    v_rcp_f32 v216, v216
    v_mfma_f32_32x32x16_bf16 v[192:207], a[132:135], v[84:87], v[192:207]
    ds_read_b64_tr_b16 a[124:125], v232 offset:38912
    ds_read_b64_tr_b16 a[126:127], v232 offset:39936
    v_fma_f32 v213, -v166, v215, v166
    v_fma_f32 v214, -v167, v216, v167
    v_cvt_pk_bf16_f32 v217, v213, v214
    v_accvgpr_write_b32 a11, v217
    v_mfma_f32_32x32x16_bf16 v[192:207], a[136:139], v[88:91], v[192:207]
    ds_read_b64_tr_b16 a[128:129], v232 offset:40960
    ds_read_b64_tr_b16 a[130:131], v232 offset:41984
    ds_read_b128 v[164:167], v236 offset:592
    v_exp_f32 v208, v168
    v_exp_f32 v209, v169
    v_mfma_f32_32x32x16_bf16 v[192:207], a[140:143], v[92:95], v[192:207]
    ds_read_b64_tr_b16 a[132:133], v232 offset:43008
    ds_read_b64_tr_b16 a[134:135], v232 offset:44032
    buffer_load_dwordx4 v227, s[12:15], s79 offen offset:0 lds
    v_fma_f32 v210, v208, 0.5, 1.0
    v_fma_f32 v211, v209, 0.5, 1.0
    s_waitcnt lgkmcnt(13)
    v_mfma_f32_32x32x16_bf16 v[176:191], a[96:99], v[96:99], v[176:191]
    ds_read_b64_tr_b16 a[136:137], v232 offset:45056
    ds_read_b64_tr_b16 a[138:139], v232 offset:46080
    v_fma_f32 v210, v208, v210, 1.0
    v_fma_f32 v211, v209, v211, 1.0
    v_rcp_f32 v210, v210
    v_mfma_f32_32x32x16_bf16 v[176:191], a[100:103], v[100:103], v[176:191]
    ds_read_b64_tr_b16 a[140:141], v232 offset:47104
    ds_read_b64_tr_b16 a[142:143], v232 offset:48128
    v_rcp_f32 v211, v211
    v_fma_f32 v208, -v168, v210, v168
    v_fma_f32 v209, -v169, v211, v169
    v_mfma_f32_32x32x16_bf16 v[176:191], a[104:107], v[104:107], v[176:191]
    ds_read_b64_tr_b16 a[96:97], v233 offset:24576
L_sm3:
    s_cbranch_execz L_retm
    ds_read_b64_tr_b16 a[98:99], v233 offset:25600
    buffer_load_dwordx4 v227, s[12:15], s80 offen offset:1024 lds
    v_cvt_pk_bf16_f32 v212, v208, v209
    v_accvgpr_write_b32 a12, v212
    v_exp_f32 v213, v170
    v_mfma_f32_32x32x16_bf16 v[176:191], a[108:111], v[108:111], v[176:191]
    ds_read_b64_tr_b16 a[100:101], v233 offset:26624
    ds_read_b64_tr_b16 a[102:103], v233 offset:27648
    v_exp_f32 v214, v171
    v_fma_f32 v215, v213, 0.5, 1.0
    s_waitcnt lgkmcnt(13)
    v_mfma_f32_32x32x16_bf16 v[176:191], a[112:115], v[112:115], v[176:191]
    ds_read_b64_tr_b16 a[104:105], v233 offset:28672
    ds_read_b64_tr_b16 a[106:107], v233 offset:29696
    v_fma_f32 v216, v214, 0.5, 1.0
    v_fma_f32 v215, v213, v215, 1.0
    v_fma_f32 v216, v214, v216, 1.0
    v_rcp_f32 v215, v215
    v_mfma_f32_32x32x16_bf16 v[176:191], a[116:119], v[116:119], v[176:191]
    ds_read_b64_tr_b16 a[108:109], v233 offset:30720
    ds_read_b64_tr_b16 a[110:111], v233 offset:31744
    buffer_load_dwordx4 v227, s[12:15], s81 offen offset:2048 lds
    v_rcp_f32 v216, v216
    v_fma_f32 v213, -v170, v215, v170
    v_mfma_f32_32x32x16_bf16 v[176:191], a[120:123], v[120:123], v[176:191]
    ds_read_b64_tr_b16 a[112:113], v233 offset:32768
    ds_read_b64_tr_b16 a[114:115], v233 offset:33792
    v_fma_f32 v214, -v171, v216, v171
    v_cvt_pk_bf16_f32 v217, v213, v214
    v_accvgpr_write_b32 a13, v217
    v_exp_f32 v208, v172
    v_mfma_f32_32x32x16_bf16 v[176:191], a[124:127], v[124:127], v[176:191]
    ds_read_b64_tr_b16 a[116:117], v233 offset:34816
    ds_read_b64_tr_b16 a[118:119], v233 offset:35840
    ds_read_b128 v[168:171], v236 offset:608
    v_exp_f32 v209, v173
    s_waitcnt lgkmcnt(13)
    v_mfma_f32_32x32x16_bf16 v[176:191], a[128:131], v[128:131], v[176:191]
    ds_read_b64_tr_b16 a[120:121], v233 offset:36864
    ds_read_b64_tr_b16 a[122:123], v233 offset:37888
    buffer_load_dwordx4 v227, s[12:15], s82 offen offset:3072 lds
    s_add_u32 m0, s34, 77824
    v_fma_f32 v210, v208, 0.5, 1.0
    v_fma_f32 v211, v209, 0.5, 1.0
    v_mfma_f32_32x32x16_bf16 v[176:191], a[132:135], v[132:135], v[176:191]
    ds_read_b64_tr_b16 a[124:125], v233 offset:38912
    ds_read_b64_tr_b16 a[126:127], v233 offset:39936
    v_fma_f32 v210, v208, v210, 1.0
    v_fma_f32 v211, v209, v211, 1.0
    v_rcp_f32 v210, v210
    v_mfma_f32_32x32x16_bf16 v[176:191], a[136:139], v[136:139], v[176:191]
    ds_read_b64_tr_b16 a[128:129], v233 offset:40960
    ds_read_b64_tr_b16 a[130:131], v233 offset:41984
    v_mov_b32 v250, 0x7ffffff0
    v_mov_b32 v251, 1
    v_cmp_eq_u32 vcc, 0, v239
    s_nop 1
    v_cndmask_b32 v250, v250, 0, vcc
    buffer_atomic_add v251, v250, s[28:31], s53 offen sc1
    v_mfma_f32_32x32x16_bf16 v[176:191], a[140:143], v[140:143], v[176:191]
    ds_read_b64_tr_b16 a[132:133], v233 offset:43008
    ds_read_b64_tr_b16 a[134:135], v233 offset:44032
    buffer_load_dwordx4 v227, s[12:15], s83 offen offset:0 lds
    v_rcp_f32 v211, v211
    s_waitcnt lgkmcnt(13)
    v_mfma_f32_32x32x16_bf16 v[192:207], a[96:99], v[96:99], v[192:207]
    ds_read_b64_tr_b16 a[136:137], v233 offset:45056
    ds_read_b64_tr_b16 a[138:139], v233 offset:46080
    v_fma_f32 v208, -v172, v210, v172
    v_fma_f32 v209, -v173, v211, v173
    v_cvt_pk_bf16_f32 v212, v208, v209
    v_accvgpr_write_b32 a14, v212
    v_mfma_f32_32x32x16_bf16 v[192:207], a[100:103], v[100:103], v[192:207]
    ds_read_b64_tr_b16 a[140:141], v233 offset:47104
    ds_read_b64_tr_b16 a[142:143], v233 offset:48128
    v_exp_f32 v213, v174
    v_exp_f32 v214, v175
    s_waitcnt vmcnt(18)
    s_barrier
    v_mfma_f32_32x32x16_bf16 v[192:207], a[104:107], v[104:107], v[192:207]
    ds_read_b64_tr_b16 a[96:97], v228 offset:0
    ds_read_b64_tr_b16 a[98:99], v228 offset:1024
    buffer_load_dwordx4 v227, s[12:15], s84 offen offset:1024 lds
    v_fma_f32 v215, v213, 0.5, 1.0
    v_fma_f32 v216, v214, 0.5, 1.0
    v_fma_f32 v215, v213, v215, 1.0
    v_mfma_f32_32x32x16_bf16 v[192:207], a[108:111], v[108:111], v[192:207]
    ds_read_b64_tr_b16 a[100:101], v228 offset:2048
    ds_read_b64_tr_b16 a[102:103], v228 offset:3072
    v_fma_f32 v216, v214, v216, 1.0
    v_rcp_f32 v215, v215
    s_waitcnt lgkmcnt(12)
    v_mfma_f32_32x32x16_bf16 v[192:207], a[112:115], v[112:115], v[192:207]
    ds_read_b64_tr_b16 a[104:105], v228 offset:4096
    ds_read_b64_tr_b16 a[106:107], v228 offset:5120
    s_add_u32 m0, s34, 98304
    s_add_u32 s4, s57, s67
    v_add_u32 v227, s4, v234
    v_rcp_f32 v216, v216
    v_mfma_f32_32x32x16_bf16 v[192:207], a[116:119], v[116:119], v[192:207]
    ds_read_b64_tr_b16 a[108:109], v228 offset:6144
    ds_read_b64_tr_b16 a[110:111], v228 offset:7168
    v_fma_f32 v213, -v174, v215, v174
    v_fma_f32 v214, -v175, v216, v175
    v_cvt_pk_bf16_f32 v217, v213, v214
    v_accvgpr_write_b32 a15, v217
    v_mfma_f32_32x32x16_bf16 v[192:207], a[120:123], v[120:123], v[192:207]
    ds_read_b64_tr_b16 a[112:113], v228 offset:8192
    ds_read_b64_tr_b16 a[114:115], v228 offset:9216
    ds_read_b128 v[172:175], v236 offset:624
    v_exp_f32 v208, v176
    v_exp_f32 v209, v177
    v_mfma_f32_32x32x16_bf16 v[192:207], a[124:127], v[124:127], v[192:207]
    ds_read_b64_tr_b16 a[116:117], v228 offset:10240
    ds_read_b64_tr_b16 a[118:119], v228 offset:11264
    buffer_load_dwordx4 v227, s[12:15], s79 offen offset:0 lds
    v_fma_f32 v210, v208, 0.5, 1.0
    v_fma_f32 v211, v209, 0.5, 1.0
    s_waitcnt lgkmcnt(13)
    v_mfma_f32_32x32x16_bf16 v[192:207], a[128:131], v[128:131], v[192:207]
    ds_read_b64_tr_b16 a[120:121], v228 offset:12288
    ds_read_b64_tr_b16 a[122:123], v228 offset:13312
    v_fma_f32 v210, v208, v210, 1.0
    v_fma_f32 v211, v209, v211, 1.0
    v_rcp_f32 v210, v210
    v_mfma_f32_32x32x16_bf16 v[192:207], a[132:135], v[132:135], v[192:207]
    ds_read_b64_tr_b16 a[124:125], v228 offset:14336
    ds_read_b64_tr_b16 a[126:127], v228 offset:15360
    v_rcp_f32 v211, v211
    v_fma_f32 v208, -v176, v210, v176
    v_fma_f32 v209, -v177, v211, v177
    v_mfma_f32_32x32x16_bf16 v[192:207], a[136:139], v[136:139], v[192:207]
    ds_read_b64_tr_b16 a[128:129], v228 offset:16384
    ds_read_b64_tr_b16 a[130:131], v228 offset:17408
    buffer_load_dwordx4 v227, s[12:15], s80 offen offset:1024 lds
    v_cvt_pk_bf16_f32 v212, v208, v209
    v_accvgpr_write_b32 a16, v212
    v_exp_f32 v213, v178
    v_mfma_f32_32x32x16_bf16 v[192:207], a[140:143], v[140:143], v[192:207]
    ds_read_b64_tr_b16 a[132:133], v228 offset:18432
    ds_read_b64_tr_b16 a[134:135], v228 offset:19456
    v_exp_f32 v214, v179
    v_fma_f32 v215, v213, 0.5, 1.0
    s_waitcnt lgkmcnt(13)
    v_mfma_f32_32x32x16_bf16 v[144:159], a[96:99], v[0:3], v[144:159]
    ds_read_b64_tr_b16 a[136:137], v228 offset:20480
    ds_read_b64_tr_b16 a[138:139], v228 offset:21504
    v_fma_f32 v216, v214, 0.5, 1.0
    v_fma_f32 v215, v213, v215, 1.0
    v_fma_f32 v216, v214, v216, 1.0
    v_rcp_f32 v215, v215
    v_mfma_f32_32x32x16_bf16 v[144:159], a[100:103], v[4:7], v[144:159]
    ds_read_b64_tr_b16 a[140:141], v228 offset:22528
    ds_read_b64_tr_b16 a[142:143], v228 offset:23552
    buffer_load_dwordx4 v227, s[12:15], s81 offen offset:2048 lds
    v_rcp_f32 v216, v216
    v_fma_f32 v213, -v178, v215, v178
    v_mfma_f32_32x32x16_bf16 v[144:159], a[104:107], v[8:11], v[144:159]
    ds_read_b64_tr_b16 a[96:97], v229 offset:0
    ds_read_b64_tr_b16 a[98:99], v229 offset:1024
    v_fma_f32 v214, -v179, v216, v179
    v_cvt_pk_bf16_f32 v217, v213, v214
    v_accvgpr_write_b32 a17, v217
    v_exp_f32 v208, v180
    v_mfma_f32_32x32x16_bf16 v[144:159], a[108:111], v[12:15], v[144:159]
    ds_read_b64_tr_b16 a[100:101], v229 offset:2048
    ds_read_b64_tr_b16 a[102:103], v229 offset:3072
    ds_read_b128 v[176:179], v236 offset:768
    v_exp_f32 v209, v181
    s_waitcnt lgkmcnt(13)
    v_mfma_f32_32x32x16_bf16 v[144:159], a[112:115], v[16:19], v[144:159]
    ds_read_b64_tr_b16 a[104:105], v229 offset:4096
    ds_read_b64_tr_b16 a[106:107], v229 offset:5120
    buffer_load_dwordx4 v227, s[12:15], s82 offen offset:3072 lds
    s_add_u32 m0, s34, 102400
    v_fma_f32 v210, v208, 0.5, 1.0
    v_fma_f32 v211, v209, 0.5, 1.0
    v_mfma_f32_32x32x16_bf16 v[144:159], a[116:119], v[20:23], v[144:159]
    ds_read_b64_tr_b16 a[108:109], v229 offset:6144
    ds_read_b64_tr_b16 a[110:111], v229 offset:7168
    v_fma_f32 v210, v208, v210, 1.0
    v_fma_f32 v211, v209, v211, 1.0
    v_rcp_f32 v210, v210
    v_mfma_f32_32x32x16_bf16 v[144:159], a[120:123], v[24:27], v[144:159]
    ds_read_b64_tr_b16 a[112:113], v229 offset:8192
    ds_read_b64_tr_b16 a[114:115], v229 offset:9216
    v_rcp_f32 v211, v211
    v_fma_f32 v208, -v180, v210, v180
    v_fma_f32 v209, -v181, v211, v181
    v_mfma_f32_32x32x16_bf16 v[144:159], a[124:127], v[28:31], v[144:159]
    ds_read_b64_tr_b16 a[116:117], v229 offset:10240
    ds_read_b64_tr_b16 a[118:119], v229 offset:11264
    buffer_load_dwordx4 v227, s[12:15], s83 offen offset:0 lds
    v_cvt_pk_bf16_f32 v212, v208, v209
    v_accvgpr_write_b32 a18, v212
    s_waitcnt lgkmcnt(13)
    v_mfma_f32_32x32x16_bf16 v[144:159], a[128:131], v[32:35], v[144:159]
    ds_read_b64_tr_b16 a[120:121], v229 offset:12288
    ds_read_b64_tr_b16 a[122:123], v229 offset:13312
    v_exp_f32 v213, v182
    v_exp_f32 v214, v183
    v_mfma_f32_32x32x16_bf16 v[144:159], a[132:135], v[36:39], v[144:159]
    ds_read_b64_tr_b16 a[124:125], v229 offset:14336
    ds_read_b64_tr_b16 a[126:127], v229 offset:15360
    v_fma_f32 v215, v213, 0.5, 1.0
    v_fma_f32 v216, v214, 0.5, 1.0
    v_fma_f32 v215, v213, v215, 1.0
    v_fma_f32 v216, v214, v216, 1.0
    v_mfma_f32_32x32x16_bf16 v[144:159], a[136:139], v[40:43], v[144:159]
    ds_read_b64_tr_b16 a[128:129], v229 offset:16384
    ds_read_b64_tr_b16 a[130:131], v229 offset:17408
    buffer_load_dwordx4 v227, s[12:15], s84 offen offset:1024 lds
    v_rcp_f32 v215, v215
    v_rcp_f32 v216, v216
    v_mfma_f32_32x32x16_bf16 v[144:159], a[140:143], v[44:47], v[144:159]
    ds_read_b64_tr_b16 a[132:133], v229 offset:18432
    ds_read_b64_tr_b16 a[134:135], v229 offset:19456
    v_fma_f32 v213, -v182, v215, v182
    v_fma_f32 v214, -v183, v216, v183
    v_cvt_pk_bf16_f32 v217, v213, v214
    s_waitcnt lgkmcnt(12)
    v_mfma_f32_32x32x16_bf16 v[160:175], a[96:99], v[0:3], v[160:175]
    ds_read_b64_tr_b16 a[136:137], v229 offset:20480
    ds_read_b64_tr_b16 a[138:139], v229 offset:21504
    v_accvgpr_write_b32 a19, v217
    v_exp_f32 v208, v184
    v_exp_f32 v209, v185
    v_mfma_f32_32x32x16_bf16 v[160:175], a[100:103], v[4:7], v[160:175]
    ds_read_b64_tr_b16 a[140:141], v229 offset:22528
    ds_read_b64_tr_b16 a[142:143], v229 offset:23552
    ds_read_b128 v[180:183], v236 offset:784
    v_fma_f32 v210, v208, 0.5, 1.0
    v_fma_f32 v211, v209, 0.5, 1.0
    v_fma_f32 v210, v208, v210, 1.0
    s_waitcnt vmcnt(19)
    s_barrier
    v_mfma_f32_32x32x16_bf16 v[160:175], a[104:107], v[8:11], v[160:175]
    ds_read_b64_tr_b16 a[96:97], v228 offset:24576
    ds_read_b64_tr_b16 a[98:99], v228 offset:25600
    s_add_u32 m0, s34, 122880
    s_add_u32 s4, s58, s67
    v_add_u32 v227, s4, v234
    v_fma_f32 v211, v209, v211, 1.0
    v_mfma_f32_32x32x16_bf16 v[160:175], a[108:111], v[12:15], v[160:175]
    ds_read_b64_tr_b16 a[100:101], v228 offset:26624
    ds_read_b64_tr_b16 a[102:103], v228 offset:27648
    v_rcp_f32 v210, v210
    v_rcp_f32 v211, v211
    s_waitcnt lgkmcnt(13)
    v_mfma_f32_32x32x16_bf16 v[160:175], a[112:115], v[16:19], v[160:175]
    ds_read_b64_tr_b16 a[104:105], v228 offset:28672
    ds_read_b64_tr_b16 a[106:107], v228 offset:29696
    v_fma_f32 v208, -v184, v210, v184
    v_fma_f32 v209, -v185, v211, v185
    v_cvt_pk_bf16_f32 v212, v208, v209
    v_accvgpr_write_b32 a20, v212
    v_mfma_f32_32x32x16_bf16 v[160:175], a[116:119], v[20:23], v[160:175]
    ds_read_b64_tr_b16 a[108:109], v228 offset:30720
    ds_read_b64_tr_b16 a[110:111], v228 offset:31744
    buffer_load_dwordx4 v227, s[12:15], s79 offen offset:0 lds
    v_exp_f32 v213, v186
    v_exp_f32 v214, v187
    v_mfma_f32_32x32x16_bf16 v[160:175], a[120:123], v[24:27], v[160:175]
    ds_read_b64_tr_b16 a[112:113], v228 offset:32768
    ds_read_b64_tr_b16 a[114:115], v228 offset:33792
    v_fma_f32 v215, v213, 0.5, 1.0
    v_fma_f32 v216, v214, 0.5, 1.0
    v_fma_f32 v215, v213, v215, 1.0
    v_fma_f32 v216, v214, v216, 1.0
    v_mfma_f32_32x32x16_bf16 v[160:175], a[124:127], v[28:31], v[160:175]
    ds_read_b64_tr_b16 a[116:117], v228 offset:34816
    ds_read_b64_tr_b16 a[118:119], v228 offset:35840
    v_rcp_f32 v215, v215
    v_rcp_f32 v216, v216
    s_waitcnt lgkmcnt(13)
    v_mfma_f32_32x32x16_bf16 v[160:175], a[128:131], v[32:35], v[160:175]
    ds_read_b64_tr_b16 a[120:121], v228 offset:36864
    ds_read_b64_tr_b16 a[122:123], v228 offset:37888
    buffer_load_dwordx4 v227, s[12:15], s80 offen offset:1024 lds
    v_fma_f32 v213, -v186, v215, v186
    v_fma_f32 v214, -v187, v216, v187
    v_cvt_pk_bf16_f32 v217, v213, v214
    v_mfma_f32_32x32x16_bf16 v[160:175], a[132:135], v[36:39], v[160:175]
    ds_read_b64_tr_b16 a[124:125], v228 offset:38912
    ds_read_b64_tr_b16 a[126:127], v228 offset:39936
    v_accvgpr_write_b32 a21, v217
    v_exp_f32 v208, v188
    v_exp_f32 v209, v189
    v_mfma_f32_32x32x16_bf16 v[160:175], a[136:139], v[40:43], v[160:175]
    ds_read_b64_tr_b16 a[128:129], v228 offset:40960
    ds_read_b64_tr_b16 a[130:131], v228 offset:41984
    ds_read_b128 v[184:187], v236 offset:800
    v_fma_f32 v210, v208, 0.5, 1.0
    v_fma_f32 v211, v209, 0.5, 1.0
    v_fma_f32 v210, v208, v210, 1.0
    v_mfma_f32_32x32x16_bf16 v[160:175], a[140:143], v[44:47], v[160:175]
    ds_read_b64_tr_b16 a[132:133], v228 offset:43008
    ds_read_b64_tr_b16 a[134:135], v228 offset:44032
    buffer_load_dwordx4 v227, s[12:15], s81 offen offset:2048 lds
    v_fma_f32 v211, v209, v211, 1.0
    v_rcp_f32 v210, v210
    s_waitcnt lgkmcnt(13)
    v_mfma_f32_32x32x16_bf16 v[144:159], a[96:99], v[48:51], v[144:159]
    ds_read_b64_tr_b16 a[136:137], v228 offset:45056
    ds_read_b64_tr_b16 a[138:139], v228 offset:46080
    v_rcp_f32 v211, v211
    v_fma_f32 v208, -v188, v210, v188
    v_fma_f32 v209, -v189, v211, v189
    v_mfma_f32_32x32x16_bf16 v[144:159], a[100:103], v[52:55], v[144:159]
    ds_read_b64_tr_b16 a[140:141], v228 offset:47104
    ds_read_b64_tr_b16 a[142:143], v228 offset:48128
    v_cvt_pk_bf16_f32 v212, v208, v209
    v_accvgpr_write_b32 a22, v212
    v_exp_f32 v213, v190
    v_mfma_f32_32x32x16_bf16 v[144:159], a[104:107], v[56:59], v[144:159]
    ds_read_b64_tr_b16 a[96:97], v229 offset:24576
    ds_read_b64_tr_b16 a[98:99], v229 offset:25600
    buffer_load_dwordx4 v227, s[12:15], s82 offen offset:3072 lds
    s_add_u32 m0, s34, 126976
    v_exp_f32 v214, v191
    v_mfma_f32_32x32x16_bf16 v[144:159], a[108:111], v[60:63], v[144:159]
    ds_read_b64_tr_b16 a[100:101], v229 offset:26624
    ds_read_b64_tr_b16 a[102:103], v229 offset:27648
    v_fma_f32 v215, v213, 0.5, 1.0
    v_fma_f32 v216, v214, 0.5, 1.0
    v_fma_f32 v215, v213, v215, 1.0
    s_waitcnt lgkmcnt(13)
    v_mfma_f32_32x32x16_bf16 v[144:159], a[112:115], v[64:67], v[144:159]
    ds_read_b64_tr_b16 a[104:105], v229 offset:28672
    ds_read_b64_tr_b16 a[106:107], v229 offset:29696
    v_fma_f32 v216, v214, v216, 1.0
    v_rcp_f32 v215, v215
    v_rcp_f32 v216, v216
    v_mfma_f32_32x32x16_bf16 v[144:159], a[116:119], v[68:71], v[144:159]
    ds_read_b64_tr_b16 a[108:109], v229 offset:30720
    ds_read_b64_tr_b16 a[110:111], v229 offset:31744
    buffer_load_dwordx4 v227, s[12:15], s83 offen offset:0 lds
    v_fma_f32 v213, -v190, v215, v190
    v_fma_f32 v214, -v191, v216, v191
    v_cvt_pk_bf16_f32 v217, v213, v214
    v_mfma_f32_32x32x16_bf16 v[144:159], a[120:123], v[72:75], v[144:159]
    ds_read_b64_tr_b16 a[112:113], v229 offset:32768
    ds_read_b64_tr_b16 a[114:115], v229 offset:33792
    v_accvgpr_write_b32 a23, v217
    v_exp_f32 v208, v192
    v_exp_f32 v209, v193
    v_mfma_f32_32x32x16_bf16 v[144:159], a[124:127], v[76:79], v[144:159]
    ds_read_b64_tr_b16 a[116:117], v229 offset:34816
    ds_read_b64_tr_b16 a[118:119], v229 offset:35840
    ds_read_b128 v[188:191], v236 offset:816
    v_fma_f32 v210, v208, 0.5, 1.0
    v_fma_f32 v211, v209, 0.5, 1.0
    s_waitcnt lgkmcnt(13)
    v_mfma_f32_32x32x16_bf16 v[144:159], a[128:131], v[80:83], v[144:159]
    ds_read_b64_tr_b16 a[120:121], v229 offset:36864
    ds_read_b64_tr_b16 a[122:123], v229 offset:37888
    buffer_load_dwordx4 v227, s[12:15], s84 offen offset:1024 lds
    v_fma_f32 v210, v208, v210, 1.0
    v_fma_f32 v211, v209, v211, 1.0
    v_rcp_f32 v210, v210
    v_mfma_f32_32x32x16_bf16 v[144:159], a[132:135], v[84:87], v[144:159]
    ds_read_b64_tr_b16 a[124:125], v229 offset:38912
    ds_read_b64_tr_b16 a[126:127], v229 offset:39936
    v_rcp_f32 v211, v211
    v_fma_f32 v208, -v192, v210, v192
    v_fma_f32 v209, -v193, v211, v193
    v_mfma_f32_32x32x16_bf16 v[144:159], a[136:139], v[88:91], v[144:159]
    ds_read_b64_tr_b16 a[128:129], v229 offset:40960
    ds_read_b64_tr_b16 a[130:131], v229 offset:41984
    buffer_load_dwordx4 a[180:183], v252, s[8:11], s70 offen
    v_cvt_pk_bf16_f32 v212, v208, v209
    v_accvgpr_write_b32 a24, v212
    v_exp_f32 v213, v194
    v_mfma_f32_32x32x16_bf16 v[144:159], a[140:143], v[92:95], v[144:159]
    ds_read_b64_tr_b16 a[132:133], v229 offset:43008
    ds_read_b64_tr_b16 a[134:135], v229 offset:44032
    v_exp_f32 v214, v195
    v_fma_f32 v215, v213, 0.5, 1.0
    s_waitcnt lgkmcnt(13)
    v_mfma_f32_32x32x16_bf16 v[160:175], a[96:99], v[48:51], v[160:175]
    ds_read_b64_tr_b16 a[136:137], v229 offset:45056
    ds_read_b64_tr_b16 a[138:139], v229 offset:46080
    v_fma_f32 v216, v214, 0.5, 1.0
    v_fma_f32 v215, v213, v215, 1.0
    v_fma_f32 v216, v214, v216, 1.0
    v_rcp_f32 v215, v215
    v_mfma_f32_32x32x16_bf16 v[160:175], a[100:103], v[52:55], v[160:175]
    ds_read_b64_tr_b16 a[140:141], v229 offset:47104
    ds_read_b64_tr_b16 a[142:143], v229 offset:48128
    v_rcp_f32 v216, v216
    v_fma_f32 v213, -v194, v215, v194
    v_fma_f32 v214, -v195, v216, v195
    s_waitcnt vmcnt(20)
    s_barrier
    v_mfma_f32_32x32x16_bf16 v[160:175], a[104:107], v[56:59], v[160:175]
    ds_read_b64_tr_b16 a[96:97], v230 offset:0
    ds_read_b64_tr_b16 a[98:99], v230 offset:1024
    s_add_u32 m0, s34, 0
    s_add_u32 s4, s56, s68
    v_add_u32 v227, s4, v234
    v_cvt_pk_bf16_f32 v217, v213, v214
    v_mfma_f32_32x32x16_bf16 v[160:175], a[108:111], v[60:63], v[160:175]
    ds_read_b64_tr_b16 a[100:101], v230 offset:2048
    ds_read_b64_tr_b16 a[102:103], v230 offset:3072
    v_accvgpr_write_b32 a25, v217
    v_exp_f32 v208, v196
    s_waitcnt lgkmcnt(12)
    v_mfma_f32_32x32x16_bf16 v[160:175], a[112:115], v[64:67], v[160:175]
    ds_read_b64_tr_b16 a[104:105], v230 offset:4096
    ds_read_b64_tr_b16 a[106:107], v230 offset:5120
    ds_read_b128 v[192:195], v236 offset:832
    v_exp_f32 v209, v197
    v_fma_f32 v210, v208, 0.5, 1.0
    v_mfma_f32_32x32x16_bf16 v[160:175], a[116:119], v[68:71], v[160:175]
    ds_read_b64_tr_b16 a[108:109], v230 offset:6144
    ds_read_b64_tr_b16 a[110:111], v230 offset:7168
    buffer_load_dwordx4 v227, s[12:15], s79 offen offset:0 lds
    v_fma_f32 v211, v209, 0.5, 1.0
    v_fma_f32 v210, v208, v210, 1.0
    v_fma_f32 v211, v209, v211, 1.0
    v_mfma_f32_32x32x16_bf16 v[160:175], a[120:123], v[72:75], v[160:175]
    ds_read_b64_tr_b16 a[112:113], v230 offset:8192
    ds_read_b64_tr_b16 a[114:115], v230 offset:9216
    v_rcp_f32 v210, v210
    v_rcp_f32 v211, v211
    v_mfma_f32_32x32x16_bf16 v[160:175], a[124:127], v[76:79], v[160:175]
    ds_read_b64_tr_b16 a[116:117], v230 offset:10240
    ds_read_b64_tr_b16 a[118:119], v230 offset:11264
    v_fma_f32 v208, -v196, v210, v196
    v_fma_f32 v209, -v197, v211, v197
    v_cvt_pk_bf16_f32 v212, v208, v209
    s_waitcnt lgkmcnt(13)
    v_mfma_f32_32x32x16_bf16 v[160:175], a[128:131], v[80:83], v[160:175]
    ds_read_b64_tr_b16 a[120:121], v230 offset:12288
    ds_read_b64_tr_b16 a[122:123], v230 offset:13312
    buffer_load_dwordx4 v227, s[12:15], s80 offen offset:1024 lds
    v_accvgpr_write_b32 a26, v212
    v_exp_f32 v213, v198
    v_mfma_f32_32x32x16_bf16 v[160:175], a[132:135], v[84:87], v[160:175]
    ds_read_b64_tr_b16 a[124:125], v230 offset:14336
    ds_read_b64_tr_b16 a[126:127], v230 offset:15360
    v_exp_f32 v214, v199
    v_fma_f32 v215, v213, 0.5, 1.0
    v_fma_f32 v216, v214, 0.5, 1.0
    v_mfma_f32_32x32x16_bf16 v[160:175], a[136:139], v[88:91], v[160:175]
    ds_read_b64_tr_b16 a[128:129], v230 offset:16384
    ds_read_b64_tr_b16 a[130:131], v230 offset:17408
    v_fma_f32 v215, v213, v215, 1.0
    v_fma_f32 v216, v214, v216, 1.0
    v_rcp_f32 v215, v215
    v_mfma_f32_32x32x16_bf16 v[160:175], a[140:143], v[92:95], v[160:175]
    ds_read_b64_tr_b16 a[132:133], v230 offset:18432
    ds_read_b64_tr_b16 a[134:135], v230 offset:19456
    buffer_load_dwordx4 v227, s[12:15], s81 offen offset:2048 lds
    v_rcp_f32 v216, v216
    s_waitcnt lgkmcnt(12)
    v_mfma_f32_32x32x16_bf16 v[144:159], a[96:99], v[96:99], v[144:159]
    ds_read_b64_tr_b16 a[136:137], v230 offset:20480
    ds_read_b64_tr_b16 a[138:139], v230 offset:21504
    v_fma_f32 v213, -v198, v215, v198
    v_fma_f32 v214, -v199, v216, v199
    v_cvt_pk_bf16_f32 v217, v213, v214
    v_accvgpr_write_b32 a27, v217
    v_mfma_f32_32x32x16_bf16 v[144:159], a[100:103], v[100:103], v[144:159]
    ds_read_b64_tr_b16 a[140:141], v230 offset:22528
    ds_read_b64_tr_b16 a[142:143], v230 offset:23552
    ds_read_b128 v[196:199], v236 offset:848
    v_exp_f32 v208, v200
    v_exp_f32 v209, v201
    v_mfma_f32_32x32x16_bf16 v[144:159], a[104:107], v[104:107], v[144:159]
    ds_read_b64_tr_b16 a[96:97], v231 offset:0
    ds_read_b64_tr_b16 a[98:99], v231 offset:1024
    buffer_load_dwordx4 v227, s[12:15], s82 offen offset:3072 lds
    s_add_u32 m0, s34, 4096
    v_fma_f32 v210, v208, 0.5, 1.0
    v_fma_f32 v211, v209, 0.5, 1.0
    v_mfma_f32_32x32x16_bf16 v[144:159], a[108:111], v[108:111], v[144:159]
    ds_read_b64_tr_b16 a[100:101], v231 offset:2048
    ds_read_b64_tr_b16 a[102:103], v231 offset:3072
    v_fma_f32 v210, v208, v210, 1.0
    v_fma_f32 v211, v209, v211, 1.0
    v_rcp_f32 v210, v210
    s_waitcnt lgkmcnt(13)
    v_mfma_f32_32x32x16_bf16 v[144:159], a[112:115], v[112:115], v[144:159]
    ds_read_b64_tr_b16 a[104:105], v231 offset:4096
    ds_read_b64_tr_b16 a[106:107], v231 offset:5120
    v_rcp_f32 v211, v211
    v_fma_f32 v208, -v200, v210, v200
    v_fma_f32 v209, -v201, v211, v201
    v_mfma_f32_32x32x16_bf16 v[144:159], a[116:119], v[116:119], v[144:159]
    ds_read_b64_tr_b16 a[108:109], v231 offset:6144
    ds_read_b64_tr_b16 a[110:111], v231 offset:7168
    buffer_load_dwordx4 v227, s[12:15], s83 offen offset:0 lds
    v_cvt_pk_bf16_f32 v212, v208, v209
    v_accvgpr_write_b32 a28, v212
    v_exp_f32 v213, v202
    v_mfma_f32_32x32x16_bf16 v[144:159], a[120:123], v[120:123], v[144:159]
    ds_read_b64_tr_b16 a[112:113], v231 offset:8192
    ds_read_b64_tr_b16 a[114:115], v231 offset:9216
    v_exp_f32 v214, v203
    v_fma_f32 v215, v213, 0.5, 1.0
    v_fma_f32 v216, v214, 0.5, 1.0
    v_mfma_f32_32x32x16_bf16 v[144:159], a[124:127], v[124:127], v[144:159]
    ds_read_b64_tr_b16 a[116:117], v231 offset:10240
    ds_read_b64_tr_b16 a[118:119], v231 offset:11264
    v_fma_f32 v215, v213, v215, 1.0
    v_fma_f32 v216, v214, v216, 1.0
    v_rcp_f32 v215, v215
    s_waitcnt lgkmcnt(13)
    v_mfma_f32_32x32x16_bf16 v[144:159], a[128:131], v[128:131], v[144:159]
    ds_read_b64_tr_b16 a[120:121], v231 offset:12288
    ds_read_b64_tr_b16 a[122:123], v231 offset:13312
    buffer_load_dwordx4 v227, s[12:15], s84 offen offset:1024 lds
    v_rcp_f32 v216, v216
    v_fma_f32 v213, -v202, v215, v202
    v_mfma_f32_32x32x16_bf16 v[144:159], a[132:135], v[132:135], v[144:159]
    ds_read_b64_tr_b16 a[124:125], v231 offset:14336
    ds_read_b64_tr_b16 a[126:127], v231 offset:15360
    v_fma_f32 v214, -v203, v216, v203
    v_cvt_pk_bf16_f32 v217, v213, v214
    v_accvgpr_write_b32 a29, v217
    v_exp_f32 v208, v204
    v_mfma_f32_32x32x16_bf16 v[144:159], a[136:139], v[136:139], v[144:159]
    ds_read_b64_tr_b16 a[128:129], v231 offset:16384
    ds_read_b64_tr_b16 a[130:131], v231 offset:17408
    buffer_load_dwordx4 a[184:187], v252, s[8:11], s71 offen
    v_exp_f32 v209, v205
    v_fma_f32 v210, v208, 0.5, 1.0
    v_mfma_f32_32x32x16_bf16 v[144:159], a[140:143], v[140:143], v[144:159]
    ds_read_b64_tr_b16 a[132:133], v231 offset:18432
    ds_read_b64_tr_b16 a[134:135], v231 offset:19456
    ds_read_b128 v[200:203], v236 offset:864
    v_fma_f32 v211, v209, 0.5, 1.0
    v_fma_f32 v210, v208, v210, 1.0
    s_waitcnt lgkmcnt(13)
    v_mfma_f32_32x32x16_bf16 v[160:175], a[96:99], v[96:99], v[160:175]
    ds_read_b64_tr_b16 a[136:137], v231 offset:20480
    ds_read_b64_tr_b16 a[138:139], v231 offset:21504
    v_fma_f32 v211, v209, v211, 1.0
    v_rcp_f32 v210, v210
    v_rcp_f32 v211, v211
    v_mfma_f32_32x32x16_bf16 v[160:175], a[100:103], v[100:103], v[160:175]
    ds_read_b64_tr_b16 a[140:141], v231 offset:22528
    ds_read_b64_tr_b16 a[142:143], v231 offset:23552
    v_fma_f32 v208, -v204, v210, v204
    v_fma_f32 v209, -v205, v211, v205
    v_cvt_pk_bf16_f32 v212, v208, v209
    v_accvgpr_write_b32 a30, v212
    s_waitcnt vmcnt(20)
    s_barrier
    v_mfma_f32_32x32x16_bf16 v[160:175], a[104:107], v[104:107], v[160:175]
    ds_read_b64_tr_b16 a[96:97], v230 offset:24576
    ds_read_b64_tr_b16 a[98:99], v230 offset:25600
    s_add_u32 m0, s34, 24576
    s_add_u32 s4, s57, s68
    v_add_u32 v227, s4, v234
    v_exp_f32 v213, v206
    v_mfma_f32_32x32x16_bf16 v[160:175], a[108:111], v[108:111], v[160:175]
    ds_read_b64_tr_b16 a[100:101], v230 offset:26624
    ds_read_b64_tr_b16 a[102:103], v230 offset:27648
    v_exp_f32 v214, v207
    v_fma_f32 v215, v213, 0.5, 1.0
    s_waitcnt lgkmcnt(13)
    v_mfma_f32_32x32x16_bf16 v[160:175], a[112:115], v[112:115], v[160:175]
    ds_read_b64_tr_b16 a[104:105], v230 offset:28672
    ds_read_b64_tr_b16 a[106:107], v230 offset:29696
    v_fma_f32 v216, v214, 0.5, 1.0
    v_fma_f32 v215, v213, v215, 1.0
    v_fma_f32 v216, v214, v216, 1.0
    v_rcp_f32 v215, v215
L_sm4:
    s_cbranch_execz L_retm
    v_mfma_f32_32x32x16_bf16 v[160:175], a[116:119], v[116:119], v[160:175]
    ds_read_b64_tr_b16 a[108:109], v230 offset:30720
    ds_read_b64_tr_b16 a[110:111], v230 offset:31744
    buffer_load_dwordx4 v227, s[12:15], s79 offen offset:0 lds
    v_rcp_f32 v216, v216
    v_fma_f32 v213, -v206, v215, v206
    v_mfma_f32_32x32x16_bf16 v[160:175], a[120:123], v[120:123], v[160:175]
    ds_read_b64_tr_b16 a[112:113], v230 offset:32768
    ds_read_b64_tr_b16 a[114:115], v230 offset:33792
    v_fma_f32 v214, -v207, v216, v207
    v_cvt_pk_bf16_f32 v217, v213, v214
    v_accvgpr_write_b32 a31, v217
    v_exp_f32 v208, v144
    v_mfma_f32_32x32x16_bf16 v[160:175], a[124:127], v[124:127], v[160:175]
    ds_read_b64_tr_b16 a[116:117], v230 offset:34816
    ds_read_b64_tr_b16 a[118:119], v230 offset:35840
    ds_read_b128 v[204:207], v236 offset:880
    v_exp_f32 v209, v145
    s_waitcnt lgkmcnt(13)
    v_mfma_f32_32x32x16_bf16 v[160:175], a[128:131], v[128:131], v[160:175]
    ds_read_b64_tr_b16 a[120:121], v230 offset:36864
    ds_read_b64_tr_b16 a[122:123], v230 offset:37888
    buffer_load_dwordx4 v227, s[12:15], s80 offen offset:1024 lds
    v_fma_f32 v210, v208, 0.5, 1.0
    v_fma_f32 v211, v209, 0.5, 1.0
    v_fma_f32 v210, v208, v210, 1.0
    v_mfma_f32_32x32x16_bf16 v[160:175], a[132:135], v[132:135], v[160:175]
    ds_read_b64_tr_b16 a[124:125], v230 offset:38912
    ds_read_b64_tr_b16 a[126:127], v230 offset:39936
    v_fma_f32 v211, v209, v211, 1.0
    v_rcp_f32 v210, v210
    v_rcp_f32 v211, v211
    v_mfma_f32_32x32x16_bf16 v[160:175], a[136:139], v[136:139], v[160:175]
    ds_read_b64_tr_b16 a[128:129], v230 offset:40960
    ds_read_b64_tr_b16 a[130:131], v230 offset:41984
    v_fma_f32 v208, -v144, v210, v144
    v_fma_f32 v209, -v145, v211, v145
    v_cvt_pk_bf16_f32 v212, v208, v209
    v_accvgpr_write_b32 a32, v212
    v_mfma_f32_32x32x16_bf16 v[160:175], a[140:143], v[140:143], v[160:175]
    ds_read_b64_tr_b16 a[132:133], v230 offset:43008
    ds_read_b64_tr_b16 a[134:135], v230 offset:44032
    buffer_load_dwordx4 v227, s[12:15], s81 offen offset:2048 lds
    v_exp_f32 v213, v146
    s_waitcnt lgkmcnt(13)
    v_mfma_f32_32x32x16_bf16 v[176:191], a[96:99], v[0:3], v[176:191]
    ds_read_b64_tr_b16 a[136:137], v230 offset:45056
    ds_read_b64_tr_b16 a[138:139], v230 offset:46080
    v_exp_f32 v214, v147
    v_fma_f32 v215, v213, 0.5, 1.0
    v_fma_f32 v216, v214, 0.5, 1.0
    v_mfma_f32_32x32x16_bf16 v[176:191], a[100:103], v[4:7], v[176:191]
    ds_read_b64_tr_b16 a[140:141], v230 offset:47104
    ds_read_b64_tr_b16 a[142:143], v230 offset:48128
    v_fma_f32 v215, v213, v215, 1.0
    v_fma_f32 v216, v214, v216, 1.0
    v_rcp_f32 v215, v215
    v_mfma_f32_32x32x16_bf16 v[176:191], a[104:107], v[8:11], v[176:191]
    ds_read_b64_tr_b16 a[96:97], v231 offset:24576
    ds_read_b64_tr_b16 a[98:99], v231 offset:25600
    buffer_load_dwordx4 v227, s[12:15], s82 offen offset:3072 lds
    s_add_u32 m0, s34, 28672
    v_rcp_f32 v216, v216
    v_mfma_f32_32x32x16_bf16 v[176:191], a[108:111], v[12:15], v[176:191]
    ds_read_b64_tr_b16 a[100:101], v231 offset:26624
    ds_read_b64_tr_b16 a[102:103], v231 offset:27648
    v_fma_f32 v213, -v146, v215, v146
    v_fma_f32 v214, -v147, v216, v147
    v_cvt_pk_bf16_f32 v217, v213, v214
    s_waitcnt lgkmcnt(12)
    v_mfma_f32_32x32x16_bf16 v[176:191], a[112:115], v[16:19], v[176:191]
    ds_read_b64_tr_b16 a[104:105], v231 offset:28672
    ds_read_b64_tr_b16 a[106:107], v231 offset:29696
    v_accvgpr_write_b32 a33, v217
    v_exp_f32 v208, v148
    v_exp_f32 v209, v149
    v_mfma_f32_32x32x16_bf16 v[176:191], a[116:119], v[20:23], v[176:191]
    ds_read_b64_tr_b16 a[108:109], v231 offset:30720
    ds_read_b64_tr_b16 a[110:111], v231 offset:31744
    ds_read_b128 v[144:147], v236 offset:1024
    v_fma_f32 v210, v208, 0.5, 1.0
    v_fma_f32 v211, v209, 0.5, 1.0
    v_fma_f32 v210, v208, v210, 1.0
    v_mfma_f32_32x32x16_bf16 v[176:191], a[120:123], v[24:27], v[176:191]
    ds_read_b64_tr_b16 a[112:113], v231 offset:32768
    ds_read_b64_tr_b16 a[114:115], v231 offset:33792
    buffer_load_dwordx4 v227, s[12:15], s83 offen offset:0 lds
    v_fma_f32 v211, v209, v211, 1.0
    v_rcp_f32 v210, v210
    v_mfma_f32_32x32x16_bf16 v[176:191], a[124:127], v[28:31], v[176:191]
    ds_read_b64_tr_b16 a[116:117], v231 offset:34816
    ds_read_b64_tr_b16 a[118:119], v231 offset:35840
    v_rcp_f32 v211, v211
    v_fma_f32 v208, -v148, v210, v148
    s_waitcnt lgkmcnt(13)
    v_mfma_f32_32x32x16_bf16 v[176:191], a[128:131], v[32:35], v[176:191]
    ds_read_b64_tr_b16 a[120:121], v231 offset:36864
    ds_read_b64_tr_b16 a[122:123], v231 offset:37888
    buffer_load_dwordx4 v227, s[12:15], s84 offen offset:1024 lds
    v_fma_f32 v209, -v149, v211, v149
    v_cvt_pk_bf16_f32 v212, v208, v209
    v_accvgpr_write_b32 a34, v212
    v_mfma_f32_32x32x16_bf16 v[176:191], a[132:135], v[36:39], v[176:191]
    ds_read_b64_tr_b16 a[124:125], v231 offset:38912
    ds_read_b64_tr_b16 a[126:127], v231 offset:39936
    v_exp_f32 v213, v150
    v_exp_f32 v214, v151
    v_mfma_f32_32x32x16_bf16 v[176:191], a[136:139], v[40:43], v[176:191]
    ds_read_b64_tr_b16 a[128:129], v231 offset:40960
    ds_read_b64_tr_b16 a[130:131], v231 offset:41984
    buffer_load_dwordx4 a[188:191], v252, s[8:11], s72 offen
    v_fma_f32 v215, v213, 0.5, 1.0
    v_fma_f32 v216, v214, 0.5, 1.0
    v_fma_f32 v215, v213, v215, 1.0
    v_mfma_f32_32x32x16_bf16 v[176:191], a[140:143], v[44:47], v[176:191]
    ds_read_b64_tr_b16 a[132:133], v231 offset:43008
    ds_read_b64_tr_b16 a[134:135], v231 offset:44032
    v_fma_f32 v216, v214, v216, 1.0
    v_rcp_f32 v215, v215
    s_waitcnt lgkmcnt(13)
    v_mfma_f32_32x32x16_bf16 v[192:207], a[96:99], v[0:3], v[192:207]
    ds_read_b64_tr_b16 a[136:137], v231 offset:45056
    ds_read_b64_tr_b16 a[138:139], v231 offset:46080
    v_rcp_f32 v216, v216
    v_fma_f32 v213, -v150, v215, v150
    v_fma_f32 v214, -v151, v216, v151
    v_mfma_f32_32x32x16_bf16 v[192:207], a[100:103], v[4:7], v[192:207]
    ds_read_b64_tr_b16 a[140:141], v231 offset:47104
    ds_read_b64_tr_b16 a[142:143], v231 offset:48128
    v_cvt_pk_bf16_f32 v217, v213, v214
    v_accvgpr_write_b32 a35, v217
    v_exp_f32 v208, v152
    s_waitcnt vmcnt(21)
    s_barrier
    v_mfma_f32_32x32x16_bf16 v[192:207], a[104:107], v[8:11], v[192:207]
    ds_read_b64_tr_b16 a[96:97], v232 offset:0
    ds_read_b64_tr_b16 a[98:99], v232 offset:1024
    ds_read_b128 v[148:151], v236 offset:1040
    v_exp_f32 v209, v153
    v_fma_f32 v210, v208, 0.5, 1.0
    v_mfma_f32_32x32x16_bf16 v[192:207], a[108:111], v[12:15], v[192:207]
    ds_read_b64_tr_b16 a[100:101], v232 offset:2048
    ds_read_b64_tr_b16 a[102:103], v232 offset:3072
    s_add_u32 m0, s34, 49152
    s_add_u32 s4, s58, s68
    v_add_u32 v227, s4, v234
    s_waitcnt lgkmcnt(13)
    v_mfma_f32_32x32x16_bf16 v[192:207], a[112:115], v[16:19], v[192:207]
    ds_read_b64_tr_b16 a[104:105], v232 offset:4096
    ds_read_b64_tr_b16 a[106:107], v232 offset:5120
    v_fma_f32 v211, v209, 0.5, 1.0
    v_fma_f32 v210, v208, v210, 1.0
    v_fma_f32 v211, v209, v211, 1.0
    v_rcp_f32 v210, v210
    v_mfma_f32_32x32x16_bf16 v[192:207], a[116:119], v[20:23], v[192:207]
    ds_read_b64_tr_b16 a[108:109], v232 offset:6144
    ds_read_b64_tr_b16 a[110:111], v232 offset:7168
    buffer_load_dwordx4 v227, s[12:15], s79 offen offset:0 lds
    v_rcp_f32 v211, v211
    v_fma_f32 v208, -v152, v210, v152
    v_mfma_f32_32x32x16_bf16 v[192:207], a[120:123], v[24:27], v[192:207]
    ds_read_b64_tr_b16 a[112:113], v232 offset:8192
    ds_read_b64_tr_b16 a[114:115], v232 offset:9216
    v_fma_f32 v209, -v153, v211, v153
    v_cvt_pk_bf16_f32 v212, v208, v209
    v_accvgpr_write_b32 a36, v212
    v_exp_f32 v213, v154
    v_mfma_f32_32x32x16_bf16 v[192:207], a[124:127], v[28:31], v[192:207]
    ds_read_b64_tr_b16 a[116:117], v232 offset:10240
    ds_read_b64_tr_b16 a[118:119], v232 offset:11264
    v_exp_f32 v214, v155
    v_fma_f32 v215, v213, 0.5, 1.0
    s_waitcnt lgkmcnt(13)
    v_mfma_f32_32x32x16_bf16 v[192:207], a[128:131], v[32:35], v[192:207]
    ds_read_b64_tr_b16 a[120:121], v232 offset:12288
    ds_read_b64_tr_b16 a[122:123], v232 offset:13312
    buffer_load_dwordx4 v227, s[12:15], s80 offen offset:1024 lds
    v_fma_f32 v216, v214, 0.5, 1.0
    v_fma_f32 v215, v213, v215, 1.0
    v_fma_f32 v216, v214, v216, 1.0
    v_mfma_f32_32x32x16_bf16 v[192:207], a[132:135], v[36:39], v[192:207]
    ds_read_b64_tr_b16 a[124:125], v232 offset:14336
    ds_read_b64_tr_b16 a[126:127], v232 offset:15360
    v_rcp_f32 v215, v215
    v_rcp_f32 v216, v216
    v_mfma_f32_32x32x16_bf16 v[192:207], a[136:139], v[40:43], v[192:207]
    ds_read_b64_tr_b16 a[128:129], v232 offset:16384
    ds_read_b64_tr_b16 a[130:131], v232 offset:17408
    v_fma_f32 v213, -v154, v215, v154
    v_fma_f32 v214, -v155, v216, v155
    v_cvt_pk_bf16_f32 v217, v213, v214
    v_accvgpr_write_b32 a37, v217
    v_mfma_f32_32x32x16_bf16 v[192:207], a[140:143], v[44:47], v[192:207]
    ds_read_b64_tr_b16 a[132:133], v232 offset:18432
    ds_read_b64_tr_b16 a[134:135], v232 offset:19456
    ds_read_b128 v[152:155], v236 offset:1056
    v_exp_f32 v208, v156
    s_waitcnt lgkmcnt(13)
    v_mfma_f32_32x32x16_bf16 v[176:191], a[96:99], v[48:51], v[176:191]
    ds_read_b64_tr_b16 a[136:137], v232 offset:20480
    ds_read_b64_tr_b16 a[138:139], v232 offset:21504
    buffer_load_dwordx4 v227, s[12:15], s81 offen offset:2048 lds
    v_exp_f32 v209, v157
    v_fma_f32 v210, v208, 0.5, 1.0
    v_mfma_f32_32x32x16_bf16 v[176:191], a[100:103], v[52:55], v[176:191]
    ds_read_b64_tr_b16 a[140:141], v232 offset:22528
    ds_read_b64_tr_b16 a[142:143], v232 offset:23552
    v_fma_f32 v211, v209, 0.5, 1.0
    v_fma_f32 v210, v208, v210, 1.0
    v_fma_f32 v211, v209, v211, 1.0
    v_rcp_f32 v210, v210
    v_mfma_f32_32x32x16_bf16 v[176:191], a[104:107], v[56:59], v[176:191]
    ds_read_b64_tr_b16 a[96:97], v233 offset:0
    ds_read_b64_tr_b16 a[98:99], v233 offset:1024
    buffer_load_dwordx4 v227, s[12:15], s82 offen offset:3072 lds
    s_add_u32 m0, s34, 53248
    v_rcp_f32 v211, v211
    v_mfma_f32_32x32x16_bf16 v[176:191], a[108:111], v[60:63], v[176:191]
    ds_read_b64_tr_b16 a[100:101], v233 offset:2048
    ds_read_b64_tr_b16 a[102:103], v233 offset:3072
    v_fma_f32 v208, -v156, v210, v156
    v_fma_f32 v209, -v157, v211, v157
    v_cvt_pk_bf16_f32 v212, v208, v209
    s_waitcnt lgkmcnt(13)
    v_mfma_f32_32x32x16_bf16 v[176:191], a[112:115], v[64:67], v[176:191]
    ds_read_b64_tr_b16 a[104:105], v233 offset:4096
    ds_read_b64_tr_b16 a[106:107], v233 offset:5120
    v_accvgpr_write_b32 a38, v212
    v_exp_f32 v213, v158
    v_exp_f32 v214, v159
    v_mfma_f32_32x32x16_bf16 v[176:191], a[116:119], v[68:71], v[176:191]
    ds_read_b64_tr_b16 a[108:109], v233 offset:6144
    ds_read_b64_tr_b16 a[110:111], v233 offset:7168
    buffer_load_dwordx4 v227, s[12:15], s83 offen offset:0 lds
    v_fma_f32 v215, v213, 0.5, 1.0
    v_fma_f32 v216, v214, 0.5, 1.0
    v_fma_f32 v215, v213, v215, 1.0
    v_mfma_f32_32x32x16_bf16 v[176:191], a[120:123], v[72:75], v[176:191]
    ds_read_b64_tr_b16 a[112:113], v233 offset:8192
    ds_read_b64_tr_b16 a[114:115], v233 offset:9216
    v_fma_f32 v216, v214, v216, 1.0
    v_rcp_f32 v215, v215
    v_rcp_f32 v216, v216
    v_mfma_f32_32x32x16_bf16 v[176:191], a[124:127], v[76:79], v[176:191]
    ds_read_b64_tr_b16 a[116:117], v233 offset:10240
    ds_read_b64_tr_b16 a[118:119], v233 offset:11264
    v_fma_f32 v213, -v158, v215, v158
    v_fma_f32 v214, -v159, v216, v159
    v_cvt_pk_bf16_f32 v217, v213, v214
    s_waitcnt lgkmcnt(12)
    v_mfma_f32_32x32x16_bf16 v[176:191], a[128:131], v[80:83], v[176:191]
    ds_read_b64_tr_b16 a[120:121], v233 offset:12288
    ds_read_b64_tr_b16 a[122:123], v233 offset:13312
    buffer_load_dwordx4 v227, s[12:15], s84 offen offset:1024 lds
    v_accvgpr_write_b32 a39, v217
    v_exp_f32 v208, v160
    v_mfma_f32_32x32x16_bf16 v[176:191], a[132:135], v[84:87], v[176:191]
    ds_read_b64_tr_b16 a[124:125], v233 offset:14336
    ds_read_b64_tr_b16 a[126:127], v233 offset:15360
    ds_read_b128 v[156:159], v236 offset:1072
    v_exp_f32 v209, v161
    v_fma_f32 v210, v208, 0.5, 1.0
    v_mfma_f32_32x32x16_bf16 v[176:191], a[136:139], v[88:91], v[176:191]
    ds_read_b64_tr_b16 a[128:129], v233 offset:16384
    ds_read_b64_tr_b16 a[130:131], v233 offset:17408
    v_fma_f32 v211, v209, 0.5, 1.0
    v_fma_f32 v210, v208, v210, 1.0
    v_fma_f32 v211, v209, v211, 1.0
    v_rcp_f32 v210, v210
    v_mfma_f32_32x32x16_bf16 v[176:191], a[140:143], v[92:95], v[176:191]
    ds_read_b64_tr_b16 a[132:133], v233 offset:18432
    ds_read_b64_tr_b16 a[134:135], v233 offset:19456
    v_rcp_f32 v211, v211
    v_fma_f32 v208, -v160, v210, v160
    s_waitcnt lgkmcnt(13)
    v_mfma_f32_32x32x16_bf16 v[192:207], a[96:99], v[48:51], v[192:207]
    ds_read_b64_tr_b16 a[136:137], v233 offset:20480
    ds_read_b64_tr_b16 a[138:139], v233 offset:21504
    v_fma_f32 v209, -v161, v211, v161
    v_cvt_pk_bf16_f32 v212, v208, v209
    v_accvgpr_write_b32 a40, v212
    v_exp_f32 v213, v162
    v_mfma_f32_32x32x16_bf16 v[192:207], a[100:103], v[52:55], v[192:207]
    ds_read_b64_tr_b16 a[140:141], v233 offset:22528
    ds_read_b64_tr_b16 a[142:143], v233 offset:23552
    v_exp_f32 v214, v163
    v_fma_f32 v215, v213, 0.5, 1.0
    v_fma_f32 v216, v214, 0.5, 1.0
    s_waitcnt vmcnt(21)
    s_barrier
    v_mfma_f32_32x32x16_bf16 v[192:207], a[104:107], v[56:59], v[192:207]
    ds_read_b64_tr_b16 a[96:97], v232 offset:24576
    ds_read_b64_tr_b16 a[98:99], v232 offset:25600
    s_add_u32 m0, s34, 73728
    s_add_u32 s4, s56, s69
    v_add_u32 v227, s4, v234
    v_fma_f32 v215, v213, v215, 1.0
    v_mfma_f32_32x32x16_bf16 v[192:207], a[108:111], v[60:63], v[192:207]
    ds_read_b64_tr_b16 a[100:101], v232 offset:26624
    ds_read_b64_tr_b16 a[102:103], v232 offset:27648
    v_fma_f32 v216, v214, v216, 1.0
    v_rcp_f32 v215, v215
    s_waitcnt lgkmcnt(13)
    v_mfma_f32_32x32x16_bf16 v[192:207], a[112:115], v[64:67], v[192:207]
    ds_read_b64_tr_b16 a[104:105], v232 offset:28672
    ds_read_b64_tr_b16 a[106:107], v232 offset:29696
    v_rcp_f32 v216, v216
    v_fma_f32 v213, -v162, v215, v162
    v_fma_f32 v214, -v163, v216, v163
    v_mfma_f32_32x32x16_bf16 v[192:207], a[116:119], v[68:71], v[192:207]
    ds_read_b64_tr_b16 a[108:109], v232 offset:30720
    ds_read_b64_tr_b16 a[110:111], v232 offset:31744
    buffer_load_dwordx4 v227, s[12:15], s79 offen offset:0 lds
    v_cvt_pk_bf16_f32 v217, v213, v214
    v_accvgpr_write_b32 a41, v217
    v_exp_f32 v208, v164
    v_mfma_f32_32x32x16_bf16 v[192:207], a[120:123], v[72:75], v[192:207]
    ds_read_b64_tr_b16 a[112:113], v232 offset:32768
    ds_read_b64_tr_b16 a[114:115], v232 offset:33792
    ds_read_b128 v[160:163], v236 offset:1088
    v_exp_f32 v209, v165
    v_fma_f32 v210, v208, 0.5, 1.0
    v_mfma_f32_32x32x16_bf16 v[192:207], a[124:127], v[76:79], v[192:207]
    ds_read_b64_tr_b16 a[116:117], v232 offset:34816
    ds_read_b64_tr_b16 a[118:119], v232 offset:35840
    v_fma_f32 v211, v209, 0.5, 1.0
    v_fma_f32 v210, v208, v210, 1.0
    v_fma_f32 v211, v209, v211, 1.0
    s_waitcnt lgkmcnt(13)
    v_mfma_f32_32x32x16_bf16 v[192:207], a[128:131], v[80:83], v[192:207]
    ds_read_b64_tr_b16 a[120:121], v232 offset:36864
    ds_read_b64_tr_b16 a[122:123], v232 offset:37888
    buffer_load_dwordx4 v227, s[12:15], s80 offen offset:1024 lds
    v_rcp_f32 v210, v210
    v_rcp_f32 v211, v211
    v_mfma_f32_32x32x16_bf16 v[192:207], a[132:135], v[84:87], v[192:207]
    ds_read_b64_tr_b16 a[124:125], v232 offset:38912
    ds_read_b64_tr_b16 a[126:127], v232 offset:39936
    v_fma_f32 v208, -v164, v210, v164
    v_fma_f32 v209, -v165, v211, v165
    v_cvt_pk_bf16_f32 v212, v208, v209
    v_accvgpr_write_b32 a42, v212
    v_mfma_f32_32x32x16_bf16 v[192:207], a[136:139], v[88:91], v[192:207]
    ds_read_b64_tr_b16 a[128:129], v232 offset:40960
    ds_read_b64_tr_b16 a[130:131], v232 offset:41984
    v_exp_f32 v213, v166
    v_exp_f32 v214, v167
    v_mfma_f32_32x32x16_bf16 v[192:207], a[140:143], v[92:95], v[192:207]
    ds_read_b64_tr_b16 a[132:133], v232 offset:43008
    ds_read_b64_tr_b16 a[134:135], v232 offset:44032
    buffer_load_dwordx4 v227, s[12:15], s81 offen offset:2048 lds
    v_fma_f32 v215, v213, 0.5, 1.0
    v_fma_f32 v216, v214, 0.5, 1.0
    s_waitcnt lgkmcnt(13)
    v_mfma_f32_32x32x16_bf16 v[176:191], a[96:99], v[96:99], v[176:191]
    ds_read_b64_tr_b16 a[136:137], v232 offset:45056
    ds_read_b64_tr_b16 a[138:139], v232 offset:46080
    v_fma_f32 v215, v213, v215, 1.0
    v_fma_f32 v216, v214, v216, 1.0
    v_rcp_f32 v215, v215
    v_mfma_f32_32x32x16_bf16 v[176:191], a[100:103], v[100:103], v[176:191]
    ds_read_b64_tr_b16 a[140:141], v232 offset:47104
    ds_read_b64_tr_b16 a[142:143], v232 offset:48128
    v_rcp_f32 v216, v216
    v_fma_f32 v213, -v166, v215, v166
    v_fma_f32 v214, -v167, v216, v167
    v_mfma_f32_32x32x16_bf16 v[176:191], a[104:107], v[104:107], v[176:191]
    ds_read_b64_tr_b16 a[96:97], v233 offset:24576
    ds_read_b64_tr_b16 a[98:99], v233 offset:25600
    buffer_load_dwordx4 v227, s[12:15], s82 offen offset:3072 lds
    s_add_u32 m0, s34, 77824
    v_cvt_pk_bf16_f32 v217, v213, v214
    v_accvgpr_write_b32 a43, v217
    v_mfma_f32_32x32x16_bf16 v[176:191], a[108:111], v[108:111], v[176:191]
    ds_read_b64_tr_b16 a[100:101], v233 offset:26624
    ds_read_b64_tr_b16 a[102:103], v233 offset:27648
    ds_read_b128 v[164:167], v236 offset:1104
    v_exp_f32 v208, v168
    s_waitcnt lgkmcnt(13)
    v_mfma_f32_32x32x16_bf16 v[176:191], a[112:115], v[112:115], v[176:191]
    ds_read_b64_tr_b16 a[104:105], v233 offset:28672
    ds_read_b64_tr_b16 a[106:107], v233 offset:29696
    v_exp_f32 v209, v169
    v_fma_f32 v210, v208, 0.5, 1.0
    v_fma_f32 v211, v209, 0.5, 1.0
    v_mfma_f32_32x32x16_bf16 v[176:191], a[116:119], v[116:119], v[176:191]
    ds_read_b64_tr_b16 a[108:109], v233 offset:30720
    ds_read_b64_tr_b16 a[110:111], v233 offset:31744
    buffer_load_dwordx4 v227, s[12:15], s83 offen offset:0 lds
    v_fma_f32 v210, v208, v210, 1.0
    v_fma_f32 v211, v209, v211, 1.0
    v_rcp_f32 v210, v210
    v_mfma_f32_32x32x16_bf16 v[176:191], a[120:123], v[120:123], v[176:191]
    ds_read_b64_tr_b16 a[112:113], v233 offset:32768
    ds_read_b64_tr_b16 a[114:115], v233 offset:33792
    v_rcp_f32 v211, v211
    v_fma_f32 v208, -v168, v210, v168
    v_fma_f32 v209, -v169, v211, v169
    v_mfma_f32_32x32x16_bf16 v[176:191], a[124:127], v[124:127], v[176:191]
    ds_read_b64_tr_b16 a[116:117], v233 offset:34816
    ds_read_b64_tr_b16 a[118:119], v233 offset:35840
    v_cvt_pk_bf16_f32 v212, v208, v209
    v_accvgpr_write_b32 a44, v212
    v_exp_f32 v213, v170
    s_waitcnt lgkmcnt(13)
    v_mfma_f32_32x32x16_bf16 v[176:191], a[128:131], v[128:131], v[176:191]
    ds_read_b64_tr_b16 a[120:121], v233 offset:36864
    ds_read_b64_tr_b16 a[122:123], v233 offset:37888
    buffer_load_dwordx4 v227, s[12:15], s84 offen offset:1024 lds
    v_exp_f32 v214, v171
    v_fma_f32 v215, v213, 0.5, 1.0
    v_mfma_f32_32x32x16_bf16 v[176:191], a[132:135], v[132:135], v[176:191]
    ds_read_b64_tr_b16 a[124:125], v233 offset:38912
    ds_read_b64_tr_b16 a[126:127], v233 offset:39936
    v_fma_f32 v216, v214, 0.5, 1.0
    v_fma_f32 v215, v213, v215, 1.0
    v_fma_f32 v216, v214, v216, 1.0
    v_rcp_f32 v215, v215
    v_mfma_f32_32x32x16_bf16 v[176:191], a[136:139], v[136:139], v[176:191]
    ds_read_b64_tr_b16 a[128:129], v233 offset:40960
    ds_read_b64_tr_b16 a[130:131], v233 offset:41984
    v_rcp_f32 v216, v216
    v_fma_f32 v213, -v170, v215, v170
    v_fma_f32 v214, -v171, v216, v171
    v_mfma_f32_32x32x16_bf16 v[176:191], a[140:143], v[140:143], v[176:191]
    ds_read_b64_tr_b16 a[132:133], v233 offset:43008
    ds_read_b64_tr_b16 a[134:135], v233 offset:44032
    v_cvt_pk_bf16_f32 v217, v213, v214
    v_accvgpr_write_b32 a45, v217
    v_exp_f32 v208, v172
    s_waitcnt lgkmcnt(12)
    v_mfma_f32_32x32x16_bf16 v[192:207], a[96:99], v[96:99], v[192:207]
    ds_read_b64_tr_b16 a[136:137], v233 offset:45056
    ds_read_b64_tr_b16 a[138:139], v233 offset:46080
    ds_read_b128 v[168:171], v236 offset:1120
    v_exp_f32 v209, v173
    v_fma_f32 v210, v208, 0.5, 1.0
    v_mfma_f32_32x32x16_bf16 v[192:207], a[100:103], v[100:103], v[192:207]
    ds_read_b64_tr_b16 a[140:141], v233 offset:47104
    ds_read_b64_tr_b16 a[142:143], v233 offset:48128
    v_fma_f32 v211, v209, 0.5, 1.0
    v_fma_f32 v210, v208, v210, 1.0
    v_fma_f32 v211, v209, v211, 1.0
    v_rcp_f32 v210, v210
    s_waitcnt vmcnt(20)
    s_barrier
    v_mfma_f32_32x32x16_bf16 v[192:207], a[104:107], v[104:107], v[192:207]
    ds_read_b64_tr_b16 a[96:97], v228 offset:0
    ds_read_b64_tr_b16 a[98:99], v228 offset:1024
    s_add_u32 m0, s34, 98304
    s_add_u32 s4, s57, s69
    v_add_u32 v227, s4, v234
    v_rcp_f32 v211, v211
    v_mfma_f32_32x32x16_bf16 v[192:207], a[108:111], v[108:111], v[192:207]
    ds_read_b64_tr_b16 a[100:101], v228 offset:2048
    ds_read_b64_tr_b16 a[102:103], v228 offset:3072
    v_fma_f32 v208, -v172, v210, v172
    v_fma_f32 v209, -v173, v211, v173
    v_cvt_pk_bf16_f32 v212, v208, v209
    s_waitcnt lgkmcnt(13)
    v_mfma_f32_32x32x16_bf16 v[192:207], a[112:115], v[112:115], v[192:207]
    ds_read_b64_tr_b16 a[104:105], v228 offset:4096
    ds_read_b64_tr_b16 a[106:107], v228 offset:5120
    v_accvgpr_write_b32 a46, v212
    v_exp_f32 v213, v174
    v_exp_f32 v214, v175
    v_mfma_f32_32x32x16_bf16 v[192:207], a[116:119], v[116:119], v[192:207]
    ds_read_b64_tr_b16 a[108:109], v228 offset:6144
    ds_read_b64_tr_b16 a[110:111], v228 offset:7168
    buffer_load_dwordx4 v227, s[12:15], s79 offen offset:0 lds
    v_fma_f32 v215, v213, 0.5, 1.0
    v_fma_f32 v216, v214, 0.5, 1.0
    v_fma_f32 v215, v213, v215, 1.0
    v_mfma_f32_32x32x16_bf16 v[192:207], a[120:123], v[120:123], v[192:207]
    ds_read_b64_tr_b16 a[112:113], v228 offset:8192
    ds_read_b64_tr_b16 a[114:115], v228 offset:9216
    v_fma_f32 v216, v214, v216, 1.0
    v_rcp_f32 v215, v215
    v_rcp_f32 v216, v216
    v_mfma_f32_32x32x16_bf16 v[192:207], a[124:127], v[124:127], v[192:207]
    ds_read_b64_tr_b16 a[116:117], v228 offset:10240
    ds_read_b64_tr_b16 a[118:119], v228 offset:11264
    v_fma_f32 v213, -v174, v215, v174
    v_fma_f32 v214, -v175, v216, v175
    v_cvt_pk_bf16_f32 v217, v213, v214
    s_waitcnt lgkmcnt(12)
    v_mfma_f32_32x32x16_bf16 v[192:207], a[128:131], v[128:131], v[192:207]
    ds_read_b64_tr_b16 a[120:121], v228 offset:12288
    ds_read_b64_tr_b16 a[122:123], v228 offset:13312
    buffer_load_dwordx4 v227, s[12:15], s80 offen offset:1024 lds
    v_accvgpr_write_b32 a47, v217
    v_exp_f32 v208, v176
    v_mfma_f32_32x32x16_bf16 v[192:207], a[132:135], v[132:135], v[192:207]
    ds_read_b64_tr_b16 a[124:125], v228 offset:14336
    ds_read_b64_tr_b16 a[126:127], v228 offset:15360
    ds_read_b128 v[172:175], v236 offset:1136
    v_exp_f32 v209, v177
    v_fma_f32 v210, v208, 0.5, 1.0
    v_mfma_f32_32x32x16_bf16 v[192:207], a[136:139], v[136:139], v[192:207]
    ds_read_b64_tr_b16 a[128:129], v228 offset:16384
    ds_read_b64_tr_b16 a[130:131], v228 offset:17408
    v_fma_f32 v211, v209, 0.5, 1.0
    v_fma_f32 v210, v208, v210, 1.0
    v_fma_f32 v211, v209, v211, 1.0
    v_rcp_f32 v210, v210
    v_mfma_f32_32x32x16_bf16 v[192:207], a[140:143], v[140:143], v[192:207]
    ds_read_b64_tr_b16 a[132:133], v228 offset:18432
    ds_read_b64_tr_b16 a[134:135], v228 offset:19456
    buffer_load_dwordx4 v227, s[12:15], s81 offen offset:2048 lds
    v_rcp_f32 v211, v211
    s_waitcnt lgkmcnt(13)
    v_mfma_f32_32x32x16_bf16 v[144:159], a[96:99], v[0:3], v[144:159]
    ds_read_b64_tr_b16 a[136:137], v228 offset:20480
    ds_read_b64_tr_b16 a[138:139], v228 offset:21504
    v_fma_f32 v208, -v176, v210, v176
    v_fma_f32 v209, -v177, v211, v177
    v_cvt_pk_bf16_f32 v212, v208, v209
    v_accvgpr_write_b32 a48, v212
    v_mfma_f32_32x32x16_bf16 v[144:159], a[100:103], v[4:7], v[144:159]
    ds_read_b64_tr_b16 a[140:141], v228 offset:22528
    ds_read_b64_tr_b16 a[142:143], v228 offset:23552
    v_exp_f32 v213, v178
    v_exp_f32 v214, v179
    v_mfma_f32_32x32x16_bf16 v[144:159], a[104:107], v[8:11], v[144:159]
    ds_read_b64_tr_b16 a[96:97], v229 offset:0
    ds_read_b64_tr_b16 a[98:99], v229 offset:1024
    buffer_load_dwordx4 v227, s[12:15], s82 offen offset:3072 lds
    s_add_u32 m0, s34, 102400
    v_fma_f32 v215, v213, 0.5, 1.0
    v_fma_f32 v216, v214, 0.5, 1.0
    v_mfma_f32_32x32x16_bf16 v[144:159], a[108:111], v[12:15], v[144:159]
    ds_read_b64_tr_b16 a[100:101], v229 offset:2048
    ds_read_b64_tr_b16 a[102:103], v229 offset:3072
    v_fma_f32 v215, v213, v215, 1.0
    v_fma_f32 v216, v214, v216, 1.0
    v_rcp_f32 v215, v215
    s_waitcnt lgkmcnt(13)
    v_mfma_f32_32x32x16_bf16 v[144:159], a[112:115], v[16:19], v[144:159]
    ds_read_b64_tr_b16 a[104:105], v229 offset:4096
    ds_read_b64_tr_b16 a[106:107], v229 offset:5120
    v_rcp_f32 v216, v216
    v_fma_f32 v213, -v178, v215, v178
    v_fma_f32 v214, -v179, v216, v179
    v_mfma_f32_32x32x16_bf16 v[144:159], a[116:119], v[20:23], v[144:159]
    ds_read_b64_tr_b16 a[108:109], v229 offset:6144
    ds_read_b64_tr_b16 a[110:111], v229 offset:7168
    buffer_load_dwordx4 v227, s[12:15], s83 offen offset:0 lds
    v_cvt_pk_bf16_f32 v217, v213, v214
    v_accvgpr_write_b32 a49, v217
    v_exp_f32 v208, v180
    v_mfma_f32_32x32x16_bf16 v[144:159], a[120:123], v[24:27], v[144:159]
    ds_read_b64_tr_b16 a[112:113], v229 offset:8192
    ds_read_b64_tr_b16 a[114:115], v229 offset:9216
    ds_read_b128 v[176:179], v236 offset:1280
    v_exp_f32 v209, v181
    v_fma_f32 v210, v208, 0.5, 1.0
    v_mfma_f32_32x32x16_bf16 v[144:159], a[124:127], v[28:31], v[144:159]
    ds_read_b64_tr_b16 a[116:117], v229 offset:10240
    ds_read_b64_tr_b16 a[118:119], v229 offset:11264
    v_fma_f32 v211, v209, 0.5, 1.0
    v_fma_f32 v210, v208, v210, 1.0
    v_fma_f32 v211, v209, v211, 1.0
    s_waitcnt lgkmcnt(13)
    v_mfma_f32_32x32x16_bf16 v[144:159], a[128:131], v[32:35], v[144:159]
    ds_read_b64_tr_b16 a[120:121], v229 offset:12288
    ds_read_b64_tr_b16 a[122:123], v229 offset:13312
L_sm5:
    s_cbranch_execz L_retm
    buffer_load_dwordx4 v227, s[12:15], s84 offen offset:1024 lds
    v_rcp_f32 v210, v210
    v_rcp_f32 v211, v211
    v_mfma_f32_32x32x16_bf16 v[144:159], a[132:135], v[36:39], v[144:159]
    ds_read_b64_tr_b16 a[124:125], v229 offset:14336
    ds_read_b64_tr_b16 a[126:127], v229 offset:15360
    v_fma_f32 v208, -v180, v210, v180
    v_fma_f32 v209, -v181, v211, v181
    v_cvt_pk_bf16_f32 v212, v208, v209
    v_accvgpr_write_b32 a50, v212
    v_mfma_f32_32x32x16_bf16 v[144:159], a[136:139], v[40:43], v[144:159]
    ds_read_b64_tr_b16 a[128:129], v229 offset:16384
    ds_read_b64_tr_b16 a[130:131], v229 offset:17408
    v_exp_f32 v213, v182
    v_exp_f32 v214, v183
    v_mfma_f32_32x32x16_bf16 v[144:159], a[140:143], v[44:47], v[144:159]
    ds_read_b64_tr_b16 a[132:133], v229 offset:18432
    ds_read_b64_tr_b16 a[134:135], v229 offset:19456
    v_fma_f32 v215, v213, 0.5, 1.0
    v_fma_f32 v216, v214, 0.5, 1.0
    v_fma_f32 v215, v213, v215, 1.0
    s_waitcnt lgkmcnt(13)
    v_mfma_f32_32x32x16_bf16 v[160:175], a[96:99], v[0:3], v[160:175]
    ds_read_b64_tr_b16 a[136:137], v229 offset:20480
    ds_read_b64_tr_b16 a[138:139], v229 offset:21504
    v_fma_f32 v216, v214, v216, 1.0
    v_rcp_f32 v215, v215
    v_rcp_f32 v216, v216
    v_mfma_f32_32x32x16_bf16 v[160:175], a[100:103], v[4:7], v[160:175]
    ds_read_b64_tr_b16 a[140:141], v229 offset:22528
    ds_read_b64_tr_b16 a[142:143], v229 offset:23552
    v_fma_f32 v213, -v182, v215, v182
    v_fma_f32 v214, -v183, v216, v183
    v_cvt_pk_bf16_f32 v217, v213, v214
    v_accvgpr_write_b32 a51, v217
    s_waitcnt vmcnt(19)
    s_barrier
    v_mfma_f32_32x32x16_bf16 v[160:175], a[104:107], v[8:11], v[160:175]
    ds_read_b64_tr_b16 a[96:97], v228 offset:24576
    ds_read_b64_tr_b16 a[98:99], v228 offset:25600
    ds_read_b128 v[180:183], v236 offset:1296
    v_exp_f32 v208, v184
    v_exp_f32 v209, v185
    v_mfma_f32_32x32x16_bf16 v[160:175], a[108:111], v[12:15], v[160:175]
    ds_read_b64_tr_b16 a[100:101], v228 offset:26624
    ds_read_b64_tr_b16 a[102:103], v228 offset:27648
    s_add_u32 m0, s34, 122880
    s_add_u32 s4, s58, s69
    v_add_u32 v227, s4, v234
    s_waitcnt lgkmcnt(13)
    v_mfma_f32_32x32x16_bf16 v[160:175], a[112:115], v[16:19], v[160:175]
    ds_read_b64_tr_b16 a[104:105], v228 offset:28672
    ds_read_b64_tr_b16 a[106:107], v228 offset:29696
    v_fma_f32 v210, v208, 0.5, 1.0
    v_fma_f32 v211, v209, 0.5, 1.0
    v_fma_f32 v210, v208, v210, 1.0
    v_fma_f32 v211, v209, v211, 1.0
    v_mfma_f32_32x32x16_bf16 v[160:175], a[116:119], v[20:23], v[160:175]
    ds_read_b64_tr_b16 a[108:109], v228 offset:30720
    ds_read_b64_tr_b16 a[110:111], v228 offset:31744
    buffer_load_dwordx4 v227, s[12:15], s79 offen offset:0 lds
    v_rcp_f32 v210, v210
    v_rcp_f32 v211, v211
    v_mfma_f32_32x32x16_bf16 v[160:175], a[120:123], v[24:27], v[160:175]
    ds_read_b64_tr_b16 a[112:113], v228 offset:32768
    ds_read_b64_tr_b16 a[114:115], v228 offset:33792
    v_fma_f32 v208, -v184, v210, v184
    v_fma_f32 v209, -v185, v211, v185
    v_cvt_pk_bf16_f32 v212, v208, v209
    v_accvgpr_write_b32 a52, v212
    v_mfma_f32_32x32x16_bf16 v[160:175], a[124:127], v[28:31], v[160:175]
    ds_read_b64_tr_b16 a[116:117], v228 offset:34816
    ds_read_b64_tr_b16 a[118:119], v228 offset:35840
    v_exp_f32 v213, v186
    v_exp_f32 v214, v187
    s_waitcnt lgkmcnt(13)
    v_mfma_f32_32x32x16_bf16 v[160:175], a[128:131], v[32:35], v[160:175]
    ds_read_b64_tr_b16 a[120:121], v228 offset:36864
    ds_read_b64_tr_b16 a[122:123], v228 offset:37888
    buffer_load_dwordx4 v227, s[12:15], s80 offen offset:1024 lds
    v_fma_f32 v215, v213, 0.5, 1.0
    v_fma_f32 v216, v214, 0.5, 1.0
    v_fma_f32 v215, v213, v215, 1.0
    v_mfma_f32_32x32x16_bf16 v[160:175], a[132:135], v[36:39], v[160:175]
    ds_read_b64_tr_b16 a[124:125], v228 offset:38912
    ds_read_b64_tr_b16 a[126:127], v228 offset:39936
    v_fma_f32 v216, v214, v216, 1.0
    v_rcp_f32 v215, v215
    v_rcp_f32 v216, v216
    v_mfma_f32_32x32x16_bf16 v[160:175], a[136:139], v[40:43], v[160:175]
    ds_read_b64_tr_b16 a[128:129], v228 offset:40960
    ds_read_b64_tr_b16 a[130:131], v228 offset:41984
    v_fma_f32 v213, -v186, v215, v186
    v_fma_f32 v214, -v187, v216, v187
    v_cvt_pk_bf16_f32 v217, v213, v214
    v_accvgpr_write_b32 a53, v217
    v_mfma_f32_32x32x16_bf16 v[160:175], a[140:143], v[44:47], v[160:175]
    ds_read_b64_tr_b16 a[132:133], v228 offset:43008
    ds_read_b64_tr_b16 a[134:135], v228 offset:44032
    ds_read_b128 v[184:187], v236 offset:1312
    v_exp_f32 v208, v188
    s_waitcnt lgkmcnt(13)
    v_mfma_f32_32x32x16_bf16 v[144:159], a[96:99], v[48:51], v[144:159]
    ds_read_b64_tr_b16 a[136:137], v228 offset:45056
    ds_read_b64_tr_b16 a[138:139], v228 offset:46080
    buffer_load_dwordx4 v227, s[12:15], s81 offen offset:2048 lds
    v_exp_f32 v209, v189
    v_fma_f32 v210, v208, 0.5, 1.0
    v_mfma_f32_32x32x16_bf16 v[144:159], a[100:103], v[52:55], v[144:159]
    ds_read_b64_tr_b16 a[140:141], v228 offset:47104
    ds_read_b64_tr_b16 a[142:143], v228 offset:48128
    v_fma_f32 v211, v209, 0.5, 1.0
    v_fma_f32 v210, v208, v210, 1.0
    v_fma_f32 v211, v209, v211, 1.0
    v_rcp_f32 v210, v210
    v_mfma_f32_32x32x16_bf16 v[144:159], a[104:107], v[56:59], v[144:159]
    ds_read_b64_tr_b16 a[96:97], v229 offset:24576
    ds_read_b64_tr_b16 a[98:99], v229 offset:25600
    buffer_load_dwordx4 v227, s[12:15], s82 offen offset:3072 lds
    s_add_u32 m0, s34, 126976
    v_rcp_f32 v211, v211
    v_mfma_f32_32x32x16_bf16 v[144:159], a[108:111], v[60:63], v[144:159]
    ds_read_b64_tr_b16 a[100:101], v229 offset:26624
    ds_read_b64_tr_b16 a[102:103], v229 offset:27648
    v_fma_f32 v208, -v188, v210, v188
    v_fma_f32 v209, -v189, v211, v189
    v_cvt_pk_bf16_f32 v212, v208, v209
    s_waitcnt lgkmcnt(13)
    v_mfma_f32_32x32x16_bf16 v[144:159], a[112:115], v[64:67], v[144:159]
    ds_read_b64_tr_b16 a[104:105], v229 offset:28672
    ds_read_b64_tr_b16 a[106:107], v229 offset:29696
    v_accvgpr_write_b32 a54, v212
    v_exp_f32 v213, v190
    v_exp_f32 v214, v191
    v_mfma_f32_32x32x16_bf16 v[144:159], a[116:119], v[68:71], v[144:159]
    ds_read_b64_tr_b16 a[108:109], v229 offset:30720
    ds_read_b64_tr_b16 a[110:111], v229 offset:31744
    buffer_load_dwordx4 v227, s[12:15], s83 offen offset:0 lds
    v_fma_f32 v215, v213, 0.5, 1.0
    v_fma_f32 v216, v214, 0.5, 1.0
    v_fma_f32 v215, v213, v215, 1.0
    v_mfma_f32_32x32x16_bf16 v[144:159], a[120:123], v[72:75], v[144:159]
    ds_read_b64_tr_b16 a[112:113], v229 offset:32768
    ds_read_b64_tr_b16 a[114:115], v229 offset:33792
    v_fma_f32 v216, v214, v216, 1.0
    v_rcp_f32 v215, v215
    v_rcp_f32 v216, v216
    v_mfma_f32_32x32x16_bf16 v[144:159], a[124:127], v[76:79], v[144:159]
    ds_read_b64_tr_b16 a[116:117], v229 offset:34816
    ds_read_b64_tr_b16 a[118:119], v229 offset:35840
    v_fma_f32 v213, -v190, v215, v190
    v_fma_f32 v214, -v191, v216, v191
    v_cvt_pk_bf16_f32 v217, v213, v214
    s_waitcnt lgkmcnt(12)
    v_mfma_f32_32x32x16_bf16 v[144:159], a[128:131], v[80:83], v[144:159]
    ds_read_b64_tr_b16 a[120:121], v229 offset:36864
    ds_read_b64_tr_b16 a[122:123], v229 offset:37888
    buffer_load_dwordx4 v227, s[12:15], s84 offen offset:1024 lds
    v_accvgpr_write_b32 a55, v217
    v_exp_f32 v208, v192
    v_mfma_f32_32x32x16_bf16 v[144:159], a[132:135], v[84:87], v[144:159]
    ds_read_b64_tr_b16 a[124:125], v229 offset:38912
    ds_read_b64_tr_b16 a[126:127], v229 offset:39936
    ds_read_b128 v[188:191], v236 offset:1328
    v_exp_f32 v209, v193
    v_fma_f32 v210, v208, 0.5, 1.0
    v_mfma_f32_32x32x16_bf16 v[144:159], a[136:139], v[88:91], v[144:159]
    ds_read_b64_tr_b16 a[128:129], v229 offset:40960
    ds_read_b64_tr_b16 a[130:131], v229 offset:41984
    v_fma_f32 v211, v209, 0.5, 1.0
    v_fma_f32 v210, v208, v210, 1.0
    v_fma_f32 v211, v209, v211, 1.0
    v_rcp_f32 v210, v210
    v_mfma_f32_32x32x16_bf16 v[144:159], a[140:143], v[92:95], v[144:159]
    ds_read_b64_tr_b16 a[132:133], v229 offset:43008
    ds_read_b64_tr_b16 a[134:135], v229 offset:44032
    v_rcp_f32 v211, v211
    v_fma_f32 v208, -v192, v210, v192
    s_waitcnt lgkmcnt(13)
    v_mfma_f32_32x32x16_bf16 v[160:175], a[96:99], v[48:51], v[160:175]
    ds_read_b64_tr_b16 a[136:137], v229 offset:45056
    ds_read_b64_tr_b16 a[138:139], v229 offset:46080
    v_fma_f32 v209, -v193, v211, v193
    v_cvt_pk_bf16_f32 v212, v208, v209
    v_accvgpr_write_b32 a56, v212
    v_exp_f32 v213, v194
    v_mfma_f32_32x32x16_bf16 v[160:175], a[100:103], v[52:55], v[160:175]
    ds_read_b64_tr_b16 a[140:141], v229 offset:47104
    ds_read_b64_tr_b16 a[142:143], v229 offset:48128
    v_exp_f32 v214, v195
    v_fma_f32 v215, v213, 0.5, 1.0
    v_fma_f32 v216, v214, 0.5, 1.0
    s_waitcnt vmcnt(18)
    s_barrier
    v_mfma_f32_32x32x16_bf16 v[160:175], a[104:107], v[56:59], v[160:175]
    ds_read_b64_tr_b16 a[96:97], v230 offset:0
    ds_read_b64_tr_b16 a[98:99], v230 offset:1024
    s_add_u32 m0, s34, 0
    v_add_u32 v227, s73, v235
    v_fma_f32 v215, v213, v215, 1.0
    v_fma_f32 v216, v214, v216, 1.0
    v_mfma_f32_32x32x16_bf16 v[160:175], a[108:111], v[60:63], v[160:175]
    ds_read_b64_tr_b16 a[100:101], v230 offset:2048
    ds_read_b64_tr_b16 a[102:103], v230 offset:3072
    v_rcp_f32 v215, v215
    v_rcp_f32 v216, v216
    s_waitcnt lgkmcnt(13)
    v_mfma_f32_32x32x16_bf16 v[160:175], a[112:115], v[64:67], v[160:175]
    ds_read_b64_tr_b16 a[104:105], v230 offset:4096
    ds_read_b64_tr_b16 a[106:107], v230 offset:5120
    v_fma_f32 v213, -v194, v215, v194
    v_fma_f32 v214, -v195, v216, v195
    v_cvt_pk_bf16_f32 v217, v213, v214
    v_accvgpr_write_b32 a57, v217
    v_mfma_f32_32x32x16_bf16 v[160:175], a[116:119], v[68:71], v[160:175]
    ds_read_b64_tr_b16 a[108:109], v230 offset:6144
    ds_read_b64_tr_b16 a[110:111], v230 offset:7168
    ds_read_b128 v[192:195], v236 offset:1344
    v_exp_f32 v208, v196
    v_exp_f32 v209, v197
    v_mfma_f32_32x32x16_bf16 v[160:175], a[120:123], v[72:75], v[160:175]
    ds_read_b64_tr_b16 a[112:113], v230 offset:8192
    ds_read_b64_tr_b16 a[114:115], v230 offset:9216
    buffer_load_dwordx4 v227, s[16:19], s40 offen offset:0 lds
    v_fma_f32 v210, v208, 0.5, 1.0
    v_fma_f32 v211, v209, 0.5, 1.0
    v_fma_f32 v210, v208, v210, 1.0
    v_mfma_f32_32x32x16_bf16 v[160:175], a[124:127], v[76:79], v[160:175]
    ds_read_b64_tr_b16 a[116:117], v230 offset:10240
    ds_read_b64_tr_b16 a[118:119], v230 offset:11264
    v_fma_f32 v211, v209, v211, 1.0
    v_rcp_f32 v210, v210
    s_waitcnt lgkmcnt(13)
    v_mfma_f32_32x32x16_bf16 v[160:175], a[128:131], v[80:83], v[160:175]
    ds_read_b64_tr_b16 a[120:121], v230 offset:12288
    ds_read_b64_tr_b16 a[122:123], v230 offset:13312
    buffer_load_dwordx4 v227, s[16:19], s41 offen offset:1024 lds
    s_add_u32 m0, s34, 2048
    v_rcp_f32 v211, v211
    v_mfma_f32_32x32x16_bf16 v[160:175], a[132:135], v[84:87], v[160:175]
    ds_read_b64_tr_b16 a[124:125], v230 offset:14336
    ds_read_b64_tr_b16 a[126:127], v230 offset:15360
    v_fma_f32 v208, -v196, v210, v196
    v_fma_f32 v209, -v197, v211, v197
    v_cvt_pk_bf16_f32 v212, v208, v209
    v_accvgpr_write_b32 a58, v212
    v_mfma_f32_32x32x16_bf16 v[160:175], a[136:139], v[88:91], v[160:175]
    ds_read_b64_tr_b16 a[128:129], v230 offset:16384
    ds_read_b64_tr_b16 a[130:131], v230 offset:17408
    v_exp_f32 v213, v198
    v_exp_f32 v214, v199
    v_mfma_f32_32x32x16_bf16 v[160:175], a[140:143], v[92:95], v[160:175]
    ds_read_b64_tr_b16 a[132:133], v230 offset:18432
    ds_read_b64_tr_b16 a[134:135], v230 offset:19456
    buffer_load_dwordx4 v227, s[16:19], s42 offen offset:0 lds
    v_fma_f32 v215, v213, 0.5, 1.0
    v_fma_f32 v216, v214, 0.5, 1.0
    s_waitcnt lgkmcnt(13)
    v_mfma_f32_32x32x16_bf16 v[144:159], a[96:99], v[96:99], v[144:159]
    ds_read_b64_tr_b16 a[136:137], v230 offset:20480
    ds_read_b64_tr_b16 a[138:139], v230 offset:21504
    v_fma_f32 v215, v213, v215, 1.0
    v_fma_f32 v216, v214, v216, 1.0
    v_rcp_f32 v215, v215
    v_mfma_f32_32x32x16_bf16 v[144:159], a[100:103], v[100:103], v[144:159]
    ds_read_b64_tr_b16 a[140:141], v230 offset:22528
    ds_read_b64_tr_b16 a[142:143], v230 offset:23552
    v_rcp_f32 v216, v216
    v_fma_f32 v213, -v198, v215, v198
    v_fma_f32 v214, -v199, v216, v199
    v_mfma_f32_32x32x16_bf16 v[144:159], a[104:107], v[104:107], v[144:159]
    ds_read_b64_tr_b16 a[96:97], v231 offset:0
    ds_read_b64_tr_b16 a[98:99], v231 offset:1024
    buffer_load_dwordx4 v227, s[16:19], s43 offen offset:1024 lds
    s_add_u32 m0, s34, 4096
    v_cvt_pk_bf16_f32 v217, v213, v214
    v_accvgpr_write_b32 a59, v217
    v_mfma_f32_32x32x16_bf16 v[144:159], a[108:111], v[108:111], v[144:159]
    ds_read_b64_tr_b16 a[100:101], v231 offset:2048
    ds_read_b64_tr_b16 a[102:103], v231 offset:3072
    ds_read_b128 v[196:199], v236 offset:1360
    v_exp_f32 v208, v200
    s_waitcnt lgkmcnt(13)
    v_mfma_f32_32x32x16_bf16 v[144:159], a[112:115], v[112:115], v[144:159]
    ds_read_b64_tr_b16 a[104:105], v231 offset:4096
    ds_read_b64_tr_b16 a[106:107], v231 offset:5120
    v_exp_f32 v209, v201
    v_fma_f32 v210, v208, 0.5, 1.0
    v_fma_f32 v211, v209, 0.5, 1.0
    v_mfma_f32_32x32x16_bf16 v[144:159], a[116:119], v[116:119], v[144:159]
    ds_read_b64_tr_b16 a[108:109], v231 offset:6144
    ds_read_b64_tr_b16 a[110:111], v231 offset:7168
    buffer_load_dwordx4 v227, s[16:19], s44 offen offset:0 lds
    v_fma_f32 v210, v208, v210, 1.0
    v_fma_f32 v211, v209, v211, 1.0
    v_rcp_f32 v210, v210
    v_mfma_f32_32x32x16_bf16 v[144:159], a[120:123], v[120:123], v[144:159]
    ds_read_b64_tr_b16 a[112:113], v231 offset:8192
    ds_read_b64_tr_b16 a[114:115], v231 offset:9216
    v_rcp_f32 v211, v211
    v_fma_f32 v208, -v200, v210, v200
    v_fma_f32 v209, -v201, v211, v201
    v_mfma_f32_32x32x16_bf16 v[144:159], a[124:127], v[124:127], v[144:159]
    ds_read_b64_tr_b16 a[116:117], v231 offset:10240
    ds_read_b64_tr_b16 a[118:119], v231 offset:11264
    v_cvt_pk_bf16_f32 v212, v208, v209
    v_accvgpr_write_b32 a60, v212
    v_exp_f32 v213, v202
    s_waitcnt lgkmcnt(13)
    v_mfma_f32_32x32x16_bf16 v[144:159], a[128:131], v[128:131], v[144:159]
    ds_read_b64_tr_b16 a[120:121], v231 offset:12288
    ds_read_b64_tr_b16 a[122:123], v231 offset:13312
    buffer_load_dwordx4 v227, s[16:19], s45 offen offset:1024 lds
    v_exp_f32 v214, v203
    v_fma_f32 v215, v213, 0.5, 1.0
    v_mfma_f32_32x32x16_bf16 v[144:159], a[132:135], v[132:135], v[144:159]
    ds_read_b64_tr_b16 a[124:125], v231 offset:14336
    ds_read_b64_tr_b16 a[126:127], v231 offset:15360
    v_fma_f32 v216, v214, 0.5, 1.0
    v_fma_f32 v215, v213, v215, 1.0
    v_fma_f32 v216, v214, v216, 1.0
    v_rcp_f32 v215, v215
    v_mfma_f32_32x32x16_bf16 v[144:159], a[136:139], v[136:139], v[144:159]
    ds_read_b64_tr_b16 a[128:129], v231 offset:16384
    ds_read_b64_tr_b16 a[130:131], v231 offset:17408
    v_rcp_f32 v216, v216
    v_fma_f32 v213, -v202, v215, v202
    v_fma_f32 v214, -v203, v216, v203
    v_mfma_f32_32x32x16_bf16 v[144:159], a[140:143], v[140:143], v[144:159]
    ds_read_b64_tr_b16 a[132:133], v231 offset:18432
    ds_read_b64_tr_b16 a[134:135], v231 offset:19456
    v_cvt_pk_bf16_f32 v217, v213, v214
    v_accvgpr_write_b32 a61, v217
    v_exp_f32 v208, v204
    s_waitcnt lgkmcnt(12)
    v_mfma_f32_32x32x16_bf16 v[160:175], a[96:99], v[96:99], v[160:175]
    ds_read_b64_tr_b16 a[136:137], v231 offset:20480
    ds_read_b64_tr_b16 a[138:139], v231 offset:21504
    ds_read_b128 v[200:203], v236 offset:1376
    v_exp_f32 v209, v205
    v_fma_f32 v210, v208, 0.5, 1.0
    v_mfma_f32_32x32x16_bf16 v[160:175], a[100:103], v[100:103], v[160:175]
    ds_read_b64_tr_b16 a[140:141], v231 offset:22528
    ds_read_b64_tr_b16 a[142:143], v231 offset:23552
    v_fma_f32 v211, v209, 0.5, 1.0
    v_fma_f32 v210, v208, v210, 1.0
    v_fma_f32 v211, v209, v211, 1.0
    v_rcp_f32 v210, v210
    s_waitcnt vmcnt(18)
    s_barrier
    v_mfma_f32_32x32x16_bf16 v[160:175], a[104:107], v[104:107], v[160:175]
    ds_read_b64_tr_b16 a[96:97], v230 offset:24576
    ds_read_b64_tr_b16 a[98:99], v230 offset:25600
    s_add_u32 m0, s34, 24576
    v_add_u32 v227, s76, v235
    v_rcp_f32 v211, v211
    v_mfma_f32_32x32x16_bf16 v[160:175], a[108:111], v[108:111], v[160:175]
    ds_read_b64_tr_b16 a[100:101], v230 offset:26624
    ds_read_b64_tr_b16 a[102:103], v230 offset:27648
    v_fma_f32 v208, -v204, v210, v204
    v_fma_f32 v209, -v205, v211, v205
    v_cvt_pk_bf16_f32 v212, v208, v209
    s_waitcnt lgkmcnt(13)
    v_mfma_f32_32x32x16_bf16 v[160:175], a[112:115], v[112:115], v[160:175]
    ds_read_b64_tr_b16 a[104:105], v230 offset:28672
    ds_read_b64_tr_b16 a[106:107], v230 offset:29696
    v_accvgpr_write_b32 a62, v212
    v_exp_f32 v213, v206
    v_exp_f32 v214, v207
    v_mfma_f32_32x32x16_bf16 v[160:175], a[116:119], v[116:119], v[160:175]
    ds_read_b64_tr_b16 a[108:109], v230 offset:30720
    ds_read_b64_tr_b16 a[110:111], v230 offset:31744
    buffer_load_dwordx4 v227, s[16:19], s40 offen offset:0 lds
    v_fma_f32 v215, v213, 0.5, 1.0
    v_fma_f32 v216, v214, 0.5, 1.0
    v_fma_f32 v215, v213, v215, 1.0
    v_mfma_f32_32x32x16_bf16 v[160:175], a[120:123], v[120:123], v[160:175]
    ds_read_b64_tr_b16 a[112:113], v230 offset:32768
    ds_read_b64_tr_b16 a[114:115], v230 offset:33792
    v_fma_f32 v216, v214, v216, 1.0
    v_rcp_f32 v215, v215
    v_rcp_f32 v216, v216
    v_mfma_f32_32x32x16_bf16 v[160:175], a[124:127], v[124:127], v[160:175]
    ds_read_b64_tr_b16 a[116:117], v230 offset:34816
    ds_read_b64_tr_b16 a[118:119], v230 offset:35840
    v_fma_f32 v213, -v206, v215, v206
    v_fma_f32 v214, -v207, v216, v207
    v_cvt_pk_bf16_f32 v217, v213, v214
    s_waitcnt lgkmcnt(12)
    v_mfma_f32_32x32x16_bf16 v[160:175], a[128:131], v[128:131], v[160:175]
    ds_read_b64_tr_b16 a[120:121], v230 offset:36864
    ds_read_b64_tr_b16 a[122:123], v230 offset:37888
    buffer_load_dwordx4 v227, s[16:19], s41 offen offset:1024 lds
    s_add_u32 m0, s34, 26624
    v_accvgpr_write_b32 a63, v217
    v_exp_f32 v208, v144
    v_mfma_f32_32x32x16_bf16 v[160:175], a[132:135], v[132:135], v[160:175]
    ds_read_b64_tr_b16 a[124:125], v230 offset:38912
    ds_read_b64_tr_b16 a[126:127], v230 offset:39936
    ds_read_b128 v[204:207], v236 offset:1392
    v_exp_f32 v209, v145
    v_fma_f32 v210, v208, 0.5, 1.0
    v_mfma_f32_32x32x16_bf16 v[160:175], a[136:139], v[136:139], v[160:175]
    ds_read_b64_tr_b16 a[128:129], v230 offset:40960
    ds_read_b64_tr_b16 a[130:131], v230 offset:41984
    v_fma_f32 v211, v209, 0.5, 1.0
    v_fma_f32 v210, v208, v210, 1.0
    v_fma_f32 v211, v209, v211, 1.0
    v_rcp_f32 v210, v210
    v_mfma_f32_32x32x16_bf16 v[160:175], a[140:143], v[140:143], v[160:175]
    ds_read_b64_tr_b16 a[132:133], v230 offset:43008
    ds_read_b64_tr_b16 a[134:135], v230 offset:44032
    buffer_load_dwordx4 v227, s[16:19], s42 offen offset:0 lds
    v_rcp_f32 v211, v211
    s_waitcnt lgkmcnt(13)
    v_mfma_f32_32x32x16_bf16 v[176:191], a[96:99], v[0:3], v[176:191]
    ds_read_b64_tr_b16 a[136:137], v230 offset:45056
    ds_read_b64_tr_b16 a[138:139], v230 offset:46080
    v_fma_f32 v208, -v144, v210, v144
    v_fma_f32 v209, -v145, v211, v145
    v_cvt_pk_bf16_f32 v212, v208, v209
    v_accvgpr_write_b32 a64, v212
    v_mfma_f32_32x32x16_bf16 v[176:191], a[100:103], v[4:7], v[176:191]
    ds_read_b64_tr_b16 a[140:141], v230 offset:47104
    ds_read_b64_tr_b16 a[142:143], v230 offset:48128
    v_exp_f32 v213, v146
    v_exp_f32 v214, v147
    v_mfma_f32_32x32x16_bf16 v[176:191], a[104:107], v[8:11], v[176:191]
    ds_read_b64_tr_b16 a[96:97], v231 offset:24576
    ds_read_b64_tr_b16 a[98:99], v231 offset:25600
    buffer_load_dwordx4 v227, s[16:19], s43 offen offset:1024 lds
    s_add_u32 m0, s34, 28672
    v_fma_f32 v215, v213, 0.5, 1.0
    v_fma_f32 v216, v214, 0.5, 1.0
    v_mfma_f32_32x32x16_bf16 v[176:191], a[108:111], v[12:15], v[176:191]
    ds_read_b64_tr_b16 a[100:101], v231 offset:26624
    ds_read_b64_tr_b16 a[102:103], v231 offset:27648
    v_fma_f32 v215, v213, v215, 1.0
    v_fma_f32 v216, v214, v216, 1.0
    v_rcp_f32 v215, v215
    s_waitcnt lgkmcnt(13)
    v_mfma_f32_32x32x16_bf16 v[176:191], a[112:115], v[16:19], v[176:191]
    ds_read_b64_tr_b16 a[104:105], v231 offset:28672
    ds_read_b64_tr_b16 a[106:107], v231 offset:29696
    v_rcp_f32 v216, v216
    v_fma_f32 v213, -v146, v215, v146
    v_fma_f32 v214, -v147, v216, v147
    v_mfma_f32_32x32x16_bf16 v[176:191], a[116:119], v[20:23], v[176:191]
    ds_read_b64_tr_b16 a[108:109], v231 offset:30720
    ds_read_b64_tr_b16 a[110:111], v231 offset:31744
    buffer_load_dwordx4 v227, s[16:19], s44 offen offset:0 lds
    v_cvt_pk_bf16_f32 v217, v213, v214
    v_accvgpr_write_b32 a65, v217
    v_exp_f32 v208, v148
    v_mfma_f32_32x32x16_bf16 v[176:191], a[120:123], v[24:27], v[176:191]
    ds_read_b64_tr_b16 a[112:113], v231 offset:32768
    ds_read_b64_tr_b16 a[114:115], v231 offset:33792
    v_exp_f32 v209, v149
    v_fma_f32 v210, v208, 0.5, 1.0
    v_fma_f32 v211, v209, 0.5, 1.0
    v_mfma_f32_32x32x16_bf16 v[176:191], a[124:127], v[28:31], v[176:191]
    ds_read_b64_tr_b16 a[116:117], v231 offset:34816
    ds_read_b64_tr_b16 a[118:119], v231 offset:35840
    v_fma_f32 v210, v208, v210, 1.0
    v_fma_f32 v211, v209, v211, 1.0
    v_rcp_f32 v210, v210
    s_waitcnt lgkmcnt(12)
    v_mfma_f32_32x32x16_bf16 v[176:191], a[128:131], v[32:35], v[176:191]
    ds_read_b64_tr_b16 a[120:121], v231 offset:36864
    ds_read_b64_tr_b16 a[122:123], v231 offset:37888
    buffer_load_dwordx4 v227, s[16:19], s45 offen offset:1024 lds
    v_rcp_f32 v211, v211
    v_fma_f32 v208, -v148, v210, v148
    v_mfma_f32_32x32x16_bf16 v[176:191], a[132:135], v[36:39], v[176:191]
    ds_read_b64_tr_b16 a[124:125], v231 offset:38912
    ds_read_b64_tr_b16 a[126:127], v231 offset:39936
    v_fma_f32 v209, -v149, v211, v149
    v_cvt_pk_bf16_f32 v212, v208, v209
    v_accvgpr_write_b32 a66, v212
    v_exp_f32 v213, v150
    v_mfma_f32_32x32x16_bf16 v[176:191], a[136:139], v[40:43], v[176:191]
    ds_read_b64_tr_b16 a[128:129], v231 offset:40960
    ds_read_b64_tr_b16 a[130:131], v231 offset:41984
    v_exp_f32 v214, v151
    v_fma_f32 v215, v213, 0.5, 1.0
    v_fma_f32 v216, v214, 0.5, 1.0
    v_mfma_f32_32x32x16_bf16 v[176:191], a[140:143], v[44:47], v[176:191]
    ds_read_b64_tr_b16 a[132:133], v231 offset:43008
    ds_read_b64_tr_b16 a[134:135], v231 offset:44032
    v_fma_f32 v215, v213, v215, 1.0
    v_fma_f32 v216, v214, v216, 1.0
    v_rcp_f32 v215, v215
    s_waitcnt lgkmcnt(12)
    v_mfma_f32_32x32x16_bf16 v[192:207], a[96:99], v[0:3], v[192:207]
    ds_read_b64_tr_b16 a[136:137], v231 offset:45056
    ds_read_b64_tr_b16 a[138:139], v231 offset:46080
    v_rcp_f32 v216, v216
    v_fma_f32 v213, -v150, v215, v150
    v_fma_f32 v214, -v151, v216, v151
    v_mfma_f32_32x32x16_bf16 v[192:207], a[100:103], v[4:7], v[192:207]
    ds_read_b64_tr_b16 a[140:141], v231 offset:47104
    ds_read_b64_tr_b16 a[142:143], v231 offset:48128
    v_cvt_pk_bf16_f32 v217, v213, v214
    v_accvgpr_write_b32 a67, v217
    v_exp_f32 v208, v152
    s_waitcnt vmcnt(18)
    s_barrier
    v_mfma_f32_32x32x16_bf16 v[192:207], a[104:107], v[8:11], v[192:207]
    ds_read_b64_tr_b16 a[96:97], v232 offset:0
    ds_read_b64_tr_b16 a[98:99], v232 offset:1024
    s_add_u32 m0, s34, 49152
    v_add_u32 v227, s73, v235
    v_exp_f32 v209, v153
    v_mfma_f32_32x32x16_bf16 v[192:207], a[108:111], v[12:15], v[192:207]
    ds_read_b64_tr_b16 a[100:101], v232 offset:2048
    ds_read_b64_tr_b16 a[102:103], v232 offset:3072
    v_fma_f32 v210, v208, 0.5, 1.0
    v_fma_f32 v211, v209, 0.5, 1.0
    v_fma_f32 v210, v208, v210, 1.0
    s_waitcnt lgkmcnt(12)
    v_mfma_f32_32x32x16_bf16 v[192:207], a[112:115], v[16:19], v[192:207]
    ds_read_b64_tr_b16 a[104:105], v232 offset:4096
    ds_read_b64_tr_b16 a[106:107], v232 offset:5120
    v_fma_f32 v211, v209, v211, 1.0
    v_rcp_f32 v210, v210
    v_rcp_f32 v211, v211
    v_mfma_f32_32x32x16_bf16 v[192:207], a[116:119], v[20:23], v[192:207]
    ds_read_b64_tr_b16 a[108:109], v232 offset:6144
    ds_read_b64_tr_b16 a[110:111], v232 offset:7168
    buffer_load_dwordx4 v227, s[16:19], s46 offen offset:0 lds
    v_fma_f32 v208, -v152, v210, v152
    v_fma_f32 v209, -v153, v211, v153
    v_cvt_pk_bf16_f32 v212, v208, v209
    v_mfma_f32_32x32x16_bf16 v[192:207], a[120:123], v[24:27], v[192:207]
    ds_read_b64_tr_b16 a[112:113], v232 offset:8192
    ds_read_b64_tr_b16 a[114:115], v232 offset:9216
    v_accvgpr_write_b32 a68, v212
    v_exp_f32 v213, v154
    v_exp_f32 v214, v155
    v_mfma_f32_32x32x16_bf16 v[192:207], a[124:127], v[28:31], v[192:207]
    ds_read_b64_tr_b16 a[116:117], v232 offset:10240
    ds_read_b64_tr_b16 a[118:119], v232 offset:11264
    v_fma_f32 v215, v213, 0.5, 1.0
    v_fma_f32 v216, v214, 0.5, 1.0
    v_fma_f32 v215, v213, v215, 1.0
    s_waitcnt lgkmcnt(12)
    v_mfma_f32_32x32x16_bf16 v[192:207], a[128:131], v[32:35], v[192:207]
    ds_read_b64_tr_b16 a[120:121], v232 offset:12288
    ds_read_b64_tr_b16 a[122:123], v232 offset:13312
    buffer_load_dwordx4 v227, s[16:19], s47 offen offset:1024 lds
    s_add_u32 m0, s34, 51200
    v_fma_f32 v216, v214, v216, 1.0
    v_rcp_f32 v215, v215
    v_mfma_f32_32x32x16_bf16 v[192:207], a[132:135], v[36:39], v[192:207]
    ds_read_b64_tr_b16 a[124:125], v232 offset:14336
    ds_read_b64_tr_b16 a[126:127], v232 offset:15360
    v_rcp_f32 v216, v216
    v_fma_f32 v213, -v154, v215, v154
    v_fma_f32 v214, -v155, v216, v155
    v_mfma_f32_32x32x16_bf16 v[192:207], a[136:139], v[40:43], v[192:207]
    ds_read_b64_tr_b16 a[128:129], v232 offset:16384
    ds_read_b64_tr_b16 a[130:131], v232 offset:17408
    v_cvt_pk_bf16_f32 v217, v213, v214
    v_accvgpr_write_b32 a69, v217
    v_exp_f32 v208, v156
    v_mfma_f32_32x32x16_bf16 v[192:207], a[140:143], v[44:47], v[192:207]
    ds_read_b64_tr_b16 a[132:133], v232 offset:18432
    ds_read_b64_tr_b16 a[134:135], v232 offset:19456
    s_nop 0
L_sm6:
    s_cbranch_execz L_retm
    buffer_load_dwordx4 v227, s[16:19], s48 offen offset:0 lds
    v_exp_f32 v209, v157
    s_waitcnt lgkmcnt(12)
    v_mfma_f32_32x32x16_bf16 v[176:191], a[96:99], v[48:51], v[176:191]
    ds_read_b64_tr_b16 a[136:137], v232 offset:20480
    ds_read_b64_tr_b16 a[138:139], v232 offset:21504
    v_fma_f32 v210, v208, 0.5, 1.0
    v_fma_f32 v211, v209, 0.5, 1.0
    v_fma_f32 v210, v208, v210, 1.0
    v_fma_f32 v211, v209, v211, 1.0
    v_mfma_f32_32x32x16_bf16 v[176:191], a[100:103], v[52:55], v[176:191]
    ds_read_b64_tr_b16 a[140:141], v232 offset:22528
    ds_read_b64_tr_b16 a[142:143], v232 offset:23552
    v_rcp_f32 v210, v210
    v_rcp_f32 v211, v211
    v_mfma_f32_32x32x16_bf16 v[176:191], a[104:107], v[56:59], v[176:191]
    ds_read_b64_tr_b16 a[96:97], v233 offset:0
    ds_read_b64_tr_b16 a[98:99], v233 offset:1024
    buffer_load_dwordx4 v227, s[16:19], s49 offen offset:1024 lds
    s_add_u32 m0, s34, 53248
    v_fma_f32 v208, -v156, v210, v156
    v_fma_f32 v209, -v157, v211, v157
    v_mfma_f32_32x32x16_bf16 v[176:191], a[108:111], v[60:63], v[176:191]
    ds_read_b64_tr_b16 a[100:101], v233 offset:2048
    ds_read_b64_tr_b16 a[102:103], v233 offset:3072
    v_cvt_pk_bf16_f32 v212, v208, v209
    v_accvgpr_write_b32 a70, v212
    v_exp_f32 v213, v158
    s_waitcnt lgkmcnt(12)
    v_mfma_f32_32x32x16_bf16 v[176:191], a[112:115], v[64:67], v[176:191]
    ds_read_b64_tr_b16 a[104:105], v233 offset:4096
    ds_read_b64_tr_b16 a[106:107], v233 offset:5120
    v_exp_f32 v214, v159
    v_fma_f32 v215, v213, 0.5, 1.0
    v_fma_f32 v216, v214, 0.5, 1.0
    v_mfma_f32_32x32x16_bf16 v[176:191], a[116:119], v[68:71], v[176:191]
    ds_read_b64_tr_b16 a[108:109], v233 offset:6144
    ds_read_b64_tr_b16 a[110:111], v233 offset:7168
    buffer_load_dwordx4 v227, s[16:19], s50 offen offset:0 lds
    v_fma_f32 v215, v213, v215, 1.0
    v_fma_f32 v216, v214, v216, 1.0
    v_rcp_f32 v215, v215
    v_mfma_f32_32x32x16_bf16 v[176:191], a[120:123], v[72:75], v[176:191]
    ds_read_b64_tr_b16 a[112:113], v233 offset:8192
    ds_read_b64_tr_b16 a[114:115], v233 offset:9216
    v_rcp_f32 v216, v216
    v_fma_f32 v213, -v158, v215, v158
    v_fma_f32 v214, -v159, v216, v159
    v_mfma_f32_32x32x16_bf16 v[176:191], a[124:127], v[76:79], v[176:191]
    ds_read_b64_tr_b16 a[116:117], v233 offset:10240
    ds_read_b64_tr_b16 a[118:119], v233 offset:11264
    v_cvt_pk_bf16_f32 v217, v213, v214
    v_accvgpr_write_b32 a71, v217
    v_exp_f32 v208, v160
    s_waitcnt lgkmcnt(12)
    v_mfma_f32_32x32x16_bf16 v[176:191], a[128:131], v[80:83], v[176:191]
    ds_read_b64_tr_b16 a[120:121], v233 offset:12288
    ds_read_b64_tr_b16 a[122:123], v233 offset:13312
    buffer_load_dwordx4 v227, s[16:19], s51 offen offset:1024 lds
    v_exp_f32 v209, v161
    v_fma_f32 v210, v208, 0.5, 1.0
    v_mfma_f32_32x32x16_bf16 v[176:191], a[132:135], v[84:87], v[176:191]
    ds_read_b64_tr_b16 a[124:125], v233 offset:14336
    ds_read_b64_tr_b16 a[126:127], v233 offset:15360
    v_fma_f32 v211, v209, 0.5, 1.0
    v_fma_f32 v210, v208, v210, 1.0
    v_fma_f32 v211, v209, v211, 1.0
    v_rcp_f32 v210, v210
    v_mfma_f32_32x32x16_bf16 v[176:191], a[136:139], v[88:91], v[176:191]
    ds_read_b64_tr_b16 a[128:129], v233 offset:16384
    ds_read_b64_tr_b16 a[130:131], v233 offset:17408
    v_rcp_f32 v211, v211
    v_fma_f32 v208, -v160, v210, v160
    v_fma_f32 v209, -v161, v211, v161
    v_mfma_f32_32x32x16_bf16 v[176:191], a[140:143], v[92:95], v[176:191]
    ds_read_b64_tr_b16 a[132:133], v233 offset:18432
    ds_read_b64_tr_b16 a[134:135], v233 offset:19456
    v_cvt_pk_bf16_f32 v212, v208, v209
    v_accvgpr_write_b32 a72, v212
    v_exp_f32 v213, v162
    s_waitcnt lgkmcnt(12)
    v_mfma_f32_32x32x16_bf16 v[192:207], a[96:99], v[48:51], v[192:207]
    ds_read_b64_tr_b16 a[136:137], v233 offset:20480
    ds_read_b64_tr_b16 a[138:139], v233 offset:21504
    v_exp_f32 v214, v163
    v_fma_f32 v215, v213, 0.5, 1.0
    v_fma_f32 v216, v214, 0.5, 1.0
    v_mfma_f32_32x32x16_bf16 v[192:207], a[100:103], v[52:55], v[192:207]
    ds_read_b64_tr_b16 a[140:141], v233 offset:22528
    ds_read_b64_tr_b16 a[142:143], v233 offset:23552
    v_fma_f32 v215, v213, v215, 1.0
    v_fma_f32 v216, v214, v216, 1.0
    v_rcp_f32 v215, v215
    s_waitcnt vmcnt(18)
    s_barrier
    v_mfma_f32_32x32x16_bf16 v[192:207], a[104:107], v[56:59], v[192:207]
    ds_read_b64_tr_b16 a[96:97], v232 offset:24576
    ds_read_b64_tr_b16 a[98:99], v232 offset:25600
    s_add_u32 m0, s34, 73728
    v_add_u32 v227, s76, v235
    v_rcp_f32 v216, v216
    v_mfma_f32_32x32x16_bf16 v[192:207], a[108:111], v[60:63], v[192:207]
    ds_read_b64_tr_b16 a[100:101], v232 offset:26624
    ds_read_b64_tr_b16 a[102:103], v232 offset:27648
    v_fma_f32 v213, -v162, v215, v162
    v_fma_f32 v214, -v163, v216, v163
    v_cvt_pk_bf16_f32 v217, v213, v214
    s_waitcnt lgkmcnt(12)
    v_mfma_f32_32x32x16_bf16 v[192:207], a[112:115], v[64:67], v[192:207]
    ds_read_b64_tr_b16 a[104:105], v232 offset:28672
    ds_read_b64_tr_b16 a[106:107], v232 offset:29696
    v_accvgpr_write_b32 a73, v217
    v_exp_f32 v208, v164
    v_exp_f32 v209, v165
    v_mfma_f32_32x32x16_bf16 v[192:207], a[116:119], v[68:71], v[192:207]
    ds_read_b64_tr_b16 a[108:109], v232 offset:30720
    ds_read_b64_tr_b16 a[110:111], v232 offset:31744
    buffer_load_dwordx4 v227, s[16:19], s46 offen offset:0 lds
    v_fma_f32 v210, v208, 0.5, 1.0
    v_fma_f32 v211, v209, 0.5, 1.0
    v_fma_f32 v210, v208, v210, 1.0
    v_mfma_f32_32x32x16_bf16 v[192:207], a[120:123], v[72:75], v[192:207]
    ds_read_b64_tr_b16 a[112:113], v232 offset:32768
    ds_read_b64_tr_b16 a[114:115], v232 offset:33792
    v_fma_f32 v211, v209, v211, 1.0
    v_rcp_f32 v210, v210
    v_rcp_f32 v211, v211
    v_mfma_f32_32x32x16_bf16 v[192:207], a[124:127], v[76:79], v[192:207]
    ds_read_b64_tr_b16 a[116:117], v232 offset:34816
    ds_read_b64_tr_b16 a[118:119], v232 offset:35840
    v_fma_f32 v208, -v164, v210, v164
    v_fma_f32 v209, -v165, v211, v165
    v_cvt_pk_bf16_f32 v212, v208, v209
    s_waitcnt lgkmcnt(12)
    v_mfma_f32_32x32x16_bf16 v[192:207], a[128:131], v[80:83], v[192:207]
    ds_read_b64_tr_b16 a[120:121], v232 offset:36864
    ds_read_b64_tr_b16 a[122:123], v232 offset:37888
    buffer_load_dwordx4 v227, s[16:19], s47 offen offset:1024 lds
    s_add_u32 m0, s34, 75776
    v_accvgpr_write_b32 a74, v212
    v_exp_f32 v213, v166
    v_mfma_f32_32x32x16_bf16 v[192:207], a[132:135], v[84:87], v[192:207]
    ds_read_b64_tr_b16 a[124:125], v232 offset:38912
    ds_read_b64_tr_b16 a[126:127], v232 offset:39936
    v_exp_f32 v214, v167
    v_fma_f32 v215, v213, 0.5, 1.0
    v_fma_f32 v216, v214, 0.5, 1.0
    v_mfma_f32_32x32x16_bf16 v[192:207], a[136:139], v[88:91], v[192:207]
    ds_read_b64_tr_b16 a[128:129], v232 offset:40960
    ds_read_b64_tr_b16 a[130:131], v232 offset:41984
    v_fma_f32 v215, v213, v215, 1.0
    v_fma_f32 v216, v214, v216, 1.0
    v_rcp_f32 v215, v215
    v_mfma_f32_32x32x16_bf16 v[192:207], a[140:143], v[92:95], v[192:207]
    ds_read_b64_tr_b16 a[132:133], v232 offset:43008
    ds_read_b64_tr_b16 a[134:135], v232 offset:44032
    buffer_load_dwordx4 v227, s[16:19], s48 offen offset:0 lds
    v_rcp_f32 v216, v216
    s_waitcnt lgkmcnt(12)
    v_mfma_f32_32x32x16_bf16 v[176:191], a[96:99], v[96:99], v[176:191]
    ds_read_b64_tr_b16 a[136:137], v232 offset:45056
    ds_read_b64_tr_b16 a[138:139], v232 offset:46080
    v_fma_f32 v213, -v166, v215, v166
    v_fma_f32 v214, -v167, v216, v167
    v_cvt_pk_bf16_f32 v217, v213, v214
    v_accvgpr_write_b32 a75, v217
    v_mfma_f32_32x32x16_bf16 v[176:191], a[100:103], v[100:103], v[176:191]
    ds_read_b64_tr_b16 a[140:141], v232 offset:47104
    ds_read_b64_tr_b16 a[142:143], v232 offset:48128
    v_exp_f32 v208, v168
    v_exp_f32 v209, v169
    v_mfma_f32_32x32x16_bf16 v[176:191], a[104:107], v[104:107], v[176:191]
    ds_read_b64_tr_b16 a[96:97], v233 offset:24576
    ds_read_b64_tr_b16 a[98:99], v233 offset:25600
    buffer_load_dwordx4 v227, s[16:19], s49 offen offset:1024 lds
    s_add_u32 m0, s34, 77824
    v_fma_f32 v210, v208, 0.5, 1.0
    v_fma_f32 v211, v209, 0.5, 1.0
    v_mfma_f32_32x32x16_bf16 v[176:191], a[108:111], v[108:111], v[176:191]
    ds_read_b64_tr_b16 a[100:101], v233 offset:26624
    ds_read_b64_tr_b16 a[102:103], v233 offset:27648
    v_fma_f32 v210, v208, v210, 1.0
    v_fma_f32 v211, v209, v211, 1.0
    v_rcp_f32 v210, v210
    s_waitcnt lgkmcnt(12)
    v_mfma_f32_32x32x16_bf16 v[176:191], a[112:115], v[112:115], v[176:191]
    ds_read_b64_tr_b16 a[104:105], v233 offset:28672
    ds_read_b64_tr_b16 a[106:107], v233 offset:29696
    v_rcp_f32 v211, v211
    v_fma_f32 v208, -v168, v210, v168
    v_fma_f32 v209, -v169, v211, v169
    v_mfma_f32_32x32x16_bf16 v[176:191], a[116:119], v[116:119], v[176:191]
    ds_read_b64_tr_b16 a[108:109], v233 offset:30720
    ds_read_b64_tr_b16 a[110:111], v233 offset:31744
    buffer_load_dwordx4 v227, s[16:19], s50 offen offset:0 lds
    v_cvt_pk_bf16_f32 v212, v208, v209
    v_accvgpr_write_b32 a76, v212
    v_exp_f32 v213, v170
    v_mfma_f32_32x32x16_bf16 v[176:191], a[120:123], v[120:123], v[176:191]
    ds_read_b64_tr_b16 a[112:113], v233 offset:32768
    ds_read_b64_tr_b16 a[114:115], v233 offset:33792
    v_exp_f32 v214, v171
    v_fma_f32 v215, v213, 0.5, 1.0
    v_fma_f32 v216, v214, 0.5, 1.0
    v_mfma_f32_32x32x16_bf16 v[176:191], a[124:127], v[124:127], v[176:191]
    ds_read_b64_tr_b16 a[116:117], v233 offset:34816
    ds_read_b64_tr_b16 a[118:119], v233 offset:35840
    v_fma_f32 v215, v213, v215, 1.0
    v_fma_f32 v216, v214, v216, 1.0
    v_rcp_f32 v215, v215
    s_waitcnt lgkmcnt(12)
    v_mfma_f32_32x32x16_bf16 v[176:191], a[128:131], v[128:131], v[176:191]
    ds_read_b64_tr_b16 a[120:121], v233 offset:36864
    ds_read_b64_tr_b16 a[122:123], v233 offset:37888
    buffer_load_dwordx4 v227, s[16:19], s51 offen offset:1024 lds
    v_rcp_f32 v216, v216
    v_fma_f32 v213, -v170, v215, v170
    v_mfma_f32_32x32x16_bf16 v[176:191], a[132:135], v[132:135], v[176:191]
    ds_read_b64_tr_b16 a[124:125], v233 offset:38912
    ds_read_b64_tr_b16 a[126:127], v233 offset:39936
    v_fma_f32 v214, -v171, v216, v171
    v_cvt_pk_bf16_f32 v217, v213, v214
    v_accvgpr_write_b32 a77, v217
    v_exp_f32 v208, v172
    v_mfma_f32_32x32x16_bf16 v[176:191], a[136:139], v[136:139], v[176:191]
    ds_read_b64_tr_b16 a[128:129], v233 offset:40960
    ds_read_b64_tr_b16 a[130:131], v233 offset:41984
    v_exp_f32 v209, v173
    v_fma_f32 v210, v208, 0.5, 1.0
    v_fma_f32 v211, v209, 0.5, 1.0
    v_mfma_f32_32x32x16_bf16 v[176:191], a[140:143], v[140:143], v[176:191]
    ds_read_b64_tr_b16 a[132:133], v233 offset:43008
    ds_read_b64_tr_b16 a[134:135], v233 offset:44032
    v_fma_f32 v210, v208, v210, 1.0
    v_fma_f32 v211, v209, v211, 1.0
    v_rcp_f32 v210, v210
    s_waitcnt lgkmcnt(12)
    v_mfma_f32_32x32x16_bf16 v[192:207], a[96:99], v[96:99], v[192:207]
    ds_read_b64_tr_b16 a[136:137], v233 offset:45056
    ds_read_b64_tr_b16 a[138:139], v233 offset:46080
    v_rcp_f32 v211, v211
    v_fma_f32 v208, -v172, v210, v172
    v_fma_f32 v209, -v173, v211, v173
    v_mfma_f32_32x32x16_bf16 v[192:207], a[100:103], v[100:103], v[192:207]
    ds_read_b64_tr_b16 a[140:141], v233 offset:47104
    ds_read_b64_tr_b16 a[142:143], v233 offset:48128
    v_cvt_pk_bf16_f32 v212, v208, v209
    v_accvgpr_write_b32 a78, v212
    v_exp_f32 v213, v174
    s_waitcnt vmcnt(18)
    s_barrier
    v_mfma_f32_32x32x16_bf16 v[192:207], a[104:107], v[104:107], v[192:207]
    ds_read_b64_tr_b16 a[96:97], v228 offset:0
    ds_read_b64_tr_b16 a[98:99], v228 offset:1024
    s_add_u32 m0, s34, 98304
    v_add_u32 v227, s74, v235
    v_exp_f32 v214, v175
    v_mfma_f32_32x32x16_bf16 v[192:207], a[108:111], v[108:111], v[192:207]
    ds_read_b64_tr_b16 a[100:101], v229 offset:0
    ds_read_b64_tr_b16 a[102:103], v229 offset:1024
    v_fma_f32 v215, v213, 0.5, 1.0
    v_fma_f32 v216, v214, 0.5, 1.0
    v_fma_f32 v215, v213, v215, 1.0
    s_waitcnt lgkmcnt(12)
    v_mfma_f32_32x32x16_bf16 v[192:207], a[112:115], v[112:115], v[192:207]
    ds_read_b64_tr_b16 a[104:105], v228 offset:6144
    ds_read_b64_tr_b16 a[106:107], v228 offset:7168
    v_fma_f32 v216, v214, v216, 1.0
    v_rcp_f32 v215, v215
    v_rcp_f32 v216, v216
    v_mfma_f32_32x32x16_bf16 v[192:207], a[116:119], v[116:119], v[192:207]
    ds_read_b64_tr_b16 a[108:109], v229 offset:6144
    ds_read_b64_tr_b16 a[110:111], v229 offset:7168
    buffer_load_dwordx4 v227, s[16:19], s40 offen offset:0 lds
    v_fma_f32 v213, -v174, v215, v174
    v_fma_f32 v214, -v175, v216, v175
    v_cvt_pk_bf16_f32 v217, v213, v214
    v_mfma_f32_32x32x16_bf16 v[192:207], a[120:123], v[120:123], v[192:207]
    ds_read_b64_tr_b16 a[112:113], v228 offset:12288
    ds_read_b64_tr_b16 a[114:115], v228 offset:13312
    v_accvgpr_write_b32 a79, v217
    v_exp_f32 v208, v176
    v_exp_f32 v209, v177
    v_mfma_f32_32x32x16_bf16 v[192:207], a[124:127], v[124:127], v[192:207]
    ds_read_b64_tr_b16 a[116:117], v229 offset:12288
    ds_read_b64_tr_b16 a[118:119], v229 offset:13312
    v_fma_f32 v210, v208, 0.5, 1.0
    v_fma_f32 v211, v209, 0.5, 1.0
    v_fma_f32 v210, v208, v210, 1.0
    s_waitcnt lgkmcnt(12)
    v_mfma_f32_32x32x16_bf16 v[192:207], a[128:131], v[128:131], v[192:207]
    ds_read_b64_tr_b16 a[120:121], v228 offset:18432
    ds_read_b64_tr_b16 a[122:123], v228 offset:19456
    buffer_load_dwordx4 v227, s[16:19], s41 offen offset:1024 lds
    s_add_u32 m0, s34, 100352
    v_fma_f32 v211, v209, v211, 1.0
    v_rcp_f32 v210, v210
    v_mfma_f32_32x32x16_bf16 v[192:207], a[132:135], v[132:135], v[192:207]
    ds_read_b64_tr_b16 a[124:125], v229 offset:18432
    ds_read_b64_tr_b16 a[126:127], v229 offset:19456
    v_rcp_f32 v211, v211
    v_fma_f32 v208, -v176, v210, v176
    v_fma_f32 v209, -v177, v211, v177
    v_mfma_f32_32x32x16_bf16 v[192:207], a[136:139], v[136:139], v[192:207]
    ds_read_b64_tr_b16 a[128:129], v228 offset:2048
    ds_read_b64_tr_b16 a[130:131], v228 offset:3072
    v_cvt_pk_bf16_f32 v212, v208, v209
    v_accvgpr_write_b32 a80, v212
    v_exp_f32 v213, v178
    v_mfma_f32_32x32x16_bf16 v[192:207], a[140:143], v[140:143], v[192:207]
    ds_read_b64_tr_b16 a[132:133], v229 offset:2048
    ds_read_b64_tr_b16 a[134:135], v229 offset:3072
    buffer_load_dwordx4 v227, s[16:19], s42 offen offset:0 lds
    v_exp_f32 v214, v179
    s_waitcnt lgkmcnt(12)
    v_mfma_f32_32x32x16_bf16 v[96:111], a[96:99], a[0:3], 0
    ds_read_b64_tr_b16 a[136:137], v228 offset:8192
    ds_read_b64_tr_b16 a[138:139], v228 offset:9216
    v_fma_f32 v215, v213, 0.5, 1.0
    v_fma_f32 v216, v214, 0.5, 1.0
    v_fma_f32 v215, v213, v215, 1.0
    v_fma_f32 v216, v214, v216, 1.0
    v_mfma_f32_32x32x16_bf16 v[112:127], a[100:103], a[0:3], 0
    ds_read_b64_tr_b16 a[140:141], v229 offset:8192
    ds_read_b64_tr_b16 a[142:143], v229 offset:9216
    v_rcp_f32 v215, v215
    v_rcp_f32 v216, v216
    v_mfma_f32_32x32x16_bf16 v[96:111], a[104:107], a[4:7], v[96:111]
    ds_read_b64_tr_b16 a[96:97], v228 offset:14336
    ds_read_b64_tr_b16 a[98:99], v228 offset:15360
    buffer_load_dwordx4 v227, s[16:19], s43 offen offset:1024 lds
    s_add_u32 m0, s34, 102400
    v_fma_f32 v213, -v178, v215, v178
    v_fma_f32 v214, -v179, v216, v179
    v_mfma_f32_32x32x16_bf16 v[112:127], a[108:111], a[4:7], v[112:127]
    ds_read_b64_tr_b16 a[100:101], v229 offset:14336
    ds_read_b64_tr_b16 a[102:103], v229 offset:15360
    v_cvt_pk_bf16_f32 v217, v213, v214
    v_accvgpr_write_b32 a81, v217
    v_exp_f32 v208, v180
    s_waitcnt lgkmcnt(12)
    v_mfma_f32_32x32x16_bf16 v[96:111], a[112:115], a[8:11], v[96:111]
    ds_read_b64_tr_b16 a[104:105], v228 offset:20480
    ds_read_b64_tr_b16 a[106:107], v228 offset:21504
    v_exp_f32 v209, v181
    v_fma_f32 v210, v208, 0.5, 1.0
    v_fma_f32 v211, v209, 0.5, 1.0
    v_mfma_f32_32x32x16_bf16 v[112:127], a[116:119], a[8:11], v[112:127]
    ds_read_b64_tr_b16 a[108:109], v229 offset:20480
    ds_read_b64_tr_b16 a[110:111], v229 offset:21504
    buffer_load_dwordx4 v227, s[16:19], s44 offen offset:0 lds
    v_fma_f32 v210, v208, v210, 1.0
    v_fma_f32 v211, v209, v211, 1.0
    v_rcp_f32 v210, v210
    v_mfma_f32_32x32x16_bf16 v[96:111], a[120:123], a[12:15], v[96:111]
    ds_read_b64_tr_b16 a[112:113], v228 offset:4096
    ds_read_b64_tr_b16 a[114:115], v228 offset:5120
    v_rcp_f32 v211, v211
    v_fma_f32 v208, -v180, v210, v180
    v_fma_f32 v209, -v181, v211, v181
    v_mfma_f32_32x32x16_bf16 v[112:127], a[124:127], a[12:15], v[112:127]
    ds_read_b64_tr_b16 a[116:117], v229 offset:4096
    ds_read_b64_tr_b16 a[118:119], v229 offset:5120
    v_cvt_pk_bf16_f32 v212, v208, v209
    v_accvgpr_write_b32 a82, v212
    v_exp_f32 v213, v182
    s_waitcnt lgkmcnt(12)
    v_mfma_f32_32x32x16_bf16 v[96:111], a[128:131], a[16:19], v[96:111]
    ds_read_b64_tr_b16 a[120:121], v228 offset:10240
    ds_read_b64_tr_b16 a[122:123], v228 offset:11264
    buffer_load_dwordx4 v227, s[16:19], s45 offen offset:1024 lds
    v_exp_f32 v214, v183
    v_fma_f32 v215, v213, 0.5, 1.0
    v_mfma_f32_32x32x16_bf16 v[112:127], a[132:135], a[16:19], v[112:127]
    ds_read_b64_tr_b16 a[124:125], v229 offset:10240
    ds_read_b64_tr_b16 a[126:127], v229 offset:11264
    v_fma_f32 v216, v214, 0.5, 1.0
    v_fma_f32 v215, v213, v215, 1.0
    v_fma_f32 v216, v214, v216, 1.0
    v_rcp_f32 v215, v215
    v_mfma_f32_32x32x16_bf16 v[96:111], a[136:139], a[20:23], v[96:111]
    ds_read_b64_tr_b16 a[128:129], v228 offset:16384
    ds_read_b64_tr_b16 a[130:131], v228 offset:17408
    v_rcp_f32 v216, v216
    v_fma_f32 v213, -v182, v215, v182
    v_fma_f32 v214, -v183, v216, v183
    v_mfma_f32_32x32x16_bf16 v[112:127], a[140:143], a[20:23], v[112:127]
    ds_read_b64_tr_b16 a[132:133], v229 offset:16384
    ds_read_b64_tr_b16 a[134:135], v229 offset:17408
    v_cvt_pk_bf16_f32 v217, v213, v214
    v_accvgpr_write_b32 a83, v217
    v_exp_f32 v208, v184
    s_waitcnt lgkmcnt(12)
    v_mfma_f32_32x32x16_bf16 v[96:111], a[96:99], a[24:27], v[96:111]
    ds_read_b64_tr_b16 a[136:137], v228 offset:22528
    ds_read_b64_tr_b16 a[138:139], v228 offset:23552
    v_exp_f32 v209, v185
    v_fma_f32 v210, v208, 0.5, 1.0
    v_fma_f32 v211, v209, 0.5, 1.0
    v_mfma_f32_32x32x16_bf16 v[112:127], a[100:103], a[24:27], v[112:127]
    ds_read_b64_tr_b16 a[140:141], v229 offset:22528
    ds_read_b64_tr_b16 a[142:143], v229 offset:23552
    v_fma_f32 v210, v208, v210, 1.0
    v_fma_f32 v211, v209, v211, 1.0
    v_rcp_f32 v210, v210
    s_waitcnt vmcnt(18)
    s_barrier
    v_mfma_f32_32x32x16_bf16 v[96:111], a[104:107], a[28:31], v[96:111]
    ds_read_b64_tr_b16 a[96:97], v228 offset:24576
    ds_read_b64_tr_b16 a[98:99], v228 offset:25600
    s_add_u32 m0, s34, 122880
    v_add_u32 v227, s74, v235
    v_rcp_f32 v211, v211
    v_mfma_f32_32x32x16_bf16 v[112:127], a[108:111], a[28:31], v[112:127]
    ds_read_b64_tr_b16 a[100:101], v229 offset:24576
    ds_read_b64_tr_b16 a[102:103], v229 offset:25600
    v_fma_f32 v208, -v184, v210, v184
    v_fma_f32 v209, -v185, v211, v185
    v_cvt_pk_bf16_f32 v212, v208, v209
    s_waitcnt lgkmcnt(12)
    v_mfma_f32_32x32x16_bf16 v[96:111], a[112:115], a[32:35], v[96:111]
    ds_read_b64_tr_b16 a[104:105], v228 offset:30720
    ds_read_b64_tr_b16 a[106:107], v228 offset:31744
    v_accvgpr_write_b32 a84, v212
    v_exp_f32 v213, v186
    v_exp_f32 v214, v187
    v_mfma_f32_32x32x16_bf16 v[112:127], a[116:119], a[32:35], v[112:127]
    ds_read_b64_tr_b16 a[108:109], v229 offset:30720
    ds_read_b64_tr_b16 a[110:111], v229 offset:31744
    buffer_load_dwordx4 v227, s[16:19], s46 offen offset:0 lds
    v_fma_f32 v215, v213, 0.5, 1.0
    v_fma_f32 v216, v214, 0.5, 1.0
    v_fma_f32 v215, v213, v215, 1.0
    v_mfma_f32_32x32x16_bf16 v[96:111], a[120:123], a[36:39], v[96:111]
    ds_read_b64_tr_b16 a[112:113], v228 offset:36864
    ds_read_b64_tr_b16 a[114:115], v228 offset:37888
    v_fma_f32 v216, v214, v216, 1.0
    v_rcp_f32 v215, v215
    v_rcp_f32 v216, v216
    v_mfma_f32_32x32x16_bf16 v[112:127], a[124:127], a[36:39], v[112:127]
    ds_read_b64_tr_b16 a[116:117], v229 offset:36864
    ds_read_b64_tr_b16 a[118:119], v229 offset:37888
    v_fma_f32 v213, -v186, v215, v186
    v_fma_f32 v214, -v187, v216, v187
    v_cvt_pk_bf16_f32 v217, v213, v214
    s_waitcnt lgkmcnt(12)
    v_mfma_f32_32x32x16_bf16 v[96:111], a[128:131], a[40:43], v[96:111]
    ds_read_b64_tr_b16 a[120:121], v228 offset:43008
    ds_read_b64_tr_b16 a[122:123], v228 offset:44032
    buffer_load_dwordx4 v227, s[16:19], s47 offen offset:1024 lds
    s_add_u32 m0, s34, 124928
    v_accvgpr_write_b32 a85, v217
    v_exp_f32 v208, v188
    v_mfma_f32_32x32x16_bf16 v[112:127], a[132:135], a[40:43], v[112:127]
    ds_read_b64_tr_b16 a[124:125], v229 offset:43008
    ds_read_b64_tr_b16 a[126:127], v229 offset:44032
    v_exp_f32 v209, v189
    v_fma_f32 v210, v208, 0.5, 1.0
    v_fma_f32 v211, v209, 0.5, 1.0
    v_mfma_f32_32x32x16_bf16 v[96:111], a[136:139], a[44:47], v[96:111]
    ds_read_b64_tr_b16 a[128:129], v228 offset:26624
    ds_read_b64_tr_b16 a[130:131], v228 offset:27648
    v_fma_f32 v210, v208, v210, 1.0
    v_fma_f32 v211, v209, v211, 1.0
    v_rcp_f32 v210, v210
    v_mfma_f32_32x32x16_bf16 v[112:127], a[140:143], a[44:47], v[112:127]
    ds_read_b64_tr_b16 a[132:133], v229 offset:26624
    ds_read_b64_tr_b16 a[134:135], v229 offset:27648
    buffer_load_dwordx4 v227, s[16:19], s48 offen offset:0 lds
    v_rcp_f32 v211, v211
    s_waitcnt lgkmcnt(12)
    v_mfma_f32_32x32x16_bf16 v[128:143], a[96:99], a[0:3], 0
    ds_read_b64_tr_b16 a[136:137], v228 offset:32768
    ds_read_b64_tr_b16 a[138:139], v228 offset:33792
    v_fma_f32 v208, -v188, v210, v188
    v_fma_f32 v209, -v189, v211, v189
    v_cvt_pk_bf16_f32 v212, v208, v209
    v_accvgpr_write_b32 a86, v212
    v_mfma_f32_32x32x16_bf16 v[144:159], a[100:103], a[0:3], 0
    ds_read_b64_tr_b16 a[140:141], v229 offset:32768
    ds_read_b64_tr_b16 a[142:143], v229 offset:33792
    v_exp_f32 v213, v190
    v_exp_f32 v214, v191
    v_mfma_f32_32x32x16_bf16 v[128:143], a[104:107], a[4:7], v[128:143]
    ds_read_b64_tr_b16 a[96:97], v228 offset:38912
    ds_read_b64_tr_b16 a[98:99], v228 offset:39936
    buffer_load_dwordx4 v227, s[16:19], s49 offen offset:1024 lds
    s_add_u32 m0, s34, 126976
    v_fma_f32 v215, v213, 0.5, 1.0
    v_fma_f32 v216, v214, 0.5, 1.0
    v_mfma_f32_32x32x16_bf16 v[144:159], a[108:111], a[4:7], v[144:159]
    ds_read_b64_tr_b16 a[100:101], v229 offset:38912
    ds_read_b64_tr_b16 a[102:103], v229 offset:39936
    v_fma_f32 v215, v213, v215, 1.0
    v_fma_f32 v216, v214, v216, 1.0
    v_rcp_f32 v215, v215
    s_waitcnt lgkmcnt(12)
    v_mfma_f32_32x32x16_bf16 v[128:143], a[112:115], a[8:11], v[128:143]
    ds_read_b64_tr_b16 a[104:105], v228 offset:45056
    ds_read_b64_tr_b16 a[106:107], v228 offset:46080
    v_rcp_f32 v216, v216
    v_fma_f32 v213, -v190, v215, v190
    v_fma_f32 v214, -v191, v216, v191
    v_mfma_f32_32x32x16_bf16 v[144:159], a[116:119], a[8:11], v[144:159]
    ds_read_b64_tr_b16 a[108:109], v229 offset:45056
    ds_read_b64_tr_b16 a[110:111], v229 offset:46080
    buffer_load_dwordx4 v227, s[16:19], s50 offen offset:0 lds
    v_cvt_pk_bf16_f32 v217, v213, v214
    v_accvgpr_write_b32 a87, v217
    v_exp_f32 v208, v192
    v_mfma_f32_32x32x16_bf16 v[128:143], a[120:123], a[12:15], v[128:143]
    ds_read_b64_tr_b16 a[112:113], v228 offset:28672
    ds_read_b64_tr_b16 a[114:115], v228 offset:29696
    v_exp_f32 v209, v193
    v_fma_f32 v210, v208, 0.5, 1.0
    v_fma_f32 v211, v209, 0.5, 1.0
    v_mfma_f32_32x32x16_bf16 v[144:159], a[124:127], a[12:15], v[144:159]
    ds_read_b64_tr_b16 a[116:117], v229 offset:28672
    ds_read_b64_tr_b16 a[118:119], v229 offset:29696
    v_fma_f32 v210, v208, v210, 1.0
    v_fma_f32 v211, v209, v211, 1.0
    v_rcp_f32 v210, v210
    s_waitcnt lgkmcnt(12)
    v_mfma_f32_32x32x16_bf16 v[128:143], a[128:131], a[16:19], v[128:143]
    ds_read_b64_tr_b16 a[120:121], v228 offset:34816
    ds_read_b64_tr_b16 a[122:123], v228 offset:35840
    buffer_load_dwordx4 v227, s[16:19], s51 offen offset:1024 lds
    v_rcp_f32 v211, v211
    v_fma_f32 v208, -v192, v210, v192
    v_mfma_f32_32x32x16_bf16 v[144:159], a[132:135], a[16:19], v[144:159]
    ds_read_b64_tr_b16 a[124:125], v229 offset:34816
    ds_read_b64_tr_b16 a[126:127], v229 offset:35840
    v_fma_f32 v209, -v193, v211, v193
    v_cvt_pk_bf16_f32 v212, v208, v209
    v_accvgpr_write_b32 a88, v212
    v_exp_f32 v213, v194
    v_mfma_f32_32x32x16_bf16 v[128:143], a[136:139], a[20:23], v[128:143]
    ds_read_b64_tr_b16 a[128:129], v228 offset:40960
    ds_read_b64_tr_b16 a[130:131], v228 offset:41984
    v_exp_f32 v214, v195
    v_fma_f32 v215, v213, 0.5, 1.0
    v_fma_f32 v216, v214, 0.5, 1.0
    v_mfma_f32_32x32x16_bf16 v[144:159], a[140:143], a[20:23], v[144:159]
    ds_read_b64_tr_b16 a[132:133], v229 offset:40960
    ds_read_b64_tr_b16 a[134:135], v229 offset:41984
    v_fma_f32 v215, v213, v215, 1.0
    v_fma_f32 v216, v214, v216, 1.0
    v_rcp_f32 v215, v215
    s_waitcnt lgkmcnt(12)
    v_mfma_f32_32x32x16_bf16 v[128:143], a[96:99], a[24:27], v[128:143]
    ds_read_b64_tr_b16 a[136:137], v228 offset:47104
    ds_read_b64_tr_b16 a[138:139], v228 offset:48128
    v_rcp_f32 v216, v216
    v_fma_f32 v213, -v194, v215, v194
    v_fma_f32 v214, -v195, v216, v195
    v_mfma_f32_32x32x16_bf16 v[144:159], a[100:103], a[24:27], v[144:159]
    ds_read_b64_tr_b16 a[140:141], v229 offset:47104
    ds_read_b64_tr_b16 a[142:143], v229 offset:48128
    v_cvt_pk_bf16_f32 v217, v213, v214
    v_accvgpr_write_b32 a89, v217
    v_exp_f32 v208, v196
    s_waitcnt vmcnt(18)
    s_barrier
    v_mfma_f32_32x32x16_bf16 v[128:143], a[104:107], a[28:31], v[128:143]
    ds_read_b64_tr_b16 a[96:97], v230 offset:0
    ds_read_b64_tr_b16 a[98:99], v230 offset:1024
    buffer_load_dword v238, v241, s[28:31], s53 offen sc1
    v_exp_f32 v209, v197
    s_nop 0
L_sm7:
    s_cbranch_execz L_retm
    v_fma_f32 v210, v208, 0.5, 1.0
    v_mfma_f32_32x32x16_bf16 v[144:159], a[108:111], a[28:31], v[144:159]
    ds_read_b64_tr_b16 a[100:101], v231 offset:0
    ds_read_b64_tr_b16 a[102:103], v231 offset:1024
    s_add_u32 m0, s34, 0
    v_add_u32 v227, s77, v235
    v_fma_f32 v211, v209, 0.5, 1.0
    s_waitcnt lgkmcnt(12)
    v_mfma_f32_32x32x16_bf16 v[128:143], a[112:115], a[32:35], v[128:143]
    ds_read_b64_tr_b16 a[104:105], v230 offset:6144
    ds_read_b64_tr_b16 a[106:107], v230 offset:7168
    v_fma_f32 v210, v208, v210, 1.0
    v_fma_f32 v211, v209, v211, 1.0
    v_rcp_f32 v210, v210
    v_mfma_f32_32x32x16_bf16 v[144:159], a[116:119], a[32:35], v[144:159]
    ds_read_b64_tr_b16 a[108:109], v231 offset:6144
    ds_read_b64_tr_b16 a[110:111], v231 offset:7168
    buffer_load_dwordx4 v227, s[16:19], s40 offen offset:0 lds
    v_rcp_f32 v211, v211
    v_fma_f32 v208, -v196, v210, v196
    v_mfma_f32_32x32x16_bf16 v[128:143], a[120:123], a[36:39], v[128:143]
    ds_read_b64_tr_b16 a[112:113], v230 offset:12288
    ds_read_b64_tr_b16 a[114:115], v230 offset:13312
    v_fma_f32 v209, -v197, v211, v197
    v_cvt_pk_bf16_f32 v212, v208, v209
    v_accvgpr_write_b32 a90, v212
    v_exp_f32 v213, v198
    v_mfma_f32_32x32x16_bf16 v[144:159], a[124:127], a[36:39], v[144:159]
    ds_read_b64_tr_b16 a[116:117], v231 offset:12288
    ds_read_b64_tr_b16 a[118:119], v231 offset:13312
    v_exp_f32 v214, v199
    v_fma_f32 v215, v213, 0.5, 1.0
    s_waitcnt lgkmcnt(12)
    v_mfma_f32_32x32x16_bf16 v[128:143], a[128:131], a[40:43], v[128:143]
    ds_read_b64_tr_b16 a[120:121], v230 offset:18432
    ds_read_b64_tr_b16 a[122:123], v230 offset:19456
    buffer_load_dwordx4 v227, s[16:19], s41 offen offset:1024 lds
    s_add_u32 m0, s34, 2048
    v_fma_f32 v216, v214, 0.5, 1.0
    v_fma_f32 v215, v213, v215, 1.0
    v_mfma_f32_32x32x16_bf16 v[144:159], a[132:135], a[40:43], v[144:159]
    ds_read_b64_tr_b16 a[124:125], v231 offset:18432
    ds_read_b64_tr_b16 a[126:127], v231 offset:19456
    v_fma_f32 v216, v214, v216, 1.0
    v_rcp_f32 v215, v215
    v_rcp_f32 v216, v216
    v_mfma_f32_32x32x16_bf16 v[128:143], a[136:139], a[44:47], v[128:143]
    ds_read_b64_tr_b16 a[128:129], v230 offset:2048
    ds_read_b64_tr_b16 a[130:131], v230 offset:3072
    v_fma_f32 v213, -v198, v215, v198
    v_fma_f32 v214, -v199, v216, v199
    v_cvt_pk_bf16_f32 v217, v213, v214
    v_accvgpr_write_b32 a91, v217
    v_mfma_f32_32x32x16_bf16 v[144:159], a[140:143], a[44:47], v[144:159]
    ds_read_b64_tr_b16 a[132:133], v231 offset:2048
    ds_read_b64_tr_b16 a[134:135], v231 offset:3072
    buffer_load_dwordx4 v227, s[16:19], s42 offen offset:0 lds
    v_exp_f32 v208, v200
    s_waitcnt lgkmcnt(12)
    v_mfma_f32_32x32x16_bf16 v[96:111], a[96:99], a[48:51], v[96:111]
    ds_read_b64_tr_b16 a[136:137], v230 offset:8192
    ds_read_b64_tr_b16 a[138:139], v230 offset:9216
    v_exp_f32 v209, v201
    v_fma_f32 v210, v208, 0.5, 1.0
    v_fma_f32 v211, v209, 0.5, 1.0
    v_mfma_f32_32x32x16_bf16 v[112:127], a[100:103], a[48:51], v[112:127]
    ds_read_b64_tr_b16 a[140:141], v231 offset:8192
    ds_read_b64_tr_b16 a[142:143], v231 offset:9216
    v_fma_f32 v210, v208, v210, 1.0
    v_fma_f32 v211, v209, v211, 1.0
    v_rcp_f32 v210, v210
    v_mfma_f32_32x32x16_bf16 v[96:111], a[104:107], a[52:55], v[96:111]
    ds_read_b64_tr_b16 a[96:97], v230 offset:14336
    ds_read_b64_tr_b16 a[98:99], v230 offset:15360
    buffer_load_dwordx4 v227, s[16:19], s43 offen offset:1024 lds
    s_add_u32 m0, s34, 4096
    v_rcp_f32 v211, v211
    v_mfma_f32_32x32x16_bf16 v[112:127], a[108:111], a[52:55], v[112:127]
    ds_read_b64_tr_b16 a[100:101], v231 offset:14336
    ds_read_b64_tr_b16 a[102:103], v231 offset:15360
    v_fma_f32 v208, -v200, v210, v200
    v_fma_f32 v209, -v201, v211, v201
    v_cvt_pk_bf16_f32 v212, v208, v209
    s_waitcnt lgkmcnt(12)
    v_mfma_f32_32x32x16_bf16 v[96:111], a[112:115], a[56:59], v[96:111]
    ds_read_b64_tr_b16 a[104:105], v230 offset:20480
    ds_read_b64_tr_b16 a[106:107], v230 offset:21504
    v_accvgpr_write_b32 a92, v212
    v_exp_f32 v213, v202
    v_exp_f32 v214, v203
    v_mfma_f32_32x32x16_bf16 v[112:127], a[116:119], a[56:59], v[112:127]
    ds_read_b64_tr_b16 a[108:109], v231 offset:20480
    ds_read_b64_tr_b16 a[110:111], v231 offset:21504
    buffer_load_dwordx4 v227, s[16:19], s44 offen offset:0 lds
    v_fma_f32 v215, v213, 0.5, 1.0
    v_fma_f32 v216, v214, 0.5, 1.0
    v_fma_f32 v215, v213, v215, 1.0
    v_mfma_f32_32x32x16_bf16 v[96:111], a[120:123], a[60:63], v[96:111]
    ds_read_b64_tr_b16 a[112:113], v230 offset:4096
    ds_read_b64_tr_b16 a[114:115], v230 offset:5120
    v_fma_f32 v216, v214, v216, 1.0
    v_rcp_f32 v215, v215
    v_rcp_f32 v216, v216
    v_mfma_f32_32x32x16_bf16 v[112:127], a[124:127], a[60:63], v[112:127]
    ds_read_b64_tr_b16 a[116:117], v231 offset:4096
    ds_read_b64_tr_b16 a[118:119], v231 offset:5120
    v_fma_f32 v213, -v202, v215, v202
    v_fma_f32 v214, -v203, v216, v203
    v_cvt_pk_bf16_f32 v217, v213, v214
    s_waitcnt lgkmcnt(12)
    v_mfma_f32_32x32x16_bf16 v[96:111], a[128:131], a[64:67], v[96:111]
    ds_read_b64_tr_b16 a[120:121], v230 offset:10240
    ds_read_b64_tr_b16 a[122:123], v230 offset:11264
    buffer_load_dwordx4 v227, s[16:19], s45 offen offset:1024 lds
    v_accvgpr_write_b32 a93, v217
    v_exp_f32 v208, v204
    v_mfma_f32_32x32x16_bf16 v[112:127], a[132:135], a[64:67], v[112:127]
    ds_read_b64_tr_b16 a[124:125], v231 offset:10240
    ds_read_b64_tr_b16 a[126:127], v231 offset:11264
    v_exp_f32 v209, v205
    v_fma_f32 v210, v208, 0.5, 1.0
    v_fma_f32 v211, v209, 0.5, 1.0
    v_mfma_f32_32x32x16_bf16 v[96:111], a[136:139], a[68:71], v[96:111]
    ds_read_b64_tr_b16 a[128:129], v230 offset:16384
    ds_read_b64_tr_b16 a[130:131], v230 offset:17408
    v_fma_f32 v210, v208, v210, 1.0
    v_fma_f32 v211, v209, v211, 1.0
    v_rcp_f32 v210, v210
    v_mfma_f32_32x32x16_bf16 v[112:127], a[140:143], a[68:71], v[112:127]
    ds_read_b64_tr_b16 a[132:133], v231 offset:16384
    ds_read_b64_tr_b16 a[134:135], v231 offset:17408
    v_rcp_f32 v211, v211
    v_fma_f32 v208, -v204, v210, v204
    s_waitcnt lgkmcnt(12)
    v_mfma_f32_32x32x16_bf16 v[96:111], a[96:99], a[72:75], v[96:111]
    ds_read_b64_tr_b16 a[136:137], v230 offset:22528
    ds_read_b64_tr_b16 a[138:139], v230 offset:23552
    v_fma_f32 v209, -v205, v211, v205
    v_cvt_pk_bf16_f32 v212, v208, v209
    v_accvgpr_write_b32 a94, v212
    v_exp_f32 v213, v206
    v_mfma_f32_32x32x16_bf16 v[112:127], a[100:103], a[72:75], v[112:127]
    ds_read_b64_tr_b16 a[140:141], v231 offset:22528
    ds_read_b64_tr_b16 a[142:143], v231 offset:23552
    v_exp_f32 v214, v207
    v_fma_f32 v215, v213, 0.5, 1.0
    v_fma_f32 v216, v214, 0.5, 1.0
    s_waitcnt vmcnt(19)
    s_barrier
    v_mfma_f32_32x32x16_bf16 v[96:111], a[104:107], a[76:79], v[96:111]
    ds_read_b64_tr_b16 a[96:97], v230 offset:24576
    ds_read_b64_tr_b16 a[98:99], v230 offset:25600
    s_add_u32 m0, s34, 24576
    v_add_u32 v227, s77, v235
    v_fma_f32 v215, v213, v215, 1.0
    v_fma_f32 v216, v214, v216, 1.0
    v_mfma_f32_32x32x16_bf16 v[112:127], a[108:111], a[76:79], v[112:127]
    ds_read_b64_tr_b16 a[100:101], v231 offset:24576
    ds_read_b64_tr_b16 a[102:103], v231 offset:25600
    v_rcp_f32 v215, v215
    v_rcp_f32 v216, v216
    v_fma_f32 v213, -v206, v215, v206
    v_fma_f32 v214, -v207, v216, v207
    v_cvt_pk_bf16_f32 v217, v213, v214
    v_accvgpr_write_b32 a95, v217
    s_waitcnt lgkmcnt(12)
    v_mfma_f32_32x32x16_bf16 v[96:111], a[112:115], a[80:83], v[96:111]
    ds_read_b64_tr_b16 a[104:105], v230 offset:30720
    ds_read_b64_tr_b16 a[106:107], v230 offset:31744
    v_mfma_f32_32x32x16_bf16 v[112:127], a[116:119], a[80:83], v[112:127]
    ds_read_b64_tr_b16 a[108:109], v231 offset:30720
    ds_read_b64_tr_b16 a[110:111], v231 offset:31744
    buffer_load_dwordx4 v227, s[16:19], s46 offen offset:0 lds
    v_mfma_f32_32x32x16_bf16 v[96:111], a[120:123], a[84:87], v[96:111]
    ds_read_b64_tr_b16 a[112:113], v230 offset:36864
    ds_read_b64_tr_b16 a[114:115], v230 offset:37888
    v_mfma_f32_32x32x16_bf16 v[112:127], a[124:127], a[84:87], v[112:127]
    ds_read_b64_tr_b16 a[116:117], v231 offset:36864
    ds_read_b64_tr_b16 a[118:119], v231 offset:37888
    s_waitcnt lgkmcnt(12)
    v_mfma_f32_32x32x16_bf16 v[96:111], a[128:131], a[88:91], v[96:111]
    ds_read_b64_tr_b16 a[120:121], v230 offset:43008
    ds_read_b64_tr_b16 a[122:123], v230 offset:44032
    buffer_load_dwordx4 v227, s[16:19], s47 offen offset:1024 lds
    s_add_u32 m0, s34, 26624
    v_mfma_f32_32x32x16_bf16 v[112:127], a[132:135], a[88:91], v[112:127]
    ds_read_b64_tr_b16 a[124:125], v231 offset:43008
    ds_read_b64_tr_b16 a[126:127], v231 offset:44032
    v_mfma_f32_32x32x16_bf16 v[96:111], a[136:139], a[92:95], v[96:111]
    ds_read_b64_tr_b16 a[128:129], v230 offset:26624
    ds_read_b64_tr_b16 a[130:131], v230 offset:27648
    v_mfma_f32_32x32x16_bf16 v[112:127], a[140:143], a[92:95], v[112:127]
    ds_read_b64_tr_b16 a[132:133], v231 offset:26624
    ds_read_b64_tr_b16 a[134:135], v231 offset:27648
    buffer_load_dwordx4 v227, s[16:19], s48 offen offset:0 lds
    s_waitcnt lgkmcnt(12)
    v_mfma_f32_32x32x16_bf16 v[128:143], a[96:99], a[48:51], v[128:143]
    ds_read_b64_tr_b16 a[136:137], v230 offset:32768
    ds_read_b64_tr_b16 a[138:139], v230 offset:33792
    v_mfma_f32_32x32x16_bf16 v[144:159], a[100:103], a[48:51], v[144:159]
    ds_read_b64_tr_b16 a[140:141], v231 offset:32768
    ds_read_b64_tr_b16 a[142:143], v231 offset:33792
    v_cvt_pk_bf16_f32 v96, v96, v97
    v_cvt_pk_bf16_f32 v97, v98, v99
    v_cvt_pk_bf16_f32 v98, v100, v101
    v_cvt_pk_bf16_f32 v99, v102, v103
    v_mfma_f32_32x32x16_bf16 v[128:143], a[104:107], a[52:55], v[128:143]
    ds_read_b64_tr_b16 a[96:97], v230 offset:38912
    ds_read_b64_tr_b16 a[98:99], v230 offset:39936
    s_lshl_b32 s39, s73, 5
    s_add_u32 s39, s39, s38
    buffer_store_dwordx4 v[96:99], v237, s[24:27], s39 offen offset:0 sc1
    v_cvt_pk_bf16_f32 v100, v104, v105
    v_cvt_pk_bf16_f32 v101, v106, v107
    v_cvt_pk_bf16_f32 v102, v108, v109
    v_mfma_f32_32x32x16_bf16 v[144:159], a[108:111], a[52:55], v[144:159]
    ds_read_b64_tr_b16 a[100:101], v231 offset:38912
    ds_read_b64_tr_b16 a[102:103], v231 offset:39936
    buffer_load_dwordx4 v227, s[16:19], s49 offen offset:1024 lds
    s_add_u32 m0, s34, 28672
    v_cvt_pk_bf16_f32 v103, v110, v111
    s_waitcnt lgkmcnt(12)
    v_mfma_f32_32x32x16_bf16 v[128:143], a[112:115], a[56:59], v[128:143]
    ds_read_b64_tr_b16 a[104:105], v230 offset:45056
    ds_read_b64_tr_b16 a[106:107], v230 offset:46080
    buffer_store_dwordx4 v[100:103], v237, s[24:27], s39 offen offset:1024 sc1
    v_cvt_pk_bf16_f32 v112, v112, v113
    v_cvt_pk_bf16_f32 v113, v114, v115
    v_cvt_pk_bf16_f32 v114, v116, v117
    v_mfma_f32_32x32x16_bf16 v[144:159], a[116:119], a[56:59], v[144:159]
    ds_read_b64_tr_b16 a[108:109], v231 offset:45056
    ds_read_b64_tr_b16 a[110:111], v231 offset:46080
    buffer_load_dwordx4 v227, s[16:19], s50 offen offset:0 lds
    v_cvt_pk_bf16_f32 v115, v118, v119
    v_cvt_pk_bf16_f32 v116, v120, v121
    v_cvt_pk_bf16_f32 v117, v122, v123
    v_mfma_f32_32x32x16_bf16 v[128:143], a[120:123], a[60:63], v[128:143]
    ds_read_b64_tr_b16 a[112:113], v230 offset:28672
    ds_read_b64_tr_b16 a[114:115], v230 offset:29696
    buffer_store_dwordx4 v[112:115], v237, s[24:27], s39 offen offset:2048 sc1
    v_cvt_pk_bf16_f32 v118, v124, v125
    v_cvt_pk_bf16_f32 v119, v126, v127
    v_mfma_f32_32x32x16_bf16 v[144:159], a[124:127], a[60:63], v[144:159]
    ds_read_b64_tr_b16 a[116:117], v231 offset:28672
    ds_read_b64_tr_b16 a[118:119], v231 offset:29696
    s_waitcnt lgkmcnt(12)
    v_mfma_f32_32x32x16_bf16 v[128:143], a[128:131], a[64:67], v[128:143]
    ds_read_b64_tr_b16 a[120:121], v230 offset:34816
    ds_read_b64_tr_b16 a[122:123], v230 offset:35840
    buffer_store_dwordx4 v[116:119], v237, s[24:27], s39 offen offset:3072 sc1
    v_mfma_f32_32x32x16_bf16 v[144:159], a[132:135], a[64:67], v[144:159]
    ds_read_b64_tr_b16 a[124:125], v231 offset:34816
    ds_read_b64_tr_b16 a[126:127], v231 offset:35840
    buffer_load_dwordx4 v227, s[16:19], s51 offen offset:1024 lds
    v_mfma_f32_32x32x16_bf16 v[128:143], a[136:139], a[68:71], v[128:143]
    ds_read_b64_tr_b16 a[128:129], v230 offset:40960
    ds_read_b64_tr_b16 a[130:131], v230 offset:41984
    v_mfma_f32_32x32x16_bf16 v[144:159], a[140:143], a[68:71], v[144:159]
    ds_read_b64_tr_b16 a[132:133], v231 offset:40960
    ds_read_b64_tr_b16 a[134:135], v231 offset:41984
    s_waitcnt lgkmcnt(12)
    v_mfma_f32_32x32x16_bf16 v[128:143], a[96:99], a[72:75], v[128:143]
    ds_read_b64_tr_b16 a[136:137], v230 offset:47104
    ds_read_b64_tr_b16 a[138:139], v230 offset:48128
    v_mfma_f32_32x32x16_bf16 v[144:159], a[100:103], a[72:75], v[144:159]
    ds_read_b64_tr_b16 a[140:141], v231 offset:47104
    ds_read_b64_tr_b16 a[142:143], v231 offset:48128
    s_waitcnt vmcnt(23)
    s_barrier
    v_mfma_f32_32x32x16_bf16 v[128:143], a[104:107], a[76:79], v[128:143]
    ds_read_b64_tr_b16 a[96:97], v232 offset:0
    ds_read_b64_tr_b16 a[98:99], v232 offset:1024
    s_add_u32 m0, s34, 49152
    v_add_u32 v227, s75, v235
    v_mfma_f32_32x32x16_bf16 v[144:159], a[108:111], a[76:79], v[144:159]
    ds_read_b64_tr_b16 a[100:101], v233 offset:0
    ds_read_b64_tr_b16 a[102:103], v233 offset:1024
    s_waitcnt lgkmcnt(12)
    v_mfma_f32_32x32x16_bf16 v[128:143], a[112:115], a[80:83], v[128:143]
    ds_read_b64_tr_b16 a[104:105], v232 offset:6144
    ds_read_b64_tr_b16 a[106:107], v232 offset:7168
    v_mfma_f32_32x32x16_bf16 v[144:159], a[116:119], a[80:83], v[144:159]
    ds_read_b64_tr_b16 a[108:109], v233 offset:6144
    ds_read_b64_tr_b16 a[110:111], v233 offset:7168
    buffer_load_dwordx4 v227, s[16:19], s40 offen offset:0 lds
    v_mfma_f32_32x32x16_bf16 v[128:143], a[120:123], a[84:87], v[128:143]
    ds_read_b64_tr_b16 a[112:113], v232 offset:12288
    ds_read_b64_tr_b16 a[114:115], v232 offset:13312
    v_mfma_f32_32x32x16_bf16 v[144:159], a[124:127], a[84:87], v[144:159]
    ds_read_b64_tr_b16 a[116:117], v233 offset:12288
    ds_read_b64_tr_b16 a[118:119], v233 offset:13312
    s_waitcnt lgkmcnt(12)
    v_mfma_f32_32x32x16_bf16 v[128:143], a[128:131], a[88:91], v[128:143]
    ds_read_b64_tr_b16 a[120:121], v232 offset:18432
    ds_read_b64_tr_b16 a[122:123], v232 offset:19456
    buffer_load_dwordx4 v227, s[16:19], s41 offen offset:1024 lds
    s_add_u32 m0, s34, 51200
    v_mfma_f32_32x32x16_bf16 v[144:159], a[132:135], a[88:91], v[144:159]
    ds_read_b64_tr_b16 a[124:125], v233 offset:18432
    ds_read_b64_tr_b16 a[126:127], v233 offset:19456
    v_mfma_f32_32x32x16_bf16 v[128:143], a[136:139], a[92:95], v[128:143]
    ds_read_b64_tr_b16 a[128:129], v232 offset:2048
    ds_read_b64_tr_b16 a[130:131], v232 offset:3072
    v_mfma_f32_32x32x16_bf16 v[144:159], a[140:143], a[92:95], v[144:159]
    ds_read_b64_tr_b16 a[132:133], v233 offset:2048
    ds_read_b64_tr_b16 a[134:135], v233 offset:3072
    buffer_load_dwordx4 v227, s[16:19], s42 offen offset:0 lds
    s_waitcnt lgkmcnt(12)
    v_mfma_f32_32x32x16_bf16 v[96:111], a[96:99], a[0:3], 0
    ds_read_b64_tr_b16 a[136:137], v232 offset:8192
    ds_read_b64_tr_b16 a[138:139], v232 offset:9216
    v_mfma_f32_32x32x16_bf16 v[112:127], a[100:103], a[0:3], 0
    ds_read_b64_tr_b16 a[140:141], v233 offset:8192
    ds_read_b64_tr_b16 a[142:143], v233 offset:9216
    v_cvt_pk_bf16_f32 v128, v128, v129
    v_cvt_pk_bf16_f32 v129, v130, v131
    v_cvt_pk_bf16_f32 v130, v132, v133
    v_cvt_pk_bf16_f32 v131, v134, v135
    v_mfma_f32_32x32x16_bf16 v[96:111], a[104:107], a[4:7], v[96:111]
    ds_read_b64_tr_b16 a[96:97], v232 offset:14336
    ds_read_b64_tr_b16 a[98:99], v232 offset:15360
    s_waitcnt vmcnt(19)
    v_and_b32 v238, 0xff, v238
    v_cmp_gt_u32 vcc, 16, v238
    s_cbranch_vccnz L_slowg
L_backg:
    v_cvt_pk_bf16_f32 v132, v136, v137
    v_mfma_f32_32x32x16_bf16 v[112:127], a[108:111], a[4:7], v[112:127]
    ds_read_b64_tr_b16 a[100:101], v233 offset:14336
    ds_read_b64_tr_b16 a[102:103], v233 offset:15360
    s_lshl_b32 s39, s76, 5
    s_add_u32 s39, s39, s38
    buffer_store_dwordx4 v[128:131], v237, s[24:27], s39 offen offset:0 sc1
    v_cvt_pk_bf16_f32 v133, v138, v139
    v_cvt_pk_bf16_f32 v134, v140, v141
    s_waitcnt lgkmcnt(12)
    v_mfma_f32_32x32x16_bf16 v[96:111], a[112:115], a[8:11], v[96:111]
    ds_read_b64_tr_b16 a[104:105], v232 offset:20480
    ds_read_b64_tr_b16 a[106:107], v232 offset:21504
    buffer_load_dwordx4 v227, s[16:19], s43 offen offset:1024 lds
    s_add_u32 m0, s34, 53248
    v_cvt_pk_bf16_f32 v135, v142, v143
    v_cvt_pk_bf16_f32 v144, v144, v145
    v_mfma_f32_32x32x16_bf16 v[112:127], a[116:119], a[8:11], v[112:127]
    ds_read_b64_tr_b16 a[108:109], v233 offset:20480
    ds_read_b64_tr_b16 a[110:111], v233 offset:21504
    buffer_store_dwordx4 v[132:135], v237, s[24:27], s39 offen offset:1024 sc1
    v_cvt_pk_bf16_f32 v145, v146, v147
    v_cvt_pk_bf16_f32 v146, v148, v149
    v_cvt_pk_bf16_f32 v147, v150, v151
    v_mfma_f32_32x32x16_bf16 v[96:111], a[120:123], a[12:15], v[96:111]
    ds_read_b64_tr_b16 a[112:113], v232 offset:4096
    ds_read_b64_tr_b16 a[114:115], v232 offset:5120
    buffer_store_dwordx4 v[144:147], v237, s[24:27], s39 offen offset:2048 sc1
    v_cvt_pk_bf16_f32 v148, v152, v153
    v_cvt_pk_bf16_f32 v149, v154, v155
    v_cvt_pk_bf16_f32 v150, v156, v157
    v_mfma_f32_32x32x16_bf16 v[112:127], a[124:127], a[12:15], v[112:127]
    ds_read_b64_tr_b16 a[116:117], v233 offset:4096
    ds_read_b64_tr_b16 a[118:119], v233 offset:5120
    buffer_load_dwordx4 v227, s[16:19], s44 offen offset:0 lds
    v_cvt_pk_bf16_f32 v151, v158, v159
    s_waitcnt lgkmcnt(12)
    v_mfma_f32_32x32x16_bf16 v[96:111], a[128:131], a[16:19], v[96:111]
    ds_read_b64_tr_b16 a[120:121], v232 offset:10240
    ds_read_b64_tr_b16 a[122:123], v232 offset:11264
    buffer_store_dwordx4 v[148:151], v237, s[24:27], s39 offen offset:3072 sc1
    v_mfma_f32_32x32x16_bf16 v[112:127], a[132:135], a[16:19], v[112:127]
    ds_read_b64_tr_b16 a[124:125], v233 offset:10240
    ds_read_b64_tr_b16 a[126:127], v233 offset:11264
    buffer_load_dwordx4 v227, s[16:19], s45 offen offset:1024 lds
    v_mfma_f32_32x32x16_bf16 v[96:111], a[136:139], a[20:23], v[96:111]
    ds_read_b64_tr_b16 a[128:129], v232 offset:16384
    ds_read_b64_tr_b16 a[130:131], v232 offset:17408
    v_mfma_f32_32x32x16_bf16 v[112:127], a[140:143], a[20:23], v[112:127]
    ds_read_b64_tr_b16 a[132:133], v233 offset:16384
    ds_read_b64_tr_b16 a[134:135], v233 offset:17408
    s_waitcnt lgkmcnt(12)
    v_mfma_f32_32x32x16_bf16 v[96:111], a[96:99], a[24:27], v[96:111]
    ds_read_b64_tr_b16 a[136:137], v232 offset:22528
    ds_read_b64_tr_b16 a[138:139], v232 offset:23552
    v_mfma_f32_32x32x16_bf16 v[112:127], a[100:103], a[24:27], v[112:127]
    ds_read_b64_tr_b16 a[140:141], v233 offset:22528
    ds_read_b64_tr_b16 a[142:143], v233 offset:23552
    s_barrier
    v_mfma_f32_32x32x16_bf16 v[96:111], a[104:107], a[28:31], v[96:111]
    ds_read_b64_tr_b16 a[96:97], v232 offset:24576
    ds_read_b64_tr_b16 a[98:99], v232 offset:25600
    s_add_u32 m0, s34, 73728
    v_add_u32 v227, s75, v235
    v_mfma_f32_32x32x16_bf16 v[112:127], a[108:111], a[28:31], v[112:127]
    ds_read_b64_tr_b16 a[100:101], v233 offset:24576
    ds_read_b64_tr_b16 a[102:103], v233 offset:25600
    s_waitcnt lgkmcnt(12)
    v_mfma_f32_32x32x16_bf16 v[96:111], a[112:115], a[32:35], v[96:111]
    ds_read_b64_tr_b16 a[104:105], v232 offset:30720
    ds_read_b64_tr_b16 a[106:107], v232 offset:31744
    v_mfma_f32_32x32x16_bf16 v[112:127], a[116:119], a[32:35], v[112:127]
    ds_read_b64_tr_b16 a[108:109], v233 offset:30720
    ds_read_b64_tr_b16 a[110:111], v233 offset:31744
    buffer_load_dwordx4 v227, s[16:19], s46 offen offset:0 lds
    v_mfma_f32_32x32x16_bf16 v[96:111], a[120:123], a[36:39], v[96:111]
    ds_read_b64_tr_b16 a[112:113], v232 offset:36864
    ds_read_b64_tr_b16 a[114:115], v232 offset:37888
    v_mfma_f32_32x32x16_bf16 v[112:127], a[124:127], a[36:39], v[112:127]
    ds_read_b64_tr_b16 a[116:117], v233 offset:36864
    ds_read_b64_tr_b16 a[118:119], v233 offset:37888
    s_waitcnt vmcnt(12)
    buffer_store_dword v249, v225, s[24:27], s85 offen offset:0 sc1
    s_waitcnt lgkmcnt(12)
    v_mfma_f32_32x32x16_bf16 v[96:111], a[128:131], a[40:43], v[96:111]
    ds_read_b64_tr_b16 a[120:121], v232 offset:43008
    ds_read_b64_tr_b16 a[122:123], v232 offset:44032
    buffer_load_dwordx4 v227, s[16:19], s47 offen offset:1024 lds
    s_add_u32 m0, s34, 75776
    v_mfma_f32_32x32x16_bf16 v[112:127], a[132:135], a[40:43], v[112:127]
    ds_read_b64_tr_b16 a[124:125], v233 offset:43008
    ds_read_b64_tr_b16 a[126:127], v233 offset:44032
    v_mfma_f32_32x32x16_bf16 v[96:111], a[136:139], a[44:47], v[96:111]
    ds_read_b64_tr_b16 a[128:129], v232 offset:26624
    ds_read_b64_tr_b16 a[130:131], v232 offset:27648
    v_mfma_f32_32x32x16_bf16 v[112:127], a[140:143], a[44:47], v[112:127]
    ds_read_b64_tr_b16 a[132:133], v233 offset:26624
    ds_read_b64_tr_b16 a[134:135], v233 offset:27648
    buffer_load_dwordx4 v227, s[16:19], s48 offen offset:0 lds
    s_waitcnt lgkmcnt(12)
    v_mfma_f32_32x32x16_bf16 v[96:111], a[96:99], a[48:51], v[96:111]
    ds_read_b64_tr_b16 a[136:137], v232 offset:32768
    ds_read_b64_tr_b16 a[138:139], v232 offset:33792
    v_mfma_f32_32x32x16_bf16 v[112:127], a[100:103], a[48:51], v[112:127]
    ds_read_b64_tr_b16 a[140:141], v233 offset:32768
    ds_read_b64_tr_b16 a[142:143], v233 offset:33792
    v_mfma_f32_32x32x16_bf16 v[96:111], a[104:107], a[52:55], v[96:111]
    ds_read_b64_tr_b16 a[96:97], v232 offset:38912
    ds_read_b64_tr_b16 a[98:99], v232 offset:39936
    buffer_load_dwordx4 v227, s[16:19], s49 offen offset:1024 lds
    s_add_u32 m0, s34, 77824
    v_mfma_f32_32x32x16_bf16 v[112:127], a[108:111], a[52:55], v[112:127]
    ds_read_b64_tr_b16 a[100:101], v233 offset:38912
    ds_read_b64_tr_b16 a[102:103], v233 offset:39936
    s_waitcnt lgkmcnt(12)
    v_mfma_f32_32x32x16_bf16 v[96:111], a[112:115], a[56:59], v[96:111]
    ds_read_b64_tr_b16 a[104:105], v232 offset:45056
    ds_read_b64_tr_b16 a[106:107], v232 offset:46080
    v_mfma_f32_32x32x16_bf16 v[112:127], a[116:119], a[56:59], v[112:127]
    ds_read_b64_tr_b16 a[108:109], v233 offset:45056
    ds_read_b64_tr_b16 a[110:111], v233 offset:46080
    buffer_load_dwordx4 v227, s[16:19], s50 offen offset:0 lds
    v_mfma_f32_32x32x16_bf16 v[96:111], a[120:123], a[60:63], v[96:111]
    ds_read_b64_tr_b16 a[112:113], v232 offset:28672
    ds_read_b64_tr_b16 a[114:115], v232 offset:29696
    v_mfma_f32_32x32x16_bf16 v[112:127], a[124:127], a[60:63], v[112:127]
    ds_read_b64_tr_b16 a[116:117], v233 offset:28672
    ds_read_b64_tr_b16 a[118:119], v233 offset:29696
    s_waitcnt lgkmcnt(12)
    v_mfma_f32_32x32x16_bf16 v[96:111], a[128:131], a[64:67], v[96:111]
    ds_read_b64_tr_b16 a[120:121], v232 offset:34816
    ds_read_b64_tr_b16 a[122:123], v232 offset:35840
    buffer_load_dwordx4 v227, s[16:19], s51 offen offset:1024 lds
    v_mfma_f32_32x32x16_bf16 v[112:127], a[132:135], a[64:67], v[112:127]
    ds_read_b64_tr_b16 a[124:125], v233 offset:34816
    ds_read_b64_tr_b16 a[126:127], v233 offset:35840
    v_mfma_f32_32x32x16_bf16 v[96:111], a[136:139], a[68:71], v[96:111]
    ds_read_b64_tr_b16 a[128:129], v232 offset:40960
    ds_read_b64_tr_b16 a[130:131], v232 offset:41984
    v_mfma_f32_32x32x16_bf16 v[112:127], a[140:143], a[68:71], v[112:127]
    ds_read_b64_tr_b16 a[132:133], v233 offset:40960
    ds_read_b64_tr_b16 a[134:135], v233 offset:41984
    s_waitcnt lgkmcnt(12)
    v_mfma_f32_32x32x16_bf16 v[96:111], a[96:99], a[72:75], v[96:111]
    ds_read_b64_tr_b16 a[136:137], v232 offset:47104
    ds_read_b64_tr_b16 a[138:139], v232 offset:48128
    v_mfma_f32_32x32x16_bf16 v[112:127], a[100:103], a[72:75], v[112:127]
    ds_read_b64_tr_b16 a[140:141], v233 offset:47104
    ds_read_b64_tr_b16 a[142:143], v233 offset:48128
    s_barrier
    v_mfma_f32_32x32x16_bf16 v[96:111], a[104:107], a[76:79], v[96:111]
    ds_read_b64_tr_b16 a[96:97], v228 offset:0
    ds_read_b64_tr_b16 a[98:99], v228 offset:1024
    s_add_u32 m0, s34, 98304
    v_add_u32 v227, s78, v235
    s_mov_b32 s12, s0
    s_and_b32 s13, s1, 0xffff
    v_mfma_f32_32x32x16_bf16 v[112:127], a[108:111], a[76:79], v[112:127]
    ds_read_b64_tr_b16 a[100:101], v229 offset:0
    ds_read_b64_tr_b16 a[102:103], v229 offset:1024
    s_mov_b32 s14, 2359296
    s_mov_b32 s15, 0x20000
    v_mov_b32 v218, 0x3f80
    s_waitcnt lgkmcnt(12)
    v_mfma_f32_32x32x16_bf16 v[96:111], a[112:115], a[80:83], v[96:111]
    ds_read_b64_tr_b16 a[104:105], v228 offset:6144
    ds_read_b64_tr_b16 a[106:107], v228 offset:7168
    v_mov_b32 v219, 0x3f800000
    s_cmp_eq_u32 s3, s33
    s_cselect_b64 s[56:57], -1, 0
    s_cmp_eq_u32 s3, s33
    s_cselect_b32 s59, 0x7ff00000, s59
    v_mfma_f32_32x32x16_bf16 v[112:127], a[116:119], a[80:83], v[112:127]
    ds_read_b64_tr_b16 a[108:109], v229 offset:6144
    ds_read_b64_tr_b16 a[110:111], v229 offset:7168
    buffer_load_dwordx4 v227, s[16:19], s40 offen offset:0 lds
    v_add_u32 v236, 147456, v237
    s_lshl_b32 s58, s3, 10
    v_add_u32 v234, s58, v236
    v_mfma_f32_32x32x16_bf16 v[96:111], a[120:123], a[84:87], v[96:111]
    ds_read_b64_tr_b16 a[112:113], v228 offset:12288
    ds_read_b64_tr_b16 a[114:115], v228 offset:13312
    s_add_u32 s58, s58, s52
    s_add_u32 s79, s33, 1
    s_and_b32 s79, s79, 3
    s_mul_i32 s79, s79, 2359296
    v_mfma_f32_32x32x16_bf16 v[112:127], a[124:127], a[84:87], v[112:127]
    ds_read_b64_tr_b16 a[116:117], v229 offset:12288
    ds_read_b64_tr_b16 a[118:119], v229 offset:13312
    s_waitcnt vmcnt(9)
    buffer_store_dword v249, v225, s[24:27], s85 offen offset:128 sc1
    s_waitcnt lgkmcnt(12)
    v_mfma_f32_32x32x16_bf16 v[96:111], a[128:131], a[88:91], v[96:111]
    ds_read_b64_tr_b16 a[120:121], v228 offset:18432
    ds_read_b64_tr_b16 a[122:123], v228 offset:19456
    buffer_load_dwordx4 v227, s[16:19], s41 offen offset:1024 lds
    s_add_u32 m0, s34, 100352
    s_add_u32 s79, s79, s58
    s_add_u32 s80, s33, 2
    v_mfma_f32_32x32x16_bf16 v[112:127], a[132:135], a[88:91], v[112:127]
    ds_read_b64_tr_b16 a[124:125], v229 offset:18432
    ds_read_b64_tr_b16 a[126:127], v229 offset:19456
    s_and_b32 s80, s80, 3
    s_mul_i32 s80, s80, 2359296
    s_add_u32 s80, s80, s58
    s_add_u32 s81, s33, 3
    v_mfma_f32_32x32x16_bf16 v[96:111], a[136:139], a[92:95], v[96:111]
    ds_read_b64_tr_b16 a[128:129], v228 offset:2048
    ds_read_b64_tr_b16 a[130:131], v228 offset:3072
    s_and_b32 s81, s81, 3
    s_mul_i32 s81, s81, 2359296
    s_add_u32 s81, s81, s58
    s_mul_i32 s37, s3, 9216
    v_mfma_f32_32x32x16_bf16 v[112:127], a[140:143], a[92:95], v[112:127]
    ds_read_b64_tr_b16 a[132:133], v229 offset:2048
    ds_read_b64_tr_b16 a[134:135], v229 offset:3072
    buffer_load_dwordx4 v227, s[16:19], s42 offen offset:0 lds
    s_add_u32 s37, s37, s52
    s_add_u32 s37, s37, 42991616
    s_waitcnt lgkmcnt(12)
    v_mfma_f32_32x32x16_bf16 v[128:143], a[96:99], a[0:3], 0
    ds_read_b64_tr_b16 a[136:137], v228 offset:8192
    ds_read_b64_tr_b16 a[138:139], v228 offset:9216
    v_mfma_f32_32x32x16_bf16 v[144:159], a[100:103], a[0:3], 0
    ds_read_b64_tr_b16 a[140:141], v229 offset:8192
    ds_read_b64_tr_b16 a[142:143], v229 offset:9216
    v_cvt_pk_bf16_f32 v96, v96, v97
    v_cvt_pk_bf16_f32 v97, v98, v99
    v_cvt_pk_bf16_f32 v98, v100, v101
    v_cvt_pk_bf16_f32 v99, v102, v103
    s_nop 0
L_sm8:
    s_cbranch_execz L_retm
    v_mfma_f32_32x32x16_bf16 v[128:143], a[104:107], a[4:7], v[128:143]
    ds_read_b64_tr_b16 a[96:97], v228 offset:14336
    ds_read_b64_tr_b16 a[98:99], v228 offset:15360
    s_lshl_b32 s39, s74, 5
    s_add_u32 s39, s39, s38
    buffer_store_dwordx4 v[96:99], v237, s[24:27], s39 offen offset:0 sc1
    v_cvt_pk_bf16_f32 v100, v104, v105
    v_cvt_pk_bf16_f32 v101, v106, v107
    v_cvt_pk_bf16_f32 v102, v108, v109
    v_mfma_f32_32x32x16_bf16 v[144:159], a[108:111], a[4:7], v[144:159]
    ds_read_b64_tr_b16 a[100:101], v229 offset:14336
    ds_read_b64_tr_b16 a[102:103], v229 offset:15360
    buffer_load_dwordx4 v227, s[16:19], s43 offen offset:1024 lds
    s_add_u32 m0, s34, 102400
    v_cvt_pk_bf16_f32 v103, v110, v111
    s_waitcnt lgkmcnt(12)
    v_mfma_f32_32x32x16_bf16 v[128:143], a[112:115], a[8:11], v[128:143]
    ds_read_b64_tr_b16 a[104:105], v228 offset:20480
    ds_read_b64_tr_b16 a[106:107], v228 offset:21504
    buffer_store_dwordx4 v[100:103], v237, s[24:27], s39 offen offset:1024 sc1
    v_cvt_pk_bf16_f32 v112, v112, v113
    v_cvt_pk_bf16_f32 v113, v114, v115
    v_cvt_pk_bf16_f32 v114, v116, v117
    v_mfma_f32_32x32x16_bf16 v[144:159], a[116:119], a[8:11], v[144:159]
    ds_read_b64_tr_b16 a[108:109], v229 offset:20480
    ds_read_b64_tr_b16 a[110:111], v229 offset:21504
    buffer_load_dwordx4 v227, s[16:19], s44 offen offset:0 lds
    v_cvt_pk_bf16_f32 v115, v118, v119
    v_cvt_pk_bf16_f32 v116, v120, v121
    v_cvt_pk_bf16_f32 v117, v122, v123
    v_mfma_f32_32x32x16_bf16 v[128:143], a[120:123], a[12:15], v[128:143]
    ds_read_b64_tr_b16 a[112:113], v228 offset:4096
    ds_read_b64_tr_b16 a[114:115], v228 offset:5120
    buffer_store_dwordx4 v[112:115], v237, s[24:27], s39 offen offset:2048 sc1
    v_cvt_pk_bf16_f32 v118, v124, v125
    v_cvt_pk_bf16_f32 v119, v126, v127
    v_mfma_f32_32x32x16_bf16 v[144:159], a[124:127], a[12:15], v[144:159]
    ds_read_b64_tr_b16 a[116:117], v229 offset:4096
    ds_read_b64_tr_b16 a[118:119], v229 offset:5120
    s_waitcnt lgkmcnt(12)
    v_mfma_f32_32x32x16_bf16 v[128:143], a[128:131], a[16:19], v[128:143]
    ds_read_b64_tr_b16 a[120:121], v228 offset:10240
    ds_read_b64_tr_b16 a[122:123], v228 offset:11264
    buffer_store_dwordx4 v[116:119], v237, s[24:27], s39 offen offset:3072 sc1
    v_mfma_f32_32x32x16_bf16 v[144:159], a[132:135], a[16:19], v[144:159]
    ds_read_b64_tr_b16 a[124:125], v229 offset:10240
    ds_read_b64_tr_b16 a[126:127], v229 offset:11264
    buffer_load_dwordx4 v227, s[16:19], s45 offen offset:1024 lds
    v_mfma_f32_32x32x16_bf16 v[128:143], a[136:139], a[20:23], v[128:143]
    ds_read_b64_tr_b16 a[128:129], v228 offset:16384
    ds_read_b64_tr_b16 a[130:131], v228 offset:17408
    v_mfma_f32_32x32x16_bf16 v[144:159], a[140:143], a[20:23], v[144:159]
    ds_read_b64_tr_b16 a[132:133], v229 offset:16384
    ds_read_b64_tr_b16 a[134:135], v229 offset:17408
    s_waitcnt lgkmcnt(12)
    v_mfma_f32_32x32x16_bf16 v[128:143], a[96:99], a[24:27], v[128:143]
    ds_read_b64_tr_b16 a[136:137], v228 offset:22528
    ds_read_b64_tr_b16 a[138:139], v228 offset:23552
    v_mfma_f32_32x32x16_bf16 v[144:159], a[100:103], a[24:27], v[144:159]
    ds_read_b64_tr_b16 a[140:141], v229 offset:22528
    ds_read_b64_tr_b16 a[142:143], v229 offset:23552
    s_barrier
    v_mfma_f32_32x32x16_bf16 v[128:143], a[104:107], a[28:31], v[128:143]
    ds_read_b64_tr_b16 a[96:97], v228 offset:24576
    ds_read_b64_tr_b16 a[98:99], v228 offset:25600
    s_add_u32 m0, s34, 122880
    v_add_u32 v227, s78, v235
    v_mfma_f32_32x32x16_bf16 v[144:159], a[108:111], a[28:31], v[144:159]
    ds_read_b64_tr_b16 a[100:101], v229 offset:24576
    ds_read_b64_tr_b16 a[102:103], v229 offset:25600
    s_waitcnt lgkmcnt(12)
    v_mfma_f32_32x32x16_bf16 v[128:143], a[112:115], a[32:35], v[128:143]
    ds_read_b64_tr_b16 a[104:105], v228 offset:30720
    ds_read_b64_tr_b16 a[106:107], v228 offset:31744
    buffer_load_dword v238, v241, s[24:27], s62 offen offset:0 sc1
    v_mfma_f32_32x32x16_bf16 v[144:159], a[116:119], a[32:35], v[144:159]
    ds_read_b64_tr_b16 a[108:109], v229 offset:30720
    ds_read_b64_tr_b16 a[110:111], v229 offset:31744
    buffer_load_dwordx4 v227, s[16:19], s46 offen offset:0 lds
    v_mfma_f32_32x32x16_bf16 v[128:143], a[120:123], a[36:39], v[128:143]
    ds_read_b64_tr_b16 a[112:113], v228 offset:36864
    ds_read_b64_tr_b16 a[114:115], v228 offset:37888
    v_mfma_f32_32x32x16_bf16 v[144:159], a[124:127], a[36:39], v[144:159]
    ds_read_b64_tr_b16 a[116:117], v229 offset:36864
    ds_read_b64_tr_b16 a[118:119], v229 offset:37888
    s_waitcnt lgkmcnt(12)
    v_mfma_f32_32x32x16_bf16 v[128:143], a[128:131], a[40:43], v[128:143]
    ds_read_b64_tr_b16 a[120:121], v228 offset:43008
    ds_read_b64_tr_b16 a[122:123], v228 offset:44032
    buffer_load_dwordx4 v227, s[16:19], s47 offen offset:1024 lds
    s_add_u32 m0, s34, 124928
    v_mfma_f32_32x32x16_bf16 v[144:159], a[132:135], a[40:43], v[144:159]
    ds_read_b64_tr_b16 a[124:125], v229 offset:43008
    ds_read_b64_tr_b16 a[126:127], v229 offset:44032
    v_mfma_f32_32x32x16_bf16 v[128:143], a[136:139], a[44:47], v[128:143]
    ds_read_b64_tr_b16 a[128:129], v228 offset:26624
    ds_read_b64_tr_b16 a[130:131], v228 offset:27648
    v_mfma_f32_32x32x16_bf16 v[144:159], a[140:143], a[44:47], v[144:159]
    ds_read_b64_tr_b16 a[132:133], v229 offset:26624
    ds_read_b64_tr_b16 a[134:135], v229 offset:27648
    buffer_load_dwordx4 v227, s[16:19], s48 offen offset:0 lds
    s_waitcnt lgkmcnt(12)
    v_mfma_f32_32x32x16_bf16 v[128:143], a[96:99], a[48:51], v[128:143]
    ds_read_b64_tr_b16 a[136:137], v228 offset:32768
    ds_read_b64_tr_b16 a[138:139], v228 offset:33792
    v_mfma_f32_32x32x16_bf16 v[144:159], a[100:103], a[48:51], v[144:159]
    ds_read_b64_tr_b16 a[140:141], v229 offset:32768
    ds_read_b64_tr_b16 a[142:143], v229 offset:33792
    v_mfma_f32_32x32x16_bf16 v[128:143], a[104:107], a[52:55], v[128:143]
    ds_read_b64_tr_b16 a[96:97], v228 offset:38912
    ds_read_b64_tr_b16 a[98:99], v228 offset:39936
    buffer_load_dwordx4 v227, s[16:19], s49 offen offset:1024 lds
    s_add_u32 m0, s34, 126976
    v_mfma_f32_32x32x16_bf16 v[144:159], a[108:111], a[52:55], v[144:159]
    ds_read_b64_tr_b16 a[100:101], v229 offset:38912
    ds_read_b64_tr_b16 a[102:103], v229 offset:39936
    s_waitcnt lgkmcnt(12)
    v_mfma_f32_32x32x16_bf16 v[128:143], a[112:115], a[56:59], v[128:143]
    ds_read_b64_tr_b16 a[104:105], v228 offset:45056
    ds_read_b64_tr_b16 a[106:107], v228 offset:46080
    v_mfma_f32_32x32x16_bf16 v[144:159], a[116:119], a[56:59], v[144:159]
    ds_read_b64_tr_b16 a[108:109], v229 offset:45056
    ds_read_b64_tr_b16 a[110:111], v229 offset:46080
    buffer_load_dwordx4 v227, s[16:19], s50 offen offset:0 lds
    v_mfma_f32_32x32x16_bf16 v[128:143], a[120:123], a[60:63], v[128:143]
    ds_read_b64_tr_b16 a[112:113], v228 offset:28672
    ds_read_b64_tr_b16 a[114:115], v228 offset:29696
    v_mfma_f32_32x32x16_bf16 v[144:159], a[124:127], a[60:63], v[144:159]
    ds_read_b64_tr_b16 a[116:117], v229 offset:28672
    ds_read_b64_tr_b16 a[118:119], v229 offset:29696
    s_waitcnt lgkmcnt(12)
    v_mfma_f32_32x32x16_bf16 v[128:143], a[128:131], a[64:67], v[128:143]
    ds_read_b64_tr_b16 a[120:121], v228 offset:34816
    ds_read_b64_tr_b16 a[122:123], v228 offset:35840
    buffer_load_dwordx4 v227, s[16:19], s51 offen offset:1024 lds
    v_mfma_f32_32x32x16_bf16 v[144:159], a[132:135], a[64:67], v[144:159]
    ds_read_b64_tr_b16 a[124:125], v229 offset:34816
    ds_read_b64_tr_b16 a[126:127], v229 offset:35840
    v_mfma_f32_32x32x16_bf16 v[128:143], a[136:139], a[68:71], v[128:143]
    ds_read_b64_tr_b16 a[128:129], v228 offset:40960
    ds_read_b64_tr_b16 a[130:131], v228 offset:41984
    v_mfma_f32_32x32x16_bf16 v[144:159], a[140:143], a[68:71], v[144:159]
    ds_read_b64_tr_b16 a[132:133], v229 offset:40960
    ds_read_b64_tr_b16 a[134:135], v229 offset:41984
    s_waitcnt lgkmcnt(12)
    v_mfma_f32_32x32x16_bf16 v[128:143], a[96:99], a[72:75], v[128:143]
    ds_read_b64_tr_b16 a[136:137], v228 offset:47104
    ds_read_b64_tr_b16 a[138:139], v228 offset:48128
    v_mfma_f32_32x32x16_bf16 v[144:159], a[100:103], a[72:75], v[144:159]
    ds_read_b64_tr_b16 a[140:141], v229 offset:47104
    ds_read_b64_tr_b16 a[142:143], v229 offset:48128
    s_waitcnt vmcnt(25)
    s_barrier
    v_mfma_f32_32x32x16_bf16 v[128:143], a[104:107], a[76:79], v[128:143]
    ds_read_b64_tr_b16 a[96:97], v230 offset:0
    ds_read_b64_tr_b16 a[98:99], v230 offset:1024
    s_add_u32 m0, s34, 0
    v_add_u32 v227, s70, v235
    v_mfma_f32_32x32x16_bf16 v[144:159], a[108:111], a[76:79], v[144:159]
    ds_read_b64_tr_b16 a[100:101], v231 offset:0
    ds_read_b64_tr_b16 a[102:103], v231 offset:1024
    s_waitcnt lgkmcnt(12)
    v_mfma_f32_32x32x16_bf16 v[128:143], a[112:115], a[80:83], v[128:143]
    ds_read_b64_tr_b16 a[104:105], v230 offset:6144
    ds_read_b64_tr_b16 a[106:107], v230 offset:7168
    v_mfma_f32_32x32x16_bf16 v[144:159], a[116:119], a[80:83], v[144:159]
    ds_read_b64_tr_b16 a[108:109], v231 offset:6144
    ds_read_b64_tr_b16 a[110:111], v231 offset:7168
    buffer_load_dwordx4 v227, s[16:19], s40 offen offset:0 lds
    v_mfma_f32_32x32x16_bf16 v[128:143], a[120:123], a[84:87], v[128:143]
    ds_read_b64_tr_b16 a[112:113], v230 offset:12288
    ds_read_b64_tr_b16 a[114:115], v230 offset:13312
    s_waitcnt vmcnt(7)
    v_cmp_ne_u32 vcc, 1, v238
    s_cbranch_vccnz L_slowp0
L_backp0:
    s_lshl_b32 s36, s70, 5
    s_add_u32 s36, s36, s60
    v_mfma_f32_32x32x16_bf16 v[144:159], a[124:127], a[84:87], v[144:159]
    ds_read_b64_tr_b16 a[116:117], v231 offset:12288
    ds_read_b64_tr_b16 a[118:119], v231 offset:13312
    buffer_store_dword v249, v225, s[24:27], s85 offen offset:256 sc1
    s_waitcnt lgkmcnt(12)
    v_mfma_f32_32x32x16_bf16 v[128:143], a[128:131], a[88:91], v[128:143]
    ds_read_b64_tr_b16 a[120:121], v230 offset:18432
    ds_read_b64_tr_b16 a[122:123], v230 offset:19456
    buffer_load_dwordx4 v[160:163], v237, s[24:27], s36 offen offset:0 sc1
    v_mfma_f32_32x32x16_bf16 v[144:159], a[132:135], a[88:91], v[144:159]
    ds_read_b64_tr_b16 a[124:125], v231 offset:18432
    ds_read_b64_tr_b16 a[126:127], v231 offset:19456
    buffer_load_dword v238, v241, s[24:27], s63 offen offset:128 sc1
    v_mfma_f32_32x32x16_bf16 v[128:143], a[136:139], a[92:95], v[128:143]
    ds_read_b64_tr_b16 a[128:129], v230 offset:2048
    ds_read_b64_tr_b16 a[130:131], v230 offset:3072
    buffer_load_dwordx4 v[164:167], v237, s[24:27], s36 offen offset:1024 sc1
    v_mfma_f32_32x32x16_bf16 v[144:159], a[140:143], a[92:95], v[144:159]
    ds_read_b64_tr_b16 a[132:133], v231 offset:2048
    ds_read_b64_tr_b16 a[134:135], v231 offset:3072
    buffer_load_dwordx4 v227, s[16:19], s41 offen offset:1024 lds
    s_add_u32 m0, s34, 2048
    s_waitcnt lgkmcnt(12)
    v_mfma_f32_32x32x16_bf16 v[96:111], a[96:99], a[0:3], 0
    ds_read_b64_tr_b16 a[136:137], v230 offset:8192
    ds_read_b64_tr_b16 a[138:139], v230 offset:9216
    buffer_load_dwordx4 v227, s[16:19], s42 offen offset:0 lds
    v_mfma_f32_32x32x16_bf16 v[112:127], a[100:103], a[0:3], 0
    ds_read_b64_tr_b16 a[140:141], v231 offset:8192
    ds_read_b64_tr_b16 a[142:143], v231 offset:9216
    buffer_load_dwordx4 v[168:171], v237, s[24:27], s36 offen offset:2048 sc1
    v_cvt_pk_bf16_f32 v128, v128, v129
    v_cvt_pk_bf16_f32 v129, v130, v131
    v_cvt_pk_bf16_f32 v130, v132, v133
    v_mfma_f32_32x32x16_bf16 v[96:111], a[104:107], a[4:7], v[96:111]
    ds_read_b64_tr_b16 a[96:97], v230 offset:14336
    ds_read_b64_tr_b16 a[98:99], v230 offset:15360
    buffer_load_dwordx4 v227, s[16:19], s43 offen offset:1024 lds
    s_add_u32 m0, s34, 4096
    v_cvt_pk_bf16_f32 v131, v134, v135
    v_cvt_pk_bf16_f32 v132, v136, v137
    v_mfma_f32_32x32x16_bf16 v[112:127], a[108:111], a[4:7], v[112:127]
    ds_read_b64_tr_b16 a[100:101], v231 offset:14336
    ds_read_b64_tr_b16 a[102:103], v231 offset:15360
    s_lshl_b32 s39, s77, 5
    s_add_u32 s39, s39, s38
    buffer_store_dwordx4 v[128:131], v237, s[24:27], s39 offen offset:0 sc1
    v_cvt_pk_bf16_f32 v133, v138, v139
    v_cvt_pk_bf16_f32 v134, v140, v141
    s_waitcnt lgkmcnt(12)
    v_mfma_f32_32x32x16_bf16 v[96:111], a[112:115], a[8:11], v[96:111]
    ds_read_b64_tr_b16 a[104:105], v230 offset:20480
    ds_read_b64_tr_b16 a[106:107], v230 offset:21504
    buffer_load_dwordx4 v[172:175], v237, s[24:27], s36 offen offset:3072 sc1
    v_cvt_pk_bf16_f32 v135, v142, v143
    v_cvt_pk_bf16_f32 v144, v144, v145
    v_cvt_pk_bf16_f32 v145, v146, v147
    v_mfma_f32_32x32x16_bf16 v[112:127], a[116:119], a[8:11], v[112:127]
    ds_read_b64_tr_b16 a[108:109], v231 offset:20480
    ds_read_b64_tr_b16 a[110:111], v231 offset:21504
    buffer_store_dwordx4 v[132:135], v237, s[24:27], s39 offen offset:1024 sc1
    v_cvt_pk_bf16_f32 v146, v148, v149
    v_cvt_pk_bf16_f32 v147, v150, v151
    v_cvt_pk_bf16_f32 v148, v152, v153
    v_mfma_f32_32x32x16_bf16 v[96:111], a[120:123], a[12:15], v[96:111]
    ds_read_b64_tr_b16 a[112:113], v230 offset:4096
    ds_read_b64_tr_b16 a[114:115], v230 offset:5120
    buffer_store_dwordx4 v[144:147], v237, s[24:27], s39 offen offset:2048 sc1
    v_cvt_pk_bf16_f32 v149, v154, v155
    v_cvt_pk_bf16_f32 v150, v156, v157
    v_cvt_pk_bf16_f32 v151, v158, v159
    v_mfma_f32_32x32x16_bf16 v[112:127], a[124:127], a[12:15], v[112:127]
    ds_read_b64_tr_b16 a[116:117], v231 offset:4096
    ds_read_b64_tr_b16 a[118:119], v231 offset:5120
    buffer_load_dwordx4 v227, s[16:19], s44 offen offset:0 lds
    s_waitcnt lgkmcnt(12)
    v_mfma_f32_32x32x16_bf16 v[96:111], a[128:131], a[16:19], v[96:111]
    ds_read_b64_tr_b16 a[120:121], v230 offset:10240
    ds_read_b64_tr_b16 a[122:123], v230 offset:11264
    buffer_store_dwordx4 v[148:151], v237, s[24:27], s39 offen offset:3072 sc1
    v_mfma_f32_32x32x16_bf16 v[112:127], a[132:135], a[16:19], v[112:127]
    ds_read_b64_tr_b16 a[124:125], v231 offset:10240
    ds_read_b64_tr_b16 a[126:127], v231 offset:11264
    buffer_load_dwordx4 v227, s[16:19], s45 offen offset:1024 lds
    v_mfma_f32_32x32x16_bf16 v[96:111], a[136:139], a[20:23], v[96:111]
    ds_read_b64_tr_b16 a[128:129], v230 offset:16384
    ds_read_b64_tr_b16 a[130:131], v230 offset:17408
    v_mfma_f32_32x32x16_bf16 v[112:127], a[140:143], a[20:23], v[112:127]
    ds_read_b64_tr_b16 a[132:133], v231 offset:16384
    ds_read_b64_tr_b16 a[134:135], v231 offset:17408
    s_waitcnt lgkmcnt(12)
    v_mfma_f32_32x32x16_bf16 v[96:111], a[96:99], a[24:27], v[96:111]
    ds_read_b64_tr_b16 a[136:137], v230 offset:22528
    ds_read_b64_tr_b16 a[138:139], v230 offset:23552
    v_mfma_f32_32x32x16_bf16 v[112:127], a[100:103], a[24:27], v[112:127]
    ds_read_b64_tr_b16 a[140:141], v231 offset:22528
    ds_read_b64_tr_b16 a[142:143], v231 offset:23552
    s_barrier
    v_mfma_f32_32x32x16_bf16 v[96:111], a[104:107], a[28:31], v[96:111]
    ds_read_b64_tr_b16 a[96:97], v230 offset:24576
    ds_read_b64_tr_b16 a[98:99], v230 offset:25600
    s_add_u32 m0, s34, 24576
    v_add_u32 v227, s70, v235
    v_mfma_f32_32x32x16_bf16 v[112:127], a[108:111], a[28:31], v[112:127]
    ds_read_b64_tr_b16 a[100:101], v231 offset:24576
    ds_read_b64_tr_b16 a[102:103], v231 offset:25600
    s_waitcnt lgkmcnt(12)
    v_mfma_f32_32x32x16_bf16 v[96:111], a[112:115], a[32:35], v[96:111]
    ds_read_b64_tr_b16 a[104:105], v230 offset:30720
    ds_read_b64_tr_b16 a[106:107], v230 offset:31744
    v_mfma_f32_32x32x16_bf16 v[112:127], a[116:119], a[32:35], v[112:127]
    ds_read_b64_tr_b16 a[108:109], v231 offset:30720
    ds_read_b64_tr_b16 a[110:111], v231 offset:31744
    buffer_load_dwordx4 v227, s[16:19], s46 offen offset:0 lds
    v_mfma_f32_32x32x16_bf16 v[96:111], a[120:123], a[36:39], v[96:111]
    ds_read_b64_tr_b16 a[112:113], v230 offset:36864
    ds_read_b64_tr_b16 a[114:115], v230 offset:37888
    v_mfma_f32_32x32x16_bf16 v[112:127], a[124:127], a[36:39], v[112:127]
    ds_read_b64_tr_b16 a[116:117], v231 offset:36864
    ds_read_b64_tr_b16 a[118:119], v231 offset:37888
    s_waitcnt lgkmcnt(12)
    v_mfma_f32_32x32x16_bf16 v[96:111], a[128:131], a[40:43], v[96:111]
    ds_read_b64_tr_b16 a[120:121], v230 offset:43008
    ds_read_b64_tr_b16 a[122:123], v230 offset:44032
    buffer_load_dwordx4 v227, s[16:19], s47 offen offset:1024 lds
    s_add_u32 m0, s34, 26624
    v_mfma_f32_32x32x16_bf16 v[112:127], a[132:135], a[40:43], v[112:127]
    ds_read_b64_tr_b16 a[124:125], v231 offset:43008
    ds_read_b64_tr_b16 a[126:127], v231 offset:44032
    v_mfma_f32_32x32x16_bf16 v[96:111], a[136:139], a[44:47], v[96:111]
    ds_read_b64_tr_b16 a[128:129], v230 offset:26624
    ds_read_b64_tr_b16 a[130:131], v230 offset:27648
    s_waitcnt vmcnt(14)
    v_cmp_ne_u32 vcc, 1, v238
    s_cbranch_vccnz L_slowp1
L_backp1:
    s_lshl_b32 s36, s70, 5
    s_add_u32 s36, s36, s61
    v_mfma_f32_32x32x16_bf16 v[112:127], a[140:143], a[44:47], v[112:127]
    ds_read_b64_tr_b16 a[132:133], v231 offset:26624
    ds_read_b64_tr_b16 a[134:135], v231 offset:27648
    buffer_load_dwordx4 v[176:179], v237, s[24:27], s36 offen offset:0 sc1
    s_waitcnt lgkmcnt(12)
    v_mfma_f32_32x32x16_bf16 v[96:111], a[96:99], a[48:51], v[96:111]
    ds_read_b64_tr_b16 a[136:137], v230 offset:32768
    ds_read_b64_tr_b16 a[138:139], v230 offset:33792
    buffer_load_dwordx4 v227, s[16:19], s48 offen offset:0 lds
    v_mfma_f32_32x32x16_bf16 v[112:127], a[100:103], a[48:51], v[112:127]
    ds_read_b64_tr_b16 a[140:141], v231 offset:32768
    ds_read_b64_tr_b16 a[142:143], v231 offset:33792
    v_mfma_f32_32x32x16_bf16 v[96:111], a[104:107], a[52:55], v[96:111]
    ds_read_b64_tr_b16 a[96:97], v230 offset:38912
    ds_read_b64_tr_b16 a[98:99], v230 offset:39936
    buffer_load_dwordx4 v[180:183], v237, s[24:27], s36 offen offset:1024 sc1
    v_mfma_f32_32x32x16_bf16 v[112:127], a[108:111], a[52:55], v[112:127]
    ds_read_b64_tr_b16 a[100:101], v231 offset:38912
    ds_read_b64_tr_b16 a[102:103], v231 offset:39936
    buffer_load_dwordx4 v227, s[16:19], s49 offen offset:1024 lds
    s_add_u32 m0, s34, 28672
    s_waitcnt lgkmcnt(12)
    v_mfma_f32_32x32x16_bf16 v[96:111], a[112:115], a[56:59], v[96:111]
    ds_read_b64_tr_b16 a[104:105], v230 offset:45056
    ds_read_b64_tr_b16 a[106:107], v230 offset:46080
    v_mfma_f32_32x32x16_bf16 v[112:127], a[116:119], a[56:59], v[112:127]
    ds_read_b64_tr_b16 a[108:109], v231 offset:45056
    ds_read_b64_tr_b16 a[110:111], v231 offset:46080
    buffer_load_dwordx4 v[184:187], v237, s[24:27], s36 offen offset:2048 sc1
    v_mfma_f32_32x32x16_bf16 v[96:111], a[120:123], a[60:63], v[96:111]
    ds_read_b64_tr_b16 a[112:113], v230 offset:28672
    ds_read_b64_tr_b16 a[114:115], v230 offset:29696
    buffer_load_dwordx4 v227, s[16:19], s50 offen offset:0 lds
    v_mfma_f32_32x32x16_bf16 v[112:127], a[124:127], a[60:63], v[112:127]
    ds_read_b64_tr_b16 a[116:117], v231 offset:28672
    ds_read_b64_tr_b16 a[118:119], v231 offset:29696
    s_waitcnt lgkmcnt(12)
    v_mfma_f32_32x32x16_bf16 v[96:111], a[128:131], a[64:67], v[96:111]
    ds_read_b64_tr_b16 a[120:121], v230 offset:34816
    ds_read_b64_tr_b16 a[122:123], v230 offset:35840
    buffer_load_dwordx4 v[188:191], v237, s[24:27], s36 offen offset:3072 sc1
    v_mfma_f32_32x32x16_bf16 v[112:127], a[132:135], a[64:67], v[112:127]
    ds_read_b64_tr_b16 a[124:125], v231 offset:34816
    ds_read_b64_tr_b16 a[126:127], v231 offset:35840
    buffer_load_dwordx4 v227, s[16:19], s51 offen offset:1024 lds
    v_mfma_f32_32x32x16_bf16 v[96:111], a[136:139], a[68:71], v[96:111]
    ds_read_b64_tr_b16 a[128:129], v230 offset:40960
    ds_read_b64_tr_b16 a[130:131], v230 offset:41984
    v_mfma_f32_32x32x16_bf16 v[112:127], a[140:143], a[68:71], v[112:127]
    ds_read_b64_tr_b16 a[132:133], v231 offset:40960
    ds_read_b64_tr_b16 a[134:135], v231 offset:41984
    s_waitcnt lgkmcnt(12)
    v_mfma_f32_32x32x16_bf16 v[96:111], a[96:99], a[72:75], v[96:111]
    ds_read_b64_tr_b16 a[136:137], v230 offset:47104
    ds_read_b64_tr_b16 a[138:139], v230 offset:48128
    v_mfma_f32_32x32x16_bf16 v[112:127], a[100:103], a[72:75], v[112:127]
    ds_read_b64_tr_b16 a[140:141], v231 offset:47104
    ds_read_b64_tr_b16 a[142:143], v231 offset:48128
    s_barrier
    v_mfma_f32_32x32x16_bf16 v[96:111], a[104:107], a[76:79], v[96:111]
    ds_read_b64_tr_b16 a[96:97], v232 offset:0
    ds_read_b64_tr_b16 a[98:99], v232 offset:1024
    s_waitcnt vmcnt(21)
    v_lshlrev_b32 v0, 16, v160
    v_and_b32 v1, 0xffff0000, v160
    v_lshlrev_b32 v2, 16, v161
    v_mfma_f32_32x32x16_bf16 v[112:127], a[108:111], a[76:79], v[112:127]
    ds_read_b64_tr_b16 a[100:101], v233 offset:0
    ds_read_b64_tr_b16 a[102:103], v233 offset:1024
    s_add_u32 m0, s34, 49152
    v_add_u32 v227, s71, v235
    v_and_b32 v3, 0xffff0000, v161
    s_waitcnt lgkmcnt(12)
    v_mfma_f32_32x32x16_bf16 v[96:111], a[112:115], a[80:83], v[96:111]
    ds_read_b64_tr_b16 a[104:105], v232 offset:6144
    ds_read_b64_tr_b16 a[106:107], v232 offset:7168
    v_lshlrev_b32 v4, 16, v162
    v_and_b32 v5, 0xffff0000, v162
    v_lshlrev_b32 v6, 16, v163
    v_and_b32 v7, 0xffff0000, v163
    v_mfma_f32_32x32x16_bf16 v[112:127], a[116:119], a[80:83], v[112:127]
    ds_read_b64_tr_b16 a[108:109], v233 offset:6144
    ds_read_b64_tr_b16 a[110:111], v233 offset:7168
    buffer_load_dwordx4 v227, s[16:19], s40 offen offset:0 lds
    v_lshlrev_b32 v8, 16, v164
    v_and_b32 v9, 0xffff0000, v164
    v_lshlrev_b32 v10, 16, v165
    v_mfma_f32_32x32x16_bf16 v[96:111], a[120:123], a[84:87], v[96:111]
    ds_read_b64_tr_b16 a[112:113], v232 offset:12288
    ds_read_b64_tr_b16 a[114:115], v232 offset:13312
    v_and_b32 v11, 0xffff0000, v165
    v_lshlrev_b32 v12, 16, v166
    v_and_b32 v13, 0xffff0000, v166
    v_lshlrev_b32 v14, 16, v167
    v_mfma_f32_32x32x16_bf16 v[112:127], a[124:127], a[84:87], v[112:127]
    ds_read_b64_tr_b16 a[116:117], v233 offset:12288
    ds_read_b64_tr_b16 a[118:119], v233 offset:13312
    s_waitcnt vmcnt(12)
    buffer_store_dword v249, v225, s[24:27], s85 offen offset:384 sc1
    s_waitcnt lgkmcnt(12)
    v_mfma_f32_32x32x16_bf16 v[96:111], a[128:131], a[88:91], v[96:111]
    ds_read_b64_tr_b16 a[120:121], v232 offset:18432
    ds_read_b64_tr_b16 a[122:123], v232 offset:19456
    buffer_load_dwordx4 v227, s[16:19], s41 offen offset:1024 lds
    s_add_u32 m0, s34, 51200
    v_and_b32 v15, 0xffff0000, v167
    v_mfma_f32_32x32x16_bf16 v[112:127], a[132:135], a[88:91], v[112:127]
    ds_read_b64_tr_b16 a[124:125], v233 offset:18432
    ds_read_b64_tr_b16 a[126:127], v233 offset:19456
    v_lshlrev_b32 v16, 16, v168
    v_and_b32 v17, 0xffff0000, v168
    v_lshlrev_b32 v18, 16, v169
    v_and_b32 v19, 0xffff0000, v169
    v_mfma_f32_32x32x16_bf16 v[96:111], a[136:139], a[92:95], v[96:111]
    ds_read_b64_tr_b16 a[128:129], v232 offset:2048
    ds_read_b64_tr_b16 a[130:131], v232 offset:3072
    buffer_load_dword v238, v241, s[24:27], s62 offen offset:256 sc1
    v_lshlrev_b32 v20, 16, v170
    v_and_b32 v21, 0xffff0000, v170
    v_lshlrev_b32 v22, 16, v171
    v_mfma_f32_32x32x16_bf16 v[112:127], a[140:143], a[92:95], v[112:127]
    ds_read_b64_tr_b16 a[132:133], v233 offset:2048
    ds_read_b64_tr_b16 a[134:135], v233 offset:3072
    buffer_load_dwordx4 v227, s[16:19], s42 offen offset:0 lds
    v_and_b32 v23, 0xffff0000, v171
    v_lshlrev_b32 v24, 16, v172
    s_waitcnt lgkmcnt(12)
    v_mfma_f32_32x32x16_bf16 v[128:143], a[96:99], a[0:3], 0
    ds_read_b64_tr_b16 a[136:137], v232 offset:8192
    ds_read_b64_tr_b16 a[138:139], v232 offset:9216
    v_and_b32 v25, 0xffff0000, v172
    v_lshlrev_b32 v26, 16, v173
    v_and_b32 v27, 0xffff0000, v173
    v_lshlrev_b32 v28, 16, v174
    v_mfma_f32_32x32x16_bf16 v[144:159], a[100:103], a[0:3], 0
    ds_read_b64_tr_b16 a[140:141], v233 offset:8192
    ds_read_b64_tr_b16 a[142:143], v233 offset:9216
    v_and_b32 v29, 0xffff0000, v174
    v_lshlrev_b32 v30, 16, v175
    v_and_b32 v31, 0xffff0000, v175
    v_cvt_pk_bf16_f32 v96, v96, v97
    v_mfma_f32_32x32x16_bf16 v[128:143], a[104:107], a[4:7], v[128:143]
    ds_read_b64_tr_b16 a[96:97], v232 offset:14336
    ds_read_b64_tr_b16 a[98:99], v232 offset:15360
    buffer_load_dwordx4 v227, s[16:19], s43 offen offset:1024 lds
    s_add_u32 m0, s34, 53248
    v_cvt_pk_bf16_f32 v97, v98, v99
    v_cvt_pk_bf16_f32 v98, v100, v101
    v_mfma_f32_32x32x16_bf16 v[144:159], a[108:111], a[4:7], v[144:159]
    ds_read_b64_tr_b16 a[100:101], v233 offset:14336
    ds_read_b64_tr_b16 a[102:103], v233 offset:15360
    v_cvt_pk_bf16_f32 v99, v102, v103
    v_cvt_pk_bf16_f32 v100, v104, v105
    v_cvt_pk_bf16_f32 v101, v106, v107
    s_waitcnt lgkmcnt(12)
    v_mfma_f32_32x32x16_bf16 v[128:143], a[112:115], a[8:11], v[128:143]
    ds_read_b64_tr_b16 a[104:105], v232 offset:20480
    ds_read_b64_tr_b16 a[106:107], v232 offset:21504
    s_lshl_b32 s39, s75, 5
    s_add_u32 s39, s39, s38
    buffer_store_dwordx4 v[96:99], v237, s[24:27], s39 offen offset:0 sc1
    v_cvt_pk_bf16_f32 v102, v108, v109
    v_cvt_pk_bf16_f32 v103, v110, v111
    v_cvt_pk_bf16_f32 v112, v112, v113
    v_mfma_f32_32x32x16_bf16 v[144:159], a[116:119], a[8:11], v[144:159]
    ds_read_b64_tr_b16 a[108:109], v233 offset:20480
    ds_read_b64_tr_b16 a[110:111], v233 offset:21504
    buffer_store_dwordx4 v[100:103], v237, s[24:27], s39 offen offset:1024 sc1
    v_cvt_pk_bf16_f32 v113, v114, v115
    v_cvt_pk_bf16_f32 v114, v116, v117
    v_cvt_pk_bf16_f32 v115, v118, v119
    v_mfma_f32_32x32x16_bf16 v[128:143], a[120:123], a[12:15], v[128:143]
    ds_read_b64_tr_b16 a[112:113], v232 offset:4096
    ds_read_b64_tr_b16 a[114:115], v232 offset:5120
    buffer_store_dwordx4 v[112:115], v237, s[24:27], s39 offen offset:2048 sc1
    v_cvt_pk_bf16_f32 v116, v120, v121
    v_cvt_pk_bf16_f32 v117, v122, v123
    v_cvt_pk_bf16_f32 v118, v124, v125
    v_mfma_f32_32x32x16_bf16 v[144:159], a[124:127], a[12:15], v[144:159]
    ds_read_b64_tr_b16 a[116:117], v233 offset:4096
    ds_read_b64_tr_b16 a[118:119], v233 offset:5120
    buffer_load_dwordx4 v227, s[16:19], s44 offen offset:0 lds
    v_cvt_pk_bf16_f32 v119, v126, v127
    s_waitcnt lgkmcnt(12)
    v_mfma_f32_32x32x16_bf16 v[128:143], a[128:131], a[16:19], v[128:143]
    ds_read_b64_tr_b16 a[120:121], v232 offset:10240
    ds_read_b64_tr_b16 a[122:123], v232 offset:11264
    buffer_store_dwordx4 v[116:119], v237, s[24:27], s39 offen offset:3072 sc1
    v_mfma_f32_32x32x16_bf16 v[144:159], a[132:135], a[16:19], v[144:159]
    ds_read_b64_tr_b16 a[124:125], v233 offset:10240
    ds_read_b64_tr_b16 a[126:127], v233 offset:11264
    buffer_load_dwordx4 v227, s[16:19], s45 offen offset:1024 lds
    v_mfma_f32_32x32x16_bf16 v[128:143], a[136:139], a[20:23], v[128:143]
    ds_read_b64_tr_b16 a[128:129], v232 offset:16384
    ds_read_b64_tr_b16 a[130:131], v232 offset:17408
    v_mfma_f32_32x32x16_bf16 v[144:159], a[140:143], a[20:23], v[144:159]
    ds_read_b64_tr_b16 a[132:133], v233 offset:16384
    ds_read_b64_tr_b16 a[134:135], v233 offset:17408
    s_waitcnt lgkmcnt(12)
    v_mfma_f32_32x32x16_bf16 v[128:143], a[96:99], a[24:27], v[128:143]
    ds_read_b64_tr_b16 a[136:137], v232 offset:22528
    ds_read_b64_tr_b16 a[138:139], v232 offset:23552
    v_mfma_f32_32x32x16_bf16 v[144:159], a[100:103], a[24:27], v[144:159]
    ds_read_b64_tr_b16 a[140:141], v233 offset:22528
    ds_read_b64_tr_b16 a[142:143], v233 offset:23552
    s_barrier
    v_mfma_f32_32x32x16_bf16 v[128:143], a[104:107], a[28:31], v[128:143]
    ds_read_b64_tr_b16 a[96:97], v232 offset:24576
    ds_read_b64_tr_b16 a[98:99], v232 offset:25600
    s_add_u32 m0, s34, 73728
    v_add_u32 v227, s71, v235
    v_mfma_f32_32x32x16_bf16 v[144:159], a[108:111], a[28:31], v[144:159]
    ds_read_b64_tr_b16 a[100:101], v233 offset:24576
    ds_read_b64_tr_b16 a[102:103], v233 offset:25600
    s_waitcnt lgkmcnt(12)
    v_mfma_f32_32x32x16_bf16 v[128:143], a[112:115], a[32:35], v[128:143]
    ds_read_b64_tr_b16 a[104:105], v232 offset:30720
    ds_read_b64_tr_b16 a[106:107], v232 offset:31744
    v_mfma_f32_32x32x16_bf16 v[144:159], a[116:119], a[32:35], v[144:159]
    ds_read_b64_tr_b16 a[108:109], v233 offset:30720
    ds_read_b64_tr_b16 a[110:111], v233 offset:31744
    buffer_load_dwordx4 v227, s[16:19], s46 offen offset:0 lds
    v_mfma_f32_32x32x16_bf16 v[128:143], a[120:123], a[36:39], v[128:143]
    ds_read_b64_tr_b16 a[112:113], v232 offset:36864
    ds_read_b64_tr_b16 a[114:115], v232 offset:37888
    s_waitcnt vmcnt(18)
    v_lshlrev_b32 v208, 16, v176
    v_and_b32 v209, 0xffff0000, v176
    v_add_f32 v0, v0, v208
    v_mfma_f32_32x32x16_bf16 v[144:159], a[124:127], a[36:39], v[144:159]
    ds_read_b64_tr_b16 a[116:117], v233 offset:36864
    ds_read_b64_tr_b16 a[118:119], v233 offset:37888
    v_add_f32 v1, v1, v209
    v_lshlrev_b32 v210, 16, v177
    v_and_b32 v211, 0xffff0000, v177
    s_waitcnt lgkmcnt(12)
    v_mfma_f32_32x32x16_bf16 v[128:143], a[128:131], a[40:43], v[128:143]
    s_nop 0
L_sm9:
    s_cbranch_execz L_retm
    ds_read_b64_tr_b16 a[120:121], v232 offset:43008
    ds_read_b64_tr_b16 a[122:123], v232 offset:44032
    buffer_load_dwordx4 v227, s[16:19], s47 offen offset:1024 lds
    s_add_u32 m0, s34, 75776
    v_add_f32 v2, v2, v210
    v_add_f32 v3, v3, v211
    v_mfma_f32_32x32x16_bf16 v[144:159], a[132:135], a[40:43], v[144:159]
    ds_read_b64_tr_b16 a[124:125], v233 offset:43008
    ds_read_b64_tr_b16 a[126:127], v233 offset:44032
    v_lshlrev_b32 v208, 16, v178
    v_and_b32 v209, 0xffff0000, v178
    v_add_f32 v4, v4, v208
    v_add_f32 v5, v5, v209
    v_mfma_f32_32x32x16_bf16 v[128:143], a[136:139], a[44:47], v[128:143]
    ds_read_b64_tr_b16 a[128:129], v232 offset:26624
    ds_read_b64_tr_b16 a[130:131], v232 offset:27648
    v_lshlrev_b32 v210, 16, v179
    v_and_b32 v211, 0xffff0000, v179
    v_add_f32 v6, v6, v210
    v_add_f32 v7, v7, v211
    v_mfma_f32_32x32x16_bf16 v[144:159], a[140:143], a[44:47], v[144:159]
    ds_read_b64_tr_b16 a[132:133], v233 offset:26624
    ds_read_b64_tr_b16 a[134:135], v233 offset:27648
    buffer_load_dwordx4 v227, s[16:19], s48 offen offset:0 lds
    v_lshlrev_b32 v208, 16, v180
    v_and_b32 v209, 0xffff0000, v180
    s_waitcnt lgkmcnt(12)
    v_mfma_f32_32x32x16_bf16 v[128:143], a[96:99], a[48:51], v[128:143]
    ds_read_b64_tr_b16 a[136:137], v232 offset:32768
    ds_read_b64_tr_b16 a[138:139], v232 offset:33792
    s_waitcnt vmcnt(11)
    v_cmp_ne_u32 vcc, 1, v238
    s_cbranch_vccnz L_slowp2
L_backp2:
    s_lshl_b32 s36, s71, 5
    s_add_u32 s36, s36, s60
    v_mfma_f32_32x32x16_bf16 v[144:159], a[100:103], a[48:51], v[144:159]
    ds_read_b64_tr_b16 a[140:141], v233 offset:32768
    ds_read_b64_tr_b16 a[142:143], v233 offset:33792
    buffer_load_dwordx4 v[192:195], v237, s[24:27], s36 offen offset:0 sc1
    v_add_f32 v8, v8, v208
    v_add_f32 v9, v9, v209
    v_lshlrev_b32 v210, 16, v181
    v_mfma_f32_32x32x16_bf16 v[128:143], a[104:107], a[52:55], v[128:143]
    ds_read_b64_tr_b16 a[96:97], v232 offset:38912
    ds_read_b64_tr_b16 a[98:99], v232 offset:39936
    buffer_load_dwordx4 v227, s[16:19], s49 offen offset:1024 lds
    s_add_u32 m0, s34, 77824
    v_and_b32 v211, 0xffff0000, v181
    v_add_f32 v10, v10, v210
    v_mfma_f32_32x32x16_bf16 v[144:159], a[108:111], a[52:55], v[144:159]
    ds_read_b64_tr_b16 a[100:101], v233 offset:38912
    ds_read_b64_tr_b16 a[102:103], v233 offset:39936
    v_add_f32 v11, v11, v211
    v_lshlrev_b32 v208, 16, v182
    v_and_b32 v209, 0xffff0000, v182
    s_waitcnt lgkmcnt(12)
    v_mfma_f32_32x32x16_bf16 v[128:143], a[112:115], a[56:59], v[128:143]
    ds_read_b64_tr_b16 a[104:105], v232 offset:45056
    ds_read_b64_tr_b16 a[106:107], v232 offset:46080
    buffer_load_dwordx4 v[196:199], v237, s[24:27], s36 offen offset:1024 sc1
    v_add_f32 v12, v12, v208
    v_add_f32 v13, v13, v209
    v_lshlrev_b32 v210, 16, v183
    v_mfma_f32_32x32x16_bf16 v[144:159], a[116:119], a[56:59], v[144:159]
    ds_read_b64_tr_b16 a[108:109], v233 offset:45056
    ds_read_b64_tr_b16 a[110:111], v233 offset:46080
    buffer_load_dwordx4 v227, s[16:19], s50 offen offset:0 lds
    v_and_b32 v211, 0xffff0000, v183
    v_add_f32 v14, v14, v210
    v_add_f32 v15, v15, v211
    v_mfma_f32_32x32x16_bf16 v[128:143], a[120:123], a[60:63], v[128:143]
    ds_read_b64_tr_b16 a[112:113], v232 offset:28672
    ds_read_b64_tr_b16 a[114:115], v232 offset:29696
    v_lshlrev_b32 v208, 16, v184
    v_and_b32 v209, 0xffff0000, v184
    v_add_f32 v16, v16, v208
    v_mfma_f32_32x32x16_bf16 v[144:159], a[124:127], a[60:63], v[144:159]
    ds_read_b64_tr_b16 a[116:117], v233 offset:28672
    ds_read_b64_tr_b16 a[118:119], v233 offset:29696
    buffer_load_dwordx4 v[200:203], v237, s[24:27], s36 offen offset:2048 sc1
    v_add_f32 v17, v17, v209
    v_lshlrev_b32 v210, 16, v185
    s_waitcnt lgkmcnt(12)
    v_mfma_f32_32x32x16_bf16 v[128:143], a[128:131], a[64:67], v[128:143]
    ds_read_b64_tr_b16 a[120:121], v232 offset:34816
    ds_read_b64_tr_b16 a[122:123], v232 offset:35840
    buffer_load_dwordx4 v227, s[16:19], s51 offen offset:1024 lds
    v_and_b32 v211, 0xffff0000, v185
    v_add_f32 v18, v18, v210
    v_add_f32 v19, v19, v211
    v_mfma_f32_32x32x16_bf16 v[144:159], a[132:135], a[64:67], v[144:159]
    ds_read_b64_tr_b16 a[124:125], v233 offset:34816
    ds_read_b64_tr_b16 a[126:127], v233 offset:35840
    v_lshlrev_b32 v208, 16, v186
    v_and_b32 v209, 0xffff0000, v186
    v_add_f32 v20, v20, v208
    v_add_f32 v21, v21, v209
    v_mfma_f32_32x32x16_bf16 v[128:143], a[136:139], a[68:71], v[128:143]
    ds_read_b64_tr_b16 a[128:129], v232 offset:40960
    ds_read_b64_tr_b16 a[130:131], v232 offset:41984
    buffer_load_dwordx4 v[204:207], v237, s[24:27], s36 offen offset:3072 sc1
    v_lshlrev_b32 v210, 16, v187
    v_and_b32 v211, 0xffff0000, v187
    v_add_f32 v22, v22, v210
    v_mfma_f32_32x32x16_bf16 v[144:159], a[140:143], a[68:71], v[144:159]
    ds_read_b64_tr_b16 a[132:133], v233 offset:40960
    ds_read_b64_tr_b16 a[134:135], v233 offset:41984
    v_add_f32 v23, v23, v211
    v_lshlrev_b32 v208, 16, v188
    v_and_b32 v209, 0xffff0000, v188
    s_waitcnt lgkmcnt(12)
    v_mfma_f32_32x32x16_bf16 v[128:143], a[96:99], a[72:75], v[128:143]
    ds_read_b64_tr_b16 a[136:137], v232 offset:47104
    ds_read_b64_tr_b16 a[138:139], v232 offset:48128
    v_add_f32 v24, v24, v208
    v_add_f32 v25, v25, v209
    v_lshlrev_b32 v210, 16, v189
    v_and_b32 v211, 0xffff0000, v189
    v_mfma_f32_32x32x16_bf16 v[144:159], a[100:103], a[72:75], v[144:159]
    ds_read_b64_tr_b16 a[140:141], v233 offset:47104
    ds_read_b64_tr_b16 a[142:143], v233 offset:48128
    v_add_f32 v26, v26, v210
    v_add_f32 v27, v27, v211
    v_lshlrev_b32 v208, 16, v190
    v_and_b32 v209, 0xffff0000, v190
    s_barrier
    v_mfma_f32_32x32x16_bf16 v[128:143], a[104:107], a[76:79], v[128:143]
    ds_read_b64_tr_b16 a[96:97], v228 offset:0
    ds_read_b64_tr_b16 a[98:99], v228 offset:1024
    s_add_u32 m0, s34, 98304
    v_add_u32 v227, s72, v235
    v_add_f32 v28, v28, v208
    v_add_f32 v29, v29, v209
    v_mfma_f32_32x32x16_bf16 v[144:159], a[108:111], a[76:79], v[144:159]
    ds_read_b64_tr_b16 a[100:101], v229 offset:0
    ds_read_b64_tr_b16 a[102:103], v229 offset:1024
    v_lshlrev_b32 v210, 16, v191
    v_and_b32 v211, 0xffff0000, v191
    v_add_f32 v30, v30, v210
    s_waitcnt lgkmcnt(12)
    v_mfma_f32_32x32x16_bf16 v[128:143], a[112:115], a[80:83], v[128:143]
    ds_read_b64_tr_b16 a[104:105], v228 offset:6144
    ds_read_b64_tr_b16 a[106:107], v228 offset:7168
    v_add_f32 v31, v31, v211
    v_mfma_f32_32x32x16_bf16 v[144:159], a[116:119], a[80:83], v[144:159]
    ds_read_b64_tr_b16 a[108:109], v229 offset:6144
    ds_read_b64_tr_b16 a[110:111], v229 offset:7168
    buffer_load_dwordx4 v227, s[16:19], s40 offen offset:0 lds
    v_mfma_f32_32x32x16_bf16 v[128:143], a[120:123], a[84:87], v[128:143]
    ds_read_b64_tr_b16 a[112:113], v228 offset:12288
    ds_read_b64_tr_b16 a[114:115], v228 offset:13312
    v_mfma_f32_32x32x16_bf16 v[144:159], a[124:127], a[84:87], v[144:159]
    ds_read_b64_tr_b16 a[116:117], v229 offset:12288
    ds_read_b64_tr_b16 a[118:119], v229 offset:13312
    s_waitcnt vmcnt(12)
    buffer_store_dword v249, v225, s[24:27], s85 offen offset:512 sc1
    s_waitcnt lgkmcnt(12)
    v_mfma_f32_32x32x16_bf16 v[128:143], a[128:131], a[88:91], v[128:143]
    ds_read_b64_tr_b16 a[120:121], v228 offset:18432
    ds_read_b64_tr_b16 a[122:123], v228 offset:19456
    buffer_load_dwordx4 v227, s[16:19], s41 offen offset:1024 lds
    s_add_u32 m0, s34, 100352
    v_mfma_f32_32x32x16_bf16 v[144:159], a[132:135], a[88:91], v[144:159]
    ds_read_b64_tr_b16 a[124:125], v229 offset:18432
    ds_read_b64_tr_b16 a[126:127], v229 offset:19456
    v_mfma_f32_32x32x16_bf16 v[128:143], a[136:139], a[92:95], v[128:143]
    ds_read_b64_tr_b16 a[128:129], v228 offset:2048
    ds_read_b64_tr_b16 a[130:131], v228 offset:3072
    v_mfma_f32_32x32x16_bf16 v[144:159], a[140:143], a[92:95], v[144:159]
    ds_read_b64_tr_b16 a[132:133], v229 offset:2048
    ds_read_b64_tr_b16 a[134:135], v229 offset:3072
    buffer_load_dwordx4 v227, s[16:19], s42 offen offset:0 lds
    s_waitcnt lgkmcnt(12)
    v_mfma_f32_32x32x16_bf16 v[0:15], a[96:99], a[0:3], v[0:15]
    ds_read_b64_tr_b16 a[136:137], v228 offset:8192
    ds_read_b64_tr_b16 a[138:139], v228 offset:9216
    v_mfma_f32_32x32x16_bf16 v[16:31], a[100:103], a[0:3], v[16:31]
    ds_read_b64_tr_b16 a[140:141], v229 offset:8192
    ds_read_b64_tr_b16 a[142:143], v229 offset:9216
    v_cvt_pk_bf16_f32 v128, v128, v129
    v_cvt_pk_bf16_f32 v129, v130, v131
    v_cvt_pk_bf16_f32 v130, v132, v133
    v_cvt_pk_bf16_f32 v131, v134, v135
    v_mfma_f32_32x32x16_bf16 v[0:15], a[104:107], a[4:7], v[0:15]
    ds_read_b64_tr_b16 a[96:97], v228 offset:14336
    ds_read_b64_tr_b16 a[98:99], v228 offset:15360
    s_lshl_b32 s39, s78, 5
    s_add_u32 s39, s39, s38
    buffer_store_dwordx4 v[128:131], v237, s[24:27], s39 offen offset:0 sc1
    v_cvt_pk_bf16_f32 v132, v136, v137
    v_cvt_pk_bf16_f32 v133, v138, v139
    v_cvt_pk_bf16_f32 v134, v140, v141
    v_mfma_f32_32x32x16_bf16 v[16:31], a[108:111], a[4:7], v[16:31]
    ds_read_b64_tr_b16 a[100:101], v229 offset:14336
    ds_read_b64_tr_b16 a[102:103], v229 offset:15360
    buffer_load_dwordx4 v227, s[16:19], s43 offen offset:1024 lds
    s_add_u32 m0, s34, 102400
    v_cvt_pk_bf16_f32 v135, v142, v143
    s_waitcnt lgkmcnt(12)
    v_mfma_f32_32x32x16_bf16 v[0:15], a[112:115], a[8:11], v[0:15]
    ds_read_b64_tr_b16 a[104:105], v228 offset:20480
    ds_read_b64_tr_b16 a[106:107], v228 offset:21504
    buffer_store_dwordx4 v[132:135], v237, s[24:27], s39 offen offset:1024 sc1
    v_cvt_pk_bf16_f32 v144, v144, v145
    v_cvt_pk_bf16_f32 v145, v146, v147
    v_cvt_pk_bf16_f32 v146, v148, v149
    v_mfma_f32_32x32x16_bf16 v[16:31], a[116:119], a[8:11], v[16:31]
    ds_read_b64_tr_b16 a[108:109], v229 offset:20480
    ds_read_b64_tr_b16 a[110:111], v229 offset:21504
    buffer_load_dwordx4 v227, s[16:19], s44 offen offset:0 lds
    v_cvt_pk_bf16_f32 v147, v150, v151
    v_cvt_pk_bf16_f32 v148, v152, v153
    v_cvt_pk_bf16_f32 v149, v154, v155
    v_mfma_f32_32x32x16_bf16 v[0:15], a[120:123], a[12:15], v[0:15]
    ds_read_b64_tr_b16 a[112:113], v228 offset:4096
    ds_read_b64_tr_b16 a[114:115], v228 offset:5120
    buffer_store_dwordx4 v[144:147], v237, s[24:27], s39 offen offset:2048 sc1
    v_cvt_pk_bf16_f32 v150, v156, v157
    v_cvt_pk_bf16_f32 v151, v158, v159
    v_mfma_f32_32x32x16_bf16 v[16:31], a[124:127], a[12:15], v[16:31]
    ds_read_b64_tr_b16 a[116:117], v229 offset:4096
    ds_read_b64_tr_b16 a[118:119], v229 offset:5120
    s_waitcnt lgkmcnt(12)
    v_mfma_f32_32x32x16_bf16 v[0:15], a[128:131], a[16:19], v[0:15]
    ds_read_b64_tr_b16 a[120:121], v228 offset:10240
    ds_read_b64_tr_b16 a[122:123], v228 offset:11264
    buffer_store_dwordx4 v[148:151], v237, s[24:27], s39 offen offset:3072 sc1
    v_mfma_f32_32x32x16_bf16 v[16:31], a[132:135], a[16:19], v[16:31]
    ds_read_b64_tr_b16 a[124:125], v229 offset:10240
    ds_read_b64_tr_b16 a[126:127], v229 offset:11264
    buffer_load_dwordx4 v227, s[16:19], s45 offen offset:1024 lds
    v_mfma_f32_32x32x16_bf16 v[0:15], a[136:139], a[20:23], v[0:15]
    ds_read_b64_tr_b16 a[128:129], v228 offset:16384
    ds_read_b64_tr_b16 a[130:131], v228 offset:17408
    v_mfma_f32_32x32x16_bf16 v[16:31], a[140:143], a[20:23], v[16:31]
    ds_read_b64_tr_b16 a[132:133], v229 offset:16384
    ds_read_b64_tr_b16 a[134:135], v229 offset:17408
    s_waitcnt lgkmcnt(12)
    v_mfma_f32_32x32x16_bf16 v[0:15], a[96:99], a[24:27], v[0:15]
    ds_read_b64_tr_b16 a[136:137], v228 offset:22528
    ds_read_b64_tr_b16 a[138:139], v228 offset:23552
    v_mfma_f32_32x32x16_bf16 v[16:31], a[100:103], a[24:27], v[16:31]
    ds_read_b64_tr_b16 a[140:141], v229 offset:22528
    ds_read_b64_tr_b16 a[142:143], v229 offset:23552
    s_barrier
    v_mfma_f32_32x32x16_bf16 v[0:15], a[104:107], a[28:31], v[0:15]
    ds_read_b64_tr_b16 a[96:97], v228 offset:24576
    ds_read_b64_tr_b16 a[98:99], v228 offset:25600
    s_add_u32 m0, s34, 122880
    v_add_u32 v227, s72, v235
    v_mfma_f32_32x32x16_bf16 v[16:31], a[108:111], a[28:31], v[16:31]
    ds_read_b64_tr_b16 a[100:101], v229 offset:24576
    ds_read_b64_tr_b16 a[102:103], v229 offset:25600
    s_waitcnt lgkmcnt(12)
    v_mfma_f32_32x32x16_bf16 v[0:15], a[112:115], a[32:35], v[0:15]
    ds_read_b64_tr_b16 a[104:105], v228 offset:30720
    ds_read_b64_tr_b16 a[106:107], v228 offset:31744
    v_mfma_f32_32x32x16_bf16 v[16:31], a[116:119], a[32:35], v[16:31]
    ds_read_b64_tr_b16 a[108:109], v229 offset:30720
    ds_read_b64_tr_b16 a[110:111], v229 offset:31744
    buffer_load_dwordx4 v227, s[16:19], s46 offen offset:0 lds
    v_mfma_f32_32x32x16_bf16 v[0:15], a[120:123], a[36:39], v[0:15]
    ds_read_b64_tr_b16 a[112:113], v228 offset:36864
    ds_read_b64_tr_b16 a[114:115], v228 offset:37888
    buffer_load_dword v238, v241, s[24:27], s63 offen offset:384 sc1
    v_mfma_f32_32x32x16_bf16 v[16:31], a[124:127], a[36:39], v[16:31]
    ds_read_b64_tr_b16 a[116:117], v229 offset:36864
    ds_read_b64_tr_b16 a[118:119], v229 offset:37888
    s_waitcnt lgkmcnt(12)
    v_mfma_f32_32x32x16_bf16 v[0:15], a[128:131], a[40:43], v[0:15]
    ds_read_b64_tr_b16 a[120:121], v228 offset:43008
    ds_read_b64_tr_b16 a[122:123], v228 offset:44032
    s_waitcnt vmcnt(17)
    v_lshlrev_b32 v32, 16, v192
    v_and_b32 v33, 0xffff0000, v192
    v_lshlrev_b32 v34, 16, v193
    v_mfma_f32_32x32x16_bf16 v[16:31], a[132:135], a[40:43], v[16:31]
    ds_read_b64_tr_b16 a[124:125], v229 offset:43008
    ds_read_b64_tr_b16 a[126:127], v229 offset:44032
    buffer_load_dwordx4 v227, s[16:19], s47 offen offset:1024 lds
    s_add_u32 m0, s34, 124928
    v_and_b32 v35, 0xffff0000, v193
    v_lshlrev_b32 v36, 16, v194
    v_mfma_f32_32x32x16_bf16 v[0:15], a[136:139], a[44:47], v[0:15]
    ds_read_b64_tr_b16 a[128:129], v228 offset:26624
    ds_read_b64_tr_b16 a[130:131], v228 offset:27648
    v_and_b32 v37, 0xffff0000, v194
    v_lshlrev_b32 v38, 16, v195
    v_and_b32 v39, 0xffff0000, v195
    v_lshlrev_b32 v40, 16, v196
    v_mfma_f32_32x32x16_bf16 v[16:31], a[140:143], a[44:47], v[16:31]
    ds_read_b64_tr_b16 a[132:133], v229 offset:26624
    ds_read_b64_tr_b16 a[134:135], v229 offset:27648
    buffer_load_dwordx4 v227, s[16:19], s48 offen offset:0 lds
    v_and_b32 v41, 0xffff0000, v196
    v_lshlrev_b32 v42, 16, v197
    s_waitcnt lgkmcnt(12)
    v_mfma_f32_32x32x16_bf16 v[0:15], a[96:99], a[48:51], v[0:15]
    ds_read_b64_tr_b16 a[136:137], v228 offset:32768
    ds_read_b64_tr_b16 a[138:139], v228 offset:33792
    v_and_b32 v43, 0xffff0000, v197
    v_lshlrev_b32 v44, 16, v198
    v_and_b32 v45, 0xffff0000, v198
    v_lshlrev_b32 v46, 16, v199
    v_mfma_f32_32x32x16_bf16 v[16:31], a[100:103], a[48:51], v[16:31]
    ds_read_b64_tr_b16 a[140:141], v229 offset:32768
    ds_read_b64_tr_b16 a[142:143], v229 offset:33792
    v_and_b32 v47, 0xffff0000, v199
    s_waitcnt vmcnt(15)
    v_lshlrev_b32 v48, 16, v200
    v_and_b32 v49, 0xffff0000, v200
    v_mfma_f32_32x32x16_bf16 v[0:15], a[104:107], a[52:55], v[0:15]
    ds_read_b64_tr_b16 a[96:97], v228 offset:38912
    ds_read_b64_tr_b16 a[98:99], v228 offset:39936
    buffer_load_dwordx4 v227, s[16:19], s49 offen offset:1024 lds
    s_add_u32 m0, s34, 126976
    v_lshlrev_b32 v50, 16, v201
    v_and_b32 v51, 0xffff0000, v201
    v_mfma_f32_32x32x16_bf16 v[16:31], a[108:111], a[52:55], v[16:31]
    ds_read_b64_tr_b16 a[100:101], v229 offset:38912
    ds_read_b64_tr_b16 a[102:103], v229 offset:39936
    v_lshlrev_b32 v52, 16, v202
    v_and_b32 v53, 0xffff0000, v202
    v_lshlrev_b32 v54, 16, v203
    s_waitcnt lgkmcnt(12)
    v_mfma_f32_32x32x16_bf16 v[0:15], a[112:115], a[56:59], v[0:15]
    ds_read_b64_tr_b16 a[104:105], v228 offset:45056
    ds_read_b64_tr_b16 a[106:107], v228 offset:46080
    v_and_b32 v55, 0xffff0000, v203
    v_lshlrev_b32 v56, 16, v204
    v_and_b32 v57, 0xffff0000, v204
    v_lshlrev_b32 v58, 16, v205
    v_mfma_f32_32x32x16_bf16 v[16:31], a[116:119], a[56:59], v[16:31]
    ds_read_b64_tr_b16 a[108:109], v229 offset:45056
    ds_read_b64_tr_b16 a[110:111], v229 offset:46080
    buffer_load_dwordx4 v227, s[16:19], s50 offen offset:0 lds
    v_and_b32 v59, 0xffff0000, v205
    v_lshlrev_b32 v60, 16, v206
    v_and_b32 v61, 0xffff0000, v206
    v_mfma_f32_32x32x16_bf16 v[0:15], a[120:123], a[60:63], v[0:15]
    ds_read_b64_tr_b16 a[112:113], v228 offset:28672
    ds_read_b64_tr_b16 a[114:115], v228 offset:29696
    v_lshlrev_b32 v62, 16, v207
    v_and_b32 v63, 0xffff0000, v207
    v_mfma_f32_32x32x16_bf16 v[16:31], a[124:127], a[60:63], v[16:31]
    ds_read_b64_tr_b16 a[116:117], v229 offset:28672
    ds_read_b64_tr_b16 a[118:119], v229 offset:29696
    s_waitcnt lgkmcnt(12)
    v_mfma_f32_32x32x16_bf16 v[0:15], a[128:131], a[64:67], v[0:15]
    ds_read_b64_tr_b16 a[120:121], v228 offset:34816
    ds_read_b64_tr_b16 a[122:123], v228 offset:35840
    buffer_load_dwordx4 v227, s[16:19], s51 offen offset:1024 lds
    v_mfma_f32_32x32x16_bf16 v[16:31], a[132:135], a[64:67], v[16:31]
    ds_read_b64_tr_b16 a[124:125], v229 offset:34816
    ds_read_b64_tr_b16 a[126:127], v229 offset:35840
    v_mfma_f32_32x32x16_bf16 v[0:15], a[136:139], a[68:71], v[0:15]
    ds_read_b64_tr_b16 a[128:129], v228 offset:40960
    ds_read_b64_tr_b16 a[130:131], v228 offset:41984
    v_mfma_f32_32x32x16_bf16 v[16:31], a[140:143], a[68:71], v[16:31]
    ds_read_b64_tr_b16 a[132:133], v229 offset:40960
    ds_read_b64_tr_b16 a[134:135], v229 offset:41984
    s_waitcnt lgkmcnt(12)
    v_mfma_f32_32x32x16_bf16 v[0:15], a[96:99], a[72:75], v[0:15]
    ds_read_b64_tr_b16 a[136:137], v228 offset:47104
    ds_read_b64_tr_b16 a[138:139], v228 offset:48128
    v_mfma_f32_32x32x16_bf16 v[16:31], a[100:103], a[72:75], v[16:31]
    ds_read_b64_tr_b16 a[140:141], v229 offset:47104
    ds_read_b64_tr_b16 a[142:143], v229 offset:48128
    s_barrier
    v_mfma_f32_32x32x16_bf16 v[0:15], a[104:107], a[76:79], v[0:15]
    ds_read_b64_tr_b16 a[96:97], v230 offset:0
    ds_read_b64_tr_b16 a[98:99], v230 offset:1024
    s_add_u32 m0, s34, 0
    v_mfma_f32_32x32x16_bf16 v[16:31], a[108:111], a[76:79], v[16:31]
    ds_read_b64_tr_b16 a[100:101], v231 offset:0
    ds_read_b64_tr_b16 a[102:103], v231 offset:1024
    s_waitcnt lgkmcnt(12)
    v_mfma_f32_32x32x16_bf16 v[0:15], a[112:115], a[80:83], v[0:15]
    ds_read_b64_tr_b16 a[104:105], v230 offset:6144
    ds_read_b64_tr_b16 a[106:107], v230 offset:7168
    v_mfma_f32_32x32x16_bf16 v[16:31], a[116:119], a[80:83], v[16:31]
    ds_read_b64_tr_b16 a[108:109], v231 offset:6144
    ds_read_b64_tr_b16 a[110:111], v231 offset:7168
    s_add_u32 s4, s70, 0
    buffer_load_dwordx4 v246, s[20:23], s4 offen offset:0 lds
    v_mfma_f32_32x32x16_bf16 v[0:15], a[120:123], a[84:87], v[0:15]
    ds_read_b64_tr_b16 a[112:113], v230 offset:12288
    ds_read_b64_tr_b16 a[114:115], v230 offset:13312
    v_mfma_f32_32x32x16_bf16 v[16:31], a[124:127], a[84:87], v[16:31]
    ds_read_b64_tr_b16 a[116:117], v231 offset:12288
    ds_read_b64_tr_b16 a[118:119], v231 offset:13312
    s_waitcnt vmcnt(9)
    buffer_store_dword v249, v225, s[24:27], s85 offen offset:640 sc1
    s_waitcnt lgkmcnt(12)
    v_mfma_f32_32x32x16_bf16 v[0:15], a[128:131], a[88:91], v[0:15]
    ds_read_b64_tr_b16 a[120:121], v230 offset:18432
    ds_read_b64_tr_b16 a[122:123], v230 offset:19456
    s_add_u32 s4, s70, 8192
    buffer_load_dwordx4 v246, s[20:23], s4 offen offset:1024 lds
    s_add_u32 m0, s34, 2048
    v_mfma_f32_32x32x16_bf16 v[16:31], a[132:135], a[88:91], v[16:31]
    ds_read_b64_tr_b16 a[124:125], v231 offset:18432
    ds_read_b64_tr_b16 a[126:127], v231 offset:19456
    v_mfma_f32_32x32x16_bf16 v[0:15], a[136:139], a[92:95], v[0:15]
    ds_read_b64_tr_b16 a[128:129], v230 offset:2048
    ds_read_b64_tr_b16 a[130:131], v230 offset:3072
    s_waitcnt vmcnt(8)
    v_cmp_ne_u32 vcc, 1, v238
    s_cbranch_vccnz L_slowp3
L_backp3:
    s_lshl_b32 s36, s71, 5
    s_add_u32 s36, s36, s61
    v_mfma_f32_32x32x16_bf16 v[16:31], a[140:143], a[92:95], v[16:31]
    ds_read_b64_tr_b16 a[132:133], v231 offset:2048
    ds_read_b64_tr_b16 a[134:135], v231 offset:3072
    buffer_load_dwordx4 v[160:163], v237, s[24:27], s36 offen offset:0 sc1
    s_waitcnt lgkmcnt(12)
    v_mfma_f32_32x32x16_bf16 v[32:47], a[96:99], a[0:3], v[32:47]
    ds_read_b64_tr_b16 a[136:137], v230 offset:8192
    ds_read_b64_tr_b16 a[138:139], v230 offset:9216
    buffer_load_dword v238, v241, s[24:27], s62 offen offset:512 sc1
    v_mfma_f32_32x32x16_bf16 v[48:63], a[100:103], a[0:3], v[48:63]
    ds_read_b64_tr_b16 a[140:141], v231 offset:8192
    ds_read_b64_tr_b16 a[142:143], v231 offset:9216
    s_add_u32 s4, s71, 0
    buffer_load_dwordx4 v246, s[20:23], s4 offen offset:0 lds
    v_cvt_pk_bf16_f32 v0, v0, v1
    v_cvt_pk_bf16_f32 v1, v2, v3
    v_mfma_f32_32x32x16_bf16 v[32:47], a[104:107], a[4:7], v[32:47]
    ds_read_b64_tr_b16 a[96:97], v230 offset:14336
    ds_read_b64_tr_b16 a[98:99], v230 offset:15360
    buffer_load_dwordx4 v[164:167], v237, s[24:27], s36 offen offset:1024 sc1
    v_cvt_pk_bf16_f32 v2, v4, v5
    v_cvt_pk_bf16_f32 v3, v6, v7
    v_cvt_pk_bf16_f32 v4, v8, v9
    v_mfma_f32_32x32x16_bf16 v[48:63], a[108:111], a[4:7], v[48:63]
    ds_read_b64_tr_b16 a[100:101], v231 offset:14336
    ds_read_b64_tr_b16 a[102:103], v231 offset:15360
    s_lshl_b32 s39, s70, 5
    s_add_u32 s39, s39, s59
    buffer_store_dwordx4 v[0:3], v237, s[24:27], s39 offen offset:0 sc1
    s_mov_b64 exec, s[56:57]
    ds_write_b128 v236, v[0:3] offset:0
    s_mov_b64 exec, -1
    v_cvt_pk_bf16_f32 v5, v10, v11
    v_cvt_pk_bf16_f32 v6, v12, v13
    s_waitcnt lgkmcnt(12)
    v_mfma_f32_32x32x16_bf16 v[32:47], a[112:115], a[8:11], v[32:47]
    ds_read_b64_tr_b16 a[104:105], v230 offset:20480
    ds_read_b64_tr_b16 a[106:107], v230 offset:21504
    s_add_u32 s4, s71, 8192
    buffer_load_dwordx4 v246, s[20:23], s4 offen offset:1024 lds
    s_add_u32 m0, s34, 4096
    v_cvt_pk_bf16_f32 v7, v14, v15
    v_cvt_pk_bf16_f32 v16, v16, v17
    v_mfma_f32_32x32x16_bf16 v[48:63], a[116:119], a[8:11], v[48:63]
    ds_read_b64_tr_b16 a[108:109], v231 offset:20480
    ds_read_b64_tr_b16 a[110:111], v231 offset:21504
    buffer_load_dwordx4 v[168:171], v237, s[24:27], s36 offen offset:2048 sc1
    v_cvt_pk_bf16_f32 v17, v18, v19
    v_cvt_pk_bf16_f32 v18, v20, v21
    v_cvt_pk_bf16_f32 v19, v22, v23
    v_mfma_f32_32x32x16_bf16 v[32:47], a[120:123], a[12:15], v[32:47]
    ds_read_b64_tr_b16 a[112:113], v230 offset:4096
    ds_read_b64_tr_b16 a[114:115], v230 offset:5120
    buffer_store_dwordx4 v[4:7], v237, s[24:27], s39 offen offset:1024 sc1
    s_mov_b64 exec, s[56:57]
    ds_write_b128 v236, v[4:7] offset:1024
    s_mov_b64 exec, -1
    v_cvt_pk_bf16_f32 v20, v24, v25
    v_cvt_pk_bf16_f32 v21, v26, v27
    v_cvt_pk_bf16_f32 v22, v28, v29
    v_mfma_f32_32x32x16_bf16 v[48:63], a[124:127], a[12:15], v[48:63]
    ds_read_b64_tr_b16 a[116:117], v231 offset:4096
    ds_read_b64_tr_b16 a[118:119], v231 offset:5120
    buffer_store_dwordx4 v[16:19], v237, s[24:27], s39 offen offset:2048 sc1
    s_mov_b64 exec, s[56:57]
    ds_write_b128 v236, v[16:19] offset:2048
    s_mov_b64 exec, -1
    v_cvt_pk_bf16_f32 v23, v30, v31
    s_waitcnt lgkmcnt(12)
    v_mfma_f32_32x32x16_bf16 v[32:47], a[128:131], a[16:19], v[32:47]
    ds_read_b64_tr_b16 a[120:121], v230 offset:10240
    ds_read_b64_tr_b16 a[122:123], v230 offset:11264
    buffer_load_dwordx4 v[172:175], v237, s[24:27], s36 offen offset:3072 sc1
    v_mfma_f32_32x32x16_bf16 v[48:63], a[132:135], a[16:19], v[48:63]
    ds_read_b64_tr_b16 a[124:125], v231 offset:10240
    ds_read_b64_tr_b16 a[126:127], v231 offset:11264
    buffer_store_dwordx4 v[20:23], v237, s[24:27], s39 offen offset:3072 sc1
    s_mov_b64 exec, s[56:57]
    ds_write_b128 v236, v[20:23] offset:3072
    s_mov_b64 exec, -1
    v_mfma_f32_32x32x16_bf16 v[32:47], a[136:139], a[20:23], v[32:47]
    ds_read_b64_tr_b16 a[128:129], v230 offset:16384
    ds_read_b64_tr_b16 a[130:131], v230 offset:17408
    s_add_u32 s4, s72, 0
    buffer_load_dwordx4 v246, s[20:23], s4 offen offset:0 lds
    v_mfma_f32_32x32x16_bf16 v[48:63], a[140:143], a[20:23], v[48:63]
    ds_read_b64_tr_b16 a[132:133], v231 offset:16384
    ds_read_b64_tr_b16 a[134:135], v231 offset:17408
    s_add_u32 s4, s72, 8192
    buffer_load_dwordx4 v246, s[20:23], s4 offen offset:1024 lds
    s_waitcnt lgkmcnt(12)
    v_mfma_f32_32x32x16_bf16 v[32:47], a[96:99], a[24:27], v[32:47]
    ds_read_b64_tr_b16 a[136:137], v230 offset:22528
    ds_read_b64_tr_b16 a[138:139], v230 offset:23552
    v_mfma_f32_32x32x16_bf16 v[48:63], a[100:103], a[24:27], v[48:63]
    ds_read_b64_tr_b16 a[140:141], v231 offset:22528
    ds_read_b64_tr_b16 a[142:143], v231 offset:23552
    s_barrier
    v_mfma_f32_32x32x16_bf16 v[32:47], a[104:107], a[28:31], v[32:47]
    ds_read_b64_tr_b16 a[96:97], v230 offset:24576
    ds_read_b64_tr_b16 a[98:99], v230 offset:25600
    s_add_u32 m0, s34, 24576
    v_mfma_f32_32x32x16_bf16 v[48:63], a[108:111], a[28:31], v[48:63]
    ds_read_b64_tr_b16 a[100:101], v231 offset:24576
    ds_read_b64_tr_b16 a[102:103], v231 offset:25600
    s_waitcnt lgkmcnt(12)
    v_mfma_f32_32x32x16_bf16 v[32:47], a[112:115], a[32:35], v[32:47]
    ds_read_b64_tr_b16 a[104:105], v230 offset:30720
    ds_read_b64_tr_b16 a[106:107], v230 offset:31744
    v_mfma_f32_32x32x16_bf16 v[48:63], a[116:119], a[32:35], v[48:63]
    ds_read_b64_tr_b16 a[108:109], v231 offset:30720
    ds_read_b64_tr_b16 a[110:111], v231 offset:31744
    s_add_u32 s4, s70, 20736
    buffer_load_dwordx4 v246, s[20:23], s4 offen offset:0 lds
    v_mfma_f32_32x32x16_bf16 v[32:47], a[120:123], a[36:39], v[32:47]
    ds_read_b64_tr_b16 a[112:113], v230 offset:36864
    ds_read_b64_tr_b16 a[114:115], v230 offset:37888
    v_mfma_f32_32x32x16_bf16 v[48:63], a[124:127], a[36:39], v[48:63]
    ds_read_b64_tr_b16 a[116:117], v231 offset:36864
    ds_read_b64_tr_b16 a[118:119], v231 offset:37888
    s_waitcnt lgkmcnt(12)
    v_mfma_f32_32x32x16_bf16 v[32:47], a[128:131], a[40:43], v[32:47]
    ds_read_b64_tr_b16 a[120:121], v230 offset:43008
    ds_read_b64_tr_b16 a[122:123], v230 offset:44032
    s_add_u32 s4, s70, 28928
    buffer_load_dwordx4 v246, s[20:23], s4 offen offset:1024 lds
    s_add_u32 m0, s34, 26624
    v_mfma_f32_32x32x16_bf16 v[48:63], a[132:135], a[40:43], v[48:63]
    ds_read_b64_tr_b16 a[124:125], v231 offset:43008
    ds_read_b64_tr_b16 a[126:127], v231 offset:44032
    v_mfma_f32_32x32x16_bf16 v[32:47], a[136:139], a[44:47], v[32:47]
    ds_read_b64_tr_b16 a[128:129], v230 offset:26624
    ds_read_b64_tr_b16 a[130:131], v230 offset:27648
    v_mfma_f32_32x32x16_bf16 v[48:63], a[140:143], a[44:47], v[48:63]
    ds_read_b64_tr_b16 a[132:133], v231 offset:26624
    ds_read_b64_tr_b16 a[134:135], v231 offset:27648
    s_add_u32 s4, s71, 20736
    buffer_load_dwordx4 v246, s[20:23], s4 offen offset:0 lds
    s_waitcnt lgkmcnt(12)
    v_mfma_f32_32x32x16_bf16 v[32:47], a[96:99], a[48:51], v[32:47]
    ds_read_b64_tr_b16 a[136:137], v230 offset:32768
    ds_read_b64_tr_b16 a[138:139], v230 offset:33792
    v_mfma_f32_32x32x16_bf16 v[48:63], a[100:103], a[48:51], v[48:63]
    ds_read_b64_tr_b16 a[140:141], v231 offset:32768
    ds_read_b64_tr_b16 a[142:143], v231 offset:33792
    v_mfma_f32_32x32x16_bf16 v[32:47], a[104:107], a[52:55], v[32:47]
    ds_read_b64_tr_b16 a[96:97], v230 offset:38912
    ds_read_b64_tr_b16 a[98:99], v230 offset:39936
    s_waitcnt vmcnt(14)
    v_cmp_ne_u32 vcc, 1, v238
    s_cbranch_vccnz L_slowp4
L_backp4:
    s_lshl_b32 s36, s72, 5
    s_add_u32 s36, s36, s60
    v_mfma_f32_32x32x16_bf16 v[48:63], a[108:111], a[52:55], v[48:63]
    ds_read_b64_tr_b16 a[100:101], v231 offset:38912
    ds_read_b64_tr_b16 a[102:103], v231 offset:39936
    buffer_load_dwordx4 v[176:179], v237, s[24:27], s36 offen offset:0 sc1
    s_waitcnt lgkmcnt(12)
    v_mfma_f32_32x32x16_bf16 v[32:47], a[112:115], a[56:59], v[32:47]
    ds_read_b64_tr_b16 a[104:105], v230 offset:45056
    ds_read_b64_tr_b16 a[106:107], v230 offset:46080
    buffer_load_dword v238, v241, s[24:27], s63 offen offset:640 sc1
    v_mfma_f32_32x32x16_bf16 v[48:63], a[116:119], a[56:59], v[48:63]
    ds_read_b64_tr_b16 a[108:109], v231 offset:45056
L_sm10:
    s_cbranch_execz L_retm
    ds_read_b64_tr_b16 a[110:111], v231 offset:46080
    s_add_u32 s4, s71, 28928
    buffer_load_dwordx4 v246, s[20:23], s4 offen offset:1024 lds
    s_add_u32 m0, s34, 28672
    v_mfma_f32_32x32x16_bf16 v[32:47], a[120:123], a[60:63], v[32:47]
    ds_read_b64_tr_b16 a[112:113], v230 offset:28672
    ds_read_b64_tr_b16 a[114:115], v230 offset:29696
    buffer_load_dwordx4 v[180:183], v237, s[24:27], s36 offen offset:1024 sc1
    v_mfma_f32_32x32x16_bf16 v[48:63], a[124:127], a[60:63], v[48:63]
    ds_read_b64_tr_b16 a[116:117], v231 offset:28672
    ds_read_b64_tr_b16 a[118:119], v231 offset:29696
    s_add_u32 s4, s72, 20736
    buffer_load_dwordx4 v246, s[20:23], s4 offen offset:0 lds
    s_waitcnt lgkmcnt(12)
    v_mfma_f32_32x32x16_bf16 v[32:47], a[128:131], a[64:67], v[32:47]
    ds_read_b64_tr_b16 a[120:121], v230 offset:34816
    ds_read_b64_tr_b16 a[122:123], v230 offset:35840
    s_add_u32 s4, s72, 28928
    buffer_load_dwordx4 v246, s[20:23], s4 offen offset:1024 lds
    v_mfma_f32_32x32x16_bf16 v[48:63], a[132:135], a[64:67], v[48:63]
    ds_read_b64_tr_b16 a[124:125], v231 offset:34816
    ds_read_b64_tr_b16 a[126:127], v231 offset:35840
    buffer_load_dwordx4 v[184:187], v237, s[24:27], s36 offen offset:2048 sc1
    v_mfma_f32_32x32x16_bf16 v[32:47], a[136:139], a[68:71], v[32:47]
    ds_read_b64_tr_b16 a[128:129], v230 offset:40960
    ds_read_b64_tr_b16 a[130:131], v230 offset:41984
    v_mfma_f32_32x32x16_bf16 v[48:63], a[140:143], a[68:71], v[48:63]
    ds_read_b64_tr_b16 a[132:133], v231 offset:40960
    ds_read_b64_tr_b16 a[134:135], v231 offset:41984
    s_waitcnt lgkmcnt(12)
    v_mfma_f32_32x32x16_bf16 v[32:47], a[96:99], a[72:75], v[32:47]
    ds_read_b64_tr_b16 a[136:137], v230 offset:47104
    ds_read_b64_tr_b16 a[138:139], v230 offset:48128
    buffer_load_dwordx4 v[188:191], v237, s[24:27], s36 offen offset:3072 sc1
    v_mfma_f32_32x32x16_bf16 v[48:63], a[100:103], a[72:75], v[48:63]
    ds_read_b64_tr_b16 a[140:141], v231 offset:47104
    ds_read_b64_tr_b16 a[142:143], v231 offset:48128
    s_barrier
    v_mfma_f32_32x32x16_bf16 v[32:47], a[104:107], a[76:79], v[32:47]
    ds_read_b64_tr_b16 a[96:97], v232 offset:0
    ds_read_b64_tr_b16 a[98:99], v232 offset:1024
    s_add_u32 m0, s34, 49152
    v_mfma_f32_32x32x16_bf16 v[48:63], a[108:111], a[76:79], v[48:63]
    ds_read_b64_tr_b16 a[100:101], v233 offset:0
    ds_read_b64_tr_b16 a[102:103], v233 offset:1024
    s_waitcnt lgkmcnt(12)
    v_mfma_f32_32x32x16_bf16 v[32:47], a[112:115], a[80:83], v[32:47]
    ds_read_b64_tr_b16 a[104:105], v232 offset:6144
    ds_read_b64_tr_b16 a[106:107], v232 offset:7168
    v_mfma_f32_32x32x16_bf16 v[48:63], a[116:119], a[80:83], v[48:63]
    ds_read_b64_tr_b16 a[108:109], v233 offset:6144
    ds_read_b64_tr_b16 a[110:111], v233 offset:7168
    s_add_u32 s4, s70, 41472
    buffer_load_dwordx4 v246, s[20:23], s4 offen offset:0 lds
    v_mfma_f32_32x32x16_bf16 v[32:47], a[120:123], a[84:87], v[32:47]
    ds_read_b64_tr_b16 a[112:113], v232 offset:12288
    ds_read_b64_tr_b16 a[114:115], v232 offset:13312
    v_mfma_f32_32x32x16_bf16 v[48:63], a[124:127], a[84:87], v[48:63]
    ds_read_b64_tr_b16 a[116:117], v233 offset:12288
    ds_read_b64_tr_b16 a[118:119], v233 offset:13312
    s_waitcnt lgkmcnt(12)
    v_mfma_f32_32x32x16_bf16 v[32:47], a[128:131], a[88:91], v[32:47]
    ds_read_b64_tr_b16 a[120:121], v232 offset:18432
    ds_read_b64_tr_b16 a[122:123], v232 offset:19456
    s_add_u32 s4, s70, 49664
    buffer_load_dwordx4 v246, s[20:23], s4 offen offset:1024 lds
    s_add_u32 m0, s34, 51200
    v_mfma_f32_32x32x16_bf16 v[48:63], a[132:135], a[88:91], v[48:63]
    ds_read_b64_tr_b16 a[124:125], v233 offset:18432
    ds_read_b64_tr_b16 a[126:127], v233 offset:19456
    v_mfma_f32_32x32x16_bf16 v[32:47], a[136:139], a[92:95], v[32:47]
    ds_read_b64_tr_b16 a[128:129], v232 offset:2048
    ds_read_b64_tr_b16 a[130:131], v232 offset:3072
    v_mfma_f32_32x32x16_bf16 v[48:63], a[140:143], a[92:95], v[48:63]
    ds_read_b64_tr_b16 a[132:133], v233 offset:2048
    ds_read_b64_tr_b16 a[134:135], v233 offset:3072
    s_add_u32 s4, s71, 41472
    buffer_load_dwordx4 v246, s[20:23], s4 offen offset:0 lds
    s_waitcnt lgkmcnt(12)
    v_mfma_f32_32x32x16_bf16 v[64:79], a[96:99], a[0:3], 0
    ds_read_b64_tr_b16 a[136:137], v232 offset:8192
    ds_read_b64_tr_b16 a[138:139], v232 offset:9216
    v_mfma_f32_32x32x16_bf16 v[80:95], a[100:103], a[0:3], 0
    ds_read_b64_tr_b16 a[140:141], v233 offset:8192
    ds_read_b64_tr_b16 a[142:143], v233 offset:9216
    s_waitcnt vmcnt(23)
    v_lshlrev_b32 v208, 16, v160
    v_and_b32 v209, 0xffff0000, v160
    v_add_f32 v32, v32, v208
    v_mfma_f32_32x32x16_bf16 v[64:79], a[104:107], a[4:7], v[64:79]
    ds_read_b64_tr_b16 a[96:97], v232 offset:14336
    ds_read_b64_tr_b16 a[98:99], v232 offset:15360
    s_add_u32 s4, s71, 49664
    buffer_load_dwordx4 v246, s[20:23], s4 offen offset:1024 lds
    s_add_u32 m0, s34, 53248
    v_add_f32 v33, v33, v209
    v_lshlrev_b32 v210, 16, v161
    v_mfma_f32_32x32x16_bf16 v[80:95], a[108:111], a[4:7], v[80:95]
    ds_read_b64_tr_b16 a[100:101], v233 offset:14336
    ds_read_b64_tr_b16 a[102:103], v233 offset:15360
    v_and_b32 v211, 0xffff0000, v161
    v_add_f32 v34, v34, v210
    v_add_f32 v35, v35, v211
    s_waitcnt lgkmcnt(12)
    v_mfma_f32_32x32x16_bf16 v[64:79], a[112:115], a[8:11], v[64:79]
    ds_read_b64_tr_b16 a[104:105], v232 offset:20480
    ds_read_b64_tr_b16 a[106:107], v232 offset:21504
    v_lshlrev_b32 v208, 16, v162
    v_and_b32 v209, 0xffff0000, v162
    v_add_f32 v36, v36, v208
    v_add_f32 v37, v37, v209
    v_mfma_f32_32x32x16_bf16 v[80:95], a[116:119], a[8:11], v[80:95]
    ds_read_b64_tr_b16 a[108:109], v233 offset:20480
    ds_read_b64_tr_b16 a[110:111], v233 offset:21504
    s_add_u32 s4, s72, 41472
    buffer_load_dwordx4 v246, s[20:23], s4 offen offset:0 lds
    v_lshlrev_b32 v210, 16, v163
    v_and_b32 v211, 0xffff0000, v163
    v_mfma_f32_32x32x16_bf16 v[64:79], a[120:123], a[12:15], v[64:79]
    ds_read_b64_tr_b16 a[112:113], v232 offset:4096
    ds_read_b64_tr_b16 a[114:115], v232 offset:5120
    s_waitcnt vmcnt(11)
    v_cmp_ne_u32 vcc, 1, v238
    s_cbranch_vccnz L_slowp5
L_backp5:
    s_lshl_b32 s36, s72, 5
    s_add_u32 s36, s36, s61
    v_mfma_f32_32x32x16_bf16 v[80:95], a[124:127], a[12:15], v[80:95]
    ds_read_b64_tr_b16 a[116:117], v233 offset:4096
    ds_read_b64_tr_b16 a[118:119], v233 offset:5120
    buffer_load_dwordx4 v[192:195], v237, s[24:27], s36 offen offset:0 sc1
    v_add_f32 v38, v38, v210
    v_add_f32 v39, v39, v211
    s_waitcnt lgkmcnt(12)
    v_mfma_f32_32x32x16_bf16 v[64:79], a[128:131], a[16:19], v[64:79]
    ds_read_b64_tr_b16 a[120:121], v232 offset:10240
    ds_read_b64_tr_b16 a[122:123], v232 offset:11264
    s_add_u32 s4, s72, 49664
    buffer_load_dwordx4 v246, s[20:23], s4 offen offset:1024 lds
    v_lshlrev_b32 v208, 16, v164
    v_and_b32 v209, 0xffff0000, v164
    v_mfma_f32_32x32x16_bf16 v[80:95], a[132:135], a[16:19], v[80:95]
    ds_read_b64_tr_b16 a[124:125], v233 offset:10240
    ds_read_b64_tr_b16 a[126:127], v233 offset:11264
    v_add_f32 v40, v40, v208
    v_add_f32 v41, v41, v209
    v_lshlrev_b32 v210, 16, v165
    v_and_b32 v211, 0xffff0000, v165
    v_mfma_f32_32x32x16_bf16 v[64:79], a[136:139], a[20:23], v[64:79]
    ds_read_b64_tr_b16 a[128:129], v232 offset:16384
    ds_read_b64_tr_b16 a[130:131], v232 offset:17408
    buffer_load_dwordx4 v[196:199], v237, s[24:27], s36 offen offset:1024 sc1
    v_add_f32 v42, v42, v210
    v_add_f32 v43, v43, v211
    v_lshlrev_b32 v208, 16, v166
    v_mfma_f32_32x32x16_bf16 v[80:95], a[140:143], a[20:23], v[80:95]
    ds_read_b64_tr_b16 a[132:133], v233 offset:16384
    ds_read_b64_tr_b16 a[134:135], v233 offset:17408
    v_and_b32 v209, 0xffff0000, v166
    v_add_f32 v44, v44, v208
    v_add_f32 v45, v45, v209
    s_waitcnt lgkmcnt(12)
    v_mfma_f32_32x32x16_bf16 v[64:79], a[96:99], a[24:27], v[64:79]
    ds_read_b64_tr_b16 a[136:137], v232 offset:22528
    ds_read_b64_tr_b16 a[138:139], v232 offset:23552
    v_lshlrev_b32 v210, 16, v167
    v_and_b32 v211, 0xffff0000, v167
    v_add_f32 v46, v46, v210
    v_add_f32 v47, v47, v211
    v_mfma_f32_32x32x16_bf16 v[80:95], a[100:103], a[24:27], v[80:95]
    ds_read_b64_tr_b16 a[140:141], v233 offset:22528
    ds_read_b64_tr_b16 a[142:143], v233 offset:23552
    buffer_load_dwordx4 v[200:203], v237, s[24:27], s36 offen offset:2048 sc1
    v_cvt_pk_bf16_f32 v32, v32, v33
    v_cvt_pk_bf16_f32 v33, v34, v35
    v_cvt_pk_bf16_f32 v34, v36, v37
    s_barrier
    v_mfma_f32_32x32x16_bf16 v[64:79], a[104:107], a[28:31], v[64:79]
    ds_read_b64_tr_b16 a[96:97], v232 offset:24576
    ds_read_b64_tr_b16 a[98:99], v232 offset:25600
    s_add_u32 m0, s34, 73728
    v_cvt_pk_bf16_f32 v35, v38, v39
    v_cvt_pk_bf16_f32 v36, v40, v41
    v_mfma_f32_32x32x16_bf16 v[80:95], a[108:111], a[28:31], v[80:95]
    ds_read_b64_tr_b16 a[100:101], v233 offset:24576
    ds_read_b64_tr_b16 a[102:103], v233 offset:25600
    s_lshl_b32 s39, s71, 5
    s_add_u32 s39, s39, s59
    buffer_store_dwordx4 v[32:35], v237, s[24:27], s39 offen offset:0 sc1
    s_mov_b64 exec, s[56:57]
    ds_write_b128 v236, v[32:35] offset:4096
    s_mov_b64 exec, -1
    v_cvt_pk_bf16_f32 v37, v42, v43
    v_cvt_pk_bf16_f32 v38, v44, v45
    s_waitcnt lgkmcnt(12)
    v_mfma_f32_32x32x16_bf16 v[64:79], a[112:115], a[32:35], v[64:79]
    ds_read_b64_tr_b16 a[104:105], v232 offset:30720
    ds_read_b64_tr_b16 a[106:107], v232 offset:31744
    buffer_load_dwordx4 v[204:207], v237, s[24:27], s36 offen offset:3072 sc1
    v_cvt_pk_bf16_f32 v39, v46, v47
    v_lshlrev_b32 v208, 16, v168
    v_mfma_f32_32x32x16_bf16 v[80:95], a[116:119], a[32:35], v[80:95]
    ds_read_b64_tr_b16 a[108:109], v233 offset:30720
    ds_read_b64_tr_b16 a[110:111], v233 offset:31744
    buffer_store_dwordx4 v[36:39], v237, s[24:27], s39 offen offset:1024 sc1
    s_mov_b64 exec, s[56:57]
    ds_write_b128 v236, v[36:39] offset:5120
    s_mov_b64 exec, -1
    v_and_b32 v209, 0xffff0000, v168
    v_add_f32 v48, v48, v208
    v_add_f32 v49, v49, v209
    v_mfma_f32_32x32x16_bf16 v[64:79], a[120:123], a[36:39], v[64:79]
    ds_read_b64_tr_b16 a[112:113], v232 offset:36864
    ds_read_b64_tr_b16 a[114:115], v232 offset:37888
    s_add_u32 s4, s70, 62208
    buffer_load_dwordx4 v246, s[20:23], s4 offen offset:0 lds
    v_lshlrev_b32 v210, 16, v169
    v_and_b32 v211, 0xffff0000, v169
    v_mfma_f32_32x32x16_bf16 v[80:95], a[124:127], a[36:39], v[80:95]
    ds_read_b64_tr_b16 a[116:117], v233 offset:36864
    ds_read_b64_tr_b16 a[118:119], v233 offset:37888
    v_add_f32 v50, v50, v210
    v_add_f32 v51, v51, v211
    v_lshlrev_b32 v208, 16, v170
    s_waitcnt lgkmcnt(12)
    v_mfma_f32_32x32x16_bf16 v[64:79], a[128:131], a[40:43], v[64:79]
    ds_read_b64_tr_b16 a[120:121], v232 offset:43008
    ds_read_b64_tr_b16 a[122:123], v232 offset:44032
    s_add_u32 s4, s70, 70400
    buffer_load_dwordx4 v246, s[20:23], s4 offen offset:1024 lds
    s_add_u32 m0, s34, 75776
    v_and_b32 v209, 0xffff0000, v170
    v_add_f32 v52, v52, v208
    v_mfma_f32_32x32x16_bf16 v[80:95], a[132:135], a[40:43], v[80:95]
    ds_read_b64_tr_b16 a[124:125], v233 offset:43008
    ds_read_b64_tr_b16 a[126:127], v233 offset:44032
    v_add_f32 v53, v53, v209
    v_lshlrev_b32 v210, 16, v171
    v_and_b32 v211, 0xffff0000, v171
    v_add_f32 v54, v54, v210
    v_mfma_f32_32x32x16_bf16 v[64:79], a[136:139], a[44:47], v[64:79]
    ds_read_b64_tr_b16 a[128:129], v232 offset:26624
    ds_read_b64_tr_b16 a[130:131], v232 offset:27648
    v_add_f32 v55, v55, v211
    v_lshlrev_b32 v208, 16, v172
    v_and_b32 v209, 0xffff0000, v172
    v_add_f32 v56, v56, v208
    v_mfma_f32_32x32x16_bf16 v[80:95], a[140:143], a[44:47], v[80:95]
    ds_read_b64_tr_b16 a[132:133], v233 offset:26624
    ds_read_b64_tr_b16 a[134:135], v233 offset:27648
    s_add_u32 s4, s71, 62208
    buffer_load_dwordx4 v246, s[20:23], s4 offen offset:0 lds
    v_add_f32 v57, v57, v209
    s_waitcnt lgkmcnt(12)
    v_mfma_f32_32x32x16_bf16 v[64:79], a[96:99], a[48:51], v[64:79]
    ds_read_b64_tr_b16 a[136:137], v232 offset:32768
    ds_read_b64_tr_b16 a[138:139], v232 offset:33792
    buffer_load_dword v253, v245, s[24:27], 0 offen sc1
    v_lshlrev_b32 v210, 16, v173
    v_and_b32 v211, 0xffff0000, v173
    v_add_f32 v58, v58, v210
    s_barrier
    v_mfma_f32_32x32x16_bf16 v[80:95], a[100:103], a[48:51], v[80:95]
    ds_read_b64_tr_b16 a[140:141], v233 offset:32768
    ds_read_b64_tr_b16 a[142:143], v233 offset:33792
    v_add_f32 v59, v59, v211
    v_lshlrev_b32 v208, 16, v174
    v_and_b32 v209, 0xffff0000, v174
    v_add_f32 v60, v60, v208
    v_mfma_f32_32x32x16_bf16 v[64:79], a[104:107], a[52:55], v[64:79]
    ds_read_b64_tr_b16 a[96:97], v232 offset:38912
    ds_read_b64_tr_b16 a[98:99], v232 offset:39936
    s_add_u32 s4, s71, 70400
    buffer_load_dwordx4 v246, s[20:23], s4 offen offset:1024 lds
    s_add_u32 m0, s34, 77824
    v_add_f32 v61, v61, v209
    v_lshlrev_b32 v210, 16, v175
    v_mfma_f32_32x32x16_bf16 v[80:95], a[108:111], a[52:55], v[80:95]
    ds_read_b64_tr_b16 a[100:101], v233 offset:38912
    ds_read_b64_tr_b16 a[102:103], v233 offset:39936
    v_and_b32 v211, 0xffff0000, v175
    v_add_f32 v62, v62, v210
    v_add_f32 v63, v63, v211
    s_waitcnt lgkmcnt(12)
    v_mfma_f32_32x32x16_bf16 v[64:79], a[112:115], a[56:59], v[64:79]
    ds_read_b64_tr_b16 a[104:105], v232 offset:45056
    ds_read_b64_tr_b16 a[106:107], v232 offset:46080
    v_cvt_pk_bf16_f32 v48, v48, v49
    v_cvt_pk_bf16_f32 v49, v50, v51
    v_cvt_pk_bf16_f32 v50, v52, v53
    v_cvt_pk_bf16_f32 v51, v54, v55
    v_mfma_f32_32x32x16_bf16 v[80:95], a[116:119], a[56:59], v[80:95]
    ds_read_b64_tr_b16 a[108:109], v233 offset:45056
    ds_read_b64_tr_b16 a[110:111], v233 offset:46080
    buffer_store_dwordx4 v[48:51], v237, s[24:27], s39 offen offset:2048 sc1
    s_mov_b64 exec, s[56:57]
    ds_write_b128 v236, v[48:51] offset:6144
    s_mov_b64 exec, -1
    v_cvt_pk_bf16_f32 v52, v56, v57
    v_cvt_pk_bf16_f32 v53, v58, v59
    v_cvt_pk_bf16_f32 v54, v60, v61
    v_mfma_f32_32x32x16_bf16 v[64:79], a[120:123], a[60:63], v[64:79]
    ds_read_b64_tr_b16 a[112:113], v232 offset:28672
    ds_read_b64_tr_b16 a[114:115], v232 offset:29696
    s_add_u32 s4, s72, 62208
    buffer_load_dwordx4 v246, s[20:23], s4 offen offset:0 lds
    v_cvt_pk_bf16_f32 v55, v62, v63
    v_mfma_f32_32x32x16_bf16 v[80:95], a[124:127], a[60:63], v[80:95]
    ds_read_b64_tr_b16 a[116:117], v233 offset:28672
    ds_read_b64_tr_b16 a[118:119], v233 offset:29696
    buffer_store_dwordx4 v[52:55], v237, s[24:27], s39 offen offset:3072 sc1
    s_mov_b64 exec, s[56:57]
    ds_write_b128 v236, v[52:55] offset:7168
    s_mov_b64 exec, -1
    s_waitcnt lgkmcnt(12)
    v_mfma_f32_32x32x16_bf16 v[64:79], a[128:131], a[64:67], v[64:79]
    ds_read_b64_tr_b16 a[120:121], v232 offset:34816
    ds_read_b64_tr_b16 a[122:123], v232 offset:35840
    s_add_u32 s4, s72, 70400
    buffer_load_dwordx4 v246, s[20:23], s4 offen offset:1024 lds
    v_mfma_f32_32x32x16_bf16 v[80:95], a[132:135], a[64:67], v[80:95]
    ds_read_b64_tr_b16 a[124:125], v233 offset:34816
    ds_read_b64_tr_b16 a[126:127], v233 offset:35840
    v_mfma_f32_32x32x16_bf16 v[64:79], a[136:139], a[68:71], v[64:79]
    ds_read_b64_tr_b16 a[128:129], v232 offset:40960
    ds_read_b64_tr_b16 a[130:131], v232 offset:41984
    s_add_u32 m0, s34, 98304
    v_mfma_f32_32x32x16_bf16 v[80:95], a[140:143], a[68:71], v[80:95]
    ds_read_b64_tr_b16 a[132:133], v233 offset:40960
    ds_read_b64_tr_b16 a[134:135], v233 offset:41984
    s_waitcnt lgkmcnt(12)
    v_mfma_f32_32x32x16_bf16 v[64:79], a[96:99], a[72:75], v[64:79]
    ds_read_b64_tr_b16 a[136:137], v232 offset:47104
    ds_read_b64_tr_b16 a[138:139], v232 offset:48128
    s_add_u32 s4, s70, 82944
    buffer_load_dwordx4 v246, s[20:23], s4 offen offset:0 lds
    v_mfma_f32_32x32x16_bf16 v[80:95], a[100:103], a[72:75], v[80:95]
    ds_read_b64_tr_b16 a[140:141], v233 offset:47104
    ds_read_b64_tr_b16 a[142:143], v233 offset:48128
    v_mfma_f32_32x32x16_bf16 v[64:79], a[104:107], a[76:79], v[64:79]
    s_add_u32 s4, s70, 91136
    buffer_load_dwordx4 v246, s[20:23], s4 offen offset:1024 lds
    s_add_u32 m0, s34, 100352
    v_mfma_f32_32x32x16_bf16 v[80:95], a[108:111], a[76:79], v[80:95]
    s_waitcnt lgkmcnt(8)
    v_mfma_f32_32x32x16_bf16 v[64:79], a[112:115], a[80:83], v[64:79]
    s_add_u32 s4, s71, 82944
    buffer_load_dwordx4 v246, s[20:23], s4 offen offset:0 lds
    v_mfma_f32_32x32x16_bf16 v[80:95], a[116:119], a[80:83], v[80:95]
    v_mfma_f32_32x32x16_bf16 v[64:79], a[120:123], a[84:87], v[64:79]
    s_add_u32 s4, s71, 91136
    buffer_load_dwordx4 v246, s[20:23], s4 offen offset:1024 lds
    s_add_u32 m0, s34, 102400
    v_mfma_f32_32x32x16_bf16 v[80:95], a[124:127], a[84:87], v[80:95]
    s_waitcnt lgkmcnt(0)
    v_mfma_f32_32x32x16_bf16 v[64:79], a[128:131], a[88:91], v[64:79]
    s_add_u32 s4, s72, 82944
    buffer_load_dwordx4 v246, s[20:23], s4 offen offset:0 lds
    v_mfma_f32_32x32x16_bf16 v[80:95], a[132:135], a[88:91], v[80:95]
    v_mfma_f32_32x32x16_bf16 v[64:79], a[136:139], a[92:95], v[64:79]
    s_add_u32 s4, s72, 91136
    buffer_load_dwordx4 v246, s[20:23], s4 offen offset:1024 lds
    v_mfma_f32_32x32x16_bf16 v[80:95], a[140:143], a[92:95], v[80:95]
    s_waitcnt lgkmcnt(0)
    s_barrier
    v_add_u32 v228, s34, v228
    v_add_u32 v229, s34, v229
    v_add_u32 v230, s34, v230
    v_add_u32 v231, s34, v231
    v_add_u32 v232, s34, v232
    v_add_u32 v233, s34, v233
    s_waitcnt vmcnt(11)
    v_readfirstlane_b32 s58, v253
    s_nop 0
    s_cmp_eq_u32 s58, 1
    s_cselect_b32 s82, s37, 0x7ff00000
    s_add_u32 s83, s82, 4096
    s_add_u32 s84, s82, 8192
    buffer_load_dwordx4 a[144:147], v237, s[24:27], s82 offen offset:0 sc1
    buffer_load_dwordx4 a[148:151], v237, s[24:27], s82 offen offset:1024 sc1
    buffer_load_dwordx4 a[152:155], v237, s[24:27], s82 offen offset:2048 sc1
    buffer_load_dwordx4 a[156:159], v237, s[24:27], s82 offen offset:3072 sc1
    buffer_load_dwordx4 a[160:163], v237, s[24:27], s83 offen offset:0 sc1
    buffer_load_dwordx4 a[164:167], v237, s[24:27], s83 offen offset:1024 sc1
    buffer_load_dwordx4 a[168:171], v237, s[24:27], s83 offen offset:2048 sc1
    buffer_load_dwordx4 a[172:175], v237, s[24:27], s83 offen offset:3072 sc1
    buffer_load_dwordx4 a[176:179], v237, s[24:27], s84 offen offset:0 sc1
    buffer_load_dword v253, v245, s[24:27], 0 offen sc1
    ds_read_b64_tr_b16 a[0:1], v228 offset:0
    ds_read_b64_tr_b16 a[2:3], v228 offset:1024
    ds_read_b64_tr_b16 a[4:5], v229 offset:0
    ds_read_b64_tr_b16 a[6:7], v229 offset:1024
    ds_read_b64_tr_b16 a[8:9], v228 offset:2048
    ds_read_b64_tr_b16 a[10:11], v228 offset:3072
    ds_read_b64_tr_b16 a[12:13], v229 offset:2048
    ds_read_b64_tr_b16 a[14:15], v229 offset:3072
    ds_read_b64_tr_b16 a[16:17], v228 offset:4096
    ds_read_b64_tr_b16 a[18:19], v228 offset:5120
    ds_read_b64_tr_b16 a[20:21], v229 offset:4096
    ds_read_b64_tr_b16 a[22:23], v229 offset:5120
    ds_read_b64_tr_b16 a[24:25], v228 offset:24576
    ds_read_b64_tr_b16 a[26:27], v228 offset:25600
    ds_read_b64_tr_b16 a[28:29], v229 offset:24576
    ds_read_b64_tr_b16 a[30:31], v229 offset:25600
    ds_read_b64_tr_b16 a[32:33], v228 offset:26624
    ds_read_b64_tr_b16 a[34:35], v228 offset:27648
    ds_read_b64_tr_b16 a[36:37], v229 offset:26624
    ds_read_b64_tr_b16 a[38:39], v229 offset:27648
    ds_read_b64_tr_b16 a[40:41], v228 offset:28672
    ds_read_b64_tr_b16 a[42:43], v228 offset:29696
    ds_read_b64_tr_b16 a[44:45], v229 offset:28672
    ds_read_b64_tr_b16 a[46:47], v229 offset:29696
    ds_read_b128 v[12:15], v234 offset:0
    ds_read_b128 v[28:31], v234 offset:4096
    v_dot2_f32_bf16 v64, v176, v218, v64
    v_dot2_f32_bf16 v65, v176, v219, v65
    v_dot2_f32_bf16 v66, v177, v218, v66
    v_dot2_f32_bf16 v67, v177, v219, v67
    v_dot2_f32_bf16 v68, v178, v218, v68
    s_add_u32 m0, s34, 122880
    v_dot2_f32_bf16 v69, v178, v219, v69
    v_dot2_f32_bf16 v70, v179, v218, v70
    v_dot2_f32_bf16 v71, v179, v219, v71
    v_dot2_f32_bf16 v72, v180, v218, v72
    v_dot2_f32_bf16 v73, v180, v219, v73
    v_dot2_f32_bf16 v74, v181, v218, v74
    s_add_u32 s4, s70, 103680
    buffer_load_dwordx4 v246, s[20:23], s4 offen offset:0 lds
    v_dot2_f32_bf16 v75, v181, v219, v75
    v_dot2_f32_bf16 v76, v182, v218, v76
    v_dot2_f32_bf16 v77, v182, v219, v77
    v_dot2_f32_bf16 v78, v183, v218, v78
    v_dot2_f32_bf16 v79, v183, v219, v79
    s_add_u32 s4, s70, 111872
    buffer_load_dwordx4 v246, s[20:23], s4 offen offset:1024 lds
    s_add_u32 m0, s34, 124928
    v_dot2_f32_bf16 v64, v192, v218, v64
    v_dot2_f32_bf16 v65, v192, v219, v65
    v_dot2_f32_bf16 v66, v193, v218, v66
    v_dot2_f32_bf16 v67, v193, v219, v67
    v_dot2_f32_bf16 v68, v194, v218, v68
    v_dot2_f32_bf16 v69, v194, v219, v69
    s_add_u32 s4, s71, 103680
    buffer_load_dwordx4 v246, s[20:23], s4 offen offset:0 lds
    v_dot2_f32_bf16 v70, v195, v218, v70
    v_dot2_f32_bf16 v71, v195, v219, v71
    v_dot2_f32_bf16 v72, v196, v218, v72
    v_dot2_f32_bf16 v73, v196, v219, v73
    v_dot2_f32_bf16 v74, v197, v218, v74
    v_dot2_f32_bf16 v75, v197, v219, v75
    s_add_u32 s4, s71, 111872
    buffer_load_dwordx4 v246, s[20:23], s4 offen offset:1024 lds
    s_add_u32 m0, s34, 126976
    v_dot2_f32_bf16 v76, v198, v218, v76
    v_dot2_f32_bf16 v77, v198, v219, v77
    v_dot2_f32_bf16 v78, v199, v218, v78
    v_dot2_f32_bf16 v79, v199, v219, v79
    v_cvt_pk_bf16_f32 v64, v64, v65
    v_cvt_pk_bf16_f32 v65, v66, v67
    s_add_u32 s4, s72, 103680
    buffer_load_dwordx4 v246, s[20:23], s4 offen offset:0 lds
    v_cvt_pk_bf16_f32 v66, v68, v69
    v_cvt_pk_bf16_f32 v67, v70, v71
    s_lshl_b32 s39, s72, 5
    s_add_u32 s39, s39, s59
    buffer_store_dwordx4 v[64:67], v237, s[24:27], s39 offen offset:0 sc1
    s_mov_b64 exec, s[56:57]
    ds_write_b128 v236, v[64:67] offset:8192
    s_mov_b64 exec, -1
    v_cvt_pk_bf16_f32 v68, v72, v73
    v_cvt_pk_bf16_f32 v69, v74, v75
    v_cvt_pk_bf16_f32 v70, v76, v77
    s_add_u32 s4, s72, 111872
    buffer_load_dwordx4 v246, s[20:23], s4 offen offset:1024 lds
    v_cvt_pk_bf16_f32 v71, v78, v79
    buffer_store_dwordx4 v[68:71], v237, s[24:27], s39 offen offset:1024 sc1
    s_mov_b64 exec, s[56:57]
    ds_write_b128 v236, v[68:71] offset:9216
    s_mov_b64 exec, -1
    v_dot2_f32_bf16 v80, v184, v218, v80
    v_dot2_f32_bf16 v81, v184, v219, v81
    v_dot2_f32_bf16 v82, v185, v218, v82
    v_dot2_f32_bf16 v83, v185, v219, v83
    v_dot2_f32_bf16 v84, v186, v218, v84
    v_dot2_f32_bf16 v85, v186, v219, v85
    v_dot2_f32_bf16 v86, v187, v218, v86
    v_dot2_f32_bf16 v87, v187, v219, v87
    v_dot2_f32_bf16 v88, v188, v218, v88
    v_dot2_f32_bf16 v89, v188, v219, v89
    v_dot2_f32_bf16 v90, v189, v218, v90
    v_dot2_f32_bf16 v91, v189, v219, v91
    v_dot2_f32_bf16 v92, v190, v218, v92
    v_dot2_f32_bf16 v93, v190, v219, v93
    v_dot2_f32_bf16 v94, v191, v218, v94
    v_dot2_f32_bf16 v95, v191, v219, v95
    v_dot2_f32_bf16 v80, v200, v218, v80
    v_dot2_f32_bf16 v81, v200, v219, v81
    v_dot2_f32_bf16 v82, v201, v218, v82
    v_dot2_f32_bf16 v83, v201, v219, v83
    v_dot2_f32_bf16 v84, v202, v218, v84
    v_dot2_f32_bf16 v85, v202, v219, v85
    v_dot2_f32_bf16 v86, v203, v218, v86
    v_dot2_f32_bf16 v87, v203, v219, v87
    v_dot2_f32_bf16 v88, v204, v218, v88
    v_dot2_f32_bf16 v89, v204, v219, v89
    v_dot2_f32_bf16 v90, v205, v218, v90
    v_dot2_f32_bf16 v91, v205, v219, v91
    v_dot2_f32_bf16 v92, v206, v218, v92
    v_dot2_f32_bf16 v93, v206, v219, v93
    v_dot2_f32_bf16 v94, v207, v218, v94
    v_dot2_f32_bf16 v95, v207, v219, v95
    v_cvt_pk_bf16_f32 v80, v80, v81
    v_cvt_pk_bf16_f32 v81, v82, v83
    v_cvt_pk_bf16_f32 v82, v84, v85
    v_cvt_pk_bf16_f32 v83, v86, v87
    buffer_store_dwordx4 v[80:83], v237, s[24:27], s39 offen offset:2048 sc1
    s_mov_b64 exec, s[56:57]
    ds_write_b128 v236, v[80:83] offset:10240
    s_mov_b64 exec, -1
    v_cvt_pk_bf16_f32 v84, v88, v89
    v_cvt_pk_bf16_f32 v85, v90, v91
    v_cvt_pk_bf16_f32 v86, v92, v93
    v_cvt_pk_bf16_f32 v87, v94, v95
    buffer_store_dwordx4 v[84:87], v237, s[24:27], s39 offen offset:3072 sc1
    s_mov_b64 exec, s[56:57]
    ds_write_b128 v236, v[84:87] offset:11264
    s_mov_b64 exec, -1
    s_waitcnt vmcnt(10)
    s_cmp_lg_u32 s58, 1
    s_cbranch_scc1 L_slowo
L_backo:
    ds_read_b64_tr_b16 a[48:49], v230 offset:0
    ds_read_b64_tr_b16 a[50:51], v230 offset:1024
    ds_read_b64_tr_b16 a[52:53], v231 offset:0
    ds_read_b64_tr_b16 a[54:55], v231 offset:1024
    ds_read_b64_tr_b16 a[56:57], v230 offset:2048
    ds_read_b64_tr_b16 a[58:59], v230 offset:3072
    ds_read_b64_tr_b16 a[60:61], v231 offset:2048
    ds_read_b64_tr_b16 a[62:63], v231 offset:3072
    ds_read_b64_tr_b16 a[64:65], v230 offset:4096
    ds_read_b64_tr_b16 a[66:67], v230 offset:5120
    ds_read_b64_tr_b16 a[68:69], v231 offset:4096
    ds_read_b64_tr_b16 a[70:71], v231 offset:5120
    s_waitcnt lgkmcnt(15)
    s_add_u32 m0, s34, 0
    v_mfma_f32_32x32x16_bf16 v[96:111], a[0:3], a[144:147], 0
    s_add_u32 s4, s70, 124416
    buffer_load_dwordx4 v246, s[20:23], s4 offen offset:0 lds
    v_accvgpr_read_b32 v208, a180
    v_lshlrev_b32 v64, 16, v208
    v_and_b32 v65, 0xffff0000, v208
    v_mfma_f32_32x32x16_bf16 v[112:127], a[4:7], a[144:147], 0
    s_add_u32 s4, s70, 132608
    buffer_load_dwordx4 v246, s[20:23], s4 offen offset:1024 lds
    s_add_u32 m0, s34, 2048
    v_accvgpr_read_b32 v209, a181
    v_lshlrev_b32 v66, 16, v209
    v_and_b32 v67, 0xffff0000, v209
    v_mfma_f32_32x32x16_bf16 v[128:143], a[8:11], a[144:147], 0
    s_add_u32 s4, s71, 124416
    buffer_load_dwordx4 v246, s[20:23], s4 offen offset:0 lds
    v_accvgpr_read_b32 v208, a182
    v_lshlrev_b32 v68, 16, v208
    v_and_b32 v69, 0xffff0000, v208
    v_mfma_f32_32x32x16_bf16 v[144:159], a[12:15], a[144:147], 0
    s_add_u32 s4, s71, 132608
    buffer_load_dwordx4 v246, s[20:23], s4 offen offset:1024 lds
    s_add_u32 m0, s34, 4096
    v_accvgpr_read_b32 v209, a183
    v_lshlrev_b32 v70, 16, v209
    s_nop 0
L_sm11:
    s_cbranch_execz L_retm
    v_and_b32 v71, 0xffff0000, v209
    v_mfma_f32_32x32x16_bf16 v[160:175], a[16:19], a[144:147], 0
    s_add_u32 s4, s72, 124416
    buffer_load_dwordx4 v246, s[20:23], s4 offen offset:0 lds
    v_accvgpr_read_b32 v208, a184
    v_lshlrev_b32 v72, 16, v208
    v_and_b32 v73, 0xffff0000, v208
    v_mfma_f32_32x32x16_bf16 v[176:191], a[20:23], a[144:147], 0
    s_add_u32 s4, s72, 132608
    buffer_load_dwordx4 v246, s[20:23], s4 offen offset:1024 lds
    v_accvgpr_read_b32 v209, a185
    v_lshlrev_b32 v74, 16, v209
    v_and_b32 v75, 0xffff0000, v209
    v_accvgpr_read_b32 v208, a186
    v_lshlrev_b32 v76, 16, v208
    ds_read_b64_tr_b16 a[72:73], v230 offset:24576
    ds_read_b64_tr_b16 a[74:75], v230 offset:25600
    ds_read_b64_tr_b16 a[76:77], v231 offset:24576
    ds_read_b64_tr_b16 a[78:79], v231 offset:25600
    ds_read_b64_tr_b16 a[80:81], v230 offset:26624
    ds_read_b64_tr_b16 a[82:83], v230 offset:27648
    ds_read_b64_tr_b16 a[84:85], v231 offset:26624
    ds_read_b64_tr_b16 a[86:87], v231 offset:27648
    ds_read_b64_tr_b16 a[88:89], v230 offset:28672
    ds_read_b64_tr_b16 a[90:91], v230 offset:29696
    ds_read_b64_tr_b16 a[92:93], v231 offset:28672
    ds_read_b64_tr_b16 a[94:95], v231 offset:29696
    s_waitcnt lgkmcnt(15)
    s_add_u32 m0, s34, 24576
    v_mfma_f32_32x32x16_bf16 v[96:111], a[24:27], a[148:151], v[96:111]
    s_add_u32 s4, s70, 145152
    buffer_load_dwordx4 v246, s[20:23], s4 offen offset:0 lds
    v_and_b32 v77, 0xffff0000, v208
    v_accvgpr_read_b32 v209, a187
    v_lshlrev_b32 v78, 16, v209
    v_mfma_f32_32x32x16_bf16 v[112:127], a[28:31], a[148:151], v[112:127]
    s_add_u32 s4, s70, 153344
    buffer_load_dwordx4 v246, s[20:23], s4 offen offset:1024 lds
    s_add_u32 m0, s34, 26624
    v_and_b32 v79, 0xffff0000, v209
    v_accvgpr_read_b32 v208, a188
    v_lshlrev_b32 v80, 16, v208
    v_mfma_f32_32x32x16_bf16 v[128:143], a[32:35], a[148:151], v[128:143]
    s_add_u32 s4, s71, 145152
    buffer_load_dwordx4 v246, s[20:23], s4 offen offset:0 lds
    v_and_b32 v81, 0xffff0000, v208
    v_accvgpr_read_b32 v209, a189
    v_lshlrev_b32 v82, 16, v209
    v_mfma_f32_32x32x16_bf16 v[144:159], a[36:39], a[148:151], v[144:159]
    s_add_u32 s4, s71, 153344
    buffer_load_dwordx4 v246, s[20:23], s4 offen offset:1024 lds
    s_add_u32 m0, s34, 28672
    v_and_b32 v83, 0xffff0000, v209
    v_accvgpr_read_b32 v208, a190
    v_lshlrev_b32 v84, 16, v208
    v_mfma_f32_32x32x16_bf16 v[160:175], a[40:43], a[148:151], v[160:175]
    s_add_u32 s4, s72, 145152
    buffer_load_dwordx4 v246, s[20:23], s4 offen offset:0 lds
    v_and_b32 v85, 0xffff0000, v208
    v_accvgpr_read_b32 v209, a191
    v_lshlrev_b32 v86, 16, v209
    v_mfma_f32_32x32x16_bf16 v[176:191], a[44:47], a[148:151], v[176:191]
    s_add_u32 s4, s72, 153344
    buffer_load_dwordx4 v246, s[20:23], s4 offen offset:1024 lds
    v_and_b32 v87, 0xffff0000, v209
    ds_read_b64_tr_b16 a[96:97], v232 offset:0
    ds_read_b64_tr_b16 a[98:99], v232 offset:1024
    ds_read_b64_tr_b16 a[100:101], v233 offset:0
    ds_read_b64_tr_b16 a[102:103], v233 offset:1024
    ds_read_b64_tr_b16 a[104:105], v232 offset:2048
    ds_read_b64_tr_b16 a[106:107], v232 offset:3072
    ds_read_b64_tr_b16 a[108:109], v233 offset:2048
    ds_read_b64_tr_b16 a[110:111], v233 offset:3072
    ds_read_b64_tr_b16 a[112:113], v232 offset:4096
    ds_read_b64_tr_b16 a[114:115], v232 offset:5120
    ds_read_b64_tr_b16 a[116:117], v233 offset:4096
    ds_read_b64_tr_b16 a[118:119], v233 offset:5120
    s_waitcnt lgkmcnt(15)
    s_add_u32 m0, s34, 49152
    v_mfma_f32_32x32x16_bf16 v[96:111], a[48:51], a[152:155], v[96:111]
    s_add_u32 s4, s70, 0
    buffer_load_dwordx4 v247, s[20:23], s4 offen offset:0 lds
    v_mfma_f32_32x32x16_bf16 v[112:127], a[52:55], a[152:155], v[112:127]
    s_add_u32 s4, s70, 81920
    buffer_load_dwordx4 v247, s[20:23], s4 offen offset:1024 lds
    s_add_u32 m0, s34, 51200
    v_mfma_f32_32x32x16_bf16 v[128:143], a[56:59], a[152:155], v[128:143]
    s_add_u32 s4, s71, 0
    buffer_load_dwordx4 v247, s[20:23], s4 offen offset:0 lds
    v_mfma_f32_32x32x16_bf16 v[144:159], a[60:63], a[152:155], v[144:159]
    s_add_u32 s4, s71, 81920
    buffer_load_dwordx4 v247, s[20:23], s4 offen offset:1024 lds
    s_add_u32 m0, s34, 53248
    v_mfma_f32_32x32x16_bf16 v[160:175], a[64:67], a[152:155], v[160:175]
    s_add_u32 s4, s72, 0
    buffer_load_dwordx4 v247, s[20:23], s4 offen offset:0 lds
    v_mfma_f32_32x32x16_bf16 v[176:191], a[68:71], a[152:155], v[176:191]
    s_add_u32 s4, s72, 81920
    buffer_load_dwordx4 v247, s[20:23], s4 offen offset:1024 lds
    s_waitcnt vmcnt(18)
    buffer_store_dword v249, v225, s[24:27], s85 offen offset:896 sc1
    ds_read_b64_tr_b16 a[120:121], v232 offset:24576
    ds_read_b64_tr_b16 a[122:123], v232 offset:25600
    ds_read_b64_tr_b16 a[124:125], v233 offset:24576
    ds_read_b64_tr_b16 a[126:127], v233 offset:25600
    ds_read_b64_tr_b16 a[128:129], v232 offset:26624
    ds_read_b64_tr_b16 a[130:131], v232 offset:27648
    ds_read_b64_tr_b16 a[132:133], v233 offset:26624
    ds_read_b64_tr_b16 a[134:135], v233 offset:27648
    ds_read_b64_tr_b16 a[136:137], v232 offset:28672
    ds_read_b64_tr_b16 a[138:139], v232 offset:29696
    ds_read_b64_tr_b16 a[140:141], v233 offset:28672
    ds_read_b64_tr_b16 a[142:143], v233 offset:29696
    s_waitcnt lgkmcnt(15)
    v_mfma_f32_32x32x16_bf16 v[96:111], a[72:75], a[156:159], v[96:111]
    v_mfma_f32_32x32x16_bf16 v[112:127], a[76:79], a[156:159], v[112:127]
    v_mfma_f32_32x32x16_bf16 v[128:143], a[80:83], a[156:159], v[128:143]
    v_mfma_f32_32x32x16_bf16 v[144:159], a[84:87], a[156:159], v[144:159]
    v_mfma_f32_32x32x16_bf16 v[160:175], a[88:91], a[156:159], v[160:175]
    v_mfma_f32_32x32x16_bf16 v[176:191], a[92:95], a[156:159], v[176:191]
    s_waitcnt vmcnt(13)
    ds_read_b64_tr_b16 a[0:1], v228 offset:0
    ds_read_b64_tr_b16 a[2:3], v228 offset:1024
    ds_read_b64_tr_b16 a[4:5], v229 offset:0
    ds_read_b64_tr_b16 a[6:7], v229 offset:1024
    ds_read_b64_tr_b16 a[8:9], v228 offset:2048
    ds_read_b64_tr_b16 a[10:11], v228 offset:3072
    ds_read_b64_tr_b16 a[12:13], v229 offset:2048
    ds_read_b64_tr_b16 a[14:15], v229 offset:3072
    ds_read_b64_tr_b16 a[16:17], v228 offset:4096
    ds_read_b64_tr_b16 a[18:19], v228 offset:5120
    ds_read_b64_tr_b16 a[20:21], v229 offset:4096
    ds_read_b64_tr_b16 a[22:23], v229 offset:5120
    s_waitcnt lgkmcnt(15)
    v_mfma_f32_32x32x16_bf16 v[96:111], a[96:99], a[160:163], v[96:111]
    v_mfma_f32_32x32x16_bf16 v[112:127], a[100:103], a[160:163], v[112:127]
    v_mfma_f32_32x32x16_bf16 v[128:143], a[104:107], a[160:163], v[128:143]
    v_mfma_f32_32x32x16_bf16 v[144:159], a[108:111], a[160:163], v[144:159]
    v_mfma_f32_32x32x16_bf16 v[160:175], a[112:115], a[160:163], v[160:175]
    v_mfma_f32_32x32x16_bf16 v[176:191], a[116:119], a[160:163], v[176:191]
    s_waitcnt vmcnt(7)
    ds_read_b64_tr_b16 a[24:25], v228 offset:24576
    ds_read_b64_tr_b16 a[26:27], v228 offset:25600
    ds_read_b64_tr_b16 a[28:29], v229 offset:24576
    ds_read_b64_tr_b16 a[30:31], v229 offset:25600
    ds_read_b64_tr_b16 a[32:33], v228 offset:26624
    ds_read_b64_tr_b16 a[34:35], v228 offset:27648
    ds_read_b64_tr_b16 a[36:37], v229 offset:26624
    ds_read_b64_tr_b16 a[38:39], v229 offset:27648
    ds_read_b64_tr_b16 a[40:41], v228 offset:28672
    ds_read_b64_tr_b16 a[42:43], v228 offset:29696
    ds_read_b64_tr_b16 a[44:45], v229 offset:28672
    ds_read_b64_tr_b16 a[46:47], v229 offset:29696
    s_waitcnt lgkmcnt(15)
    v_mfma_f32_32x32x16_bf16 v[96:111], a[120:123], a[164:167], v[96:111]
    v_mfma_f32_32x32x16_bf16 v[112:127], a[124:127], a[164:167], v[112:127]
    v_mfma_f32_32x32x16_bf16 v[128:143], a[128:131], a[164:167], v[128:143]
    v_mfma_f32_32x32x16_bf16 v[144:159], a[132:135], a[164:167], v[144:159]
    v_mfma_f32_32x32x16_bf16 v[160:175], a[136:139], a[164:167], v[160:175]
    v_mfma_f32_32x32x16_bf16 v[176:191], a[140:143], a[164:167], v[176:191]
    s_waitcnt vmcnt(1)
    ds_read_b64_tr_b16 a[48:49], v230 offset:0
    ds_read_b64_tr_b16 a[50:51], v230 offset:1024
    ds_read_b64_tr_b16 a[52:53], v231 offset:0
    ds_read_b64_tr_b16 a[54:55], v231 offset:1024
    ds_read_b64_tr_b16 a[56:57], v230 offset:2048
    ds_read_b64_tr_b16 a[58:59], v230 offset:3072
    ds_read_b64_tr_b16 a[60:61], v231 offset:2048
    ds_read_b64_tr_b16 a[62:63], v231 offset:3072
    ds_read_b64_tr_b16 a[64:65], v230 offset:4096
    ds_read_b64_tr_b16 a[66:67], v230 offset:5120
    ds_read_b64_tr_b16 a[68:69], v231 offset:4096
    ds_read_b64_tr_b16 a[70:71], v231 offset:5120
    s_waitcnt lgkmcnt(15)
    v_mfma_f32_32x32x16_bf16 v[96:111], a[0:3], a[168:171], v[96:111]
    v_mfma_f32_32x32x16_bf16 v[112:127], a[4:7], a[168:171], v[112:127]
    v_mfma_f32_32x32x16_bf16 v[128:143], a[8:11], a[168:171], v[128:143]
    v_mfma_f32_32x32x16_bf16 v[144:159], a[12:15], a[168:171], v[144:159]
    v_mfma_f32_32x32x16_bf16 v[160:175], a[16:19], a[168:171], v[160:175]
    v_mfma_f32_32x32x16_bf16 v[176:191], a[20:23], a[168:171], v[176:191]
    buffer_load_dword v238, v244, s[24:27], 0 offen offset:896 sc1
    s_waitcnt lgkmcnt(12)
    v_mfma_f32_32x32x16_bf16 v[96:111], a[24:27], a[172:175], v[96:111]
    v_mfma_f32_32x32x16_bf16 v[112:127], a[28:31], a[172:175], v[112:127]
    v_mfma_f32_32x32x16_bf16 v[128:143], a[32:35], a[172:175], v[128:143]
    v_mfma_f32_32x32x16_bf16 v[144:159], a[36:39], a[172:175], v[144:159]
    v_mfma_f32_32x32x16_bf16 v[160:175], a[40:43], a[172:175], v[160:175]
    v_mfma_f32_32x32x16_bf16 v[176:191], a[44:47], a[172:175], v[176:191]
    s_waitcnt lgkmcnt(0)
    v_mfma_f32_32x32x16_bf16 v[96:111], a[48:51], a[176:179], v[96:111]
    v_mfma_f32_32x32x16_bf16 v[112:127], a[52:55], a[176:179], v[112:127]
    v_mfma_f32_32x32x16_bf16 v[128:143], a[56:59], a[176:179], v[128:143]
    v_mfma_f32_32x32x16_bf16 v[144:159], a[60:63], a[176:179], v[144:159]
    v_mfma_f32_32x32x16_bf16 v[160:175], a[64:67], a[176:179], v[160:175]
    v_mfma_f32_32x32x16_bf16 v[176:191], a[68:71], a[176:179], v[176:191]
    s_waitcnt vmcnt(0)
    v_cmp_ne_u32 vcc, 1, v238
    s_nop 0
    s_cmp_eq_u64 vcc, 0
    s_cselect_b32 s58, 0, 0x7ff00000
    v_add_u32 v227, s58, v237
    s_lshl_b32 s36, s70, 5
    v_add_u32 v250, s36, v227
    buffer_load_dwordx4 v[0:3], v250, s[24:27], s79 offen sc1
    buffer_load_dwordx4 v[4:7], v250, s[24:27], s80 offen sc1
    buffer_load_dwordx4 v[8:11], v250, s[24:27], s81 offen sc1
    s_lshl_b32 s36, s71, 5
    v_add_u32 v250, s36, v227
    buffer_load_dwordx4 v[16:19], v250, s[24:27], s79 offen sc1
    buffer_load_dwordx4 v[20:23], v250, s[24:27], s80 offen sc1
    buffer_load_dwordx4 v[24:27], v250, s[24:27], s81 offen sc1
    s_lshl_b32 s36, s72, 5
    v_add_u32 v250, s36, v227
    buffer_load_dwordx4 v[32:35], v250, s[24:27], s79 offen sc1
    buffer_load_dwordx4 v[36:39], v250, s[24:27], s80 offen sc1
    buffer_load_dwordx4 v[40:43], v250, s[24:27], s81 offen sc1
    v_add_u32 v254, s34, v237
    v_add_u32 v254, 73728, v254
    s_lshl_b32 s36, s3, 10
    s_add_u32 s36, s36, 73728
    v_add_u32 v251, s36, v237
    v_cvt_pk_bf16_f32 v96, v96, v97
    v_cvt_pk_bf16_f32 v97, v98, v99
    v_cvt_pk_bf16_f32 v98, v100, v101
    v_cvt_pk_bf16_f32 v99, v102, v103
    v_cvt_pk_bf16_f32 v100, v104, v105
    v_cvt_pk_bf16_f32 v101, v106, v107
    v_cvt_pk_bf16_f32 v102, v108, v109
    v_cvt_pk_bf16_f32 v103, v110, v111
    ds_write_b128 v254, v[96:99] offset:0
    ds_write_b128 v254, v[100:103] offset:1024
    v_cvt_pk_bf16_f32 v112, v112, v113
    v_cvt_pk_bf16_f32 v113, v114, v115
    v_cvt_pk_bf16_f32 v114, v116, v117
    v_cvt_pk_bf16_f32 v115, v118, v119
    v_cvt_pk_bf16_f32 v116, v120, v121
    v_cvt_pk_bf16_f32 v117, v122, v123
    v_cvt_pk_bf16_f32 v118, v124, v125
    v_cvt_pk_bf16_f32 v119, v126, v127
    ds_write_b128 v254, v[112:115] offset:2048
    ds_write_b128 v254, v[116:119] offset:3072
    v_cvt_pk_bf16_f32 v128, v128, v129
    v_cvt_pk_bf16_f32 v129, v130, v131
    v_cvt_pk_bf16_f32 v130, v132, v133
    v_cvt_pk_bf16_f32 v131, v134, v135
    v_cvt_pk_bf16_f32 v132, v136, v137
    v_cvt_pk_bf16_f32 v133, v138, v139
    v_cvt_pk_bf16_f32 v134, v140, v141
    v_cvt_pk_bf16_f32 v135, v142, v143
    ds_write_b128 v254, v[128:131] offset:24576
    ds_write_b128 v254, v[132:135] offset:25600
    v_cvt_pk_bf16_f32 v144, v144, v145
    v_cvt_pk_bf16_f32 v145, v146, v147
    v_cvt_pk_bf16_f32 v146, v148, v149
    v_cvt_pk_bf16_f32 v147, v150, v151
    v_cvt_pk_bf16_f32 v148, v152, v153
    v_cvt_pk_bf16_f32 v149, v154, v155
    v_cvt_pk_bf16_f32 v150, v156, v157
    v_cvt_pk_bf16_f32 v151, v158, v159
    ds_write_b128 v254, v[144:147] offset:26624
    ds_write_b128 v254, v[148:151] offset:27648
    v_cvt_pk_bf16_f32 v160, v160, v161
    v_cvt_pk_bf16_f32 v161, v162, v163
    v_cvt_pk_bf16_f32 v162, v164, v165
    v_cvt_pk_bf16_f32 v163, v166, v167
    v_cvt_pk_bf16_f32 v164, v168, v169
    v_cvt_pk_bf16_f32 v165, v170, v171
    v_cvt_pk_bf16_f32 v166, v172, v173
    v_cvt_pk_bf16_f32 v167, v174, v175
    ds_write_b128 v254, v[160:163] offset:49152
    ds_write_b128 v254, v[164:167] offset:50176
    v_cvt_pk_bf16_f32 v176, v176, v177
    v_cvt_pk_bf16_f32 v177, v178, v179
    v_cvt_pk_bf16_f32 v178, v180, v181
    v_cvt_pk_bf16_f32 v179, v182, v183
    v_cvt_pk_bf16_f32 v180, v184, v185
    v_cvt_pk_bf16_f32 v181, v186, v187
    v_cvt_pk_bf16_f32 v182, v188, v189
    v_cvt_pk_bf16_f32 v183, v190, v191
    ds_write_b128 v254, v[176:179] offset:51200
    ds_write_b128 v254, v[180:183] offset:52224
    s_waitcnt lgkmcnt(0)
    s_barrier
    v_add_u32 v254, 49152, v251
    ds_read_b128 v[44:47], v234 offset:8192
    ds_read_b128 v[96:99], v251 offset:0
    ds_read_b128 v[100:103], v251 offset:6144
    ds_read_b128 v[104:107], v251 offset:12288
    ds_read_b128 v[108:111], v251 offset:18432
    ds_read_b128 v[112:115], v251 offset:24576
    ds_read_b128 v[116:119], v251 offset:30720
    ds_read_b128 v[120:123], v251 offset:36864
    ds_read_b128 v[124:127], v251 offset:43008
    ds_read_b128 v[128:131], v254 offset:0
    ds_read_b128 v[132:135], v254 offset:6144
    ds_read_b128 v[136:139], v254 offset:12288
    ds_read_b128 v[140:143], v254 offset:18432
    s_waitcnt lgkmcnt(8)
    v_dot2_f32_bf16 v144, v96, v218, 0
    v_dot2_f32_bf16 v145, v96, v219, 0
    v_dot2_f32_bf16 v146, v97, v218, 0
    v_dot2_f32_bf16 v147, v97, v219, 0
    v_dot2_f32_bf16 v148, v98, v218, 0
    v_dot2_f32_bf16 v149, v98, v219, 0
    v_dot2_f32_bf16 v150, v99, v218, 0
    v_dot2_f32_bf16 v151, v99, v219, 0
    v_dot2_f32_bf16 v144, v100, v218, v144
    v_dot2_f32_bf16 v145, v100, v219, v145
    v_dot2_f32_bf16 v146, v101, v218, v146
    v_dot2_f32_bf16 v147, v101, v219, v147
    v_dot2_f32_bf16 v148, v102, v218, v148
    v_dot2_f32_bf16 v149, v102, v219, v149
    v_dot2_f32_bf16 v150, v103, v218, v150
    v_dot2_f32_bf16 v151, v103, v219, v151
    v_dot2_f32_bf16 v144, v104, v218, v144
    v_dot2_f32_bf16 v145, v104, v219, v145
    v_dot2_f32_bf16 v146, v105, v218, v146
    v_dot2_f32_bf16 v147, v105, v219, v147
    v_dot2_f32_bf16 v148, v106, v218, v148
    v_dot2_f32_bf16 v149, v106, v219, v149
    v_dot2_f32_bf16 v150, v107, v218, v150
    v_dot2_f32_bf16 v151, v107, v219, v151
    v_dot2_f32_bf16 v144, v108, v218, v144
    v_dot2_f32_bf16 v145, v108, v219, v145
    v_dot2_f32_bf16 v146, v109, v218, v146
    v_dot2_f32_bf16 v147, v109, v219, v147
    v_dot2_f32_bf16 v148, v110, v218, v148
    v_dot2_f32_bf16 v149, v110, v219, v149
    v_dot2_f32_bf16 v150, v111, v218, v150
    v_dot2_f32_bf16 v151, v111, v219, v151
    s_waitcnt lgkmcnt(4)
    v_dot2_f32_bf16 v152, v112, v218, 0
    v_dot2_f32_bf16 v153, v112, v219, 0
    v_dot2_f32_bf16 v154, v113, v218, 0
    v_dot2_f32_bf16 v155, v113, v219, 0
    v_dot2_f32_bf16 v156, v114, v218, 0
    v_dot2_f32_bf16 v157, v114, v219, 0
    v_dot2_f32_bf16 v158, v115, v218, 0
    v_dot2_f32_bf16 v159, v115, v219, 0
    v_dot2_f32_bf16 v152, v116, v218, v152
    v_dot2_f32_bf16 v153, v116, v219, v153
    v_dot2_f32_bf16 v154, v117, v218, v154
    v_dot2_f32_bf16 v155, v117, v219, v155
    v_dot2_f32_bf16 v156, v118, v218, v156
    v_dot2_f32_bf16 v157, v118, v219, v157
    v_dot2_f32_bf16 v158, v119, v218, v158
    v_dot2_f32_bf16 v159, v119, v219, v159
    v_dot2_f32_bf16 v152, v120, v218, v152
    v_dot2_f32_bf16 v153, v120, v219, v153
    v_dot2_f32_bf16 v154, v121, v218, v154
    v_dot2_f32_bf16 v155, v121, v219, v155
    v_dot2_f32_bf16 v156, v122, v218, v156
    v_dot2_f32_bf16 v157, v122, v219, v157
    v_dot2_f32_bf16 v158, v123, v218, v158
    v_dot2_f32_bf16 v159, v123, v219, v159
    v_dot2_f32_bf16 v152, v124, v218, v152
    v_dot2_f32_bf16 v153, v124, v219, v153
    v_dot2_f32_bf16 v154, v125, v218, v154
    v_dot2_f32_bf16 v155, v125, v219, v155
    v_dot2_f32_bf16 v156, v126, v218, v156
    v_dot2_f32_bf16 v157, v126, v219, v157
    v_dot2_f32_bf16 v158, v127, v218, v158
    v_dot2_f32_bf16 v159, v127, v219, v159
    s_waitcnt lgkmcnt(0)
    v_dot2_f32_bf16 v160, v128, v218, 0
    v_dot2_f32_bf16 v161, v128, v219, 0
    v_dot2_f32_bf16 v162, v129, v218, 0
    v_dot2_f32_bf16 v163, v129, v219, 0
    v_dot2_f32_bf16 v164, v130, v218, 0
    v_dot2_f32_bf16 v165, v130, v219, 0
    v_dot2_f32_bf16 v166, v131, v218, 0
    v_dot2_f32_bf16 v167, v131, v219, 0
    v_dot2_f32_bf16 v160, v132, v218, v160
    v_dot2_f32_bf16 v161, v132, v219, v161
    v_dot2_f32_bf16 v162, v133, v218, v162
    v_dot2_f32_bf16 v163, v133, v219, v163
    v_dot2_f32_bf16 v164, v134, v218, v164
    v_dot2_f32_bf16 v165, v134, v219, v165
    v_dot2_f32_bf16 v166, v135, v218, v166
    v_dot2_f32_bf16 v167, v135, v219, v167
    v_dot2_f32_bf16 v160, v136, v218, v160
    v_dot2_f32_bf16 v161, v136, v219, v161
    v_dot2_f32_bf16 v162, v137, v218, v162
    v_dot2_f32_bf16 v163, v137, v219, v163
    v_dot2_f32_bf16 v164, v138, v218, v164
    v_dot2_f32_bf16 v165, v138, v219, v165
    v_dot2_f32_bf16 v166, v139, v218, v166
    v_dot2_f32_bf16 v167, v139, v219, v167
    v_dot2_f32_bf16 v160, v140, v218, v160
    v_dot2_f32_bf16 v161, v140, v219, v161
    v_dot2_f32_bf16 v162, v141, v218, v162
    v_dot2_f32_bf16 v163, v141, v219, v163
    v_dot2_f32_bf16 v164, v142, v218, v164
    v_dot2_f32_bf16 v165, v142, v219, v165
    v_dot2_f32_bf16 v166, v143, v218, v166
    v_dot2_f32_bf16 v167, v143, v219, v167
    s_cmp_lg_u32 s58, 0
    s_cbranch_scc1 L_slowa
L_backa:
    s_waitcnt vmcnt(6)
    v_dot2_f32_bf16 v48, v0, v218, 0
    v_dot2_f32_bf16 v49, v0, v219, 0
    v_dot2_f32_bf16 v50, v1, v218, 0
    v_dot2_f32_bf16 v51, v1, v219, 0
    v_dot2_f32_bf16 v52, v2, v218, 0
    v_dot2_f32_bf16 v53, v2, v219, 0
    v_dot2_f32_bf16 v54, v3, v218, 0
    v_dot2_f32_bf16 v55, v3, v219, 0
    v_dot2_f32_bf16 v48, v4, v218, v48
    v_dot2_f32_bf16 v49, v4, v219, v49
    v_dot2_f32_bf16 v50, v5, v218, v50
    v_dot2_f32_bf16 v51, v5, v219, v51
    v_dot2_f32_bf16 v52, v6, v218, v52
    v_dot2_f32_bf16 v53, v6, v219, v53
    v_dot2_f32_bf16 v54, v7, v218, v54
    v_dot2_f32_bf16 v55, v7, v219, v55
    v_dot2_f32_bf16 v48, v8, v218, v48
    v_dot2_f32_bf16 v49, v8, v219, v49
    v_dot2_f32_bf16 v50, v9, v218, v50
    v_dot2_f32_bf16 v51, v9, v219, v51
    v_dot2_f32_bf16 v52, v10, v218, v52
    v_dot2_f32_bf16 v53, v10, v219, v53
    v_dot2_f32_bf16 v54, v11, v218, v54
    v_dot2_f32_bf16 v55, v11, v219, v55
    v_dot2_f32_bf16 v48, v12, v218, v48
    v_dot2_f32_bf16 v49, v12, v219, v49
    v_dot2_f32_bf16 v50, v13, v218, v50
    v_dot2_f32_bf16 v51, v13, v219, v51
    v_dot2_f32_bf16 v52, v14, v218, v52
    v_dot2_f32_bf16 v53, v14, v219, v53
    v_dot2_f32_bf16 v54, v15, v218, v54
    v_dot2_f32_bf16 v55, v15, v219, v55
    v_exp_f32_e64 v192, -v48
    v_exp_f32_e64 v193, -v49
    v_exp_f32_e64 v194, -v50
    v_exp_f32_e64 v195, -v51
    v_exp_f32_e64 v196, -v52
    v_exp_f32_e64 v197, -v53
    v_exp_f32_e64 v198, -v54
    v_exp_f32_e64 v199, -v55
    v_mul_f32 v48, 0x3ef5fdf0, v48
    v_mul_f32 v49, 0x3ef5fdf0, v49
    v_mul_f32 v50, 0x3ef5fdf0, v50
    v_mul_f32 v51, 0x3ef5fdf0, v51
    v_mul_f32 v52, 0x3ef5fdf0, v52
    v_mul_f32 v53, 0x3ef5fdf0, v53
    v_mul_f32 v54, 0x3ef5fdf0, v54
    v_mul_f32 v55, 0x3ef5fdf0, v55
    v_add_f32 v192, 1.0, v192
    v_add_f32 v193, 1.0, v193
    v_add_f32 v194, 1.0, v194
    v_add_f32 v195, 1.0, v195
    v_add_f32 v196, 1.0, v196
    v_add_f32 v197, 1.0, v197
    v_add_f32 v198, 1.0, v198
    v_add_f32 v199, 1.0, v199
    v_rcp_f32 v192, v192
    v_rcp_f32 v193, v193
    v_rcp_f32 v194, v194
    v_rcp_f32 v195, v195
    v_rcp_f32 v196, v196
    v_rcp_f32 v197, v197
    v_rcp_f32 v198, v198
    v_rcp_f32 v199, v199
    v_mul_f32 v48, v48, v192
    v_mul_f32 v49, v49, v193
    v_mul_f32 v50, v50, v194
    v_mul_f32 v51, v51, v195
    v_mul_f32 v52, v52, v196
    v_mul_f32 v53, v53, v197
    v_mul_f32 v54, v54, v198
    v_mul_f32 v55, v55, v199
    v_fma_f32 v64, v144, v48, v64
    v_fma_f32 v65, v145, v49, v65
    v_fma_f32 v66, v146, v50, v66
    v_fma_f32 v67, v147, v51, v67
    v_fma_f32 v68, v148, v52, v68
    v_fma_f32 v69, v149, v53, v69
    v_fma_f32 v70, v150, v54, v70
    v_fma_f32 v71, v151, v55, v71
    v_cvt_pk_bf16_f32 v64, v64, v65
    v_cvt_pk_bf16_f32 v65, v66, v67
    v_cvt_pk_bf16_f32 v66, v68, v69
    v_cvt_pk_bf16_f32 v67, v70, v71
    buffer_store_dwordx4 v[64:67], v252, s[12:15], s70 offen
    s_waitcnt vmcnt(4)
    v_dot2_f32_bf16 v56, v16, v218, 0
    v_dot2_f32_bf16 v57, v16, v219, 0
    v_dot2_f32_bf16 v58, v17, v218, 0
    v_dot2_f32_bf16 v59, v17, v219, 0
    v_dot2_f32_bf16 v60, v18, v218, 0
    v_dot2_f32_bf16 v61, v18, v219, 0
    v_dot2_f32_bf16 v62, v19, v218, 0
    v_dot2_f32_bf16 v63, v19, v219, 0
    v_dot2_f32_bf16 v56, v20, v218, v56
    v_dot2_f32_bf16 v57, v20, v219, v57
    v_dot2_f32_bf16 v58, v21, v218, v58
    v_dot2_f32_bf16 v59, v21, v219, v59
    v_dot2_f32_bf16 v60, v22, v218, v60
    v_dot2_f32_bf16 v61, v22, v219, v61
    v_dot2_f32_bf16 v62, v23, v218, v62
    v_dot2_f32_bf16 v63, v23, v219, v63
    v_dot2_f32_bf16 v56, v24, v218, v56
    v_dot2_f32_bf16 v57, v24, v219, v57
    v_dot2_f32_bf16 v58, v25, v218, v58
    v_dot2_f32_bf16 v59, v25, v219, v59
    v_dot2_f32_bf16 v60, v26, v218, v60
    v_dot2_f32_bf16 v61, v26, v219, v61
    v_dot2_f32_bf16 v62, v27, v218, v62
    v_dot2_f32_bf16 v63, v27, v219, v63
    v_dot2_f32_bf16 v56, v28, v218, v56
    v_dot2_f32_bf16 v57, v28, v219, v57
    v_dot2_f32_bf16 v58, v29, v218, v58
    v_dot2_f32_bf16 v59, v29, v219, v59
    v_dot2_f32_bf16 v60, v30, v218, v60
    v_dot2_f32_bf16 v61, v30, v219, v61
    v_dot2_f32_bf16 v62, v31, v218, v62
    v_dot2_f32_bf16 v63, v31, v219, v63
    v_exp_f32_e64 v192, -v56
    v_exp_f32_e64 v193, -v57
    v_exp_f32_e64 v194, -v58
    v_exp_f32_e64 v195, -v59
    v_exp_f32_e64 v196, -v60
    v_exp_f32_e64 v197, -v61
    v_exp_f32_e64 v198, -v62
    v_exp_f32_e64 v199, -v63
    v_mul_f32 v56, 0x3ef5fdf0, v56
    v_mul_f32 v57, 0x3ef5fdf0, v57
    v_mul_f32 v58, 0x3ef5fdf0, v58
    v_mul_f32 v59, 0x3ef5fdf0, v59
    v_mul_f32 v60, 0x3ef5fdf0, v60
    v_mul_f32 v61, 0x3ef5fdf0, v61
    v_mul_f32 v62, 0x3ef5fdf0, v62
    v_mul_f32 v63, 0x3ef5fdf0, v63
    v_add_f32 v192, 1.0, v192
    v_add_f32 v193, 1.0, v193
    v_add_f32 v194, 1.0, v194
    v_add_f32 v195, 1.0, v195
    v_add_f32 v196, 1.0, v196
    v_add_f32 v197, 1.0, v197
    v_add_f32 v198, 1.0, v198
    v_add_f32 v199, 1.0, v199
    v_rcp_f32 v192, v192
    v_rcp_f32 v193, v193
    v_rcp_f32 v194, v194
    v_rcp_f32 v195, v195
    v_rcp_f32 v196, v196
    v_rcp_f32 v197, v197
    v_rcp_f32 v198, v198
    v_rcp_f32 v199, v199
    v_mul_f32 v56, v56, v192
    v_mul_f32 v57, v57, v193
    v_mul_f32 v58, v58, v194
    v_mul_f32 v59, v59, v195
    v_mul_f32 v60, v60, v196
    v_mul_f32 v61, v61, v197
    v_mul_f32 v62, v62, v198
    v_mul_f32 v63, v63, v199
    v_fma_f32 v72, v152, v56, v72
    s_nop 0
L_sm12:
    s_cbranch_execz L_retm
    v_fma_f32 v73, v153, v57, v73
    v_fma_f32 v74, v154, v58, v74
    v_fma_f32 v75, v155, v59, v75
    v_fma_f32 v76, v156, v60, v76
    v_fma_f32 v77, v157, v61, v77
    v_fma_f32 v78, v158, v62, v78
    v_fma_f32 v79, v159, v63, v79
    v_cvt_pk_bf16_f32 v72, v72, v73
    v_cvt_pk_bf16_f32 v73, v74, v75
    v_cvt_pk_bf16_f32 v74, v76, v77
    v_cvt_pk_bf16_f32 v75, v78, v79
    buffer_store_dwordx4 v[72:75], v252, s[12:15], s71 offen
    s_waitcnt vmcnt(2)
    v_dot2_f32_bf16 v88, v32, v218, 0
    v_dot2_f32_bf16 v89, v32, v219, 0
    v_dot2_f32_bf16 v90, v33, v218, 0
    v_dot2_f32_bf16 v91, v33, v219, 0
    v_dot2_f32_bf16 v92, v34, v218, 0
    v_dot2_f32_bf16 v93, v34, v219, 0
    v_dot2_f32_bf16 v94, v35, v218, 0
    v_dot2_f32_bf16 v95, v35, v219, 0
    v_dot2_f32_bf16 v88, v36, v218, v88
    v_dot2_f32_bf16 v89, v36, v219, v89
    v_dot2_f32_bf16 v90, v37, v218, v90
    v_dot2_f32_bf16 v91, v37, v219, v91
    v_dot2_f32_bf16 v92, v38, v218, v92
    v_dot2_f32_bf16 v93, v38, v219, v93
    v_dot2_f32_bf16 v94, v39, v218, v94
    v_dot2_f32_bf16 v95, v39, v219, v95
    v_dot2_f32_bf16 v88, v40, v218, v88
    v_dot2_f32_bf16 v89, v40, v219, v89
    v_dot2_f32_bf16 v90, v41, v218, v90
    v_dot2_f32_bf16 v91, v41, v219, v91
    v_dot2_f32_bf16 v92, v42, v218, v92
    v_dot2_f32_bf16 v93, v42, v219, v93
    v_dot2_f32_bf16 v94, v43, v218, v94
    v_dot2_f32_bf16 v95, v43, v219, v95
    v_dot2_f32_bf16 v88, v44, v218, v88
    v_dot2_f32_bf16 v89, v44, v219, v89
    v_dot2_f32_bf16 v90, v45, v218, v90
    v_dot2_f32_bf16 v91, v45, v219, v91
    v_dot2_f32_bf16 v92, v46, v218, v92
    v_dot2_f32_bf16 v93, v46, v219, v93
    v_dot2_f32_bf16 v94, v47, v218, v94
    v_dot2_f32_bf16 v95, v47, v219, v95
    v_exp_f32_e64 v192, -v88
    v_exp_f32_e64 v193, -v89
    v_exp_f32_e64 v194, -v90
    v_exp_f32_e64 v195, -v91
    v_exp_f32_e64 v196, -v92
    v_exp_f32_e64 v197, -v93
    v_exp_f32_e64 v198, -v94
    v_exp_f32_e64 v199, -v95
    v_mul_f32 v88, 0x3ef5fdf0, v88
    v_mul_f32 v89, 0x3ef5fdf0, v89
    v_mul_f32 v90, 0x3ef5fdf0, v90
    v_mul_f32 v91, 0x3ef5fdf0, v91
    v_mul_f32 v92, 0x3ef5fdf0, v92
    v_mul_f32 v93, 0x3ef5fdf0, v93
    v_mul_f32 v94, 0x3ef5fdf0, v94
    v_mul_f32 v95, 0x3ef5fdf0, v95
    v_add_f32 v192, 1.0, v192
    v_add_f32 v193, 1.0, v193
    v_add_f32 v194, 1.0, v194
    v_add_f32 v195, 1.0, v195
    v_add_f32 v196, 1.0, v196
    v_add_f32 v197, 1.0, v197
    v_add_f32 v198, 1.0, v198
    v_add_f32 v199, 1.0, v199
    v_rcp_f32 v192, v192
    v_rcp_f32 v193, v193
    v_rcp_f32 v194, v194
    v_rcp_f32 v195, v195
    v_rcp_f32 v196, v196
    v_rcp_f32 v197, v197
    v_rcp_f32 v198, v198
    v_rcp_f32 v199, v199
    v_mul_f32 v88, v88, v192
    v_mul_f32 v89, v89, v193
    v_mul_f32 v90, v90, v194
    v_mul_f32 v91, v91, v195
    v_mul_f32 v92, v92, v196
    v_mul_f32 v93, v93, v197
    v_mul_f32 v94, v94, v198
    v_mul_f32 v95, v95, v199
    v_fma_f32 v80, v160, v88, v80
    v_fma_f32 v81, v161, v89, v81
    v_fma_f32 v82, v162, v90, v82
    v_fma_f32 v83, v163, v91, v83
    v_fma_f32 v84, v164, v92, v84
    v_fma_f32 v85, v165, v93, v85
    v_fma_f32 v86, v166, v94, v86
    v_fma_f32 v87, v167, v95, v87
    v_cvt_pk_bf16_f32 v80, v80, v81
    v_cvt_pk_bf16_f32 v81, v82, v83
    v_cvt_pk_bf16_f32 v82, v84, v85
    v_cvt_pk_bf16_f32 v83, v86, v87
    buffer_store_dwordx4 v[80:83], v252, s[12:15], s72 offen
    s_endpgm
L_slowg:
    s_mov_b32 s5, 0
L_sping:
    s_sleep 2
    buffer_load_dword v238, v241, s[28:31], s53 offen sc1
    s_waitcnt vmcnt(0)
    v_and_b32 v238, 0xff, v238
    v_cmp_gt_u32 vcc, 16, v238
    s_cbranch_vccz L_fing
    s_add_u32 s5, s5, 1
    s_cmp_lt_u32 s5, 0x40000
    s_cbranch_scc1 L_sping
L_fing:
    s_branch L_backg
L_slowp0:
    s_mov_b32 s5, 0
L_spinp0:
    s_sleep 2
    buffer_load_dword v238, v241, s[24:27], s62 offen offset:0 sc1
    s_waitcnt vmcnt(0)
    v_cmp_ne_u32 vcc, 1, v238
    s_cbranch_vccz L_finp0
    s_add_u32 s5, s5, 1
    s_cmp_lt_u32 s5, 0x40000
    s_cbranch_scc1 L_spinp0
L_finp0:
    s_branch L_backp0
L_slowp1:
    s_mov_b32 s5, 0
L_spinp1:
    s_sleep 2
    buffer_load_dword v238, v241, s[24:27], s63 offen offset:128 sc1
    s_waitcnt vmcnt(0)
    v_cmp_ne_u32 vcc, 1, v238
    s_cbranch_vccz L_finp1
    s_add_u32 s5, s5, 1
    s_cmp_lt_u32 s5, 0x40000
    s_cbranch_scc1 L_spinp1
L_finp1:
    s_branch L_backp1
L_slowp2:
    s_mov_b32 s5, 0
L_spinp2:
    s_sleep 2
    buffer_load_dword v238, v241, s[24:27], s62 offen offset:256 sc1
    s_waitcnt vmcnt(0)
    v_cmp_ne_u32 vcc, 1, v238
    s_cbranch_vccz L_finp2
    s_add_u32 s5, s5, 1
    s_cmp_lt_u32 s5, 0x40000
    s_cbranch_scc1 L_spinp2
L_finp2:
    s_branch L_backp2
L_slowp3:
    s_mov_b32 s5, 0
L_spinp3:
    s_sleep 2
    buffer_load_dword v238, v241, s[24:27], s63 offen offset:384 sc1
    s_waitcnt vmcnt(0)
    v_cmp_ne_u32 vcc, 1, v238
    s_cbranch_vccz L_finp3
    s_add_u32 s5, s5, 1
    s_cmp_lt_u32 s5, 0x40000
    s_cbranch_scc1 L_spinp3
L_finp3:
    s_branch L_backp3
L_slowp4:
    s_mov_b32 s5, 0
L_spinp4:
    s_sleep 2
    buffer_load_dword v238, v241, s[24:27], s62 offen offset:512 sc1
    s_waitcnt vmcnt(0)
    v_cmp_ne_u32 vcc, 1, v238
    s_cbranch_vccz L_finp4
    s_add_u32 s5, s5, 1
    s_cmp_lt_u32 s5, 0x40000
    s_cbranch_scc1 L_spinp4
L_finp4:
    s_branch L_backp4
L_slowp5:
    s_mov_b32 s5, 0
L_spinp5:
    s_sleep 2
    buffer_load_dword v238, v241, s[24:27], s63 offen offset:640 sc1
    s_waitcnt vmcnt(0)
    v_cmp_ne_u32 vcc, 1, v238
    s_cbranch_vccz L_finp5
    s_add_u32 s5, s5, 1
    s_cmp_lt_u32 s5, 0x40000
    s_cbranch_scc1 L_spinp5
L_finp5:
    s_branch L_backp5
L_slowo:
    v_cmp_ne_u32 vcc, 1, v253
    s_cbranch_vccz L_fino
    s_waitcnt vmcnt(0)
    buffer_store_dword v249, v225, s[24:27], s85 offen offset:896 sc1
    v_mov_b32 v225, 0x7ffffff0
    s_mov_b32 s5, 0
L_spino:
    s_sleep 2
    buffer_load_dword v253, v245, s[24:27], 0 offen sc1
    s_waitcnt vmcnt(0)
    v_cmp_ne_u32 vcc, 1, v253
    s_cbranch_vccz L_fino
    s_add_u32 s5, s5, 1
    s_cmp_lt_u32 s5, 0x40000
    s_cbranch_scc1 L_spino
L_fino:
    s_mov_b32 s82, s37
    s_add_u32 s83, s82, 4096
    s_add_u32 s84, s82, 8192
    buffer_load_dwordx4 a[144:147], v237, s[24:27], s82 offen offset:0 sc1
    buffer_load_dwordx4 a[148:151], v237, s[24:27], s82 offen offset:1024 sc1
    buffer_load_dwordx4 a[152:155], v237, s[24:27], s82 offen offset:2048 sc1
    buffer_load_dwordx4 a[156:159], v237, s[24:27], s82 offen offset:3072 sc1
    buffer_load_dwordx4 a[160:163], v237, s[24:27], s83 offen offset:0 sc1
    buffer_load_dwordx4 a[164:167], v237, s[24:27], s83 offen offset:1024 sc1
    buffer_load_dwordx4 a[168:171], v237, s[24:27], s83 offen offset:2048 sc1
    buffer_load_dwordx4 a[172:175], v237, s[24:27], s83 offen offset:3072 sc1
    buffer_load_dwordx4 a[176:179], v237, s[24:27], s84 offen offset:0 sc1
    s_waitcnt vmcnt(0)
    s_branch L_backo
L_slowa:
    s_mov_b32 s5, 0
L_spina:
    s_sleep 2
    buffer_load_dword v238, v244, s[24:27], 0 offen offset:896 sc1
    s_waitcnt vmcnt(0)
    v_cmp_ne_u32 vcc, 1, v238
    s_cbranch_vccz L_fina
    s_add_u32 s5, s5, 1
    s_cmp_lt_u32 s5, 0x40000
    s_cbranch_scc1 L_spina
L_fina:
    v_mov_b32 v227, v237
    s_lshl_b32 s36, s70, 5
    v_add_u32 v250, s36, v227
    buffer_load_dwordx4 v[0:3], v250, s[24:27], s79 offen sc1
    buffer_load_dwordx4 v[4:7], v250, s[24:27], s80 offen sc1
    buffer_load_dwordx4 v[8:11], v250, s[24:27], s81 offen sc1
    s_lshl_b32 s36, s71, 5
    v_add_u32 v250, s36, v227
    buffer_load_dwordx4 v[16:19], v250, s[24:27], s79 offen sc1
    buffer_load_dwordx4 v[20:23], v250, s[24:27], s80 offen sc1
    buffer_load_dwordx4 v[24:27], v250, s[24:27], s81 offen sc1
    s_lshl_b32 s36, s72, 5
    v_add_u32 v250, s36, v227
    buffer_load_dwordx4 v[32:35], v250, s[24:27], s79 offen sc1
    buffer_load_dwordx4 v[36:39], v250, s[24:27], s80 offen sc1
    buffer_load_dwordx4 v[40:43], v250, s[24:27], s81 offen sc1
    s_branch L_backa
L1_end:
.section .rodata,"a"
.p2align 6
.amdhsa_kernel recurrent_scan__linear_kernel_hedgehog__dense_activation_mish__prompt_kernel
  .amdhsa_next_free_vgpr 512
  .amdhsa_next_free_sgpr 102
  .amdhsa_accum_offset 256
  .amdhsa_group_segment_fixed_size 0
  .amdhsa_kernarg_size 88
  .amdhsa_user_sgpr_count 2
  .amdhsa_user_sgpr_kernarg_segment_ptr 1
  .amdhsa_system_sgpr_workgroup_id_x 1
.end_amdhsa_kernel
```
